```python
import torch

def _softmax(x, axis=-1):
    return torch.softmax(x, dim=axis)

def _gelu(x):
    return torch.nn.functional.gelu(x, approximate='tanh')

def _silu(x):
    return torch.nn.functional.silu(x)

def _sigmoid(x):
    return torch.sigmoid(x)

def _layernorm(x, axis=-1, eps=1e-05):
    m = x.mean(dim=axis, keepdim=True)
    v = x.var(dim=axis, keepdim=True, unbiased=False)
    return (x - m) / torch.sqrt(v + eps)

def _scatter_add(tgt, idx, src, axis=0):
    return tgt.clone().index_add_(axis, idx, src)

def _segment_sum(src, seg, n):
    out = torch.zeros((n,) + src.shape[1:], dtype=src.dtype)
    return out.index_add_(0, seg, src)

def _pad(x, pw):
    flat = tuple((v for pair in reversed(pw) for v in pair))
    return torch.nn.functional.pad(x, flat)
kernel_name = 'interleave_layers__linear_kernel_hedgehog__mixer_gmlp__prompt'

def setup_inputs():

    _w = lambda a: (lambda t: t.to(torch.bfloat16) if t.is_floating_point() else t)(torch.as_tensor(a))

    def _A_setup():
        B, S, D, H = (1, 2048, 640, 32)
        Dh = D // H
        return {'x': _w((lambda *s: torch.randn(*s, dtype=torch.bfloat16) * 0.05)(B, S, D)), 'wqkv': _w((lambda *s: torch.randn(*s, dtype=torch.bfloat16) * 0.4)(D, 3 * D)), 'w_phi': _w((lambda *s: torch.randn(*s, dtype=torch.bfloat16) * 0.4)(H, Dh, Dh) * Dh ** (-0.5)), 'wo': _w((lambda *s: torch.randn(*s, dtype=torch.bfloat16) * 0.05)(D, D))}
    _A_in = _A_setup()

    def _B_setup():
        B, S, D, F = (1, 2048, 640, 1536)
        Fh = F // 2
        return {'x': _w((lambda *s: torch.randn(*s, dtype=torch.bfloat16) * 0.05)(B, S, D)), 'w_in': _w((lambda *s: torch.randn(*s, dtype=torch.bfloat16) * 0.4)(D, 2 * Fh)), 'w_sp': _w(0.01 * (lambda *s: torch.randn(*s, dtype=torch.bfloat16) * 0.4)(S, S)), 'b_sp': _w(1.0 + 0.01 * (lambda *s: torch.randn(*s, dtype=torch.bfloat16) * 0.05)(S)), 'w_out': _w((lambda *s: torch.randn(*s, dtype=torch.bfloat16) * 0.05)(Fh, D))}
    _B_in = _B_setup()
    return {'A_x': _A_in['x'], 'A_wqkv': _A_in['wqkv'], 'A_w_phi': _A_in['w_phi'], 'A_wo': _A_in['wo'], 'B_x': _B_in['x'], 'B_w_in': _B_in['w_in'], 'B_w_sp': _B_in['w_sp'], 'B_b_sp': _B_in['b_sp'], 'B_w_out': _B_in['w_out']}

def reference(A_x, A_wqkv, A_w_phi, A_wo, B_x, B_w_in, B_w_sp, B_b_sp, B_w_out):

    def _A_ref(x, wqkv, w_phi, wo):
        B, S, D = x.shape
        H = 32
        Dh = D // H
        qkv = (lambda x, *d: x.permute(*d))((x @ wqkv).reshape(B, S, 3, H, Dh), 2, 0, 3, 1, 4)
        q, k, v = (qkv[0], qkv[1], qkv[2])
        pq = torch.einsum('bhsd,hdf->bhsf', q, w_phi)
        pk = torch.einsum('bhsd,hdf->bhsf', k, w_phi)
        phi_q = torch.concatenate([_softmax(pq, axis=-1), _softmax(-pq, axis=-1)], axis=-1)
        phi_k = torch.concatenate([_softmax(pk, axis=-1), _softmax(-pk, axis=-1)], axis=-1)
        kv = torch.einsum('bhsf,bhsd->bhfd', phi_k, v)
        z = torch.einsum('bhsf->bhf', phi_k)
        num = torch.einsum('bhqf,bhfd->bhqd', phi_q, kv)
        den = torch.einsum('bhqf,bhf->bhq', phi_q, z)[..., None] + 1e-06
        o = num / den
        return (lambda x, *d: x.permute(*d))(o, 0, 2, 1, 3).reshape(B, S, D) @ wo

    def _B_ref(x, w_in, w_sp, b_sp, w_out):
        B, S, D = x.shape
        F = w_in.shape[-1]
        Fh = F // 2
        z = _gelu(torch.einsum('bsd,df->bsf', x, w_in))
        z1 = z[..., :Fh].clone()
        z2 = _layernorm(z[..., Fh:], axis=-1)
        g = torch.einsum('ts,bsf->btf', w_sp, z2) + b_sp[None, :, None]
        return torch.einsum('bsf,fd->bsd', z1 * g, w_out)
    x = A_x
    x = x + _A_ref(_layernorm(x, axis=-1), A_wqkv, A_w_phi, A_wo)
    x = x + _B_ref(_layernorm(x, axis=-1), B_w_in, B_w_sp, B_b_sp, B_w_out)
    x = x + _A_ref(_layernorm(x, axis=-1), A_wqkv, A_w_phi, A_wo)
    x = x + _B_ref(_layernorm(x, axis=-1), B_w_in, B_w_sp, B_b_sp, B_w_out)
    return x
```

```asm
; @launch kernel=prep_kernel grid=(620,1,1) block=(256,1,1) lds=2048
; @launch kernel=qkv0_kernel grid=(240,1,1) block=(512,1,1) lds=131072
; @launch kernel=kv_kernel grid=(256,1,1) block=(256,1,1) lds=32768
; @launch kernel=attn_kernel grid=(256,1,1) block=(256,1,1) lds=8192
; @launch kernel=wo0_kernel grid=(160,1,1) block=(512,1,1) lds=98304
; @launch kernel=win0_kernel grid=(192,1,1) block=(512,1,1) lds=131072
; @launch kernel=lnz_kernel grid=(512,1,1) block=(256,1,1) lds=0
; @launch kernel=sp_kernel grid=(192,1,1) block=(512,1,1) lds=98304
; @launch kernel=wout0_kernel grid=(160,1,1) block=(512,1,1) lds=98304
; @launch kernel=qkv1_kernel grid=(240,1,1) block=(512,1,1) lds=131072
; @launch kernel=kv_kernel grid=(256,1,1) block=(256,1,1) lds=32768
; @launch kernel=attn_kernel grid=(256,1,1) block=(256,1,1) lds=8192
; @launch kernel=wo1_kernel grid=(160,1,1) block=(512,1,1) lds=98304
; @launch kernel=win1_kernel grid=(192,1,1) block=(512,1,1) lds=131072
; @launch kernel=lnz_kernel grid=(512,1,1) block=(256,1,1) lds=0
; @launch kernel=sp_kernel grid=(192,1,1) block=(512,1,1) lds=98304
; @launch kernel=wout1_kernel grid=(160,1,1) block=(512,1,1) lds=98304
.amdgcn_target "amdgcn-amd-amdhsa--gfx950"
.text
.globl prep_kernel
.p2align 8
.type prep_kernel,@function
prep_kernel:
    s_cmp_ge_u32 s2, 620
    s_cbranch_scc1 Lend_prep_kernel_1
    v_and_b32 v1, 63, v0
    v_lshrrev_b32 v2, 6, v0
    s_cmp_ge_u32 s2, 512
    s_cbranch_scc1 Lcol_prep_kernel_2
    s_load_dwordx2 s[4:5], s[0:1], 0
    s_load_dwordx2 s[6:7], s[0:1], 88
    s_waitcnt lgkmcnt(0)
    s_mov_b32 s8, s4
    s_mov_b32 s9, s5
    s_mov_b32 s10, 2621440
    s_mov_b32 s11, 0x00020000
    s_add_u32 s12, s6, 37748736
    s_addc_u32 s13, s7, 0
    s_mov_b32 s14, 163840
    s_mov_b32 s15, 0x00020000
    s_lshl_b32 s16, s2, 2
    v_add_u32 v2, s16, v2
    v_mul_u32_u24 v3, 1280, v2
    v_lshl_add_u32 v3, v1, 2, v3
    buffer_load_dword v8, v3, s[8:11], 0 offen offset:0
    buffer_load_dword v9, v3, s[8:11], 0 offen offset:256
    buffer_load_dword v10, v3, s[8:11], 0 offen offset:512
    buffer_load_dword v11, v3, s[8:11], 0 offen offset:768
    buffer_load_dword v12, v3, s[8:11], 0 offen offset:1024
    s_waitcnt vmcnt(0)
    v_mov_b32 v4, 0
    v_mov_b32 v5, 0
    v_lshlrev_b32 v6, 16, v8
    v_and_b32 v7, 0xffff0000, v8
    v_add_f32 v4, v4, v6
    v_fmac_f32 v5, v6, v6
    v_add_f32 v4, v4, v7
    v_fmac_f32 v5, v7, v7
    v_lshlrev_b32 v6, 16, v9
    v_and_b32 v7, 0xffff0000, v9
    v_add_f32 v4, v4, v6
    v_fmac_f32 v5, v6, v6
    v_add_f32 v4, v4, v7
    v_fmac_f32 v5, v7, v7
    v_lshlrev_b32 v6, 16, v10
    v_and_b32 v7, 0xffff0000, v10
    v_add_f32 v4, v4, v6
    v_fmac_f32 v5, v6, v6
    v_add_f32 v4, v4, v7
    v_fmac_f32 v5, v7, v7
    v_lshlrev_b32 v6, 16, v11
    v_and_b32 v7, 0xffff0000, v11
    v_add_f32 v4, v4, v6
    v_fmac_f32 v5, v6, v6
    v_add_f32 v4, v4, v7
    v_fmac_f32 v5, v7, v7
    v_lshlrev_b32 v6, 16, v12
    v_and_b32 v7, 0xffff0000, v12
    v_add_f32 v4, v4, v6
    v_fmac_f32 v5, v6, v6
    v_add_f32 v4, v4, v7
    v_fmac_f32 v5, v7, v7
    s_nop 1
    v_add_f32_dpp v6, v4, v4 row_ror:8 row_mask:0xf bank_mask:0xf
    v_mov_b32 v4, v6
    s_nop 1
    v_add_f32_dpp v6, v4, v4 row_ror:4 row_mask:0xf bank_mask:0xf
    v_mov_b32 v4, v6
    s_nop 1
    v_add_f32_dpp v6, v4, v4 row_ror:2 row_mask:0xf bank_mask:0xf
    v_mov_b32 v4, v6
    s_nop 1
    v_add_f32_dpp v6, v4, v4 row_ror:1 row_mask:0xf bank_mask:0xf
    v_mov_b32 v4, v6
    s_nop 1
    v_readlane_b32 s20, v4, 0
    v_readlane_b32 s21, v4, 16
    v_readlane_b32 s22, v4, 32
    v_readlane_b32 s23, v4, 48
    s_nop 1
    v_mov_b32 v4, s20
    v_add_f32 v4, s21, v4
    v_add_f32 v4, s22, v4
    v_add_f32 v4, s23, v4
    s_nop 1
    v_add_f32_dpp v6, v5, v5 row_ror:8 row_mask:0xf bank_mask:0xf
    v_mov_b32 v5, v6
    s_nop 1
    v_add_f32_dpp v6, v5, v5 row_ror:4 row_mask:0xf bank_mask:0xf
    v_mov_b32 v5, v6
    s_nop 1
    v_add_f32_dpp v6, v5, v5 row_ror:2 row_mask:0xf bank_mask:0xf
    v_mov_b32 v5, v6
    s_nop 1
    v_add_f32_dpp v6, v5, v5 row_ror:1 row_mask:0xf bank_mask:0xf
    v_mov_b32 v5, v6
    s_nop 1
    v_readlane_b32 s20, v5, 0
    v_readlane_b32 s21, v5, 16
    v_readlane_b32 s22, v5, 32
    v_readlane_b32 s23, v5, 48
    s_nop 1
    v_mov_b32 v5, s20
    v_add_f32 v5, s21, v5
    v_add_f32 v5, s22, v5
    v_add_f32 v5, s23, v5
    v_mov_b32 v6, 0
    v_cmp_eq_u32 vcc, 0, v1
    s_nop 1
    v_cndmask_b32 v6, v6, v4, vcc
    v_cmp_eq_u32 vcc, 1, v1
    s_nop 1
    v_cndmask_b32 v6, v6, v5, vcc
    v_mul_u32_u24 v3, 80, v2
    v_lshl_add_u32 v3, v1, 2, v3
    v_cmp_gt_u32 vcc, 20, v1
    s_and_saveexec_b64 s[24:25], vcc
    buffer_store_dword v6, v3, s[12:15], 0 offen
    s_mov_b64 exec, s[24:25]
    s_endpgm
Lcol_prep_kernel_2:
    s_sub_u32 s16, s2, 512
    s_cmp_ge_u32 s16, 60
    s_cbranch_scc1 Lsel2_prep_kernel_3
    s_load_dwordx2 s[4:5], s[0:1], 8
    s_load_dwordx2 s[6:7], s[0:1], 88
    s_waitcnt lgkmcnt(0)
    s_mov_b32 s8, s4
    s_mov_b32 s9, s5
    s_mov_b32 s10, 2457600
    s_mov_b32 s11, 0x00020000
    s_add_u32 s12, s6, 39845888
    s_addc_u32 s13, s7, 0
    s_mov_b32 s14, 7680
    s_mov_b32 s15, 0x00020000
    s_mov_b32 s17, 3840
    s_branch Lgo_prep_kernel_4
Lsel2_prep_kernel_3:
    s_sub_u32 s16, s16, 60
    s_load_dwordx2 s[4:5], s[0:1], 40
    s_load_dwordx2 s[6:7], s[0:1], 88
    s_waitcnt lgkmcnt(0)
    s_mov_b32 s8, s4
    s_mov_b32 s9, s5
    s_mov_b32 s10, 1966080
    s_mov_b32 s11, 0x00020000
    s_add_u32 s12, s6, 39911424
    s_addc_u32 s13, s7, 0
    s_mov_b32 s14, 6144
    s_mov_b32 s15, 0x00020000
    s_mov_b32 s17, 3072
Lgo_prep_kernel_4:
    v_and_b32 v6, 15, v1
    v_lshrrev_b32 v7, 4, v1
    v_mul_u32_u24 v3, 160, v2
    v_add_u32 v3, v3, v7
    v_mul_lo_u32 v3, v3, s17
    s_lshl_b32 s18, s16, 6
    v_lshl_add_u32 v3, v6, 2, v3
    v_add_u32 v3, s18, v3
    v_mov_b32 v4, 0
    v_mov_b32 v5, 0
    s_lshl_b32 s19, s17, 2
    s_mul_i32 s22, s19, 0
    buffer_load_dword v8, v3, s[8:11], s22 offen
    s_mul_i32 s22, s19, 1
    buffer_load_dword v9, v3, s[8:11], s22 offen
    s_mul_i32 s22, s19, 2
    buffer_load_dword v10, v3, s[8:11], s22 offen
    s_mul_i32 s22, s19, 3
    buffer_load_dword v11, v3, s[8:11], s22 offen
    s_mul_i32 s22, s19, 4
    buffer_load_dword v12, v3, s[8:11], s22 offen
    s_mul_i32 s22, s19, 5
    buffer_load_dword v13, v3, s[8:11], s22 offen
    s_mul_i32 s22, s19, 6
    buffer_load_dword v14, v3, s[8:11], s22 offen
    s_mul_i32 s22, s19, 7
    buffer_load_dword v15, v3, s[8:11], s22 offen
    s_mul_i32 s22, s19, 8
    buffer_load_dword v16, v3, s[8:11], s22 offen
    s_mul_i32 s22, s19, 9
    buffer_load_dword v17, v3, s[8:11], s22 offen
    s_mul_i32 s22, s19, 10
    buffer_load_dword v18, v3, s[8:11], s22 offen
    s_mul_i32 s22, s19, 11
    buffer_load_dword v19, v3, s[8:11], s22 offen
    s_mul_i32 s22, s19, 12
    buffer_load_dword v20, v3, s[8:11], s22 offen
    s_mul_i32 s22, s19, 13
    buffer_load_dword v21, v3, s[8:11], s22 offen
    s_mul_i32 s22, s19, 14
    buffer_load_dword v22, v3, s[8:11], s22 offen
    s_mul_i32 s22, s19, 15
    buffer_load_dword v23, v3, s[8:11], s22 offen
    s_mul_i32 s22, s19, 16
    buffer_load_dword v24, v3, s[8:11], s22 offen
    s_mul_i32 s22, s19, 17
    buffer_load_dword v25, v3, s[8:11], s22 offen
    s_mul_i32 s22, s19, 18
    buffer_load_dword v26, v3, s[8:11], s22 offen
    s_mul_i32 s22, s19, 19
    buffer_load_dword v27, v3, s[8:11], s22 offen
    s_waitcnt vmcnt(0)
    v_lshlrev_b32 v6, 16, v8
    v_and_b32 v7, 0xffff0000, v8
    v_add_f32 v4, v4, v6
    v_add_f32 v5, v5, v7
    v_lshlrev_b32 v6, 16, v9
    v_and_b32 v7, 0xffff0000, v9
    v_add_f32 v4, v4, v6
    v_add_f32 v5, v5, v7
    v_lshlrev_b32 v6, 16, v10
    v_and_b32 v7, 0xffff0000, v10
    v_add_f32 v4, v4, v6
    v_add_f32 v5, v5, v7
    v_lshlrev_b32 v6, 16, v11
    v_and_b32 v7, 0xffff0000, v11
    v_add_f32 v4, v4, v6
    v_add_f32 v5, v5, v7
    v_lshlrev_b32 v6, 16, v12
    v_and_b32 v7, 0xffff0000, v12
    v_add_f32 v4, v4, v6
    v_add_f32 v5, v5, v7
    v_lshlrev_b32 v6, 16, v13
    v_and_b32 v7, 0xffff0000, v13
    v_add_f32 v4, v4, v6
    v_add_f32 v5, v5, v7
    v_lshlrev_b32 v6, 16, v14
    v_and_b32 v7, 0xffff0000, v14
    v_add_f32 v4, v4, v6
    v_add_f32 v5, v5, v7
    v_lshlrev_b32 v6, 16, v15
    v_and_b32 v7, 0xffff0000, v15
    v_add_f32 v4, v4, v6
    v_add_f32 v5, v5, v7
    v_lshlrev_b32 v6, 16, v16
    v_and_b32 v7, 0xffff0000, v16
    v_add_f32 v4, v4, v6
    v_add_f32 v5, v5, v7
    v_lshlrev_b32 v6, 16, v17
    v_and_b32 v7, 0xffff0000, v17
    v_add_f32 v4, v4, v6
    v_add_f32 v5, v5, v7
    v_lshlrev_b32 v6, 16, v18
    v_and_b32 v7, 0xffff0000, v18
    v_add_f32 v4, v4, v6
    v_add_f32 v5, v5, v7
    v_lshlrev_b32 v6, 16, v19
    v_and_b32 v7, 0xffff0000, v19
    v_add_f32 v4, v4, v6
    v_add_f32 v5, v5, v7
    v_lshlrev_b32 v6, 16, v20
    v_and_b32 v7, 0xffff0000, v20
    v_add_f32 v4, v4, v6
    v_add_f32 v5, v5, v7
    v_lshlrev_b32 v6, 16, v21
    v_and_b32 v7, 0xffff0000, v21
    v_add_f32 v4, v4, v6
    v_add_f32 v5, v5, v7
    v_lshlrev_b32 v6, 16, v22
    v_and_b32 v7, 0xffff0000, v22
    v_add_f32 v4, v4, v6
    v_add_f32 v5, v5, v7
    v_lshlrev_b32 v6, 16, v23
    v_and_b32 v7, 0xffff0000, v23
    v_add_f32 v4, v4, v6
    v_add_f32 v5, v5, v7
    v_lshlrev_b32 v6, 16, v24
    v_and_b32 v7, 0xffff0000, v24
    v_add_f32 v4, v4, v6
    v_add_f32 v5, v5, v7
    v_lshlrev_b32 v6, 16, v25
    v_and_b32 v7, 0xffff0000, v25
    v_add_f32 v4, v4, v6
    v_add_f32 v5, v5, v7
    v_lshlrev_b32 v6, 16, v26
    v_and_b32 v7, 0xffff0000, v26
    v_add_f32 v4, v4, v6
    v_add_f32 v5, v5, v7
    v_lshlrev_b32 v6, 16, v27
    v_and_b32 v7, 0xffff0000, v27
    v_add_f32 v4, v4, v6
    v_add_f32 v5, v5, v7
    s_mul_i32 s22, s19, 20
    buffer_load_dword v8, v3, s[8:11], s22 offen
    s_mul_i32 s22, s19, 21
    buffer_load_dword v9, v3, s[8:11], s22 offen
    s_mul_i32 s22, s19, 22
    buffer_load_dword v10, v3, s[8:11], s22 offen
    s_mul_i32 s22, s19, 23
    buffer_load_dword v11, v3, s[8:11], s22 offen
    s_mul_i32 s22, s19, 24
    buffer_load_dword v12, v3, s[8:11], s22 offen
    s_mul_i32 s22, s19, 25
    buffer_load_dword v13, v3, s[8:11], s22 offen
    s_mul_i32 s22, s19, 26
    buffer_load_dword v14, v3, s[8:11], s22 offen
    s_mul_i32 s22, s19, 27
    buffer_load_dword v15, v3, s[8:11], s22 offen
    s_mul_i32 s22, s19, 28
    buffer_load_dword v16, v3, s[8:11], s22 offen
    s_mul_i32 s22, s19, 29
    buffer_load_dword v17, v3, s[8:11], s22 offen
    s_mul_i32 s22, s19, 30
    buffer_load_dword v18, v3, s[8:11], s22 offen
    s_mul_i32 s22, s19, 31
    buffer_load_dword v19, v3, s[8:11], s22 offen
    s_mul_i32 s22, s19, 32
    buffer_load_dword v20, v3, s[8:11], s22 offen
    s_mul_i32 s22, s19, 33
    buffer_load_dword v21, v3, s[8:11], s22 offen
    s_mul_i32 s22, s19, 34
    buffer_load_dword v22, v3, s[8:11], s22 offen
    s_mul_i32 s22, s19, 35
    buffer_load_dword v23, v3, s[8:11], s22 offen
    s_mul_i32 s22, s19, 36
    buffer_load_dword v24, v3, s[8:11], s22 offen
    s_mul_i32 s22, s19, 37
    buffer_load_dword v25, v3, s[8:11], s22 offen
    s_mul_i32 s22, s19, 38
    buffer_load_dword v26, v3, s[8:11], s22 offen
    s_mul_i32 s22, s19, 39
    buffer_load_dword v27, v3, s[8:11], s22 offen
    s_waitcnt vmcnt(0)
    v_lshlrev_b32 v6, 16, v8
    v_and_b32 v7, 0xffff0000, v8
    v_add_f32 v4, v4, v6
    v_add_f32 v5, v5, v7
    v_lshlrev_b32 v6, 16, v9
    v_and_b32 v7, 0xffff0000, v9
    v_add_f32 v4, v4, v6
    v_add_f32 v5, v5, v7
    v_lshlrev_b32 v6, 16, v10
    v_and_b32 v7, 0xffff0000, v10
    v_add_f32 v4, v4, v6
    v_add_f32 v5, v5, v7
    v_lshlrev_b32 v6, 16, v11
    v_and_b32 v7, 0xffff0000, v11
    v_add_f32 v4, v4, v6
    v_add_f32 v5, v5, v7
    v_lshlrev_b32 v6, 16, v12
    v_and_b32 v7, 0xffff0000, v12
    v_add_f32 v4, v4, v6
    v_add_f32 v5, v5, v7
    v_lshlrev_b32 v6, 16, v13
    v_and_b32 v7, 0xffff0000, v13
    v_add_f32 v4, v4, v6
    v_add_f32 v5, v5, v7
    v_lshlrev_b32 v6, 16, v14
    v_and_b32 v7, 0xffff0000, v14
    v_add_f32 v4, v4, v6
    v_add_f32 v5, v5, v7
    v_lshlrev_b32 v6, 16, v15
    v_and_b32 v7, 0xffff0000, v15
    v_add_f32 v4, v4, v6
    v_add_f32 v5, v5, v7
    v_lshlrev_b32 v6, 16, v16
    v_and_b32 v7, 0xffff0000, v16
    v_add_f32 v4, v4, v6
    v_add_f32 v5, v5, v7
    v_lshlrev_b32 v6, 16, v17
    v_and_b32 v7, 0xffff0000, v17
    v_add_f32 v4, v4, v6
    v_add_f32 v5, v5, v7
    v_lshlrev_b32 v6, 16, v18
    v_and_b32 v7, 0xffff0000, v18
    v_add_f32 v4, v4, v6
    v_add_f32 v5, v5, v7
    v_lshlrev_b32 v6, 16, v19
    v_and_b32 v7, 0xffff0000, v19
    v_add_f32 v4, v4, v6
    v_add_f32 v5, v5, v7
    v_lshlrev_b32 v6, 16, v20
    v_and_b32 v7, 0xffff0000, v20
    v_add_f32 v4, v4, v6
    v_add_f32 v5, v5, v7
    v_lshlrev_b32 v6, 16, v21
    v_and_b32 v7, 0xffff0000, v21
    v_add_f32 v4, v4, v6
    v_add_f32 v5, v5, v7
    v_lshlrev_b32 v6, 16, v22
    v_and_b32 v7, 0xffff0000, v22
    v_add_f32 v4, v4, v6
    v_add_f32 v5, v5, v7
    v_lshlrev_b32 v6, 16, v23
    v_and_b32 v7, 0xffff0000, v23
    v_add_f32 v4, v4, v6
    v_add_f32 v5, v5, v7
    v_lshlrev_b32 v6, 16, v24
    v_and_b32 v7, 0xffff0000, v24
    v_add_f32 v4, v4, v6
    v_add_f32 v5, v5, v7
    v_lshlrev_b32 v6, 16, v25
    v_and_b32 v7, 0xffff0000, v25
    v_add_f32 v4, v4, v6
    v_add_f32 v5, v5, v7
    v_lshlrev_b32 v6, 16, v26
    v_and_b32 v7, 0xffff0000, v26
    v_add_f32 v4, v4, v6
    v_add_f32 v5, v5, v7
    v_lshlrev_b32 v6, 16, v27
    v_and_b32 v7, 0xffff0000, v27
    v_add_f32 v4, v4, v6
    v_add_f32 v5, v5, v7
    v_lshlrev_b32 v6, 3, v0
    ds_write_b64 v6, v[4:5]
    s_waitcnt lgkmcnt(0)
    s_barrier
    v_lshlrev_b32 v6, 3, v0
    ds_read_b64 v[8:9], v6 offset:0
    ds_read_b64 v[10:11], v6 offset:128
    ds_read_b64 v[12:13], v6 offset:256
    ds_read_b64 v[14:15], v6 offset:384
    ds_read_b64 v[16:17], v6 offset:512
    ds_read_b64 v[18:19], v6 offset:640
    ds_read_b64 v[20:21], v6 offset:768
    ds_read_b64 v[22:23], v6 offset:896
    ds_read_b64 v[24:25], v6 offset:1024
    ds_read_b64 v[26:27], v6 offset:1152
    ds_read_b64 v[28:29], v6 offset:1280
    ds_read_b64 v[30:31], v6 offset:1408
    ds_read_b64 v[32:33], v6 offset:1536
    ds_read_b64 v[34:35], v6 offset:1664
    ds_read_b64 v[36:37], v6 offset:1792
    ds_read_b64 v[38:39], v6 offset:1920
    s_waitcnt lgkmcnt(0)
    v_add_f32 v8, v8, v10
    v_add_f32 v9, v9, v11
    v_add_f32 v8, v8, v12
    v_add_f32 v9, v9, v13
    v_add_f32 v8, v8, v14
    v_add_f32 v9, v9, v15
    v_add_f32 v8, v8, v16
    v_add_f32 v9, v9, v17
    v_add_f32 v8, v8, v18
    v_add_f32 v9, v9, v19
    v_add_f32 v8, v8, v20
    v_add_f32 v9, v9, v21
    v_add_f32 v8, v8, v22
    v_add_f32 v9, v9, v23
    v_add_f32 v8, v8, v24
    v_add_f32 v9, v9, v25
    v_add_f32 v8, v8, v26
    v_add_f32 v9, v9, v27
    v_add_f32 v8, v8, v28
    v_add_f32 v9, v9, v29
    v_add_f32 v8, v8, v30
    v_add_f32 v9, v9, v31
    v_add_f32 v8, v8, v32
    v_add_f32 v9, v9, v33
    v_add_f32 v8, v8, v34
    v_add_f32 v9, v9, v35
    v_add_f32 v8, v8, v36
    v_add_f32 v9, v9, v37
    v_add_f32 v8, v8, v38
    v_add_f32 v9, v9, v39
    s_lshl_b32 s18, s16, 7
    v_add_u32 v6, s18, v6
    v_cmp_gt_u32 vcc, 16, v0
    s_and_saveexec_b64 s[24:25], vcc
    buffer_store_dwordx2 v[8:9], v6, s[12:15], 0 offen
    s_mov_b64 exec, s[24:25]
Lend_prep_kernel_1:
    s_endpgm
.section .rodata,"a"
.p2align 6
.amdhsa_kernel prep_kernel
  .amdhsa_next_free_vgpr 48
  .amdhsa_next_free_sgpr 32
  .amdhsa_accum_offset 48
  .amdhsa_group_segment_fixed_size 0
  .amdhsa_kernarg_size 96
  .amdhsa_user_sgpr_count 2
  .amdhsa_user_sgpr_kernarg_segment_ptr 1
  .amdhsa_system_sgpr_workgroup_id_x 1
.end_amdhsa_kernel
.text

.globl qkv0_kernel
.p2align 8
.type qkv0_kernel,@function
qkv0_kernel:
    s_cmp_ge_u32 s2, 240
    s_cbranch_scc1 Lend_qkv0_kernel_1
    s_load_dwordx2 s[4:5], s[0:1], 0
    s_load_dwordx2 s[6:7], s[0:1], 8
    s_load_dwordx2 s[24:25], s[0:1], 88
    s_and_b32 s26, s2, 7
    s_lshr_b32 s27, s2, 3
    s_mul_i32 s26, s26, 30
    s_add_u32 s26, s26, s27
    s_mul_hi_u32 s27, s26, 286331154
    s_mul_i32 s28, s27, 15
    s_sub_u32 s28, s26, s28
    s_mul_i32 s27, s27, 128
    s_mul_i32 s28, s28, 128
    s_waitcnt lgkmcnt(0)
    s_mov_b32 s8, s4
    s_mov_b32 s9, s5
    s_mov_b32 s10, 2621440
    s_mov_b32 s11, 0x00020000
    s_mov_b32 s12, s6
    s_mov_b32 s13, s7
    s_mov_b32 s14, 2457600
    s_mov_b32 s15, 0x00020000
    s_add_u32 s16, s24, 5242880
    s_addc_u32 s17, s25, 0
    s_mov_b32 s18, 7864320
    s_mov_b32 s19, 0x00020000
    v_and_b32 v1, 63, v0
    v_lshrrev_b32 v2, 6, v0
    s_nop 0
    v_readfirstlane_b32 s41, v2
    s_nop 3
    s_cmp_ge_u32 s41, 4
    s_cbranch_scc1 Lloader_qkv0_kernel_2
    v_lshrrev_b32 v3, 1, v2
    v_and_b32 v4, 1, v2
    v_lshrrev_b32 v5, 4, v1
    v_and_b32 v6, 15, v1
    v_mul_u32_u24 v7, 64, v3
    v_add_u32 v7, v7, v6
    v_lshlrev_b32 v7, 7, v7
    v_add_u32 v18, 0, v5
    v_and_b32 v3, 7, v6
    v_xor_b32 v18, v18, v3
    v_lshl_add_u32 v18, v18, 4, v7
    v_add_u32 v26, 65536, v18
    v_add_u32 v19, 4, v5
    v_and_b32 v3, 7, v6
    v_xor_b32 v19, v19, v3
    v_lshl_add_u32 v19, v19, 4, v7
    v_add_u32 v27, 65536, v19
    v_lshrrev_b32 v3, 2, v6
    v_and_b32 v7, 1, v5
    v_lshl_add_u32 v7, v7, 2, v3
    v_lshl_add_u32 v32, v5, 3, v3
    v_lshlrev_b32 v32, 8, v32
    v_and_b32 v33, 3, v6
    v_lshl_add_u32 v32, v33, 3, v32
    v_lshlrev_b32 v33, 2, v4
    v_add_u32 v34, 0, v33
    v_xor_b32 v34, v34, v7
    v_lshl_add_u32 v20, v34, 5, v32
    v_add_u32 v28, 65536, v20
    v_add_u32 v34, 1, v33
    v_xor_b32 v34, v34, v7
    v_lshl_add_u32 v21, v34, 5, v32
    v_add_u32 v29, 65536, v21
    v_add_u32 v34, 2, v33
    v_xor_b32 v34, v34, v7
    v_lshl_add_u32 v22, v34, 5, v32
    v_add_u32 v30, 65536, v22
    v_add_u32 v34, 3, v33
    v_xor_b32 v34, v34, v7
    v_lshl_add_u32 v23, v34, 5, v32
    v_add_u32 v31, 65536, v23
    s_load_dwordx2 s[36:37], s[0:1], 88
    s_waitcnt lgkmcnt(0)
    s_add_u32 s20, s36, 37748736
    s_addc_u32 s21, s37, 0
    s_mov_b32 s22, 163840
    s_mov_b32 s23, 0x00020000
    v_lshrrev_b32 v3, 1, v2
    v_and_b32 v6, 15, v1
    v_mul_u32_u24 v3, 64, v3
    v_add_u32 v3, v3, v6
    v_add_u32 v3, s27, v3
    v_mul_u32_u24 v3, 80, v3
    buffer_load_dwordx4 v[32:35], v3, s[20:23], 0 offen offset:0
    buffer_load_dwordx4 v[36:39], v3, s[20:23], 0 offen offset:16
    buffer_load_dwordx4 v[40:43], v3, s[20:23], 0 offen offset:32
    buffer_load_dwordx4 v[44:47], v3, s[20:23], 0 offen offset:48
    buffer_load_dwordx4 v[48:51], v3, s[20:23], 0 offen offset:64
    buffer_load_dwordx4 v[52:55], v3, s[20:23], 0 offen offset:1280
    buffer_load_dwordx4 v[56:59], v3, s[20:23], 0 offen offset:1296
    buffer_load_dwordx4 v[60:63], v3, s[20:23], 0 offen offset:1312
    buffer_load_dwordx4 v[64:67], v3, s[20:23], 0 offen offset:1328
    buffer_load_dwordx4 v[68:71], v3, s[20:23], 0 offen offset:1344
    buffer_load_dwordx4 v[72:75], v3, s[20:23], 0 offen offset:2560
    buffer_load_dwordx4 v[76:79], v3, s[20:23], 0 offen offset:2576
    buffer_load_dwordx4 v[80:83], v3, s[20:23], 0 offen offset:2592
    buffer_load_dwordx4 v[84:87], v3, s[20:23], 0 offen offset:2608
    buffer_load_dwordx4 v[88:91], v3, s[20:23], 0 offen offset:2624
    buffer_load_dwordx4 v[92:95], v3, s[20:23], 0 offen offset:3840
    buffer_load_dwordx4 v[96:99], v3, s[20:23], 0 offen offset:3856
    buffer_load_dwordx4 v[100:103], v3, s[20:23], 0 offen offset:3872
    buffer_load_dwordx4 v[104:107], v3, s[20:23], 0 offen offset:3888
    buffer_load_dwordx4 v[108:111], v3, s[20:23], 0 offen offset:3904
    s_waitcnt vmcnt(0)
    v_add_f32 v8, v32, v34
    v_add_f32 v12, v33, v35
    v_add_f32 v8, v8, v36
    v_add_f32 v12, v12, v37
    v_add_f32 v8, v8, v38
    v_add_f32 v12, v12, v39
    v_add_f32 v8, v8, v40
    v_add_f32 v12, v12, v41
    v_add_f32 v8, v8, v42
    v_add_f32 v12, v12, v43
    v_add_f32 v8, v8, v44
    v_add_f32 v12, v12, v45
    v_add_f32 v8, v8, v46
    v_add_f32 v12, v12, v47
    v_add_f32 v8, v8, v48
    v_add_f32 v12, v12, v49
    v_add_f32 v8, v8, v50
    v_add_f32 v12, v12, v51
    v_mul_f32 v8, 0x3acccccd, v8
    v_mul_f32 v12, 0x3acccccd, v12
    v_fma_f32 v12, -v8, v8, v12
    v_max_f32 v12, 0, v12
    v_cvt_pk_bf16_f32 v8, v8, v8
    v_lshlrev_b32 v8, 16, v8
    v_cvt_pk_bf16_f32 v12, v12, v12
    v_lshlrev_b32 v12, 16, v12
    v_add_f32 v12, 0x3727c5ac, v12
    v_cvt_pk_bf16_f32 v12, v12, v12
    v_lshlrev_b32 v12, 16, v12
    v_sqrt_f32 v12, v12
    s_nop 0
    v_cvt_pk_bf16_f32 v12, v12, v12
    v_lshlrev_b32 v12, 16, v12
    v_rcp_f32 v12, v12
    v_add_f32 v9, v52, v54
    v_add_f32 v13, v53, v55
    v_add_f32 v9, v9, v56
    v_add_f32 v13, v13, v57
    v_add_f32 v9, v9, v58
    v_add_f32 v13, v13, v59
    v_add_f32 v9, v9, v60
    v_add_f32 v13, v13, v61
    v_add_f32 v9, v9, v62
    v_add_f32 v13, v13, v63
    v_add_f32 v9, v9, v64
    v_add_f32 v13, v13, v65
    v_add_f32 v9, v9, v66
    v_add_f32 v13, v13, v67
    v_add_f32 v9, v9, v68
    v_add_f32 v13, v13, v69
    v_add_f32 v9, v9, v70
    v_add_f32 v13, v13, v71
    v_mul_f32 v9, 0x3acccccd, v9
    v_mul_f32 v13, 0x3acccccd, v13
    v_fma_f32 v13, -v9, v9, v13
    v_max_f32 v13, 0, v13
    v_cvt_pk_bf16_f32 v9, v9, v9
    v_lshlrev_b32 v9, 16, v9
    v_cvt_pk_bf16_f32 v13, v13, v13
    v_lshlrev_b32 v13, 16, v13
    v_add_f32 v13, 0x3727c5ac, v13
    v_cvt_pk_bf16_f32 v13, v13, v13
    v_lshlrev_b32 v13, 16, v13
    v_sqrt_f32 v13, v13
    s_nop 0
    v_cvt_pk_bf16_f32 v13, v13, v13
    v_lshlrev_b32 v13, 16, v13
    v_rcp_f32 v13, v13
    v_add_f32 v10, v72, v74
    v_add_f32 v14, v73, v75
    v_add_f32 v10, v10, v76
    v_add_f32 v14, v14, v77
    v_add_f32 v10, v10, v78
    v_add_f32 v14, v14, v79
    v_add_f32 v10, v10, v80
    v_add_f32 v14, v14, v81
    v_add_f32 v10, v10, v82
    v_add_f32 v14, v14, v83
    v_add_f32 v10, v10, v84
    v_add_f32 v14, v14, v85
    v_add_f32 v10, v10, v86
    v_add_f32 v14, v14, v87
    v_add_f32 v10, v10, v88
    v_add_f32 v14, v14, v89
    v_add_f32 v10, v10, v90
    v_add_f32 v14, v14, v91
    v_mul_f32 v10, 0x3acccccd, v10
    v_mul_f32 v14, 0x3acccccd, v14
    v_fma_f32 v14, -v10, v10, v14
    v_max_f32 v14, 0, v14
    v_cvt_pk_bf16_f32 v10, v10, v10
    v_lshlrev_b32 v10, 16, v10
    v_cvt_pk_bf16_f32 v14, v14, v14
    v_lshlrev_b32 v14, 16, v14
    v_add_f32 v14, 0x3727c5ac, v14
    v_cvt_pk_bf16_f32 v14, v14, v14
    v_lshlrev_b32 v14, 16, v14
    v_sqrt_f32 v14, v14
    s_nop 0
    v_cvt_pk_bf16_f32 v14, v14, v14
    v_lshlrev_b32 v14, 16, v14
    v_rcp_f32 v14, v14
    v_add_f32 v11, v92, v94
    v_add_f32 v15, v93, v95
    v_add_f32 v11, v11, v96
    v_add_f32 v15, v15, v97
    v_add_f32 v11, v11, v98
    v_add_f32 v15, v15, v99
    v_add_f32 v11, v11, v100
    v_add_f32 v15, v15, v101
    v_add_f32 v11, v11, v102
    v_add_f32 v15, v15, v103
    v_add_f32 v11, v11, v104
    v_add_f32 v15, v15, v105
    v_add_f32 v11, v11, v106
    v_add_f32 v15, v15, v107
    v_add_f32 v11, v11, v108
    v_add_f32 v15, v15, v109
    v_add_f32 v11, v11, v110
    v_add_f32 v15, v15, v111
    v_mul_f32 v11, 0x3acccccd, v11
    v_mul_f32 v15, 0x3acccccd, v15
    v_fma_f32 v15, -v11, v11, v15
    v_max_f32 v15, 0, v15
    v_cvt_pk_bf16_f32 v11, v11, v11
    v_lshlrev_b32 v11, 16, v11
    v_cvt_pk_bf16_f32 v15, v15, v15
    v_lshlrev_b32 v15, 16, v15
    v_add_f32 v15, 0x3727c5ac, v15
    v_cvt_pk_bf16_f32 v15, v15, v15
    v_lshlrev_b32 v15, 16, v15
    v_sqrt_f32 v15, v15
    s_nop 0
    v_cvt_pk_bf16_f32 v15, v15, v15
    v_lshlrev_b32 v15, 16, v15
    v_rcp_f32 v15, v15
    s_nop 0
    v_mov_b32 v96, 0
    v_mov_b32 v97, 0
    v_mov_b32 v98, 0
    v_mov_b32 v99, 0
    v_mov_b32 v100, 0
    v_mov_b32 v101, 0
    v_mov_b32 v102, 0
    v_mov_b32 v103, 0
    v_mov_b32 v104, 0
    v_mov_b32 v105, 0
    v_mov_b32 v106, 0
    v_mov_b32 v107, 0
    v_mov_b32 v108, 0
    v_mov_b32 v109, 0
    v_mov_b32 v110, 0
    v_mov_b32 v111, 0
    v_mov_b32 v112, 0
    v_mov_b32 v113, 0
    v_mov_b32 v114, 0
    v_mov_b32 v115, 0
    v_mov_b32 v116, 0
    v_mov_b32 v117, 0
    v_mov_b32 v118, 0
    v_mov_b32 v119, 0
    v_mov_b32 v120, 0
    v_mov_b32 v121, 0
    v_mov_b32 v122, 0
    v_mov_b32 v123, 0
    v_mov_b32 v124, 0
    v_mov_b32 v125, 0
    v_mov_b32 v126, 0
    v_mov_b32 v127, 0
    v_mov_b32 v128, 0
    v_mov_b32 v129, 0
    v_mov_b32 v130, 0
    v_mov_b32 v131, 0
    v_mov_b32 v132, 0
    v_mov_b32 v133, 0
    v_mov_b32 v134, 0
    v_mov_b32 v135, 0
    v_mov_b32 v136, 0
    v_mov_b32 v137, 0
    v_mov_b32 v138, 0
    v_mov_b32 v139, 0
    v_mov_b32 v140, 0
    v_mov_b32 v141, 0
    v_mov_b32 v142, 0
    v_mov_b32 v143, 0
    v_mov_b32 v144, 0
    v_mov_b32 v145, 0
    v_mov_b32 v146, 0
    v_mov_b32 v147, 0
    v_mov_b32 v148, 0
    v_mov_b32 v149, 0
    v_mov_b32 v150, 0
    v_mov_b32 v151, 0
    v_mov_b32 v152, 0
    v_mov_b32 v153, 0
    v_mov_b32 v154, 0
    v_mov_b32 v155, 0
    v_mov_b32 v156, 0
    v_mov_b32 v157, 0
    v_mov_b32 v158, 0
    v_mov_b32 v159, 0
    s_barrier
    ds_read_b128 v[32:35], v18 offset:0
    ds_read_b128 v[36:39], v18 offset:2048
    ds_read_b128 v[40:43], v18 offset:4096
    ds_read_b128 v[44:47], v18 offset:6144
    ds_read_b64_tr_b16 v[64:65], v20 offset:16384
    ds_read_b64_tr_b16 v[66:67], v20 offset:17408
    ds_read_b64_tr_b16 v[68:69], v21 offset:16384
    ds_read_b64_tr_b16 v[70:71], v21 offset:17408
    ds_read_b64_tr_b16 v[72:73], v22 offset:16384
    ds_read_b64_tr_b16 v[74:75], v22 offset:17408
    ds_read_b64_tr_b16 v[76:77], v23 offset:16384
    ds_read_b64_tr_b16 v[78:79], v23 offset:17408
    s_mov_b32 s31, 0
Lcloop_qkv0_kernel_3:
    s_waitcnt lgkmcnt(0)
    v_mfma_f32_16x16x32_bf16 v[96:99], v[64:67], v[32:35], v[96:99]
    v_mfma_f32_16x16x32_bf16 v[100:103], v[68:71], v[32:35], v[100:103]
    ds_read_b128 v[48:51], v19 offset:0
    v_mfma_f32_16x16x32_bf16 v[104:107], v[72:75], v[32:35], v[104:107]
    ds_read_b128 v[52:55], v19 offset:2048
    v_mfma_f32_16x16x32_bf16 v[108:111], v[76:79], v[32:35], v[108:111]
    ds_read_b128 v[56:59], v19 offset:4096
    v_mfma_f32_16x16x32_bf16 v[112:115], v[64:67], v[36:39], v[112:115]
    v_mfma_f32_16x16x32_bf16 v[116:119], v[68:71], v[36:39], v[116:119]
    ds_read_b128 v[60:63], v19 offset:6144
    v_mfma_f32_16x16x32_bf16 v[120:123], v[72:75], v[36:39], v[120:123]
    ds_read_b64_tr_b16 v[80:81], v20 offset:24576
    v_mfma_f32_16x16x32_bf16 v[124:127], v[76:79], v[36:39], v[124:127]
    ds_read_b64_tr_b16 v[82:83], v20 offset:25600
    v_mfma_f32_16x16x32_bf16 v[128:131], v[64:67], v[40:43], v[128:131]
    v_mfma_f32_16x16x32_bf16 v[132:135], v[68:71], v[40:43], v[132:135]
    ds_read_b64_tr_b16 v[84:85], v21 offset:24576
    v_mfma_f32_16x16x32_bf16 v[136:139], v[72:75], v[40:43], v[136:139]
    ds_read_b64_tr_b16 v[86:87], v21 offset:25600
    v_mfma_f32_16x16x32_bf16 v[140:143], v[76:79], v[40:43], v[140:143]
    ds_read_b64_tr_b16 v[88:89], v22 offset:24576
    v_mfma_f32_16x16x32_bf16 v[144:147], v[64:67], v[44:47], v[144:147]
    v_mfma_f32_16x16x32_bf16 v[148:151], v[68:71], v[44:47], v[148:151]
    ds_read_b64_tr_b16 v[90:91], v22 offset:25600
    v_mfma_f32_16x16x32_bf16 v[152:155], v[72:75], v[44:47], v[152:155]
    ds_read_b64_tr_b16 v[92:93], v23 offset:24576
    v_mfma_f32_16x16x32_bf16 v[156:159], v[76:79], v[44:47], v[156:159]
    ds_read_b64_tr_b16 v[94:95], v23 offset:25600
    s_waitcnt lgkmcnt(0)
    v_mfma_f32_16x16x32_bf16 v[96:99], v[80:83], v[48:51], v[96:99]
    v_mfma_f32_16x16x32_bf16 v[100:103], v[84:87], v[48:51], v[100:103]
    ds_read_b128 v[32:35], v18 offset:32768
    v_mfma_f32_16x16x32_bf16 v[104:107], v[88:91], v[48:51], v[104:107]
    ds_read_b128 v[36:39], v18 offset:34816
    v_mfma_f32_16x16x32_bf16 v[108:111], v[92:95], v[48:51], v[108:111]
    ds_read_b128 v[40:43], v18 offset:36864
    v_mfma_f32_16x16x32_bf16 v[112:115], v[80:83], v[52:55], v[112:115]
    v_mfma_f32_16x16x32_bf16 v[116:119], v[84:87], v[52:55], v[116:119]
    ds_read_b128 v[44:47], v18 offset:38912
    v_mfma_f32_16x16x32_bf16 v[120:123], v[88:91], v[52:55], v[120:123]
    ds_read_b64_tr_b16 v[64:65], v20 offset:49152
    v_mfma_f32_16x16x32_bf16 v[124:127], v[92:95], v[52:55], v[124:127]
    ds_read_b64_tr_b16 v[66:67], v20 offset:50176
    v_mfma_f32_16x16x32_bf16 v[128:131], v[80:83], v[56:59], v[128:131]
    v_mfma_f32_16x16x32_bf16 v[132:135], v[84:87], v[56:59], v[132:135]
    ds_read_b64_tr_b16 v[68:69], v21 offset:49152
    v_mfma_f32_16x16x32_bf16 v[136:139], v[88:91], v[56:59], v[136:139]
    ds_read_b64_tr_b16 v[70:71], v21 offset:50176
    v_mfma_f32_16x16x32_bf16 v[140:143], v[92:95], v[56:59], v[140:143]
    ds_read_b64_tr_b16 v[72:73], v22 offset:49152
    v_mfma_f32_16x16x32_bf16 v[144:147], v[80:83], v[60:63], v[144:147]
    v_mfma_f32_16x16x32_bf16 v[148:151], v[84:87], v[60:63], v[148:151]
    ds_read_b64_tr_b16 v[74:75], v22 offset:50176
    v_mfma_f32_16x16x32_bf16 v[152:155], v[88:91], v[60:63], v[152:155]
    ds_read_b64_tr_b16 v[76:77], v23 offset:49152
    v_mfma_f32_16x16x32_bf16 v[156:159], v[92:95], v[60:63], v[156:159]
    ds_read_b64_tr_b16 v[78:79], v23 offset:50176
    s_barrier
    s_waitcnt lgkmcnt(0)
    v_mfma_f32_16x16x32_bf16 v[96:99], v[64:67], v[32:35], v[96:99]
    v_mfma_f32_16x16x32_bf16 v[100:103], v[68:71], v[32:35], v[100:103]
    ds_read_b128 v[48:51], v19 offset:32768
    v_mfma_f32_16x16x32_bf16 v[104:107], v[72:75], v[32:35], v[104:107]
    ds_read_b128 v[52:55], v19 offset:34816
    v_mfma_f32_16x16x32_bf16 v[108:111], v[76:79], v[32:35], v[108:111]
    ds_read_b128 v[56:59], v19 offset:36864
    v_mfma_f32_16x16x32_bf16 v[112:115], v[64:67], v[36:39], v[112:115]
    v_mfma_f32_16x16x32_bf16 v[116:119], v[68:71], v[36:39], v[116:119]
    ds_read_b128 v[60:63], v19 offset:38912
    v_mfma_f32_16x16x32_bf16 v[120:123], v[72:75], v[36:39], v[120:123]
    ds_read_b64_tr_b16 v[80:81], v20 offset:57344
    v_mfma_f32_16x16x32_bf16 v[124:127], v[76:79], v[36:39], v[124:127]
    ds_read_b64_tr_b16 v[82:83], v20 offset:58368
    v_mfma_f32_16x16x32_bf16 v[128:131], v[64:67], v[40:43], v[128:131]
    v_mfma_f32_16x16x32_bf16 v[132:135], v[68:71], v[40:43], v[132:135]
    ds_read_b64_tr_b16 v[84:85], v21 offset:57344
    v_mfma_f32_16x16x32_bf16 v[136:139], v[72:75], v[40:43], v[136:139]
    ds_read_b64_tr_b16 v[86:87], v21 offset:58368
    v_mfma_f32_16x16x32_bf16 v[140:143], v[76:79], v[40:43], v[140:143]
    ds_read_b64_tr_b16 v[88:89], v22 offset:57344
    v_mfma_f32_16x16x32_bf16 v[144:147], v[64:67], v[44:47], v[144:147]
    v_mfma_f32_16x16x32_bf16 v[148:151], v[68:71], v[44:47], v[148:151]
    ds_read_b64_tr_b16 v[90:91], v22 offset:58368
    v_mfma_f32_16x16x32_bf16 v[152:155], v[72:75], v[44:47], v[152:155]
    ds_read_b64_tr_b16 v[92:93], v23 offset:57344
    v_mfma_f32_16x16x32_bf16 v[156:159], v[76:79], v[44:47], v[156:159]
    ds_read_b64_tr_b16 v[94:95], v23 offset:58368
    s_waitcnt lgkmcnt(0)
    v_mfma_f32_16x16x32_bf16 v[96:99], v[80:83], v[48:51], v[96:99]
    v_mfma_f32_16x16x32_bf16 v[100:103], v[84:87], v[48:51], v[100:103]
    ds_read_b128 v[32:35], v26 offset:0
    v_mfma_f32_16x16x32_bf16 v[104:107], v[88:91], v[48:51], v[104:107]
    ds_read_b128 v[36:39], v26 offset:2048
    v_mfma_f32_16x16x32_bf16 v[108:111], v[92:95], v[48:51], v[108:111]
    ds_read_b128 v[40:43], v26 offset:4096
    v_mfma_f32_16x16x32_bf16 v[112:115], v[80:83], v[52:55], v[112:115]
    v_mfma_f32_16x16x32_bf16 v[116:119], v[84:87], v[52:55], v[116:119]
    ds_read_b128 v[44:47], v26 offset:6144
    v_mfma_f32_16x16x32_bf16 v[120:123], v[88:91], v[52:55], v[120:123]
    ds_read_b64_tr_b16 v[64:65], v28 offset:16384
    v_mfma_f32_16x16x32_bf16 v[124:127], v[92:95], v[52:55], v[124:127]
    ds_read_b64_tr_b16 v[66:67], v28 offset:17408
    v_mfma_f32_16x16x32_bf16 v[128:131], v[80:83], v[56:59], v[128:131]
    v_mfma_f32_16x16x32_bf16 v[132:135], v[84:87], v[56:59], v[132:135]
    ds_read_b64_tr_b16 v[68:69], v29 offset:16384
    v_mfma_f32_16x16x32_bf16 v[136:139], v[88:91], v[56:59], v[136:139]
    ds_read_b64_tr_b16 v[70:71], v29 offset:17408
    v_mfma_f32_16x16x32_bf16 v[140:143], v[92:95], v[56:59], v[140:143]
    ds_read_b64_tr_b16 v[72:73], v30 offset:16384
    v_mfma_f32_16x16x32_bf16 v[144:147], v[80:83], v[60:63], v[144:147]
    v_mfma_f32_16x16x32_bf16 v[148:151], v[84:87], v[60:63], v[148:151]
    ds_read_b64_tr_b16 v[74:75], v30 offset:17408
    v_mfma_f32_16x16x32_bf16 v[152:155], v[88:91], v[60:63], v[152:155]
    ds_read_b64_tr_b16 v[76:77], v31 offset:16384
    v_mfma_f32_16x16x32_bf16 v[156:159], v[92:95], v[60:63], v[156:159]
    ds_read_b64_tr_b16 v[78:79], v31 offset:17408
    s_barrier
    s_waitcnt lgkmcnt(0)
    v_mfma_f32_16x16x32_bf16 v[96:99], v[64:67], v[32:35], v[96:99]
    v_mfma_f32_16x16x32_bf16 v[100:103], v[68:71], v[32:35], v[100:103]
    ds_read_b128 v[48:51], v27 offset:0
    v_mfma_f32_16x16x32_bf16 v[104:107], v[72:75], v[32:35], v[104:107]
    ds_read_b128 v[52:55], v27 offset:2048
    v_mfma_f32_16x16x32_bf16 v[108:111], v[76:79], v[32:35], v[108:111]
    ds_read_b128 v[56:59], v27 offset:4096
    v_mfma_f32_16x16x32_bf16 v[112:115], v[64:67], v[36:39], v[112:115]
    v_mfma_f32_16x16x32_bf16 v[116:119], v[68:71], v[36:39], v[116:119]
    ds_read_b128 v[60:63], v27 offset:6144
    v_mfma_f32_16x16x32_bf16 v[120:123], v[72:75], v[36:39], v[120:123]
    ds_read_b64_tr_b16 v[80:81], v28 offset:24576
    v_mfma_f32_16x16x32_bf16 v[124:127], v[76:79], v[36:39], v[124:127]
    ds_read_b64_tr_b16 v[82:83], v28 offset:25600
    v_mfma_f32_16x16x32_bf16 v[128:131], v[64:67], v[40:43], v[128:131]
    v_mfma_f32_16x16x32_bf16 v[132:135], v[68:71], v[40:43], v[132:135]
    ds_read_b64_tr_b16 v[84:85], v29 offset:24576
    v_mfma_f32_16x16x32_bf16 v[136:139], v[72:75], v[40:43], v[136:139]
    ds_read_b64_tr_b16 v[86:87], v29 offset:25600
    v_mfma_f32_16x16x32_bf16 v[140:143], v[76:79], v[40:43], v[140:143]
    ds_read_b64_tr_b16 v[88:89], v30 offset:24576
    v_mfma_f32_16x16x32_bf16 v[144:147], v[64:67], v[44:47], v[144:147]
    v_mfma_f32_16x16x32_bf16 v[148:151], v[68:71], v[44:47], v[148:151]
    ds_read_b64_tr_b16 v[90:91], v30 offset:25600
    v_mfma_f32_16x16x32_bf16 v[152:155], v[72:75], v[44:47], v[152:155]
    ds_read_b64_tr_b16 v[92:93], v31 offset:24576
    v_mfma_f32_16x16x32_bf16 v[156:159], v[76:79], v[44:47], v[156:159]
    ds_read_b64_tr_b16 v[94:95], v31 offset:25600
    s_waitcnt lgkmcnt(0)
    v_mfma_f32_16x16x32_bf16 v[96:99], v[80:83], v[48:51], v[96:99]
    v_mfma_f32_16x16x32_bf16 v[100:103], v[84:87], v[48:51], v[100:103]
    ds_read_b128 v[32:35], v26 offset:32768
    v_mfma_f32_16x16x32_bf16 v[104:107], v[88:91], v[48:51], v[104:107]
    ds_read_b128 v[36:39], v26 offset:34816
    v_mfma_f32_16x16x32_bf16 v[108:111], v[92:95], v[48:51], v[108:111]
    ds_read_b128 v[40:43], v26 offset:36864
    v_mfma_f32_16x16x32_bf16 v[112:115], v[80:83], v[52:55], v[112:115]
    v_mfma_f32_16x16x32_bf16 v[116:119], v[84:87], v[52:55], v[116:119]
    ds_read_b128 v[44:47], v26 offset:38912
    v_mfma_f32_16x16x32_bf16 v[120:123], v[88:91], v[52:55], v[120:123]
    ds_read_b64_tr_b16 v[64:65], v28 offset:49152
    v_mfma_f32_16x16x32_bf16 v[124:127], v[92:95], v[52:55], v[124:127]
    ds_read_b64_tr_b16 v[66:67], v28 offset:50176
    v_mfma_f32_16x16x32_bf16 v[128:131], v[80:83], v[56:59], v[128:131]
    v_mfma_f32_16x16x32_bf16 v[132:135], v[84:87], v[56:59], v[132:135]
    ds_read_b64_tr_b16 v[68:69], v29 offset:49152
    v_mfma_f32_16x16x32_bf16 v[136:139], v[88:91], v[56:59], v[136:139]
    ds_read_b64_tr_b16 v[70:71], v29 offset:50176
    v_mfma_f32_16x16x32_bf16 v[140:143], v[92:95], v[56:59], v[140:143]
    ds_read_b64_tr_b16 v[72:73], v30 offset:49152
    v_mfma_f32_16x16x32_bf16 v[144:147], v[80:83], v[60:63], v[144:147]
    v_mfma_f32_16x16x32_bf16 v[148:151], v[84:87], v[60:63], v[148:151]
    ds_read_b64_tr_b16 v[74:75], v30 offset:50176
    v_mfma_f32_16x16x32_bf16 v[152:155], v[88:91], v[60:63], v[152:155]
    ds_read_b64_tr_b16 v[76:77], v31 offset:49152
    v_mfma_f32_16x16x32_bf16 v[156:159], v[92:95], v[60:63], v[156:159]
    ds_read_b64_tr_b16 v[78:79], v31 offset:50176
    s_barrier
    s_waitcnt lgkmcnt(0)
    v_mfma_f32_16x16x32_bf16 v[96:99], v[64:67], v[32:35], v[96:99]
    v_mfma_f32_16x16x32_bf16 v[100:103], v[68:71], v[32:35], v[100:103]
    ds_read_b128 v[48:51], v27 offset:32768
    v_mfma_f32_16x16x32_bf16 v[104:107], v[72:75], v[32:35], v[104:107]
    ds_read_b128 v[52:55], v27 offset:34816
    v_mfma_f32_16x16x32_bf16 v[108:111], v[76:79], v[32:35], v[108:111]
    ds_read_b128 v[56:59], v27 offset:36864
    v_mfma_f32_16x16x32_bf16 v[112:115], v[64:67], v[36:39], v[112:115]
    v_mfma_f32_16x16x32_bf16 v[116:119], v[68:71], v[36:39], v[116:119]
    ds_read_b128 v[60:63], v27 offset:38912
    v_mfma_f32_16x16x32_bf16 v[120:123], v[72:75], v[36:39], v[120:123]
    ds_read_b64_tr_b16 v[80:81], v28 offset:57344
    v_mfma_f32_16x16x32_bf16 v[124:127], v[76:79], v[36:39], v[124:127]
    ds_read_b64_tr_b16 v[82:83], v28 offset:58368
    v_mfma_f32_16x16x32_bf16 v[128:131], v[64:67], v[40:43], v[128:131]
    v_mfma_f32_16x16x32_bf16 v[132:135], v[68:71], v[40:43], v[132:135]
    ds_read_b64_tr_b16 v[84:85], v29 offset:57344
    v_mfma_f32_16x16x32_bf16 v[136:139], v[72:75], v[40:43], v[136:139]
    ds_read_b64_tr_b16 v[86:87], v29 offset:58368
    v_mfma_f32_16x16x32_bf16 v[140:143], v[76:79], v[40:43], v[140:143]
    ds_read_b64_tr_b16 v[88:89], v30 offset:57344
    v_mfma_f32_16x16x32_bf16 v[144:147], v[64:67], v[44:47], v[144:147]
    v_mfma_f32_16x16x32_bf16 v[148:151], v[68:71], v[44:47], v[148:151]
    ds_read_b64_tr_b16 v[90:91], v30 offset:58368
    v_mfma_f32_16x16x32_bf16 v[152:155], v[72:75], v[44:47], v[152:155]
    ds_read_b64_tr_b16 v[92:93], v31 offset:57344
    v_mfma_f32_16x16x32_bf16 v[156:159], v[76:79], v[44:47], v[156:159]
    ds_read_b64_tr_b16 v[94:95], v31 offset:58368
    s_waitcnt lgkmcnt(0)
    v_mfma_f32_16x16x32_bf16 v[96:99], v[80:83], v[48:51], v[96:99]
    v_mfma_f32_16x16x32_bf16 v[100:103], v[84:87], v[48:51], v[100:103]
    ds_read_b128 v[32:35], v18 offset:0
    v_mfma_f32_16x16x32_bf16 v[104:107], v[88:91], v[48:51], v[104:107]
    ds_read_b128 v[36:39], v18 offset:2048
    v_mfma_f32_16x16x32_bf16 v[108:111], v[92:95], v[48:51], v[108:111]
    ds_read_b128 v[40:43], v18 offset:4096
    v_mfma_f32_16x16x32_bf16 v[112:115], v[80:83], v[52:55], v[112:115]
    v_mfma_f32_16x16x32_bf16 v[116:119], v[84:87], v[52:55], v[116:119]
    ds_read_b128 v[44:47], v18 offset:6144
    v_mfma_f32_16x16x32_bf16 v[120:123], v[88:91], v[52:55], v[120:123]
    ds_read_b64_tr_b16 v[64:65], v20 offset:16384
    v_mfma_f32_16x16x32_bf16 v[124:127], v[92:95], v[52:55], v[124:127]
    ds_read_b64_tr_b16 v[66:67], v20 offset:17408
    v_mfma_f32_16x16x32_bf16 v[128:131], v[80:83], v[56:59], v[128:131]
    v_mfma_f32_16x16x32_bf16 v[132:135], v[84:87], v[56:59], v[132:135]
    ds_read_b64_tr_b16 v[68:69], v21 offset:16384
    v_mfma_f32_16x16x32_bf16 v[136:139], v[88:91], v[56:59], v[136:139]
    ds_read_b64_tr_b16 v[70:71], v21 offset:17408
    v_mfma_f32_16x16x32_bf16 v[140:143], v[92:95], v[56:59], v[140:143]
    ds_read_b64_tr_b16 v[72:73], v22 offset:16384
    v_mfma_f32_16x16x32_bf16 v[144:147], v[80:83], v[60:63], v[144:147]
    v_mfma_f32_16x16x32_bf16 v[148:151], v[84:87], v[60:63], v[148:151]
    ds_read_b64_tr_b16 v[74:75], v22 offset:17408
    v_mfma_f32_16x16x32_bf16 v[152:155], v[88:91], v[60:63], v[152:155]
    ds_read_b64_tr_b16 v[76:77], v23 offset:16384
    v_mfma_f32_16x16x32_bf16 v[156:159], v[92:95], v[60:63], v[156:159]
    ds_read_b64_tr_b16 v[78:79], v23 offset:17408
    s_barrier
    s_add_u32 s31, s31, 1
    s_cmp_lt_u32 s31, 2
    s_cbranch_scc1 Lcloop_qkv0_kernel_3
    s_waitcnt lgkmcnt(0)
    v_mfma_f32_16x16x32_bf16 v[96:99], v[64:67], v[32:35], v[96:99]
    v_mfma_f32_16x16x32_bf16 v[100:103], v[68:71], v[32:35], v[100:103]
    ds_read_b128 v[48:51], v19 offset:0
    v_mfma_f32_16x16x32_bf16 v[104:107], v[72:75], v[32:35], v[104:107]
    ds_read_b128 v[52:55], v19 offset:2048
    v_mfma_f32_16x16x32_bf16 v[108:111], v[76:79], v[32:35], v[108:111]
    ds_read_b128 v[56:59], v19 offset:4096
    v_mfma_f32_16x16x32_bf16 v[112:115], v[64:67], v[36:39], v[112:115]
    v_mfma_f32_16x16x32_bf16 v[116:119], v[68:71], v[36:39], v[116:119]
    ds_read_b128 v[60:63], v19 offset:6144
    v_mfma_f32_16x16x32_bf16 v[120:123], v[72:75], v[36:39], v[120:123]
    ds_read_b64_tr_b16 v[80:81], v20 offset:24576
    v_mfma_f32_16x16x32_bf16 v[124:127], v[76:79], v[36:39], v[124:127]
    ds_read_b64_tr_b16 v[82:83], v20 offset:25600
    v_mfma_f32_16x16x32_bf16 v[128:131], v[64:67], v[40:43], v[128:131]
    v_mfma_f32_16x16x32_bf16 v[132:135], v[68:71], v[40:43], v[132:135]
    ds_read_b64_tr_b16 v[84:85], v21 offset:24576
    v_mfma_f32_16x16x32_bf16 v[136:139], v[72:75], v[40:43], v[136:139]
    ds_read_b64_tr_b16 v[86:87], v21 offset:25600
    v_mfma_f32_16x16x32_bf16 v[140:143], v[76:79], v[40:43], v[140:143]
    ds_read_b64_tr_b16 v[88:89], v22 offset:24576
    v_mfma_f32_16x16x32_bf16 v[144:147], v[64:67], v[44:47], v[144:147]
    v_mfma_f32_16x16x32_bf16 v[148:151], v[68:71], v[44:47], v[148:151]
    ds_read_b64_tr_b16 v[90:91], v22 offset:25600
    v_mfma_f32_16x16x32_bf16 v[152:155], v[72:75], v[44:47], v[152:155]
    ds_read_b64_tr_b16 v[92:93], v23 offset:24576
    v_mfma_f32_16x16x32_bf16 v[156:159], v[76:79], v[44:47], v[156:159]
    ds_read_b64_tr_b16 v[94:95], v23 offset:25600
    s_waitcnt lgkmcnt(0)
    v_mfma_f32_16x16x32_bf16 v[96:99], v[80:83], v[48:51], v[96:99]
    v_mfma_f32_16x16x32_bf16 v[100:103], v[84:87], v[48:51], v[100:103]
    ds_read_b128 v[32:35], v18 offset:32768
    v_mfma_f32_16x16x32_bf16 v[104:107], v[88:91], v[48:51], v[104:107]
    ds_read_b128 v[36:39], v18 offset:34816
    v_mfma_f32_16x16x32_bf16 v[108:111], v[92:95], v[48:51], v[108:111]
    ds_read_b128 v[40:43], v18 offset:36864
    v_mfma_f32_16x16x32_bf16 v[112:115], v[80:83], v[52:55], v[112:115]
    v_mfma_f32_16x16x32_bf16 v[116:119], v[84:87], v[52:55], v[116:119]
    ds_read_b128 v[44:47], v18 offset:38912
    v_mfma_f32_16x16x32_bf16 v[120:123], v[88:91], v[52:55], v[120:123]
    ds_read_b64_tr_b16 v[64:65], v20 offset:49152
    v_mfma_f32_16x16x32_bf16 v[124:127], v[92:95], v[52:55], v[124:127]
    ds_read_b64_tr_b16 v[66:67], v20 offset:50176
    v_mfma_f32_16x16x32_bf16 v[128:131], v[80:83], v[56:59], v[128:131]
    v_mfma_f32_16x16x32_bf16 v[132:135], v[84:87], v[56:59], v[132:135]
    ds_read_b64_tr_b16 v[68:69], v21 offset:49152
    v_mfma_f32_16x16x32_bf16 v[136:139], v[88:91], v[56:59], v[136:139]
    ds_read_b64_tr_b16 v[70:71], v21 offset:50176
    v_mfma_f32_16x16x32_bf16 v[140:143], v[92:95], v[56:59], v[140:143]
    ds_read_b64_tr_b16 v[72:73], v22 offset:49152
    v_mfma_f32_16x16x32_bf16 v[144:147], v[80:83], v[60:63], v[144:147]
    v_mfma_f32_16x16x32_bf16 v[148:151], v[84:87], v[60:63], v[148:151]
    ds_read_b64_tr_b16 v[74:75], v22 offset:50176
    v_mfma_f32_16x16x32_bf16 v[152:155], v[88:91], v[60:63], v[152:155]
    ds_read_b64_tr_b16 v[76:77], v23 offset:49152
    v_mfma_f32_16x16x32_bf16 v[156:159], v[92:95], v[60:63], v[156:159]
    ds_read_b64_tr_b16 v[78:79], v23 offset:50176
    s_barrier
    s_waitcnt lgkmcnt(0)
    v_mfma_f32_16x16x32_bf16 v[96:99], v[64:67], v[32:35], v[96:99]
    v_mfma_f32_16x16x32_bf16 v[100:103], v[68:71], v[32:35], v[100:103]
    ds_read_b128 v[48:51], v19 offset:32768
    v_mfma_f32_16x16x32_bf16 v[104:107], v[72:75], v[32:35], v[104:107]
    ds_read_b128 v[52:55], v19 offset:34816
    v_mfma_f32_16x16x32_bf16 v[108:111], v[76:79], v[32:35], v[108:111]
    ds_read_b128 v[56:59], v19 offset:36864
    v_mfma_f32_16x16x32_bf16 v[112:115], v[64:67], v[36:39], v[112:115]
    v_mfma_f32_16x16x32_bf16 v[116:119], v[68:71], v[36:39], v[116:119]
    ds_read_b128 v[60:63], v19 offset:38912
    v_mfma_f32_16x16x32_bf16 v[120:123], v[72:75], v[36:39], v[120:123]
    ds_read_b64_tr_b16 v[80:81], v20 offset:57344
    v_mfma_f32_16x16x32_bf16 v[124:127], v[76:79], v[36:39], v[124:127]
    ds_read_b64_tr_b16 v[82:83], v20 offset:58368
    v_mfma_f32_16x16x32_bf16 v[128:131], v[64:67], v[40:43], v[128:131]
    v_mfma_f32_16x16x32_bf16 v[132:135], v[68:71], v[40:43], v[132:135]
    ds_read_b64_tr_b16 v[84:85], v21 offset:57344
    v_mfma_f32_16x16x32_bf16 v[136:139], v[72:75], v[40:43], v[136:139]
    ds_read_b64_tr_b16 v[86:87], v21 offset:58368
    v_mfma_f32_16x16x32_bf16 v[140:143], v[76:79], v[40:43], v[140:143]
    ds_read_b64_tr_b16 v[88:89], v22 offset:57344
    v_mfma_f32_16x16x32_bf16 v[144:147], v[64:67], v[44:47], v[144:147]
    v_mfma_f32_16x16x32_bf16 v[148:151], v[68:71], v[44:47], v[148:151]
    ds_read_b64_tr_b16 v[90:91], v22 offset:58368
    v_mfma_f32_16x16x32_bf16 v[152:155], v[72:75], v[44:47], v[152:155]
    ds_read_b64_tr_b16 v[92:93], v23 offset:57344
    v_mfma_f32_16x16x32_bf16 v[156:159], v[76:79], v[44:47], v[156:159]
    ds_read_b64_tr_b16 v[94:95], v23 offset:58368
    s_waitcnt lgkmcnt(0)
    v_mfma_f32_16x16x32_bf16 v[96:99], v[80:83], v[48:51], v[96:99]
    v_mfma_f32_16x16x32_bf16 v[100:103], v[84:87], v[48:51], v[100:103]
    v_mfma_f32_16x16x32_bf16 v[104:107], v[88:91], v[48:51], v[104:107]
    v_mfma_f32_16x16x32_bf16 v[108:111], v[92:95], v[48:51], v[108:111]
    v_mfma_f32_16x16x32_bf16 v[112:115], v[80:83], v[52:55], v[112:115]
    v_mfma_f32_16x16x32_bf16 v[116:119], v[84:87], v[52:55], v[116:119]
    v_mfma_f32_16x16x32_bf16 v[120:123], v[88:91], v[52:55], v[120:123]
    v_mfma_f32_16x16x32_bf16 v[124:127], v[92:95], v[52:55], v[124:127]
    v_mfma_f32_16x16x32_bf16 v[128:131], v[80:83], v[56:59], v[128:131]
    v_mfma_f32_16x16x32_bf16 v[132:135], v[84:87], v[56:59], v[132:135]
    v_mfma_f32_16x16x32_bf16 v[136:139], v[88:91], v[56:59], v[136:139]
    v_mfma_f32_16x16x32_bf16 v[140:143], v[92:95], v[56:59], v[140:143]
    v_mfma_f32_16x16x32_bf16 v[144:147], v[80:83], v[60:63], v[144:147]
    v_mfma_f32_16x16x32_bf16 v[148:151], v[84:87], v[60:63], v[148:151]
    v_mfma_f32_16x16x32_bf16 v[152:155], v[88:91], v[60:63], v[152:155]
    v_mfma_f32_16x16x32_bf16 v[156:159], v[92:95], v[60:63], v[156:159]
    s_barrier
    s_nop 7
    s_nop 7
    v_lshrrev_b32 v3, 1, v2
    v_and_b32 v4, 1, v2
    v_lshrrev_b32 v5, 4, v1
    v_and_b32 v6, 15, v1
    s_load_dwordx2 s[36:37], s[0:1], 88
    s_waitcnt lgkmcnt(0)
    s_add_u32 s20, s36, 39845888
    s_addc_u32 s21, s37, 0
    s_mov_b32 s22, 7680
    s_mov_b32 s23, 0x00020000
    v_lshlrev_b32 v7, 6, v4
    v_lshl_add_u32 v7, v5, 2, v7
    v_add_u32 v7, s28, v7
    v_lshlrev_b32 v7, 2, v7
    buffer_load_dwordx4 v[64:67], v7, s[20:23], 0 offen offset:0
    buffer_load_dwordx4 v[68:71], v7, s[20:23], 0 offen offset:64
    buffer_load_dwordx4 v[72:75], v7, s[20:23], 0 offen offset:128
    buffer_load_dwordx4 v[76:79], v7, s[20:23], 0 offen offset:192
    s_waitcnt vmcnt(0)
    v_fma_f32 v96, -v8, v64, v96
    v_mul_f32 v96, v96, v12
    v_fma_f32 v97, -v8, v65, v97
    v_mul_f32 v97, v97, v12
    v_fma_f32 v98, -v8, v66, v98
    v_mul_f32 v98, v98, v12
    v_fma_f32 v99, -v8, v67, v99
    v_mul_f32 v99, v99, v12
    v_fma_f32 v100, -v8, v68, v100
    v_mul_f32 v100, v100, v12
    v_fma_f32 v101, -v8, v69, v101
    v_mul_f32 v101, v101, v12
    v_fma_f32 v102, -v8, v70, v102
    v_mul_f32 v102, v102, v12
    v_fma_f32 v103, -v8, v71, v103
    v_mul_f32 v103, v103, v12
    v_fma_f32 v104, -v8, v72, v104
    v_mul_f32 v104, v104, v12
    v_fma_f32 v105, -v8, v73, v105
    v_mul_f32 v105, v105, v12
    v_fma_f32 v106, -v8, v74, v106
    v_mul_f32 v106, v106, v12
    v_fma_f32 v107, -v8, v75, v107
    v_mul_f32 v107, v107, v12
    v_fma_f32 v108, -v8, v76, v108
    v_mul_f32 v108, v108, v12
    v_fma_f32 v109, -v8, v77, v109
    v_mul_f32 v109, v109, v12
    v_fma_f32 v110, -v8, v78, v110
    v_mul_f32 v110, v110, v12
    v_fma_f32 v111, -v8, v79, v111
    v_mul_f32 v111, v111, v12
    v_fma_f32 v112, -v9, v64, v112
    v_mul_f32 v112, v112, v13
    v_fma_f32 v113, -v9, v65, v113
    v_mul_f32 v113, v113, v13
    v_fma_f32 v114, -v9, v66, v114
    v_mul_f32 v114, v114, v13
    v_fma_f32 v115, -v9, v67, v115
    v_mul_f32 v115, v115, v13
    v_fma_f32 v116, -v9, v68, v116
    v_mul_f32 v116, v116, v13
    v_fma_f32 v117, -v9, v69, v117
    v_mul_f32 v117, v117, v13
    v_fma_f32 v118, -v9, v70, v118
    v_mul_f32 v118, v118, v13
    v_fma_f32 v119, -v9, v71, v119
    v_mul_f32 v119, v119, v13
    v_fma_f32 v120, -v9, v72, v120
    v_mul_f32 v120, v120, v13
    v_fma_f32 v121, -v9, v73, v121
    v_mul_f32 v121, v121, v13
    v_fma_f32 v122, -v9, v74, v122
    v_mul_f32 v122, v122, v13
    v_fma_f32 v123, -v9, v75, v123
    v_mul_f32 v123, v123, v13
    v_fma_f32 v124, -v9, v76, v124
    v_mul_f32 v124, v124, v13
    v_fma_f32 v125, -v9, v77, v125
    v_mul_f32 v125, v125, v13
    v_fma_f32 v126, -v9, v78, v126
    v_mul_f32 v126, v126, v13
    v_fma_f32 v127, -v9, v79, v127
    v_mul_f32 v127, v127, v13
    v_fma_f32 v128, -v10, v64, v128
    v_mul_f32 v128, v128, v14
    v_fma_f32 v129, -v10, v65, v129
    v_mul_f32 v129, v129, v14
    v_fma_f32 v130, -v10, v66, v130
    v_mul_f32 v130, v130, v14
    v_fma_f32 v131, -v10, v67, v131
    v_mul_f32 v131, v131, v14
    v_fma_f32 v132, -v10, v68, v132
    v_mul_f32 v132, v132, v14
    v_fma_f32 v133, -v10, v69, v133
    v_mul_f32 v133, v133, v14
    v_fma_f32 v134, -v10, v70, v134
    v_mul_f32 v134, v134, v14
    v_fma_f32 v135, -v10, v71, v135
    v_mul_f32 v135, v135, v14
    v_fma_f32 v136, -v10, v72, v136
    v_mul_f32 v136, v136, v14
    v_fma_f32 v137, -v10, v73, v137
    v_mul_f32 v137, v137, v14
    v_fma_f32 v138, -v10, v74, v138
    v_mul_f32 v138, v138, v14
    v_fma_f32 v139, -v10, v75, v139
    v_mul_f32 v139, v139, v14
    v_fma_f32 v140, -v10, v76, v140
    v_mul_f32 v140, v140, v14
    v_fma_f32 v141, -v10, v77, v141
    v_mul_f32 v141, v141, v14
    v_fma_f32 v142, -v10, v78, v142
    v_mul_f32 v142, v142, v14
    v_fma_f32 v143, -v10, v79, v143
    v_mul_f32 v143, v143, v14
    v_fma_f32 v144, -v11, v64, v144
    v_mul_f32 v144, v144, v15
    v_fma_f32 v145, -v11, v65, v145
    v_mul_f32 v145, v145, v15
    v_fma_f32 v146, -v11, v66, v146
    v_mul_f32 v146, v146, v15
    v_fma_f32 v147, -v11, v67, v147
    v_mul_f32 v147, v147, v15
    v_fma_f32 v148, -v11, v68, v148
    v_mul_f32 v148, v148, v15
    v_fma_f32 v149, -v11, v69, v149
    v_mul_f32 v149, v149, v15
    v_fma_f32 v150, -v11, v70, v150
    v_mul_f32 v150, v150, v15
    v_fma_f32 v151, -v11, v71, v151
    v_mul_f32 v151, v151, v15
    v_fma_f32 v152, -v11, v72, v152
    v_mul_f32 v152, v152, v15
    v_fma_f32 v153, -v11, v73, v153
    v_mul_f32 v153, v153, v15
    v_fma_f32 v154, -v11, v74, v154
    v_mul_f32 v154, v154, v15
    v_fma_f32 v155, -v11, v75, v155
    v_mul_f32 v155, v155, v15
    v_fma_f32 v156, -v11, v76, v156
    v_mul_f32 v156, v156, v15
    v_fma_f32 v157, -v11, v77, v157
    v_mul_f32 v157, v157, v15
    v_fma_f32 v158, -v11, v78, v158
    v_mul_f32 v158, v158, v15
    v_fma_f32 v159, -v11, v79, v159
    v_mul_f32 v159, v159, v15
    v_mul_u32_u24 v7, 9216, v2
    v_mul_u32_u24 v8, 144, v6
    v_add_u32 v7, v7, v8
    v_lshl_add_u32 v7, v5, 3, v7
    v_cvt_pk_bf16_f32 v32, v96, v97
    v_cvt_pk_bf16_f32 v33, v98, v99
    ds_write_b64 v7, v[32:33] offset:0
    v_cvt_pk_bf16_f32 v40, v100, v101
    v_cvt_pk_bf16_f32 v41, v102, v103
    ds_write_b64 v7, v[40:41] offset:32
    v_cvt_pk_bf16_f32 v48, v104, v105
    v_cvt_pk_bf16_f32 v49, v106, v107
    ds_write_b64 v7, v[48:49] offset:64
    v_cvt_pk_bf16_f32 v56, v108, v109
    v_cvt_pk_bf16_f32 v57, v110, v111
    ds_write_b64 v7, v[56:57] offset:96
    v_cvt_pk_bf16_f32 v32, v112, v113
    v_cvt_pk_bf16_f32 v33, v114, v115
    ds_write_b64 v7, v[32:33] offset:2304
    v_cvt_pk_bf16_f32 v40, v116, v117
    v_cvt_pk_bf16_f32 v41, v118, v119
    ds_write_b64 v7, v[40:41] offset:2336
    v_cvt_pk_bf16_f32 v48, v120, v121
    v_cvt_pk_bf16_f32 v49, v122, v123
    ds_write_b64 v7, v[48:49] offset:2368
    v_cvt_pk_bf16_f32 v56, v124, v125
    v_cvt_pk_bf16_f32 v57, v126, v127
    ds_write_b64 v7, v[56:57] offset:2400
    v_cvt_pk_bf16_f32 v32, v128, v129
    v_cvt_pk_bf16_f32 v33, v130, v131
    ds_write_b64 v7, v[32:33] offset:4608
    v_cvt_pk_bf16_f32 v40, v132, v133
    v_cvt_pk_bf16_f32 v41, v134, v135
    ds_write_b64 v7, v[40:41] offset:4640
    v_cvt_pk_bf16_f32 v48, v136, v137
    v_cvt_pk_bf16_f32 v49, v138, v139
    ds_write_b64 v7, v[48:49] offset:4672
    v_cvt_pk_bf16_f32 v56, v140, v141
    v_cvt_pk_bf16_f32 v57, v142, v143
    ds_write_b64 v7, v[56:57] offset:4704
    v_cvt_pk_bf16_f32 v32, v144, v145
    v_cvt_pk_bf16_f32 v33, v146, v147
    ds_write_b64 v7, v[32:33] offset:6912
    v_cvt_pk_bf16_f32 v40, v148, v149
    v_cvt_pk_bf16_f32 v41, v150, v151
    ds_write_b64 v7, v[40:41] offset:6944
    v_cvt_pk_bf16_f32 v48, v152, v153
    v_cvt_pk_bf16_f32 v49, v154, v155
    ds_write_b64 v7, v[48:49] offset:6976
    v_cvt_pk_bf16_f32 v56, v156, v157
    v_cvt_pk_bf16_f32 v57, v158, v159
    ds_write_b64 v7, v[56:57] offset:7008
    s_waitcnt lgkmcnt(0)
    v_lshrrev_b32 v8, 3, v1
    v_and_b32 v9, 7, v1
    v_mul_u32_u24 v7, 9216, v2
    v_mul_u32_u24 v10, 144, v8
    v_add_u32 v7, v7, v10
    v_lshl_add_u32 v7, v9, 4, v7
    v_mul_u32_u24 v10, 64, v3
    v_add_u32 v10, v10, v8
    v_add_u32 v10, s27, v10
    v_lshlrev_b32 v11, 6, v4
    v_lshl_add_u32 v11, v9, 3, v11
    v_add_u32 v11, s28, v11
    v_mul_u32_u24 v12, 3840, v10
    v_lshl_add_u32 v12, v11, 1, v12
    ds_read_b128 v[96:99], v7 offset:0
    ds_read_b128 v[100:103], v7 offset:1152
    ds_read_b128 v[104:107], v7 offset:2304
    ds_read_b128 v[108:111], v7 offset:3456
    ds_read_b128 v[112:115], v7 offset:4608
    ds_read_b128 v[116:119], v7 offset:5760
    ds_read_b128 v[120:123], v7 offset:6912
    ds_read_b128 v[124:127], v7 offset:8064
    s_waitcnt lgkmcnt(0)
    buffer_store_dwordx4 v[96:99], v12, s[16:19], 0 offen
    v_add_u32 v12, 30720, v12
    buffer_store_dwordx4 v[100:103], v12, s[16:19], 0 offen
    v_add_u32 v12, 30720, v12
    buffer_store_dwordx4 v[104:107], v12, s[16:19], 0 offen
    v_add_u32 v12, 30720, v12
    buffer_store_dwordx4 v[108:111], v12, s[16:19], 0 offen
    v_add_u32 v12, 30720, v12
    buffer_store_dwordx4 v[112:115], v12, s[16:19], 0 offen
    v_add_u32 v12, 30720, v12
    buffer_store_dwordx4 v[116:119], v12, s[16:19], 0 offen
    v_add_u32 v12, 30720, v12
    buffer_store_dwordx4 v[120:123], v12, s[16:19], 0 offen
    v_add_u32 v12, 30720, v12
    buffer_store_dwordx4 v[124:127], v12, s[16:19], 0 offen
Lend_qkv0_kernel_1:
    s_endpgm
Lloader_qkv0_kernel_2:
    v_subrev_u32 v0, 256, v0
    v_and_b32 v1, 63, v0
    s_sub_u32 s42, s41, 4
    v_lshrrev_b32 v3, 3, v1
    v_and_b32 v4, 7, v1
    v_xor_b32 v4, v4, v3
    s_mul_i32 s43, s42, 32
    s_add_u32 s43, s43, s27
    v_add_u32 v5, s43, v3
    v_mul_u32_u24 v5, 1280, v5
    v_lshl_add_u32 v8, v4, 4, v5
    v_add_u32 v9, 10240, v8
    v_add_u32 v10, 20480, v8
    v_add_u32 v11, 30720, v8
    v_lshrrev_b32 v3, 4, v1
    v_and_b32 v4, 15, v1
    v_lshrrev_b32 v5, 1, v4
    v_and_b32 v6, 1, v4
    s_mul_i32 s43, s42, 4
    s_add_u32 s44, s43, 0
    s_lshr_b32 s44, s44, 1
    s_and_b32 s44, s44, 1
    s_lshl_b32 s44, s44, 2
    v_add_u32 v7, s44, v3
    v_xor_b32 v7, v5, v7
    v_lshl_add_u32 v7, v7, 1, v6
    v_lshlrev_b32 v7, 4, v7
    s_add_u32 s44, s43, 0
    s_lshl_b32 s44, s44, 2
    v_add_u32 v12, s44, v3
    v_mul_u32_u24 v12, 3840, v12
    v_add_u32 v12, v12, v7
    v_lshl_add_u32 v12, s28, 1, v12
    s_add_u32 s44, s43, 1
    s_lshr_b32 s44, s44, 1
    s_and_b32 s44, s44, 1
    s_lshl_b32 s44, s44, 2
    v_add_u32 v7, s44, v3
    v_xor_b32 v7, v5, v7
    v_lshl_add_u32 v7, v7, 1, v6
    v_lshlrev_b32 v7, 4, v7
    s_add_u32 s44, s43, 1
    s_lshl_b32 s44, s44, 2
    v_add_u32 v13, s44, v3
    v_mul_u32_u24 v13, 3840, v13
    v_add_u32 v13, v13, v7
    v_lshl_add_u32 v13, s28, 1, v13
    s_add_u32 s44, s43, 2
    s_lshr_b32 s44, s44, 1
    s_and_b32 s44, s44, 1
    s_lshl_b32 s44, s44, 2
    v_add_u32 v7, s44, v3
    v_xor_b32 v7, v5, v7
    v_lshl_add_u32 v7, v7, 1, v6
    v_lshlrev_b32 v7, 4, v7
    s_add_u32 s44, s43, 2
    s_lshl_b32 s44, s44, 2
    v_add_u32 v14, s44, v3
    v_mul_u32_u24 v14, 3840, v14
    v_add_u32 v14, v14, v7
    v_lshl_add_u32 v14, s28, 1, v14
    s_add_u32 s44, s43, 3
    s_lshr_b32 s44, s44, 1
    s_and_b32 s44, s44, 1
    s_lshl_b32 s44, s44, 2
    v_add_u32 v7, s44, v3
    v_xor_b32 v7, v5, v7
    v_lshl_add_u32 v7, v7, 1, v6
    v_lshlrev_b32 v7, 4, v7
    s_add_u32 s44, s43, 3
    s_lshl_b32 s44, s44, 2
    v_add_u32 v15, s44, v3
    v_mul_u32_u24 v15, 3840, v15
    v_add_u32 v15, v15, v7
    v_lshl_add_u32 v15, s28, 1, v15
    s_mul_i32 s45, s42, 4096
    s_mul_i32 s46, s42, 4096
    s_add_u32 s46, s46, 16384
    s_mov_b32 s29, 0
    s_mov_b32 s30, 0
    s_add_u32 m0, s45, 0
    s_nop 0
    buffer_load_dwordx4 v8, s[8:11], s29 offen lds
    s_add_u32 m0, s45, 1024
    s_nop 0
    buffer_load_dwordx4 v9, s[8:11], s29 offen lds
    s_add_u32 m0, s45, 2048
    s_nop 0
    buffer_load_dwordx4 v10, s[8:11], s29 offen lds
    s_add_u32 m0, s45, 3072
    s_nop 0
    buffer_load_dwordx4 v11, s[8:11], s29 offen lds
    s_add_u32 m0, s46, 0
    s_nop 0
    buffer_load_dwordx4 v12, s[12:15], s30 offen lds
    s_add_u32 m0, s46, 1024
    s_nop 0
    buffer_load_dwordx4 v13, s[12:15], s30 offen lds
    s_add_u32 m0, s46, 2048
    s_nop 0
    buffer_load_dwordx4 v14, s[12:15], s30 offen lds
    s_add_u32 m0, s46, 3072
    s_nop 0
    buffer_load_dwordx4 v15, s[12:15], s30 offen lds
    s_add_u32 s29, s29, 128
    s_add_u32 s30, s30, 245760
    s_add_u32 m0, s45, 32768
    s_nop 0
    buffer_load_dwordx4 v8, s[8:11], s29 offen lds
    s_add_u32 m0, s45, 33792
    s_nop 0
    buffer_load_dwordx4 v9, s[8:11], s29 offen lds
    s_add_u32 m0, s45, 34816
    s_nop 0
    buffer_load_dwordx4 v10, s[8:11], s29 offen lds
    s_add_u32 m0, s45, 35840
    s_nop 0
    buffer_load_dwordx4 v11, s[8:11], s29 offen lds
    s_add_u32 m0, s46, 32768
    s_nop 0
    buffer_load_dwordx4 v12, s[12:15], s30 offen lds
    s_add_u32 m0, s46, 33792
    s_nop 0
    buffer_load_dwordx4 v13, s[12:15], s30 offen lds
    s_add_u32 m0, s46, 34816
    s_nop 0
    buffer_load_dwordx4 v14, s[12:15], s30 offen lds
    s_add_u32 m0, s46, 35840
    s_nop 0
    buffer_load_dwordx4 v15, s[12:15], s30 offen lds
    s_add_u32 s29, s29, 128
    s_add_u32 s30, s30, 245760
    s_add_u32 m0, s45, 65536
    s_nop 0
    buffer_load_dwordx4 v8, s[8:11], s29 offen lds
    s_add_u32 m0, s45, 66560
    s_nop 0
    buffer_load_dwordx4 v9, s[8:11], s29 offen lds
    s_add_u32 m0, s45, 67584
    s_nop 0
    buffer_load_dwordx4 v10, s[8:11], s29 offen lds
    s_add_u32 m0, s45, 68608
    s_nop 0
    buffer_load_dwordx4 v11, s[8:11], s29 offen lds
    s_add_u32 m0, s46, 65536
    s_nop 0
    buffer_load_dwordx4 v12, s[12:15], s30 offen lds
    s_add_u32 m0, s46, 66560
    s_nop 0
    buffer_load_dwordx4 v13, s[12:15], s30 offen lds
    s_add_u32 m0, s46, 67584
    s_nop 0
    buffer_load_dwordx4 v14, s[12:15], s30 offen lds
    s_add_u32 m0, s46, 68608
    s_nop 0
    buffer_load_dwordx4 v15, s[12:15], s30 offen lds
    s_add_u32 s29, s29, 128
    s_add_u32 s30, s30, 245760
    s_waitcnt vmcnt(8)
    s_barrier
    s_mov_b32 s31, 0
Llloop_qkv0_kernel_4:
    s_add_u32 m0, s45, 98304
    s_nop 0
    buffer_load_dwordx4 v8, s[8:11], s29 offen lds
    s_add_u32 m0, s45, 99328
    s_nop 0
    buffer_load_dwordx4 v9, s[8:11], s29 offen lds
    s_add_u32 m0, s45, 100352
    s_nop 0
    buffer_load_dwordx4 v10, s[8:11], s29 offen lds
    s_add_u32 m0, s45, 101376
    s_nop 0
    buffer_load_dwordx4 v11, s[8:11], s29 offen lds
    s_add_u32 m0, s46, 98304
    s_nop 0
    buffer_load_dwordx4 v12, s[12:15], s30 offen lds
    s_add_u32 m0, s46, 99328
    s_nop 0
    buffer_load_dwordx4 v13, s[12:15], s30 offen lds
    s_add_u32 m0, s46, 100352
    s_nop 0
    buffer_load_dwordx4 v14, s[12:15], s30 offen lds
    s_add_u32 m0, s46, 101376
    s_nop 0
    buffer_load_dwordx4 v15, s[12:15], s30 offen lds
    s_add_u32 s29, s29, 128
    s_add_u32 s30, s30, 245760
    s_waitcnt vmcnt(8)
    s_barrier
    s_add_u32 m0, s45, 0
    s_nop 0
    buffer_load_dwordx4 v8, s[8:11], s29 offen lds
    s_add_u32 m0, s45, 1024
    s_nop 0
    buffer_load_dwordx4 v9, s[8:11], s29 offen lds
    s_add_u32 m0, s45, 2048
    s_nop 0
    buffer_load_dwordx4 v10, s[8:11], s29 offen lds
    s_add_u32 m0, s45, 3072
    s_nop 0
    buffer_load_dwordx4 v11, s[8:11], s29 offen lds
    s_add_u32 m0, s46, 0
    s_nop 0
    buffer_load_dwordx4 v12, s[12:15], s30 offen lds
    s_add_u32 m0, s46, 1024
    s_nop 0
    buffer_load_dwordx4 v13, s[12:15], s30 offen lds
    s_add_u32 m0, s46, 2048
    s_nop 0
    buffer_load_dwordx4 v14, s[12:15], s30 offen lds
    s_add_u32 m0, s46, 3072
    s_nop 0
    buffer_load_dwordx4 v15, s[12:15], s30 offen lds
    s_add_u32 s29, s29, 128
    s_add_u32 s30, s30, 245760
    s_waitcnt vmcnt(8)
    s_barrier
    s_add_u32 m0, s45, 32768
    s_nop 0
    buffer_load_dwordx4 v8, s[8:11], s29 offen lds
    s_add_u32 m0, s45, 33792
    s_nop 0
    buffer_load_dwordx4 v9, s[8:11], s29 offen lds
    s_add_u32 m0, s45, 34816
    s_nop 0
    buffer_load_dwordx4 v10, s[8:11], s29 offen lds
    s_add_u32 m0, s45, 35840
    s_nop 0
    buffer_load_dwordx4 v11, s[8:11], s29 offen lds
    s_add_u32 m0, s46, 32768
    s_nop 0
    buffer_load_dwordx4 v12, s[12:15], s30 offen lds
    s_add_u32 m0, s46, 33792
    s_nop 0
    buffer_load_dwordx4 v13, s[12:15], s30 offen lds
    s_add_u32 m0, s46, 34816
    s_nop 0
    buffer_load_dwordx4 v14, s[12:15], s30 offen lds
    s_add_u32 m0, s46, 35840
    s_nop 0
    buffer_load_dwordx4 v15, s[12:15], s30 offen lds
    s_add_u32 s29, s29, 128
    s_add_u32 s30, s30, 245760
    s_waitcnt vmcnt(8)
    s_barrier
    s_add_u32 m0, s45, 65536
    s_nop 0
    buffer_load_dwordx4 v8, s[8:11], s29 offen lds
    s_add_u32 m0, s45, 66560
    s_nop 0
    buffer_load_dwordx4 v9, s[8:11], s29 offen lds
    s_add_u32 m0, s45, 67584
    s_nop 0
    buffer_load_dwordx4 v10, s[8:11], s29 offen lds
    s_add_u32 m0, s45, 68608
    s_nop 0
    buffer_load_dwordx4 v11, s[8:11], s29 offen lds
    s_add_u32 m0, s46, 65536
    s_nop 0
    buffer_load_dwordx4 v12, s[12:15], s30 offen lds
    s_add_u32 m0, s46, 66560
    s_nop 0
    buffer_load_dwordx4 v13, s[12:15], s30 offen lds
    s_add_u32 m0, s46, 67584
    s_nop 0
    buffer_load_dwordx4 v14, s[12:15], s30 offen lds
    s_add_u32 m0, s46, 68608
    s_nop 0
    buffer_load_dwordx4 v15, s[12:15], s30 offen lds
    s_add_u32 s29, s29, 128
    s_add_u32 s30, s30, 245760
    s_waitcnt vmcnt(8)
    s_barrier
    s_add_u32 s31, s31, 1
    s_cmp_lt_u32 s31, 1
    s_cbranch_scc1 Llloop_qkv0_kernel_4
    s_add_u32 m0, s45, 98304
    s_nop 0
    buffer_load_dwordx4 v8, s[8:11], s29 offen lds
    s_add_u32 m0, s45, 99328
    s_nop 0
    buffer_load_dwordx4 v9, s[8:11], s29 offen lds
    s_add_u32 m0, s45, 100352
    s_nop 0
    buffer_load_dwordx4 v10, s[8:11], s29 offen lds
    s_add_u32 m0, s45, 101376
    s_nop 0
    buffer_load_dwordx4 v11, s[8:11], s29 offen lds
    s_add_u32 m0, s46, 98304
    s_nop 0
    buffer_load_dwordx4 v12, s[12:15], s30 offen lds
    s_add_u32 m0, s46, 99328
    s_nop 0
    buffer_load_dwordx4 v13, s[12:15], s30 offen lds
    s_add_u32 m0, s46, 100352
    s_nop 0
    buffer_load_dwordx4 v14, s[12:15], s30 offen lds
    s_add_u32 m0, s46, 101376
    s_nop 0
    buffer_load_dwordx4 v15, s[12:15], s30 offen lds
    s_add_u32 s29, s29, 128
    s_add_u32 s30, s30, 245760
    s_waitcnt vmcnt(8)
    s_barrier
    s_add_u32 m0, s45, 0
    s_nop 0
    buffer_load_dwordx4 v8, s[8:11], s29 offen lds
    s_add_u32 m0, s45, 1024
    s_nop 0
    buffer_load_dwordx4 v9, s[8:11], s29 offen lds
    s_add_u32 m0, s45, 2048
    s_nop 0
    buffer_load_dwordx4 v10, s[8:11], s29 offen lds
    s_add_u32 m0, s45, 3072
    s_nop 0
    buffer_load_dwordx4 v11, s[8:11], s29 offen lds
    s_add_u32 m0, s46, 0
    s_nop 0
    buffer_load_dwordx4 v12, s[12:15], s30 offen lds
    s_add_u32 m0, s46, 1024
    s_nop 0
    buffer_load_dwordx4 v13, s[12:15], s30 offen lds
    s_add_u32 m0, s46, 2048
    s_nop 0
    buffer_load_dwordx4 v14, s[12:15], s30 offen lds
    s_add_u32 m0, s46, 3072
    s_nop 0
    buffer_load_dwordx4 v15, s[12:15], s30 offen lds
    s_add_u32 s29, s29, 128
    s_add_u32 s30, s30, 245760
    s_waitcnt vmcnt(8)
    s_barrier
    s_add_u32 m0, s45, 32768
    s_nop 0
    buffer_load_dwordx4 v8, s[8:11], s29 offen lds
    s_add_u32 m0, s45, 33792
    s_nop 0
    buffer_load_dwordx4 v9, s[8:11], s29 offen lds
    s_add_u32 m0, s45, 34816
    s_nop 0
    buffer_load_dwordx4 v10, s[8:11], s29 offen lds
    s_add_u32 m0, s45, 35840
    s_nop 0
    buffer_load_dwordx4 v11, s[8:11], s29 offen lds
    s_add_u32 m0, s46, 32768
    s_nop 0
    buffer_load_dwordx4 v12, s[12:15], s30 offen lds
    s_add_u32 m0, s46, 33792
    s_nop 0
    buffer_load_dwordx4 v13, s[12:15], s30 offen lds
    s_add_u32 m0, s46, 34816
    s_nop 0
    buffer_load_dwordx4 v14, s[12:15], s30 offen lds
    s_add_u32 m0, s46, 35840
    s_nop 0
    buffer_load_dwordx4 v15, s[12:15], s30 offen lds
    s_add_u32 s29, s29, 128
    s_add_u32 s30, s30, 245760
    s_waitcnt vmcnt(8)
    s_barrier
    s_waitcnt vmcnt(0)
    s_barrier
    s_waitcnt vmcnt(0)
    s_barrier
    s_waitcnt vmcnt(0)
    s_barrier
    s_endpgm
.section .rodata,"a"
.p2align 6
.amdhsa_kernel qkv0_kernel
  .amdhsa_next_free_vgpr 160
  .amdhsa_next_free_sgpr 56
  .amdhsa_accum_offset 160
  .amdhsa_group_segment_fixed_size 0
  .amdhsa_kernarg_size 96
  .amdhsa_user_sgpr_count 2
  .amdhsa_user_sgpr_kernarg_segment_ptr 1
  .amdhsa_system_sgpr_workgroup_id_x 1
.end_amdhsa_kernel
.text

.globl kv_kernel
.p2align 8
.type kv_kernel,@function
kv_kernel:
    s_cmp_ge_u32 s2, 256
    s_cbranch_scc1 Lend_kv_kernel_1
    s_load_dwordx2 s[4:5], s[0:1], 88
    s_load_dwordx2 s[6:7], s[0:1], 16
    s_load_dwordx2 s[24:25], s[0:1], 88
    s_lshr_b32 s26, s2, 3
    s_and_b32 s28, s2, 7
    s_waitcnt lgkmcnt(0)
    s_add_u32 s8, s4, 5242880
    s_addc_u32 s9, s5, 0
    s_mov_b32 s10, 7864320
    s_mov_b32 s11, 0x00020000
    s_mov_b32 s12, s6
    s_mov_b32 s13, s7
    s_mov_b32 s14, 25600
    s_mov_b32 s15, 0x00020000
    s_add_u32 s16, s24, 28311552
    s_addc_u32 s17, s25, 0
    s_mov_b32 s18, 6291456
    s_mov_b32 s19, 0x00020000
    v_and_b32 v1, 63, v0
    v_lshrrev_b32 v2, 6, v0
    v_and_b32 v3, 31, v1
    v_lshrrev_b32 v4, 5, v1
    v_mul_u32_u24 v5, 320, v4
    v_lshl_add_u32 v5, v3, 1, v5
    s_mul_i32 s27, s26, 800
    v_add_u32 v5, s27, v5
    v_cmp_gt_u32 vcc, 20, v3
    v_mov_b32 v6, 0x7ffffff0
    s_nop 1
    v_cndmask_b32 v5, v6, v5, vcc
    buffer_load_ushort v116, v5, s[12:15], 0 offen offset:0
    buffer_load_ushort v117, v5, s[12:15], 0 offen offset:40
    buffer_load_ushort v118, v5, s[12:15], 0 offen offset:80
    buffer_load_ushort v119, v5, s[12:15], 0 offen offset:120
    buffer_load_ushort v120, v5, s[12:15], 0 offen offset:160
    buffer_load_ushort v121, v5, s[12:15], 0 offen offset:200
    buffer_load_ushort v122, v5, s[12:15], 0 offen offset:240
    buffer_load_ushort v123, v5, s[12:15], 0 offen offset:280
    v_cmp_eq_u32 vcc, 0, v4
    s_nop 1
    v_cndmask_b32 v6, v6, v5, vcc
    buffer_load_ushort v124, v6, s[12:15], 0 offen offset:640
    buffer_load_ushort v125, v6, s[12:15], 0 offen offset:680
    buffer_load_ushort v126, v6, s[12:15], 0 offen offset:720
    buffer_load_ushort v127, v6, s[12:15], 0 offen offset:760
    s_waitcnt vmcnt(0)
    v_lshl_or_b32 v8, v117, 16, v116
    v_lshl_or_b32 v9, v119, 16, v118
    v_lshl_or_b32 v10, v121, 16, v120
    v_lshl_or_b32 v11, v123, 16, v122
    v_lshl_or_b32 v12, v125, 16, v124
    v_lshl_or_b32 v13, v127, 16, v126
    v_mov_b32 v14, 0
    v_mov_b32 v15, 0
    v_and_b32 v3, 31, v1
    v_lshrrev_b32 v4, 5, v1
    s_lshl_b32 s29, s28, 8
    v_lshl_add_u32 v5, v2, 6, v3
    v_add_u32 v5, s29, v5
    v_mul_u32_u24 v5, 3840, v5
    s_mul_i32 s30, s26, 40
    v_lshl_add_u32 v6, v4, 4, v5
    v_add_u32 v6, s30, v6
    v_add_u32 v132, 1280, v6
    v_add_u32 v133, 32, v132
    v_mov_b32 v7, 0x7ffffff0
    v_cmp_eq_u32 vcc, 0, v4
    s_nop 1
    v_cndmask_b32 v133, v7, v133, vcc
    v_add_u32 v134, 2560, v6
    v_add_u32 v135, 32, v134
    v_cndmask_b32 v135, v7, v135, vcc
    v_mov_b32 v141, 0xff800000
    v_cndmask_b32 v141, v141, 0, vcc
    v_lshlrev_b32 v5, 13, v2
    v_lshl_add_u32 v6, v3, 7, v5
    v_lshl_add_u32 v136, v4, 3, v6
    v_add_u32 v137, 32, v136
    v_add_u32 v7, 80, v6
    v_cndmask_b32 v137, v7, v137, vcc
    v_lshl_add_u32 v6, v3, 6, v5
    v_add_u32 v6, 4096, v6
    v_lshl_add_u32 v138, v4, 4, v6
    v_lshrrev_b32 v3, 4, v1
    v_and_b32 v4, 15, v1
    v_lshrrev_b32 v6, 2, v4
    v_lshl_add_u32 v3, v3, 3, v6
    v_and_b32 v4, 3, v4
    v_lshl_add_u32 v6, v3, 7, v5
    v_lshl_add_u32 v139, v4, 3, v6
    v_lshl_add_u32 v6, v3, 6, v5
    v_add_u32 v6, 4096, v6
    v_lshl_add_u32 v140, v4, 3, v6
    v_mov_b32 v116, 0x00003f80
    v_mov_b32 v117, 0
    v_mov_b32 v118, 0
    v_mov_b32 v119, 0
    v_mov_b32 v120, 0
    v_mov_b32 v121, 0
    v_lshrrev_b32 v4, 5, v1
    v_cmp_eq_u32 vcc, 1, v4
    s_and_saveexec_b64 s[32:33], vcc
    ds_write_b64 v138, v[116:117] offset:24
    ds_write_b128 v138, v[118:121] offset:32
    s_mov_b64 exec, s[32:33]
    v_mov_b32 v64, 0
    v_mov_b32 v65, 0
    v_mov_b32 v66, 0
    v_mov_b32 v67, 0
    v_mov_b32 v68, 0
    v_mov_b32 v69, 0
    v_mov_b32 v70, 0
    v_mov_b32 v71, 0
    v_mov_b32 v72, 0
    v_mov_b32 v73, 0
    v_mov_b32 v74, 0
    v_mov_b32 v75, 0
    v_mov_b32 v76, 0
    v_mov_b32 v77, 0
    v_mov_b32 v78, 0
    v_mov_b32 v79, 0
    v_mov_b32 v80, 0
    v_mov_b32 v81, 0
    v_mov_b32 v82, 0
    v_mov_b32 v83, 0
    v_mov_b32 v84, 0
    v_mov_b32 v85, 0
    v_mov_b32 v86, 0
    v_mov_b32 v87, 0
    buffer_load_dwordx4 v[16:19], v132, s[8:11], 0 offen
    buffer_load_dwordx2 v[20:21], v133, s[8:11], 0 offen
    v_mov_b32 v22, 0
    v_mov_b32 v23, 0
    buffer_load_dwordx4 v[88:91], v134, s[8:11], 0 offen
    buffer_load_dwordx2 v[92:93], v135, s[8:11], 0 offen
    s_waitcnt vmcnt(0)
    ds_write_b128 v138, v[88:91]
    v_lshrrev_b32 v4, 5, v1
    v_cmp_eq_u32 vcc, 0, v4
    s_and_saveexec_b64 s[32:33], vcc
    ds_write_b64 v138, v[92:93] offset:32
    s_mov_b64 exec, s[32:33]
    s_nop 4
    v_mfma_f32_32x32x16_bf16 v[24:39], v[8:11], v[16:19], 0
    v_mfma_f32_32x32x16_bf16 v[24:39], v[12:15], v[20:23], v[24:39]
    s_nop 15
    s_nop 3
    v_cvt_pk_bf16_f32 v116, v24, v25
    v_lshlrev_b32 v24, 16, v116
    v_and_b32 v25, 0xffff0000, v116
    v_cvt_pk_bf16_f32 v116, v26, v27
    v_lshlrev_b32 v26, 16, v116
    v_and_b32 v27, 0xffff0000, v116
    v_cvt_pk_bf16_f32 v116, v28, v29
    v_lshlrev_b32 v28, 16, v116
    v_and_b32 v29, 0xffff0000, v116
    v_cvt_pk_bf16_f32 v116, v30, v31
    v_lshlrev_b32 v30, 16, v116
    v_and_b32 v31, 0xffff0000, v116
    v_cvt_pk_bf16_f32 v116, v32, v33
    v_lshlrev_b32 v32, 16, v116
    v_and_b32 v33, 0xffff0000, v116
    v_cvt_pk_bf16_f32 v116, v34, v35
    v_lshlrev_b32 v34, 16, v116
    v_and_b32 v35, 0xffff0000, v116
    v_add_f32 v48, v32, v141
    v_sub_f32 v60, v141, v32
    v_add_f32 v49, v33, v141
    v_sub_f32 v61, v141, v33
    v_add_f32 v50, v34, v141
    v_sub_f32 v62, v141, v34
    v_add_f32 v51, v35, v141
    v_sub_f32 v63, v141, v35
    v_max3_f32 v117, v24, v25, v26
    v_max3_f32 v117, v117, v27, v28
    v_max3_f32 v117, v117, v29, v30
    v_max3_f32 v117, v117, v31, v48
    v_max3_f32 v117, v117, v49, v50
    v_max_f32 v117, v117, v51
    v_min3_f32 v118, v24, v25, v26
    v_min3_f32 v118, v118, v27, v28
    v_min3_f32 v118, v118, v29, v30
    v_min_f32 v118, v118, v31
    v_sub_f32 v118, 0, v118
    v_max3_f32 v118, v118, v60, v61
    v_max3_f32 v118, v118, v62, v63
    v_mov_b32 v119, v117
    v_mov_b32 v120, v118
    s_nop 1
    v_permlane32_swap_b32 v117, v119
    v_permlane32_swap_b32 v118, v120
    v_max_f32 v117, v117, v119
    v_max_f32 v118, v118, v120
    v_mul_f32 v117, 0xbfb8aa3b, v117
    v_mul_f32 v118, 0xbfb8aa3b, v118
    v_mov_b32 v121, 0x3fb8aa3b
    v_fma_f32 v40, v24, v121, v117
    v_fma_f32 v52, -v24, v121, v118
    v_fma_f32 v41, v25, v121, v117
    v_fma_f32 v53, -v25, v121, v118
    v_fma_f32 v42, v26, v121, v117
    v_fma_f32 v54, -v26, v121, v118
    v_fma_f32 v43, v27, v121, v117
    v_fma_f32 v55, -v27, v121, v118
    v_fma_f32 v44, v28, v121, v117
    v_fma_f32 v56, -v28, v121, v118
    v_fma_f32 v45, v29, v121, v117
    v_fma_f32 v57, -v29, v121, v118
    v_fma_f32 v46, v30, v121, v117
    v_fma_f32 v58, -v30, v121, v118
    v_fma_f32 v47, v31, v121, v117
    v_fma_f32 v59, -v31, v121, v118
    v_fma_f32 v48, v48, v121, v117
    v_fma_f32 v60, v60, v121, v118
    v_fma_f32 v49, v49, v121, v117
    v_fma_f32 v61, v61, v121, v118
    v_fma_f32 v50, v50, v121, v117
    v_fma_f32 v62, v62, v121, v118
    v_fma_f32 v51, v51, v121, v117
    v_fma_f32 v63, v63, v121, v118
    v_exp_f32 v40, v40
    v_exp_f32 v52, v52
    v_exp_f32 v41, v41
    v_exp_f32 v53, v53
    v_exp_f32 v42, v42
    v_exp_f32 v54, v54
    v_exp_f32 v43, v43
    v_exp_f32 v55, v55
    v_exp_f32 v44, v44
    v_exp_f32 v56, v56
    v_exp_f32 v45, v45
    v_exp_f32 v57, v57
    v_exp_f32 v46, v46
    v_exp_f32 v58, v58
    v_exp_f32 v47, v47
    v_exp_f32 v59, v59
    v_exp_f32 v48, v48
    v_exp_f32 v60, v60
    v_exp_f32 v49, v49
    v_exp_f32 v61, v61
    v_exp_f32 v50, v50
    v_exp_f32 v62, v62
    v_exp_f32 v51, v51
    v_exp_f32 v63, v63
    s_nop 0
    v_add_f32 v117, v40, v41
    v_add_f32 v118, v52, v53
    v_add_f32 v117, v117, v42
    v_add_f32 v118, v118, v54
    v_add_f32 v117, v117, v43
    v_add_f32 v118, v118, v55
    v_add_f32 v117, v117, v44
    v_add_f32 v118, v118, v56
    v_add_f32 v117, v117, v45
    v_add_f32 v118, v118, v57
    v_add_f32 v117, v117, v46
    v_add_f32 v118, v118, v58
    v_add_f32 v117, v117, v47
    v_add_f32 v118, v118, v59
    v_add_f32 v117, v117, v48
    v_add_f32 v118, v118, v60
    v_add_f32 v117, v117, v49
    v_add_f32 v118, v118, v61
    v_add_f32 v117, v117, v50
    v_add_f32 v118, v118, v62
    v_add_f32 v117, v117, v51
    v_add_f32 v118, v118, v63
    v_mov_b32 v119, v117
    v_mov_b32 v120, v118
    s_nop 1
    v_permlane32_swap_b32 v117, v119
    v_permlane32_swap_b32 v118, v120
    v_add_f32 v117, v117, v119
    v_add_f32 v118, v118, v120
    v_rcp_f32 v117, v117
    v_rcp_f32 v118, v118
    s_nop 0
    v_mul_f32 v40, v40, v117
    v_mul_f32 v52, v52, v118
    v_mul_f32 v41, v41, v117
    v_mul_f32 v53, v53, v118
    v_mul_f32 v42, v42, v117
    v_mul_f32 v54, v54, v118
    v_mul_f32 v43, v43, v117
    v_mul_f32 v55, v55, v118
    v_mul_f32 v44, v44, v117
    v_mul_f32 v56, v56, v118
    v_mul_f32 v45, v45, v117
    v_mul_f32 v57, v57, v118
    v_mul_f32 v46, v46, v117
    v_mul_f32 v58, v58, v118
    v_mul_f32 v47, v47, v117
    v_mul_f32 v59, v59, v118
    v_mul_f32 v48, v48, v117
    v_mul_f32 v60, v60, v118
    v_mul_f32 v49, v49, v117
    v_mul_f32 v61, v61, v118
    v_mul_f32 v50, v50, v117
    v_mul_f32 v62, v62, v118
    v_mul_f32 v51, v51, v117
    v_mul_f32 v63, v63, v118
    v_cvt_pk_bf16_f32 v116, v40, v41
    v_cvt_pk_bf16_f32 v117, v42, v43
    ds_write_b64 v136, v[116:117] offset:0
    s_nop 0
    v_cvt_pk_bf16_f32 v118, v52, v53
    v_cvt_pk_bf16_f32 v119, v54, v55
    ds_write_b64 v136, v[118:119] offset:40
    s_nop 0
    v_cvt_pk_bf16_f32 v116, v44, v45
    v_cvt_pk_bf16_f32 v117, v46, v47
    ds_write_b64 v136, v[116:117] offset:16
    s_nop 0
    v_cvt_pk_bf16_f32 v118, v56, v57
    v_cvt_pk_bf16_f32 v119, v58, v59
    ds_write_b64 v136, v[118:119] offset:56
    s_nop 0
    v_cvt_pk_bf16_f32 v116, v48, v49
    v_cvt_pk_bf16_f32 v117, v50, v51
    ds_write_b64 v137, v[116:117] offset:0
    s_nop 0
    v_cvt_pk_bf16_f32 v118, v60, v61
    v_cvt_pk_bf16_f32 v119, v62, v63
    ds_write_b64 v137, v[118:119] offset:40
    s_nop 0
    s_waitcnt lgkmcnt(0)
    ds_read_b64_tr_b16 v[96:97], v139 offset:0
    ds_read_b64_tr_b16 v[98:99], v139 offset:512
    ds_read_b64_tr_b16 v[100:101], v139 offset:32
    ds_read_b64_tr_b16 v[102:103], v139 offset:544
    ds_read_b64_tr_b16 v[104:105], v139 offset:64
    ds_read_b64_tr_b16 v[106:107], v139 offset:576
    ds_read_b64_tr_b16 v[108:109], v140 offset:0
    ds_read_b64_tr_b16 v[110:111], v140 offset:256
    ds_read_b64_tr_b16 v[112:113], v140 offset:32
    ds_read_b64_tr_b16 v[114:115], v140 offset:288
    s_waitcnt lgkmcnt(0)
    v_mfma_f32_16x16x32_bf16 v[64:67], v[96:99], v[108:111], v[64:67]
    v_mfma_f32_16x16x32_bf16 v[68:71], v[96:99], v[112:115], v[68:71]
    v_mfma_f32_16x16x32_bf16 v[72:75], v[100:103], v[108:111], v[72:75]
    v_mfma_f32_16x16x32_bf16 v[76:79], v[100:103], v[112:115], v[76:79]
    v_mfma_f32_16x16x32_bf16 v[80:83], v[104:107], v[108:111], v[80:83]
    v_mfma_f32_16x16x32_bf16 v[84:87], v[104:107], v[112:115], v[84:87]
    s_nop 7
    s_nop 7
    v_add_u32 v132, 122880, v132
    v_add_u32 v133, 122880, v133
    v_add_u32 v134, 122880, v134
    v_add_u32 v135, 122880, v135
    buffer_load_dwordx4 v[16:19], v132, s[8:11], 0 offen
    buffer_load_dwordx2 v[20:21], v133, s[8:11], 0 offen
    v_mov_b32 v22, 0
    v_mov_b32 v23, 0
    buffer_load_dwordx4 v[88:91], v134, s[8:11], 0 offen
    buffer_load_dwordx2 v[92:93], v135, s[8:11], 0 offen
    s_waitcnt vmcnt(0)
    ds_write_b128 v138, v[88:91]
    v_lshrrev_b32 v4, 5, v1
    v_cmp_eq_u32 vcc, 0, v4
    s_and_saveexec_b64 s[32:33], vcc
    ds_write_b64 v138, v[92:93] offset:32
    s_mov_b64 exec, s[32:33]
    s_nop 4
    v_mfma_f32_32x32x16_bf16 v[24:39], v[8:11], v[16:19], 0
    v_mfma_f32_32x32x16_bf16 v[24:39], v[12:15], v[20:23], v[24:39]
    s_nop 15
    s_nop 3
    v_cvt_pk_bf16_f32 v116, v24, v25
    v_lshlrev_b32 v24, 16, v116
    v_and_b32 v25, 0xffff0000, v116
    v_cvt_pk_bf16_f32 v116, v26, v27
    v_lshlrev_b32 v26, 16, v116
    v_and_b32 v27, 0xffff0000, v116
    v_cvt_pk_bf16_f32 v116, v28, v29
    v_lshlrev_b32 v28, 16, v116
    v_and_b32 v29, 0xffff0000, v116
    v_cvt_pk_bf16_f32 v116, v30, v31
    v_lshlrev_b32 v30, 16, v116
    v_and_b32 v31, 0xffff0000, v116
    v_cvt_pk_bf16_f32 v116, v32, v33
    v_lshlrev_b32 v32, 16, v116
    v_and_b32 v33, 0xffff0000, v116
    v_cvt_pk_bf16_f32 v116, v34, v35
    v_lshlrev_b32 v34, 16, v116
    v_and_b32 v35, 0xffff0000, v116
    v_add_f32 v48, v32, v141
    v_sub_f32 v60, v141, v32
    v_add_f32 v49, v33, v141
    v_sub_f32 v61, v141, v33
    v_add_f32 v50, v34, v141
    v_sub_f32 v62, v141, v34
    v_add_f32 v51, v35, v141
    v_sub_f32 v63, v141, v35
    v_max3_f32 v117, v24, v25, v26
    v_max3_f32 v117, v117, v27, v28
    v_max3_f32 v117, v117, v29, v30
    v_max3_f32 v117, v117, v31, v48
    v_max3_f32 v117, v117, v49, v50
    v_max_f32 v117, v117, v51
    v_min3_f32 v118, v24, v25, v26
    v_min3_f32 v118, v118, v27, v28
    v_min3_f32 v118, v118, v29, v30
    v_min_f32 v118, v118, v31
    v_sub_f32 v118, 0, v118
    v_max3_f32 v118, v118, v60, v61
    v_max3_f32 v118, v118, v62, v63
    v_mov_b32 v119, v117
    v_mov_b32 v120, v118
    s_nop 1
    v_permlane32_swap_b32 v117, v119
    v_permlane32_swap_b32 v118, v120
    v_max_f32 v117, v117, v119
    v_max_f32 v118, v118, v120
    v_mul_f32 v117, 0xbfb8aa3b, v117
    v_mul_f32 v118, 0xbfb8aa3b, v118
    v_mov_b32 v121, 0x3fb8aa3b
    v_fma_f32 v40, v24, v121, v117
    v_fma_f32 v52, -v24, v121, v118
    v_fma_f32 v41, v25, v121, v117
    v_fma_f32 v53, -v25, v121, v118
    v_fma_f32 v42, v26, v121, v117
    v_fma_f32 v54, -v26, v121, v118
    v_fma_f32 v43, v27, v121, v117
    v_fma_f32 v55, -v27, v121, v118
    v_fma_f32 v44, v28, v121, v117
    v_fma_f32 v56, -v28, v121, v118
    v_fma_f32 v45, v29, v121, v117
    v_fma_f32 v57, -v29, v121, v118
    v_fma_f32 v46, v30, v121, v117
    v_fma_f32 v58, -v30, v121, v118
    v_fma_f32 v47, v31, v121, v117
    v_fma_f32 v59, -v31, v121, v118
    v_fma_f32 v48, v48, v121, v117
    v_fma_f32 v60, v60, v121, v118
    v_fma_f32 v49, v49, v121, v117
    v_fma_f32 v61, v61, v121, v118
    v_fma_f32 v50, v50, v121, v117
    v_fma_f32 v62, v62, v121, v118
    v_fma_f32 v51, v51, v121, v117
    v_fma_f32 v63, v63, v121, v118
    v_exp_f32 v40, v40
    v_exp_f32 v52, v52
    v_exp_f32 v41, v41
    v_exp_f32 v53, v53
    v_exp_f32 v42, v42
    v_exp_f32 v54, v54
    v_exp_f32 v43, v43
    v_exp_f32 v55, v55
    v_exp_f32 v44, v44
    v_exp_f32 v56, v56
    v_exp_f32 v45, v45
    v_exp_f32 v57, v57
    v_exp_f32 v46, v46
    v_exp_f32 v58, v58
    v_exp_f32 v47, v47
    v_exp_f32 v59, v59
    v_exp_f32 v48, v48
    v_exp_f32 v60, v60
    v_exp_f32 v49, v49
    v_exp_f32 v61, v61
    v_exp_f32 v50, v50
    v_exp_f32 v62, v62
    v_exp_f32 v51, v51
    v_exp_f32 v63, v63
    s_nop 0
    v_add_f32 v117, v40, v41
    v_add_f32 v118, v52, v53
    v_add_f32 v117, v117, v42
    v_add_f32 v118, v118, v54
    v_add_f32 v117, v117, v43
    v_add_f32 v118, v118, v55
    v_add_f32 v117, v117, v44
    v_add_f32 v118, v118, v56
    v_add_f32 v117, v117, v45
    v_add_f32 v118, v118, v57
    v_add_f32 v117, v117, v46
    v_add_f32 v118, v118, v58
    v_add_f32 v117, v117, v47
    v_add_f32 v118, v118, v59
    v_add_f32 v117, v117, v48
    v_add_f32 v118, v118, v60
    v_add_f32 v117, v117, v49
    v_add_f32 v118, v118, v61
    v_add_f32 v117, v117, v50
    v_add_f32 v118, v118, v62
    v_add_f32 v117, v117, v51
    v_add_f32 v118, v118, v63
    v_mov_b32 v119, v117
    v_mov_b32 v120, v118
    s_nop 1
    v_permlane32_swap_b32 v117, v119
    v_permlane32_swap_b32 v118, v120
    v_add_f32 v117, v117, v119
    v_add_f32 v118, v118, v120
    v_rcp_f32 v117, v117
    v_rcp_f32 v118, v118
    s_nop 0
    v_mul_f32 v40, v40, v117
    v_mul_f32 v52, v52, v118
    v_mul_f32 v41, v41, v117
    v_mul_f32 v53, v53, v118
    v_mul_f32 v42, v42, v117
    v_mul_f32 v54, v54, v118
    v_mul_f32 v43, v43, v117
    v_mul_f32 v55, v55, v118
    v_mul_f32 v44, v44, v117
    v_mul_f32 v56, v56, v118
    v_mul_f32 v45, v45, v117
    v_mul_f32 v57, v57, v118
    v_mul_f32 v46, v46, v117
    v_mul_f32 v58, v58, v118
    v_mul_f32 v47, v47, v117
    v_mul_f32 v59, v59, v118
    v_mul_f32 v48, v48, v117
    v_mul_f32 v60, v60, v118
    v_mul_f32 v49, v49, v117
    v_mul_f32 v61, v61, v118
    v_mul_f32 v50, v50, v117
    v_mul_f32 v62, v62, v118
    v_mul_f32 v51, v51, v117
    v_mul_f32 v63, v63, v118
    v_cvt_pk_bf16_f32 v116, v40, v41
    v_cvt_pk_bf16_f32 v117, v42, v43
    ds_write_b64 v136, v[116:117] offset:0
    s_nop 0
    v_cvt_pk_bf16_f32 v118, v52, v53
    v_cvt_pk_bf16_f32 v119, v54, v55
    ds_write_b64 v136, v[118:119] offset:40
    s_nop 0
    v_cvt_pk_bf16_f32 v116, v44, v45
    v_cvt_pk_bf16_f32 v117, v46, v47
    ds_write_b64 v136, v[116:117] offset:16
    s_nop 0
    v_cvt_pk_bf16_f32 v118, v56, v57
    v_cvt_pk_bf16_f32 v119, v58, v59
    ds_write_b64 v136, v[118:119] offset:56
    s_nop 0
    v_cvt_pk_bf16_f32 v116, v48, v49
    v_cvt_pk_bf16_f32 v117, v50, v51
    ds_write_b64 v137, v[116:117] offset:0
    s_nop 0
    v_cvt_pk_bf16_f32 v118, v60, v61
    v_cvt_pk_bf16_f32 v119, v62, v63
    ds_write_b64 v137, v[118:119] offset:40
    s_nop 0
    s_waitcnt lgkmcnt(0)
    ds_read_b64_tr_b16 v[96:97], v139 offset:0
    ds_read_b64_tr_b16 v[98:99], v139 offset:512
    ds_read_b64_tr_b16 v[100:101], v139 offset:32
    ds_read_b64_tr_b16 v[102:103], v139 offset:544
    ds_read_b64_tr_b16 v[104:105], v139 offset:64
    ds_read_b64_tr_b16 v[106:107], v139 offset:576
    ds_read_b64_tr_b16 v[108:109], v140 offset:0
    ds_read_b64_tr_b16 v[110:111], v140 offset:256
    ds_read_b64_tr_b16 v[112:113], v140 offset:32
    ds_read_b64_tr_b16 v[114:115], v140 offset:288
    s_waitcnt lgkmcnt(0)
    v_mfma_f32_16x16x32_bf16 v[64:67], v[96:99], v[108:111], v[64:67]
    v_mfma_f32_16x16x32_bf16 v[68:71], v[96:99], v[112:115], v[68:71]
    v_mfma_f32_16x16x32_bf16 v[72:75], v[100:103], v[108:111], v[72:75]
    v_mfma_f32_16x16x32_bf16 v[76:79], v[100:103], v[112:115], v[76:79]
    v_mfma_f32_16x16x32_bf16 v[80:83], v[104:107], v[108:111], v[80:83]
    v_mfma_f32_16x16x32_bf16 v[84:87], v[104:107], v[112:115], v[84:87]
    s_nop 7
    s_nop 7
    s_barrier
    v_lshlrev_b32 v3, 13, v2
    v_lshl_add_u32 v3, v1, 2, v3
    ds_write_b32 v3, v64 offset:0
    ds_write_b32 v3, v65 offset:256
    ds_write_b32 v3, v66 offset:512
    ds_write_b32 v3, v67 offset:768
    ds_write_b32 v3, v68 offset:1024
    ds_write_b32 v3, v69 offset:1280
    ds_write_b32 v3, v70 offset:1536
    ds_write_b32 v3, v71 offset:1792
    ds_write_b32 v3, v72 offset:2048
    ds_write_b32 v3, v73 offset:2304
    ds_write_b32 v3, v74 offset:2560
    ds_write_b32 v3, v75 offset:2816
    ds_write_b32 v3, v76 offset:3072
    ds_write_b32 v3, v77 offset:3328
    ds_write_b32 v3, v78 offset:3584
    ds_write_b32 v3, v79 offset:3840
    ds_write_b32 v3, v80 offset:4096
    ds_write_b32 v3, v81 offset:4352
    ds_write_b32 v3, v82 offset:4608
    ds_write_b32 v3, v83 offset:4864
    ds_write_b32 v3, v84 offset:5120
    ds_write_b32 v3, v85 offset:5376
    ds_write_b32 v3, v86 offset:5632
    ds_write_b32 v3, v87 offset:5888
    s_waitcnt lgkmcnt(0)
    s_barrier
    v_mul_u32_u24 v3, 1536, v2
    v_lshl_add_u32 v3, v1, 2, v3
    ds_read_b32 v24, v3 offset:0
    ds_read_b32 v25, v3 offset:8192
    ds_read_b32 v26, v3 offset:16384
    ds_read_b32 v27, v3 offset:24576
    ds_read_b32 v28, v3 offset:256
    ds_read_b32 v29, v3 offset:8448
    ds_read_b32 v30, v3 offset:16640
    ds_read_b32 v31, v3 offset:24832
    ds_read_b32 v32, v3 offset:512
    ds_read_b32 v33, v3 offset:8704
    ds_read_b32 v34, v3 offset:16896
    ds_read_b32 v35, v3 offset:25088
    ds_read_b32 v36, v3 offset:768
    ds_read_b32 v37, v3 offset:8960
    ds_read_b32 v38, v3 offset:17152
    ds_read_b32 v39, v3 offset:25344
    ds_read_b32 v40, v3 offset:1024
    ds_read_b32 v41, v3 offset:9216
    ds_read_b32 v42, v3 offset:17408
    ds_read_b32 v43, v3 offset:25600
    ds_read_b32 v44, v3 offset:1280
    ds_read_b32 v45, v3 offset:9472
    ds_read_b32 v46, v3 offset:17664
    ds_read_b32 v47, v3 offset:25856
    s_waitcnt lgkmcnt(0)
    v_add_f32 v24, v24, v25
    v_add_f32 v26, v26, v27
    v_add_f32 v24, v24, v26
    v_add_f32 v28, v28, v29
    v_add_f32 v30, v30, v31
    v_add_f32 v28, v28, v30
    v_add_f32 v32, v32, v33
    v_add_f32 v34, v34, v35
    v_add_f32 v32, v32, v34
    v_add_f32 v36, v36, v37
    v_add_f32 v38, v38, v39
    v_add_f32 v36, v36, v38
    v_add_f32 v40, v40, v41
    v_add_f32 v42, v42, v43
    v_add_f32 v40, v40, v42
    v_add_f32 v44, v44, v45
    v_add_f32 v46, v46, v47
    v_add_f32 v44, v44, v46
    v_lshrrev_b32 v3, 4, v1
    v_and_b32 v4, 15, v1
    v_lshlrev_b32 v3, 9, v3
    v_lshl_add_u32 v3, v4, 2, v3
    s_lshl_b32 s29, s26, 3
    s_add_u32 s29, s29, s28
    s_mul_i32 s29, s29, 6144
    v_add_u32 v3, s29, v3
    v_readfirstlane_b32 s30, v2
    s_nop 3
    s_cmp_lg_u32 s30, 0
    s_cbranch_scc1 Lw_kv_kernel_2
    v_add_u32 v4, 0, v3
    buffer_store_dword v24, v4, s[16:19], 0 offen
    v_add_u32 v4, 128, v3
    buffer_store_dword v28, v4, s[16:19], 0 offen
    v_add_u32 v4, 256, v3
    buffer_store_dword v32, v4, s[16:19], 0 offen
    v_add_u32 v4, 384, v3
    buffer_store_dword v36, v4, s[16:19], 0 offen
    v_add_u32 v4, 64, v3
    buffer_store_dword v40, v4, s[16:19], 0 offen
    v_add_u32 v4, 192, v3
    buffer_store_dword v44, v4, s[16:19], 0 offen
Lw_kv_kernel_2:
    s_cmp_lg_u32 s30, 1
    s_cbranch_scc1 Lw_kv_kernel_3
    v_add_u32 v4, 320, v3
    buffer_store_dword v24, v4, s[16:19], 0 offen
    v_add_u32 v4, 448, v3
    buffer_store_dword v28, v4, s[16:19], 0 offen
    v_add_u32 v4, 2048, v3
    buffer_store_dword v32, v4, s[16:19], 0 offen
    v_add_u32 v4, 2176, v3
    buffer_store_dword v36, v4, s[16:19], 0 offen
    v_add_u32 v4, 2304, v3
    buffer_store_dword v40, v4, s[16:19], 0 offen
    v_add_u32 v4, 2432, v3
    buffer_store_dword v44, v4, s[16:19], 0 offen
Lw_kv_kernel_3:
    s_cmp_lg_u32 s30, 2
    s_cbranch_scc1 Lw_kv_kernel_4
    v_add_u32 v4, 2112, v3
    buffer_store_dword v24, v4, s[16:19], 0 offen
    v_add_u32 v4, 2240, v3
    buffer_store_dword v28, v4, s[16:19], 0 offen
    v_add_u32 v4, 2368, v3
    buffer_store_dword v32, v4, s[16:19], 0 offen
    v_add_u32 v4, 2496, v3
    buffer_store_dword v36, v4, s[16:19], 0 offen
    v_add_u32 v4, 4096, v3
    buffer_store_dword v40, v4, s[16:19], 0 offen
    v_add_u32 v4, 4224, v3
    buffer_store_dword v44, v4, s[16:19], 0 offen
Lw_kv_kernel_4:
    s_cmp_lg_u32 s30, 3
    s_cbranch_scc1 Lw_kv_kernel_5
    v_add_u32 v4, 4352, v3
    buffer_store_dword v24, v4, s[16:19], 0 offen
    v_add_u32 v4, 4480, v3
    buffer_store_dword v28, v4, s[16:19], 0 offen
    v_add_u32 v4, 4160, v3
    buffer_store_dword v32, v4, s[16:19], 0 offen
    v_add_u32 v4, 4288, v3
    buffer_store_dword v36, v4, s[16:19], 0 offen
    v_add_u32 v4, 4416, v3
    buffer_store_dword v40, v4, s[16:19], 0 offen
    v_add_u32 v4, 4544, v3
    buffer_store_dword v44, v4, s[16:19], 0 offen
Lw_kv_kernel_5:
Lend_kv_kernel_1:
    s_endpgm
.section .rodata,"a"
.p2align 6
.amdhsa_kernel kv_kernel
  .amdhsa_next_free_vgpr 144
  .amdhsa_next_free_sgpr 40
  .amdhsa_accum_offset 144
  .amdhsa_group_segment_fixed_size 0
  .amdhsa_kernarg_size 96
  .amdhsa_user_sgpr_count 2
  .amdhsa_user_sgpr_kernarg_segment_ptr 1
  .amdhsa_system_sgpr_workgroup_id_x 1
.end_amdhsa_kernel
.text

.globl attn_kernel
.p2align 8
.type attn_kernel,@function
attn_kernel:
    s_cmp_ge_u32 s2, 256
    s_cbranch_scc1 Lend_attn_kernel_1
    s_load_dwordx2 s[4:5], s[0:1], 88
    s_load_dwordx2 s[6:7], s[0:1], 16
    s_load_dwordx2 s[24:25], s[0:1], 88
    s_load_dwordx2 s[36:37], s[0:1], 88
    s_lshr_b32 s26, s2, 3
    s_and_b32 s28, s2, 7
    s_waitcnt lgkmcnt(0)
    s_add_u32 s8, s4, 5242880
    s_addc_u32 s9, s5, 0
    s_mov_b32 s10, 7864320
    s_mov_b32 s11, 0x00020000
    s_mov_b32 s12, s6
    s_mov_b32 s13, s7
    s_mov_b32 s14, 25600
    s_mov_b32 s15, 0x00020000
    s_add_u32 s16, s24, 28311552
    s_addc_u32 s17, s25, 0
    s_mov_b32 s18, 6291456
    s_mov_b32 s19, 0x00020000
    s_add_u32 s20, s36, 13107200
    s_addc_u32 s21, s37, 0
    s_mov_b32 s22, 2621440
    s_mov_b32 s23, 0x00020000
    v_and_b32 v1, 63, v0
    v_lshrrev_b32 v2, 6, v0
    s_mul_i32 s29, s26, 49152
    v_lshlrev_b32 v3, 3, v0
    v_add_u32 v3, s29, v3
    v_mov_b32 v112, 0
    v_mov_b32 v113, 0
    v_mov_b32 v114, 0
    v_mov_b32 v115, 0
    v_mov_b32 v116, 0
    v_mov_b32 v117, 0
    v_add_u32 v4, 0, v3
    buffer_load_dwordx2 v[24:25], v4, s[16:19], 0 offen
    v_add_u32 v4, 2048, v3
    buffer_load_dwordx2 v[26:27], v4, s[16:19], 0 offen
    v_add_u32 v4, 4096, v3
    buffer_load_dwordx2 v[28:29], v4, s[16:19], 0 offen
    v_add_u32 v4, 6144, v3
    buffer_load_dwordx2 v[30:31], v4, s[16:19], 0 offen
    v_add_u32 v4, 8192, v3
    buffer_load_dwordx2 v[32:33], v4, s[16:19], 0 offen
    v_add_u32 v4, 10240, v3
    buffer_load_dwordx2 v[34:35], v4, s[16:19], 0 offen
    v_add_u32 v4, 12288, v3
    buffer_load_dwordx2 v[36:37], v4, s[16:19], 0 offen
    v_add_u32 v4, 14336, v3
    buffer_load_dwordx2 v[38:39], v4, s[16:19], 0 offen
    v_add_u32 v4, 16384, v3
    buffer_load_dwordx2 v[40:41], v4, s[16:19], 0 offen
    v_add_u32 v4, 18432, v3
    buffer_load_dwordx2 v[42:43], v4, s[16:19], 0 offen
    v_add_u32 v4, 20480, v3
    buffer_load_dwordx2 v[44:45], v4, s[16:19], 0 offen
    v_add_u32 v4, 22528, v3
    buffer_load_dwordx2 v[46:47], v4, s[16:19], 0 offen
    s_waitcnt vmcnt(0)
    v_add_f32 v112, v112, v24
    v_add_f32 v113, v113, v25
    v_add_f32 v114, v114, v26
    v_add_f32 v115, v115, v27
    v_add_f32 v116, v116, v28
    v_add_f32 v117, v117, v29
    v_add_f32 v112, v112, v30
    v_add_f32 v113, v113, v31
    v_add_f32 v114, v114, v32
    v_add_f32 v115, v115, v33
    v_add_f32 v116, v116, v34
    v_add_f32 v117, v117, v35
    v_add_f32 v112, v112, v36
    v_add_f32 v113, v113, v37
    v_add_f32 v114, v114, v38
    v_add_f32 v115, v115, v39
    v_add_f32 v116, v116, v40
    v_add_f32 v117, v117, v41
    v_add_f32 v112, v112, v42
    v_add_f32 v113, v113, v43
    v_add_f32 v114, v114, v44
    v_add_f32 v115, v115, v45
    v_add_f32 v116, v116, v46
    v_add_f32 v117, v117, v47
    v_add_u32 v4, 24576, v3
    buffer_load_dwordx2 v[24:25], v4, s[16:19], 0 offen
    v_add_u32 v4, 26624, v3
    buffer_load_dwordx2 v[26:27], v4, s[16:19], 0 offen
    v_add_u32 v4, 28672, v3
    buffer_load_dwordx2 v[28:29], v4, s[16:19], 0 offen
    v_add_u32 v4, 30720, v3
    buffer_load_dwordx2 v[30:31], v4, s[16:19], 0 offen
    v_add_u32 v4, 32768, v3
    buffer_load_dwordx2 v[32:33], v4, s[16:19], 0 offen
    v_add_u32 v4, 34816, v3
    buffer_load_dwordx2 v[34:35], v4, s[16:19], 0 offen
    v_add_u32 v4, 36864, v3
    buffer_load_dwordx2 v[36:37], v4, s[16:19], 0 offen
    v_add_u32 v4, 38912, v3
    buffer_load_dwordx2 v[38:39], v4, s[16:19], 0 offen
    v_add_u32 v4, 40960, v3
    buffer_load_dwordx2 v[40:41], v4, s[16:19], 0 offen
    v_add_u32 v4, 43008, v3
    buffer_load_dwordx2 v[42:43], v4, s[16:19], 0 offen
    v_add_u32 v4, 45056, v3
    buffer_load_dwordx2 v[44:45], v4, s[16:19], 0 offen
    v_add_u32 v4, 47104, v3
    buffer_load_dwordx2 v[46:47], v4, s[16:19], 0 offen
    s_waitcnt vmcnt(0)
    v_add_f32 v112, v112, v24
    v_add_f32 v113, v113, v25
    v_add_f32 v114, v114, v26
    v_add_f32 v115, v115, v27
    v_add_f32 v116, v116, v28
    v_add_f32 v117, v117, v29
    v_add_f32 v112, v112, v30
    v_add_f32 v113, v113, v31
    v_add_f32 v114, v114, v32
    v_add_f32 v115, v115, v33
    v_add_f32 v116, v116, v34
    v_add_f32 v117, v117, v35
    v_add_f32 v112, v112, v36
    v_add_f32 v113, v113, v37
    v_add_f32 v114, v114, v38
    v_add_f32 v115, v115, v39
    v_add_f32 v116, v116, v40
    v_add_f32 v117, v117, v41
    v_add_f32 v112, v112, v42
    v_add_f32 v113, v113, v43
    v_add_f32 v114, v114, v44
    v_add_f32 v115, v115, v45
    v_add_f32 v116, v116, v46
    v_add_f32 v117, v117, v47
    v_lshlrev_b32 v3, 2, v0
    v_cvt_pk_bf16_f32 v118, v112, v113
    ds_write_b32 v3, v118 offset:0
    v_cvt_pk_bf16_f32 v119, v114, v115
    ds_write_b32 v3, v119 offset:1024
    v_cvt_pk_bf16_f32 v120, v116, v117
    ds_write_b32 v3, v120 offset:2048
    v_mov_b32 v121, 0
    ds_write_b32 v3, v121 offset:4096
    s_waitcnt lgkmcnt(0)
    s_barrier
    v_and_b32 v3, 31, v1
    v_lshrrev_b32 v4, 5, v1
    v_mul_u32_u24 v5, 320, v4
    v_lshl_add_u32 v5, v3, 1, v5
    s_mul_i32 s27, s26, 800
    v_add_u32 v5, s27, v5
    v_cmp_gt_u32 vcc, 20, v3
    v_mov_b32 v6, 0x7ffffff0
    s_nop 1
    v_cndmask_b32 v5, v6, v5, vcc
    buffer_load_ushort v112, v5, s[12:15], 0 offen offset:0
    buffer_load_ushort v113, v5, s[12:15], 0 offen offset:40
    buffer_load_ushort v114, v5, s[12:15], 0 offen offset:80
    buffer_load_ushort v115, v5, s[12:15], 0 offen offset:120
    buffer_load_ushort v116, v5, s[12:15], 0 offen offset:160
    buffer_load_ushort v117, v5, s[12:15], 0 offen offset:200
    buffer_load_ushort v118, v5, s[12:15], 0 offen offset:240
    buffer_load_ushort v119, v5, s[12:15], 0 offen offset:280
    v_cmp_eq_u32 vcc, 0, v4
    s_nop 1
    v_cndmask_b32 v6, v6, v5, vcc
    buffer_load_ushort v120, v6, s[12:15], 0 offen offset:640
    buffer_load_ushort v121, v6, s[12:15], 0 offen offset:680
    buffer_load_ushort v122, v6, s[12:15], 0 offen offset:720
    buffer_load_ushort v123, v6, s[12:15], 0 offen offset:760
    s_waitcnt vmcnt(0)
    v_lshl_or_b32 v8, v113, 16, v112
    v_lshl_or_b32 v9, v115, 16, v114
    v_lshl_or_b32 v10, v117, 16, v116
    v_lshl_or_b32 v11, v119, 16, v118
    v_lshl_or_b32 v12, v121, 16, v120
    v_lshl_or_b32 v13, v123, 16, v122
    v_mov_b32 v14, 0
    v_mov_b32 v15, 0
    v_and_b32 v3, 31, v1
    v_lshrrev_b32 v4, 5, v1
    v_lshlrev_b32 v5, 1, v3
    v_lshl_add_u32 v5, v4, 8, v5
    v_cmp_ge_u32 vcc, 20, v3
    v_mov_b32 v6, 4096
    s_nop 1
    v_cndmask_b32 v5, v6, v5, vcc
    v_cmp_eq_u32 vcc, 0, v4
    s_nop 1
    v_cndmask_b32 v7, v6, v5, vcc
    v_add_u32 v122, 0, v5
    v_cmp_eq_u32 vcc, 4096, v5
    s_nop 1
    v_cndmask_b32 v122, v122, v5, vcc
    ds_read_u16 v80, v122
    v_add_u32 v122, 64, v5
    v_cmp_eq_u32 vcc, 4096, v5
    s_nop 1
    v_cndmask_b32 v122, v122, v5, vcc
    ds_read_u16 v81, v122
    v_add_u32 v122, 128, v5
    v_cmp_eq_u32 vcc, 4096, v5
    s_nop 1
    v_cndmask_b32 v122, v122, v5, vcc
    ds_read_u16 v82, v122
    v_add_u32 v122, 192, v5
    v_cmp_eq_u32 vcc, 4096, v5
    s_nop 1
    v_cndmask_b32 v122, v122, v5, vcc
    ds_read_u16 v83, v122
    v_add_u32 v122, 512, v5
    v_cmp_eq_u32 vcc, 4096, v5
    s_nop 1
    v_cndmask_b32 v122, v122, v5, vcc
    ds_read_u16 v84, v122
    v_add_u32 v122, 576, v5
    v_cmp_eq_u32 vcc, 4096, v5
    s_nop 1
    v_cndmask_b32 v122, v122, v5, vcc
    ds_read_u16 v85, v122
    v_add_u32 v122, 640, v5
    v_cmp_eq_u32 vcc, 4096, v5
    s_nop 1
    v_cndmask_b32 v122, v122, v5, vcc
    ds_read_u16 v86, v122
    v_add_u32 v122, 704, v5
    v_cmp_eq_u32 vcc, 4096, v5
    s_nop 1
    v_cndmask_b32 v122, v122, v5, vcc
    ds_read_u16 v87, v122
    s_waitcnt lgkmcnt(0)
    v_lshl_or_b32 v64, v81, 16, v80
    v_lshl_or_b32 v65, v83, 16, v82
    v_lshl_or_b32 v66, v85, 16, v84
    v_lshl_or_b32 v67, v87, 16, v86
    v_add_u32 v122, 1024, v7
    v_cmp_eq_u32 vcc, 4096, v7
    s_nop 1
    v_cndmask_b32 v122, v122, v7, vcc
    ds_read_u16 v80, v122
    v_add_u32 v122, 1088, v7
    v_cmp_eq_u32 vcc, 4096, v7
    s_nop 1
    v_cndmask_b32 v122, v122, v7, vcc
    ds_read_u16 v81, v122
    v_add_u32 v122, 1152, v7
    v_cmp_eq_u32 vcc, 4096, v7
    s_nop 1
    v_cndmask_b32 v122, v122, v7, vcc
    ds_read_u16 v82, v122
    v_add_u32 v122, 1216, v7
    v_cmp_eq_u32 vcc, 4096, v7
    s_nop 1
    v_cndmask_b32 v122, v122, v7, vcc
    ds_read_u16 v83, v122
    v_mov_b32 v84, 0
    v_mov_b32 v85, 0
    v_mov_b32 v86, 0
    v_mov_b32 v87, 0
    s_waitcnt lgkmcnt(0)
    v_lshl_or_b32 v68, v81, 16, v80
    v_lshl_or_b32 v69, v83, 16, v82
    v_lshl_or_b32 v70, v85, 16, v84
    v_lshl_or_b32 v71, v87, 16, v86
    v_add_u32 v122, 1280, v5
    v_cmp_eq_u32 vcc, 4096, v5
    s_nop 1
    v_cndmask_b32 v122, v122, v5, vcc
    ds_read_u16 v80, v122
    v_add_u32 v122, 1344, v5
    v_cmp_eq_u32 vcc, 4096, v5
    s_nop 1
    v_cndmask_b32 v122, v122, v5, vcc
    ds_read_u16 v81, v122
    v_add_u32 v122, 1408, v5
    v_cmp_eq_u32 vcc, 4096, v5
    s_nop 1
    v_cndmask_b32 v122, v122, v5, vcc
    ds_read_u16 v82, v122
    v_add_u32 v122, 1472, v5
    v_cmp_eq_u32 vcc, 4096, v5
    s_nop 1
    v_cndmask_b32 v122, v122, v5, vcc
    ds_read_u16 v83, v122
    v_add_u32 v122, 1792, v5
    v_cmp_eq_u32 vcc, 4096, v5
    s_nop 1
    v_cndmask_b32 v122, v122, v5, vcc
    ds_read_u16 v84, v122
    v_add_u32 v122, 1856, v5
    v_cmp_eq_u32 vcc, 4096, v5
    s_nop 1
    v_cndmask_b32 v122, v122, v5, vcc
    ds_read_u16 v85, v122
    v_add_u32 v122, 1920, v5
    v_cmp_eq_u32 vcc, 4096, v5
    s_nop 1
    v_cndmask_b32 v122, v122, v5, vcc
    ds_read_u16 v86, v122
    v_add_u32 v122, 1984, v5
    v_cmp_eq_u32 vcc, 4096, v5
    s_nop 1
    v_cndmask_b32 v122, v122, v5, vcc
    ds_read_u16 v87, v122
    s_waitcnt lgkmcnt(0)
    v_lshl_or_b32 v72, v81, 16, v80
    v_lshl_or_b32 v73, v83, 16, v82
    v_lshl_or_b32 v74, v85, 16, v84
    v_lshl_or_b32 v75, v87, 16, v86
    v_add_u32 v122, 2304, v7
    v_cmp_eq_u32 vcc, 4096, v7
    s_nop 1
    v_cndmask_b32 v122, v122, v7, vcc
    ds_read_u16 v80, v122
    v_add_u32 v122, 2368, v7
    v_cmp_eq_u32 vcc, 4096, v7
    s_nop 1
    v_cndmask_b32 v122, v122, v7, vcc
    ds_read_u16 v81, v122
    v_add_u32 v122, 2432, v7
    v_cmp_eq_u32 vcc, 4096, v7
    s_nop 1
    v_cndmask_b32 v122, v122, v7, vcc
    ds_read_u16 v82, v122
    v_add_u32 v122, 2496, v7
    v_cmp_eq_u32 vcc, 4096, v7
    s_nop 1
    v_cndmask_b32 v122, v122, v7, vcc
    ds_read_u16 v83, v122
    v_mov_b32 v84, 0
    v_mov_b32 v85, 0
    v_mov_b32 v86, 0
    v_mov_b32 v87, 0
    s_waitcnt lgkmcnt(0)
    v_lshl_or_b32 v76, v81, 16, v80
    v_lshl_or_b32 v77, v83, 16, v82
    v_lshl_or_b32 v78, v85, 16, v84
    v_lshl_or_b32 v79, v87, 16, v86
    v_and_b32 v3, 31, v1
    v_lshrrev_b32 v4, 5, v1
    s_lshl_b32 s29, s28, 8
    v_lshl_add_u32 v5, v2, 6, v3
    v_add_u32 v5, s29, v5
    v_mul_u32_u24 v6, 3840, v5
    s_mul_i32 s30, s26, 40
    v_lshl_add_u32 v6, v4, 4, v6
    v_add_u32 v132, s30, v6
    v_add_u32 v133, 32, v132
    v_mov_b32 v7, 0x7ffffff0
    v_cmp_eq_u32 vcc, 0, v4
    s_nop 1
    v_cndmask_b32 v133, v7, v133, vcc
    v_mov_b32 v134, 0xff800000
    v_cndmask_b32 v134, v134, 0, vcc
    v_mul_u32_u24 v6, 1280, v5
    v_lshl_add_u32 v6, v4, 3, v6
    v_add_u32 v135, s30, v6
    buffer_load_dwordx4 v[16:19], v132, s[8:11], 0 offen
    buffer_load_dwordx2 v[20:21], v133, s[8:11], 0 offen
    v_mov_b32 v22, 0
    v_mov_b32 v23, 0
    s_waitcnt vmcnt(0)
    s_nop 1
    v_mfma_f32_32x32x16_bf16 v[24:39], v[8:11], v[16:19], 0
    v_mfma_f32_32x32x16_bf16 v[24:39], v[12:15], v[20:23], v[24:39]
    s_nop 15
    s_nop 3
    v_cvt_pk_bf16_f32 v112, v24, v25
    v_lshlrev_b32 v24, 16, v112
    v_and_b32 v25, 0xffff0000, v112
    v_cvt_pk_bf16_f32 v112, v26, v27
    v_lshlrev_b32 v26, 16, v112
    v_and_b32 v27, 0xffff0000, v112
    v_cvt_pk_bf16_f32 v112, v28, v29
    v_lshlrev_b32 v28, 16, v112
    v_and_b32 v29, 0xffff0000, v112
    v_cvt_pk_bf16_f32 v112, v30, v31
    v_lshlrev_b32 v30, 16, v112
    v_and_b32 v31, 0xffff0000, v112
    v_cvt_pk_bf16_f32 v112, v32, v33
    v_lshlrev_b32 v32, 16, v112
    v_and_b32 v33, 0xffff0000, v112
    v_cvt_pk_bf16_f32 v112, v34, v35
    v_lshlrev_b32 v34, 16, v112
    v_and_b32 v35, 0xffff0000, v112
    v_add_f32 v48, v32, v134
    v_sub_f32 v60, v134, v32
    v_add_f32 v49, v33, v134
    v_sub_f32 v61, v134, v33
    v_add_f32 v50, v34, v134
    v_sub_f32 v62, v134, v34
    v_add_f32 v51, v35, v134
    v_sub_f32 v63, v134, v35
    v_max3_f32 v113, v24, v25, v26
    v_max3_f32 v113, v113, v27, v28
    v_max3_f32 v113, v113, v29, v30
    v_max3_f32 v113, v113, v31, v48
    v_max3_f32 v113, v113, v49, v50
    v_max_f32 v113, v113, v51
    v_min3_f32 v114, v24, v25, v26
    v_min3_f32 v114, v114, v27, v28
    v_min3_f32 v114, v114, v29, v30
    v_min_f32 v114, v114, v31
    v_sub_f32 v114, 0, v114
    v_max3_f32 v114, v114, v60, v61
    v_max3_f32 v114, v114, v62, v63
    v_mov_b32 v115, v113
    v_mov_b32 v116, v114
    s_nop 1
    v_permlane32_swap_b32 v113, v115
    v_permlane32_swap_b32 v114, v116
    v_max_f32 v113, v113, v115
    v_max_f32 v114, v114, v116
    v_mul_f32 v113, 0xbfb8aa3b, v113
    v_mul_f32 v114, 0xbfb8aa3b, v114
    v_mov_b32 v117, 0x3fb8aa3b
    v_fma_f32 v40, v24, v117, v113
    v_fma_f32 v52, -v24, v117, v114
    v_fma_f32 v41, v25, v117, v113
    v_fma_f32 v53, -v25, v117, v114
    v_fma_f32 v42, v26, v117, v113
    v_fma_f32 v54, -v26, v117, v114
    v_fma_f32 v43, v27, v117, v113
    v_fma_f32 v55, -v27, v117, v114
    v_fma_f32 v44, v28, v117, v113
    v_fma_f32 v56, -v28, v117, v114
    v_fma_f32 v45, v29, v117, v113
    v_fma_f32 v57, -v29, v117, v114
    v_fma_f32 v46, v30, v117, v113
    v_fma_f32 v58, -v30, v117, v114
    v_fma_f32 v47, v31, v117, v113
    v_fma_f32 v59, -v31, v117, v114
    v_fma_f32 v48, v48, v117, v113
    v_fma_f32 v60, v60, v117, v114
    v_fma_f32 v49, v49, v117, v113
    v_fma_f32 v61, v61, v117, v114
    v_fma_f32 v50, v50, v117, v113
    v_fma_f32 v62, v62, v117, v114
    v_fma_f32 v51, v51, v117, v113
    v_fma_f32 v63, v63, v117, v114
    v_exp_f32 v40, v40
    v_exp_f32 v52, v52
    v_exp_f32 v41, v41
    v_exp_f32 v53, v53
    v_exp_f32 v42, v42
    v_exp_f32 v54, v54
    v_exp_f32 v43, v43
    v_exp_f32 v55, v55
    v_exp_f32 v44, v44
    v_exp_f32 v56, v56
    v_exp_f32 v45, v45
    v_exp_f32 v57, v57
    v_exp_f32 v46, v46
    v_exp_f32 v58, v58
    v_exp_f32 v47, v47
    v_exp_f32 v59, v59
    v_exp_f32 v48, v48
    v_exp_f32 v60, v60
    v_exp_f32 v49, v49
    v_exp_f32 v61, v61
    v_exp_f32 v50, v50
    v_exp_f32 v62, v62
    v_exp_f32 v51, v51
    v_exp_f32 v63, v63
    s_nop 0
    v_add_f32 v113, v40, v41
    v_add_f32 v114, v52, v53
    v_add_f32 v113, v113, v42
    v_add_f32 v114, v114, v54
    v_add_f32 v113, v113, v43
    v_add_f32 v114, v114, v55
    v_add_f32 v113, v113, v44
    v_add_f32 v114, v114, v56
    v_add_f32 v113, v113, v45
    v_add_f32 v114, v114, v57
    v_add_f32 v113, v113, v46
    v_add_f32 v114, v114, v58
    v_add_f32 v113, v113, v47
    v_add_f32 v114, v114, v59
    v_add_f32 v113, v113, v48
    v_add_f32 v114, v114, v60
    v_add_f32 v113, v113, v49
    v_add_f32 v114, v114, v61
    v_add_f32 v113, v113, v50
    v_add_f32 v114, v114, v62
    v_add_f32 v113, v113, v51
    v_add_f32 v114, v114, v63
    v_mov_b32 v115, v113
    v_mov_b32 v116, v114
    s_nop 1
    v_permlane32_swap_b32 v113, v115
    v_permlane32_swap_b32 v114, v116
    v_add_f32 v113, v113, v115
    v_add_f32 v114, v114, v116
    v_rcp_f32 v113, v113
    v_rcp_f32 v114, v114
    s_nop 0
    v_mul_f32 v40, v40, v113
    v_mul_f32 v52, v52, v114
    v_mul_f32 v41, v41, v113
    v_mul_f32 v53, v53, v114
    v_mul_f32 v42, v42, v113
    v_mul_f32 v54, v54, v114
    v_mul_f32 v43, v43, v113
    v_mul_f32 v55, v55, v114
    v_mul_f32 v44, v44, v113
    v_mul_f32 v56, v56, v114
    v_mul_f32 v45, v45, v113
    v_mul_f32 v57, v57, v114
    v_mul_f32 v46, v46, v113
    v_mul_f32 v58, v58, v114
    v_mul_f32 v47, v47, v113
    v_mul_f32 v59, v59, v114
    v_mul_f32 v48, v48, v113
    v_mul_f32 v60, v60, v114
    v_mul_f32 v49, v49, v113
    v_mul_f32 v61, v61, v114
    v_mul_f32 v50, v50, v113
    v_mul_f32 v62, v62, v114
    v_mul_f32 v51, v51, v113
    v_mul_f32 v63, v63, v114
    v_cvt_pk_bf16_f32 v80, v40, v41
    v_cvt_pk_bf16_f32 v81, v42, v43
    v_cvt_pk_bf16_f32 v82, v44, v45
    v_cvt_pk_bf16_f32 v83, v46, v47
    v_cvt_pk_bf16_f32 v84, v48, v49
    v_cvt_pk_bf16_f32 v85, v50, v51
    v_mov_b32 v86, 0
    v_mov_b32 v87, 0
    v_cvt_pk_bf16_f32 v88, v52, v53
    v_cvt_pk_bf16_f32 v89, v54, v55
    v_cvt_pk_bf16_f32 v90, v56, v57
    v_cvt_pk_bf16_f32 v91, v58, v59
    v_cvt_pk_bf16_f32 v92, v60, v61
    v_cvt_pk_bf16_f32 v93, v62, v63
    v_mov_b32 v94, 0
    v_mov_b32 v95, 0
    s_nop 1
    v_mfma_f32_32x32x16_bf16 v[96:111], v[64:67], v[80:83], 0
    v_mfma_f32_32x32x16_bf16 v[96:111], v[68:71], v[84:87], v[96:111]
    v_mfma_f32_32x32x16_bf16 v[96:111], v[72:75], v[88:91], v[96:111]
    v_mfma_f32_32x32x16_bf16 v[96:111], v[76:79], v[92:95], v[96:111]
    s_nop 15
    s_nop 3
    v_mov_b32 v112, v104
    v_mov_b32 v113, v104
    s_nop 1
    v_permlane32_swap_b32 v112, v113
    v_cvt_pk_bf16_f32 v113, v113, v113
    v_lshlrev_b32 v113, 16, v113
    v_add_f32 v113, 0x358637bd, v113
    v_cvt_pk_bf16_f32 v113, v113, v113
    v_lshlrev_b32 v113, 16, v113
    v_rcp_f32 v113, v113
    s_nop 0
    v_cvt_pk_bf16_f32 v114, v96, v97
    v_cvt_pk_bf16_f32 v115, v98, v99
    v_lshlrev_b32 v96, 16, v114
    v_and_b32 v97, 0xffff0000, v114
    v_lshlrev_b32 v98, 16, v115
    v_and_b32 v99, 0xffff0000, v115
    v_mul_f32 v96, v96, v113
    v_mul_f32 v97, v97, v113
    v_mul_f32 v98, v98, v113
    v_mul_f32 v99, v99, v113
    v_cvt_pk_bf16_f32 v96, v96, v97
    v_cvt_pk_bf16_f32 v97, v98, v99
    v_cvt_pk_bf16_f32 v114, v100, v101
    v_cvt_pk_bf16_f32 v115, v102, v103
    v_lshlrev_b32 v100, 16, v114
    v_and_b32 v101, 0xffff0000, v114
    v_lshlrev_b32 v102, 16, v115
    v_and_b32 v103, 0xffff0000, v115
    v_mul_f32 v100, v100, v113
    v_mul_f32 v101, v101, v113
    v_mul_f32 v102, v102, v113
    v_mul_f32 v103, v103, v113
    v_cvt_pk_bf16_f32 v100, v100, v101
    v_cvt_pk_bf16_f32 v101, v102, v103
    v_cvt_pk_bf16_f32 v114, v104, v105
    v_cvt_pk_bf16_f32 v115, v106, v107
    v_lshlrev_b32 v104, 16, v114
    v_and_b32 v105, 0xffff0000, v114
    v_lshlrev_b32 v106, 16, v115
    v_and_b32 v107, 0xffff0000, v115
    v_mul_f32 v104, v104, v113
    v_mul_f32 v105, v105, v113
    v_mul_f32 v106, v106, v113
    v_mul_f32 v107, v107, v113
    v_cvt_pk_bf16_f32 v104, v104, v105
    v_cvt_pk_bf16_f32 v105, v106, v107
    buffer_store_dwordx2 v[96:97], v135, s[20:23], 0 offen
    buffer_store_dwordx2 v[100:101], v135, s[20:23], 0 offen offset:16
    v_lshrrev_b32 v4, 5, v1
    v_cmp_eq_u32 vcc, 0, v4
    s_and_saveexec_b64 s[32:33], vcc
    buffer_store_dwordx2 v[104:105], v135, s[20:23], 0 offen offset:32
    s_mov_b64 exec, s[32:33]
    s_waitcnt vmcnt(0)
    v_add_u32 v132, 122880, v132
    v_add_u32 v133, 122880, v133
    v_add_u32 v135, 40960, v135
    buffer_load_dwordx4 v[16:19], v132, s[8:11], 0 offen
    buffer_load_dwordx2 v[20:21], v133, s[8:11], 0 offen
    v_mov_b32 v22, 0
    v_mov_b32 v23, 0
    s_waitcnt vmcnt(0)
    s_nop 1
    v_mfma_f32_32x32x16_bf16 v[24:39], v[8:11], v[16:19], 0
    v_mfma_f32_32x32x16_bf16 v[24:39], v[12:15], v[20:23], v[24:39]
    s_nop 15
    s_nop 3
    v_cvt_pk_bf16_f32 v112, v24, v25
    v_lshlrev_b32 v24, 16, v112
    v_and_b32 v25, 0xffff0000, v112
    v_cvt_pk_bf16_f32 v112, v26, v27
    v_lshlrev_b32 v26, 16, v112
    v_and_b32 v27, 0xffff0000, v112
    v_cvt_pk_bf16_f32 v112, v28, v29
    v_lshlrev_b32 v28, 16, v112
    v_and_b32 v29, 0xffff0000, v112
    v_cvt_pk_bf16_f32 v112, v30, v31
    v_lshlrev_b32 v30, 16, v112
    v_and_b32 v31, 0xffff0000, v112
    v_cvt_pk_bf16_f32 v112, v32, v33
    v_lshlrev_b32 v32, 16, v112
    v_and_b32 v33, 0xffff0000, v112
    v_cvt_pk_bf16_f32 v112, v34, v35
    v_lshlrev_b32 v34, 16, v112
    v_and_b32 v35, 0xffff0000, v112
    v_add_f32 v48, v32, v134
    v_sub_f32 v60, v134, v32
    v_add_f32 v49, v33, v134
    v_sub_f32 v61, v134, v33
    v_add_f32 v50, v34, v134
    v_sub_f32 v62, v134, v34
    v_add_f32 v51, v35, v134
    v_sub_f32 v63, v134, v35
    v_max3_f32 v113, v24, v25, v26
    v_max3_f32 v113, v113, v27, v28
    v_max3_f32 v113, v113, v29, v30
    v_max3_f32 v113, v113, v31, v48
    v_max3_f32 v113, v113, v49, v50
    v_max_f32 v113, v113, v51
    v_min3_f32 v114, v24, v25, v26
    v_min3_f32 v114, v114, v27, v28
    v_min3_f32 v114, v114, v29, v30
    v_min_f32 v114, v114, v31
    v_sub_f32 v114, 0, v114
    v_max3_f32 v114, v114, v60, v61
    v_max3_f32 v114, v114, v62, v63
    v_mov_b32 v115, v113
    v_mov_b32 v116, v114
    s_nop 1
    v_permlane32_swap_b32 v113, v115
    v_permlane32_swap_b32 v114, v116
    v_max_f32 v113, v113, v115
    v_max_f32 v114, v114, v116
    v_mul_f32 v113, 0xbfb8aa3b, v113
    v_mul_f32 v114, 0xbfb8aa3b, v114
    v_mov_b32 v117, 0x3fb8aa3b
    v_fma_f32 v40, v24, v117, v113
    v_fma_f32 v52, -v24, v117, v114
    v_fma_f32 v41, v25, v117, v113
    v_fma_f32 v53, -v25, v117, v114
    v_fma_f32 v42, v26, v117, v113
    v_fma_f32 v54, -v26, v117, v114
    v_fma_f32 v43, v27, v117, v113
    v_fma_f32 v55, -v27, v117, v114
    v_fma_f32 v44, v28, v117, v113
    v_fma_f32 v56, -v28, v117, v114
    v_fma_f32 v45, v29, v117, v113
    v_fma_f32 v57, -v29, v117, v114
    v_fma_f32 v46, v30, v117, v113
    v_fma_f32 v58, -v30, v117, v114
    v_fma_f32 v47, v31, v117, v113
    v_fma_f32 v59, -v31, v117, v114
    v_fma_f32 v48, v48, v117, v113
    v_fma_f32 v60, v60, v117, v114
    v_fma_f32 v49, v49, v117, v113
    v_fma_f32 v61, v61, v117, v114
    v_fma_f32 v50, v50, v117, v113
    v_fma_f32 v62, v62, v117, v114
    v_fma_f32 v51, v51, v117, v113
    v_fma_f32 v63, v63, v117, v114
    v_exp_f32 v40, v40
    v_exp_f32 v52, v52
    v_exp_f32 v41, v41
    v_exp_f32 v53, v53
    v_exp_f32 v42, v42
    v_exp_f32 v54, v54
    v_exp_f32 v43, v43
    v_exp_f32 v55, v55
    v_exp_f32 v44, v44
    v_exp_f32 v56, v56
    v_exp_f32 v45, v45
    v_exp_f32 v57, v57
    v_exp_f32 v46, v46
    v_exp_f32 v58, v58
    v_exp_f32 v47, v47
    v_exp_f32 v59, v59
    v_exp_f32 v48, v48
    v_exp_f32 v60, v60
    v_exp_f32 v49, v49
    v_exp_f32 v61, v61
    v_exp_f32 v50, v50
    v_exp_f32 v62, v62
    v_exp_f32 v51, v51
    v_exp_f32 v63, v63
    s_nop 0
    v_add_f32 v113, v40, v41
    v_add_f32 v114, v52, v53
    v_add_f32 v113, v113, v42
    v_add_f32 v114, v114, v54
    v_add_f32 v113, v113, v43
    v_add_f32 v114, v114, v55
    v_add_f32 v113, v113, v44
    v_add_f32 v114, v114, v56
    v_add_f32 v113, v113, v45
    v_add_f32 v114, v114, v57
    v_add_f32 v113, v113, v46
    v_add_f32 v114, v114, v58
    v_add_f32 v113, v113, v47
    v_add_f32 v114, v114, v59
    v_add_f32 v113, v113, v48
    v_add_f32 v114, v114, v60
    v_add_f32 v113, v113, v49
    v_add_f32 v114, v114, v61
    v_add_f32 v113, v113, v50
    v_add_f32 v114, v114, v62
    v_add_f32 v113, v113, v51
    v_add_f32 v114, v114, v63
    v_mov_b32 v115, v113
    v_mov_b32 v116, v114
    s_nop 1
    v_permlane32_swap_b32 v113, v115
    v_permlane32_swap_b32 v114, v116
    v_add_f32 v113, v113, v115
    v_add_f32 v114, v114, v116
    v_rcp_f32 v113, v113
    v_rcp_f32 v114, v114
    s_nop 0
    v_mul_f32 v40, v40, v113
    v_mul_f32 v52, v52, v114
    v_mul_f32 v41, v41, v113
    v_mul_f32 v53, v53, v114
    v_mul_f32 v42, v42, v113
    v_mul_f32 v54, v54, v114
    v_mul_f32 v43, v43, v113
    v_mul_f32 v55, v55, v114
    v_mul_f32 v44, v44, v113
    v_mul_f32 v56, v56, v114
    v_mul_f32 v45, v45, v113
    v_mul_f32 v57, v57, v114
    v_mul_f32 v46, v46, v113
    v_mul_f32 v58, v58, v114
    v_mul_f32 v47, v47, v113
    v_mul_f32 v59, v59, v114
    v_mul_f32 v48, v48, v113
    v_mul_f32 v60, v60, v114
    v_mul_f32 v49, v49, v113
    v_mul_f32 v61, v61, v114
    v_mul_f32 v50, v50, v113
    v_mul_f32 v62, v62, v114
    v_mul_f32 v51, v51, v113
    v_mul_f32 v63, v63, v114
    v_cvt_pk_bf16_f32 v80, v40, v41
    v_cvt_pk_bf16_f32 v81, v42, v43
    v_cvt_pk_bf16_f32 v82, v44, v45
    v_cvt_pk_bf16_f32 v83, v46, v47
    v_cvt_pk_bf16_f32 v84, v48, v49
    v_cvt_pk_bf16_f32 v85, v50, v51
    v_mov_b32 v86, 0
    v_mov_b32 v87, 0
    v_cvt_pk_bf16_f32 v88, v52, v53
    v_cvt_pk_bf16_f32 v89, v54, v55
    v_cvt_pk_bf16_f32 v90, v56, v57
    v_cvt_pk_bf16_f32 v91, v58, v59
    v_cvt_pk_bf16_f32 v92, v60, v61
    v_cvt_pk_bf16_f32 v93, v62, v63
    v_mov_b32 v94, 0
    v_mov_b32 v95, 0
    s_nop 1
    v_mfma_f32_32x32x16_bf16 v[96:111], v[64:67], v[80:83], 0
    v_mfma_f32_32x32x16_bf16 v[96:111], v[68:71], v[84:87], v[96:111]
    v_mfma_f32_32x32x16_bf16 v[96:111], v[72:75], v[88:91], v[96:111]
    v_mfma_f32_32x32x16_bf16 v[96:111], v[76:79], v[92:95], v[96:111]
    s_nop 15
    s_nop 3
    v_mov_b32 v112, v104
    v_mov_b32 v113, v104
    s_nop 1
    v_permlane32_swap_b32 v112, v113
    v_cvt_pk_bf16_f32 v113, v113, v113
    v_lshlrev_b32 v113, 16, v113
    v_add_f32 v113, 0x358637bd, v113
    v_cvt_pk_bf16_f32 v113, v113, v113
    v_lshlrev_b32 v113, 16, v113
    v_rcp_f32 v113, v113
    s_nop 0
    v_cvt_pk_bf16_f32 v114, v96, v97
    v_cvt_pk_bf16_f32 v115, v98, v99
    v_lshlrev_b32 v96, 16, v114
    v_and_b32 v97, 0xffff0000, v114
    v_lshlrev_b32 v98, 16, v115
    v_and_b32 v99, 0xffff0000, v115
    v_mul_f32 v96, v96, v113
    v_mul_f32 v97, v97, v113
    v_mul_f32 v98, v98, v113
    v_mul_f32 v99, v99, v113
    v_cvt_pk_bf16_f32 v96, v96, v97
    v_cvt_pk_bf16_f32 v97, v98, v99
    v_cvt_pk_bf16_f32 v114, v100, v101
    v_cvt_pk_bf16_f32 v115, v102, v103
    v_lshlrev_b32 v100, 16, v114
    v_and_b32 v101, 0xffff0000, v114
    v_lshlrev_b32 v102, 16, v115
    v_and_b32 v103, 0xffff0000, v115
    v_mul_f32 v100, v100, v113
    v_mul_f32 v101, v101, v113
    v_mul_f32 v102, v102, v113
    v_mul_f32 v103, v103, v113
    v_cvt_pk_bf16_f32 v100, v100, v101
    v_cvt_pk_bf16_f32 v101, v102, v103
    v_cvt_pk_bf16_f32 v114, v104, v105
    v_cvt_pk_bf16_f32 v115, v106, v107
    v_lshlrev_b32 v104, 16, v114
    v_and_b32 v105, 0xffff0000, v114
    v_lshlrev_b32 v106, 16, v115
    v_and_b32 v107, 0xffff0000, v115
    v_mul_f32 v104, v104, v113
    v_mul_f32 v105, v105, v113
    v_mul_f32 v106, v106, v113
    v_mul_f32 v107, v107, v113
    v_cvt_pk_bf16_f32 v104, v104, v105
    v_cvt_pk_bf16_f32 v105, v106, v107
    buffer_store_dwordx2 v[96:97], v135, s[20:23], 0 offen
    buffer_store_dwordx2 v[100:101], v135, s[20:23], 0 offen offset:16
    v_lshrrev_b32 v4, 5, v1
    v_cmp_eq_u32 vcc, 0, v4
    s_and_saveexec_b64 s[32:33], vcc
    buffer_store_dwordx2 v[104:105], v135, s[20:23], 0 offen offset:32
    s_mov_b64 exec, s[32:33]
    s_waitcnt vmcnt(0)
Lend_attn_kernel_1:
    s_endpgm
.section .rodata,"a"
.p2align 6
.amdhsa_kernel attn_kernel
  .amdhsa_next_free_vgpr 144
  .amdhsa_next_free_sgpr 40
  .amdhsa_accum_offset 144
  .amdhsa_group_segment_fixed_size 0
  .amdhsa_kernarg_size 96
  .amdhsa_user_sgpr_count 2
  .amdhsa_user_sgpr_kernarg_segment_ptr 1
  .amdhsa_system_sgpr_workgroup_id_x 1
.end_amdhsa_kernel
.text

.globl wo0_kernel
.p2align 8
.type wo0_kernel,@function
wo0_kernel:
    s_cmp_ge_u32 s2, 160
    s_cbranch_scc1 Lend_wo0_kernel_1
    s_load_dwordx2 s[4:5], s[0:1], 88
    s_load_dwordx2 s[6:7], s[0:1], 24
    s_load_dwordx2 s[24:25], s[0:1], 88
    s_and_b32 s26, s2, 7
    s_lshr_b32 s27, s2, 3
    s_mul_i32 s26, s26, 20
    s_add_u32 s26, s26, s27
    s_mul_hi_u32 s27, s26, 858993460
    s_mul_i32 s28, s27, 5
    s_sub_u32 s28, s26, s28
    s_mul_i32 s27, s27, 64
    s_mul_i32 s28, s28, 128
    s_waitcnt lgkmcnt(0)
    s_add_u32 s8, s4, 13107200
    s_addc_u32 s9, s5, 0
    s_mov_b32 s10, 2621440
    s_mov_b32 s11, 0x00020000
    s_mov_b32 s12, s6
    s_mov_b32 s13, s7
    s_mov_b32 s14, 819200
    s_mov_b32 s15, 0x00020000
    s_mov_b32 s16, s24
    s_mov_b32 s17, s25
    s_mov_b32 s18, 2621440
    s_mov_b32 s19, 0x00020000
    v_and_b32 v1, 63, v0
    v_lshrrev_b32 v2, 6, v0
    s_nop 0
    v_readfirstlane_b32 s41, v2
    s_nop 3
    s_cmp_ge_u32 s41, 4
    s_cbranch_scc1 Lloader_wo0_kernel_2
    v_lshrrev_b32 v3, 1, v2
    v_and_b32 v4, 1, v2
    v_lshrrev_b32 v5, 4, v1
    v_and_b32 v6, 15, v1
    v_mul_u32_u24 v7, 32, v3
    v_add_u32 v7, v7, v6
    v_lshlrev_b32 v7, 7, v7
    v_add_u32 v18, 0, v5
    v_and_b32 v3, 7, v6
    v_xor_b32 v18, v18, v3
    v_lshl_add_u32 v18, v18, 4, v7
    v_add_u32 v26, 49152, v18
    v_add_u32 v19, 4, v5
    v_and_b32 v3, 7, v6
    v_xor_b32 v19, v19, v3
    v_lshl_add_u32 v19, v19, 4, v7
    v_add_u32 v27, 49152, v19
    v_lshrrev_b32 v3, 2, v6
    v_and_b32 v7, 1, v5
    v_lshl_add_u32 v7, v7, 2, v3
    v_lshl_add_u32 v32, v5, 3, v3
    v_lshlrev_b32 v32, 8, v32
    v_and_b32 v33, 3, v6
    v_lshl_add_u32 v32, v33, 3, v32
    v_lshlrev_b32 v33, 2, v4
    v_add_u32 v34, 0, v33
    v_xor_b32 v34, v34, v7
    v_lshl_add_u32 v20, v34, 5, v32
    v_add_u32 v28, 49152, v20
    v_add_u32 v34, 1, v33
    v_xor_b32 v34, v34, v7
    v_lshl_add_u32 v21, v34, 5, v32
    v_add_u32 v29, 49152, v21
    v_add_u32 v34, 2, v33
    v_xor_b32 v34, v34, v7
    v_lshl_add_u32 v22, v34, 5, v32
    v_add_u32 v30, 49152, v22
    v_add_u32 v34, 3, v33
    v_xor_b32 v34, v34, v7
    v_lshl_add_u32 v23, v34, 5, v32
    v_add_u32 v31, 49152, v23
    v_mov_b32 v80, 0
    v_mov_b32 v81, 0
    v_mov_b32 v82, 0
    v_mov_b32 v83, 0
    v_mov_b32 v84, 0
    v_mov_b32 v85, 0
    v_mov_b32 v86, 0
    v_mov_b32 v87, 0
    v_mov_b32 v88, 0
    v_mov_b32 v89, 0
    v_mov_b32 v90, 0
    v_mov_b32 v91, 0
    v_mov_b32 v92, 0
    v_mov_b32 v93, 0
    v_mov_b32 v94, 0
    v_mov_b32 v95, 0
    v_mov_b32 v96, 0
    v_mov_b32 v97, 0
    v_mov_b32 v98, 0
    v_mov_b32 v99, 0
    v_mov_b32 v100, 0
    v_mov_b32 v101, 0
    v_mov_b32 v102, 0
    v_mov_b32 v103, 0
    v_mov_b32 v104, 0
    v_mov_b32 v105, 0
    v_mov_b32 v106, 0
    v_mov_b32 v107, 0
    v_mov_b32 v108, 0
    v_mov_b32 v109, 0
    v_mov_b32 v110, 0
    v_mov_b32 v111, 0
    s_barrier
    ds_read_b128 v[32:35], v18 offset:0
    ds_read_b128 v[36:39], v18 offset:2048
    ds_read_b64_tr_b16 v[48:49], v20 offset:8192
    ds_read_b64_tr_b16 v[50:51], v20 offset:9216
    ds_read_b64_tr_b16 v[52:53], v21 offset:8192
    ds_read_b64_tr_b16 v[54:55], v21 offset:9216
    ds_read_b64_tr_b16 v[56:57], v22 offset:8192
    ds_read_b64_tr_b16 v[58:59], v22 offset:9216
    ds_read_b64_tr_b16 v[60:61], v23 offset:8192
    ds_read_b64_tr_b16 v[62:63], v23 offset:9216
    s_mov_b32 s31, 0
Lcloop_wo0_kernel_3:
    s_waitcnt lgkmcnt(0)
    v_mfma_f32_16x16x32_bf16 v[80:83], v[48:51], v[32:35], v[80:83]
    ds_read_b128 v[40:43], v19 offset:0
    v_mfma_f32_16x16x32_bf16 v[84:87], v[52:55], v[32:35], v[84:87]
    ds_read_b128 v[44:47], v19 offset:2048
    v_mfma_f32_16x16x32_bf16 v[88:91], v[56:59], v[32:35], v[88:91]
    ds_read_b64_tr_b16 v[64:65], v20 offset:16384
    v_mfma_f32_16x16x32_bf16 v[92:95], v[60:63], v[32:35], v[92:95]
    ds_read_b64_tr_b16 v[66:67], v20 offset:17408
    ds_read_b64_tr_b16 v[68:69], v21 offset:16384
    v_mfma_f32_16x16x32_bf16 v[96:99], v[48:51], v[36:39], v[96:99]
    ds_read_b64_tr_b16 v[70:71], v21 offset:17408
    v_mfma_f32_16x16x32_bf16 v[100:103], v[52:55], v[36:39], v[100:103]
    ds_read_b64_tr_b16 v[72:73], v22 offset:16384
    v_mfma_f32_16x16x32_bf16 v[104:107], v[56:59], v[36:39], v[104:107]
    ds_read_b64_tr_b16 v[74:75], v22 offset:17408
    v_mfma_f32_16x16x32_bf16 v[108:111], v[60:63], v[36:39], v[108:111]
    ds_read_b64_tr_b16 v[76:77], v23 offset:16384
    ds_read_b64_tr_b16 v[78:79], v23 offset:17408
    s_waitcnt lgkmcnt(0)
    v_mfma_f32_16x16x32_bf16 v[80:83], v[64:67], v[40:43], v[80:83]
    ds_read_b128 v[32:35], v18 offset:24576
    v_mfma_f32_16x16x32_bf16 v[84:87], v[68:71], v[40:43], v[84:87]
    ds_read_b128 v[36:39], v18 offset:26624
    v_mfma_f32_16x16x32_bf16 v[88:91], v[72:75], v[40:43], v[88:91]
    ds_read_b64_tr_b16 v[48:49], v20 offset:32768
    v_mfma_f32_16x16x32_bf16 v[92:95], v[76:79], v[40:43], v[92:95]
    ds_read_b64_tr_b16 v[50:51], v20 offset:33792
    ds_read_b64_tr_b16 v[52:53], v21 offset:32768
    v_mfma_f32_16x16x32_bf16 v[96:99], v[64:67], v[44:47], v[96:99]
    ds_read_b64_tr_b16 v[54:55], v21 offset:33792
    v_mfma_f32_16x16x32_bf16 v[100:103], v[68:71], v[44:47], v[100:103]
    ds_read_b64_tr_b16 v[56:57], v22 offset:32768
    v_mfma_f32_16x16x32_bf16 v[104:107], v[72:75], v[44:47], v[104:107]
    ds_read_b64_tr_b16 v[58:59], v22 offset:33792
    v_mfma_f32_16x16x32_bf16 v[108:111], v[76:79], v[44:47], v[108:111]
    ds_read_b64_tr_b16 v[60:61], v23 offset:32768
    ds_read_b64_tr_b16 v[62:63], v23 offset:33792
    s_barrier
    s_waitcnt lgkmcnt(0)
    v_mfma_f32_16x16x32_bf16 v[80:83], v[48:51], v[32:35], v[80:83]
    ds_read_b128 v[40:43], v19 offset:24576
    v_mfma_f32_16x16x32_bf16 v[84:87], v[52:55], v[32:35], v[84:87]
    ds_read_b128 v[44:47], v19 offset:26624
    v_mfma_f32_16x16x32_bf16 v[88:91], v[56:59], v[32:35], v[88:91]
    ds_read_b64_tr_b16 v[64:65], v20 offset:40960
    v_mfma_f32_16x16x32_bf16 v[92:95], v[60:63], v[32:35], v[92:95]
    ds_read_b64_tr_b16 v[66:67], v20 offset:41984
    ds_read_b64_tr_b16 v[68:69], v21 offset:40960
    v_mfma_f32_16x16x32_bf16 v[96:99], v[48:51], v[36:39], v[96:99]
    ds_read_b64_tr_b16 v[70:71], v21 offset:41984
    v_mfma_f32_16x16x32_bf16 v[100:103], v[52:55], v[36:39], v[100:103]
    ds_read_b64_tr_b16 v[72:73], v22 offset:40960
    v_mfma_f32_16x16x32_bf16 v[104:107], v[56:59], v[36:39], v[104:107]
    ds_read_b64_tr_b16 v[74:75], v22 offset:41984
    v_mfma_f32_16x16x32_bf16 v[108:111], v[60:63], v[36:39], v[108:111]
    ds_read_b64_tr_b16 v[76:77], v23 offset:40960
    ds_read_b64_tr_b16 v[78:79], v23 offset:41984
    s_waitcnt lgkmcnt(0)
    v_mfma_f32_16x16x32_bf16 v[80:83], v[64:67], v[40:43], v[80:83]
    ds_read_b128 v[32:35], v26 offset:0
    v_mfma_f32_16x16x32_bf16 v[84:87], v[68:71], v[40:43], v[84:87]
    ds_read_b128 v[36:39], v26 offset:2048
    v_mfma_f32_16x16x32_bf16 v[88:91], v[72:75], v[40:43], v[88:91]
    ds_read_b64_tr_b16 v[48:49], v28 offset:8192
    v_mfma_f32_16x16x32_bf16 v[92:95], v[76:79], v[40:43], v[92:95]
    ds_read_b64_tr_b16 v[50:51], v28 offset:9216
    ds_read_b64_tr_b16 v[52:53], v29 offset:8192
    v_mfma_f32_16x16x32_bf16 v[96:99], v[64:67], v[44:47], v[96:99]
    ds_read_b64_tr_b16 v[54:55], v29 offset:9216
    v_mfma_f32_16x16x32_bf16 v[100:103], v[68:71], v[44:47], v[100:103]
    ds_read_b64_tr_b16 v[56:57], v30 offset:8192
    v_mfma_f32_16x16x32_bf16 v[104:107], v[72:75], v[44:47], v[104:107]
    ds_read_b64_tr_b16 v[58:59], v30 offset:9216
    v_mfma_f32_16x16x32_bf16 v[108:111], v[76:79], v[44:47], v[108:111]
    ds_read_b64_tr_b16 v[60:61], v31 offset:8192
    ds_read_b64_tr_b16 v[62:63], v31 offset:9216
    s_barrier
    s_waitcnt lgkmcnt(0)
    v_mfma_f32_16x16x32_bf16 v[80:83], v[48:51], v[32:35], v[80:83]
    ds_read_b128 v[40:43], v27 offset:0
    v_mfma_f32_16x16x32_bf16 v[84:87], v[52:55], v[32:35], v[84:87]
    ds_read_b128 v[44:47], v27 offset:2048
    v_mfma_f32_16x16x32_bf16 v[88:91], v[56:59], v[32:35], v[88:91]
    ds_read_b64_tr_b16 v[64:65], v28 offset:16384
    v_mfma_f32_16x16x32_bf16 v[92:95], v[60:63], v[32:35], v[92:95]
    ds_read_b64_tr_b16 v[66:67], v28 offset:17408
    ds_read_b64_tr_b16 v[68:69], v29 offset:16384
    v_mfma_f32_16x16x32_bf16 v[96:99], v[48:51], v[36:39], v[96:99]
    ds_read_b64_tr_b16 v[70:71], v29 offset:17408
    v_mfma_f32_16x16x32_bf16 v[100:103], v[52:55], v[36:39], v[100:103]
    ds_read_b64_tr_b16 v[72:73], v30 offset:16384
    v_mfma_f32_16x16x32_bf16 v[104:107], v[56:59], v[36:39], v[104:107]
    ds_read_b64_tr_b16 v[74:75], v30 offset:17408
    v_mfma_f32_16x16x32_bf16 v[108:111], v[60:63], v[36:39], v[108:111]
    ds_read_b64_tr_b16 v[76:77], v31 offset:16384
    ds_read_b64_tr_b16 v[78:79], v31 offset:17408
    s_waitcnt lgkmcnt(0)
    v_mfma_f32_16x16x32_bf16 v[80:83], v[64:67], v[40:43], v[80:83]
    ds_read_b128 v[32:35], v26 offset:24576
    v_mfma_f32_16x16x32_bf16 v[84:87], v[68:71], v[40:43], v[84:87]
    ds_read_b128 v[36:39], v26 offset:26624
    v_mfma_f32_16x16x32_bf16 v[88:91], v[72:75], v[40:43], v[88:91]
    ds_read_b64_tr_b16 v[48:49], v28 offset:32768
    v_mfma_f32_16x16x32_bf16 v[92:95], v[76:79], v[40:43], v[92:95]
    ds_read_b64_tr_b16 v[50:51], v28 offset:33792
    ds_read_b64_tr_b16 v[52:53], v29 offset:32768
    v_mfma_f32_16x16x32_bf16 v[96:99], v[64:67], v[44:47], v[96:99]
    ds_read_b64_tr_b16 v[54:55], v29 offset:33792
    v_mfma_f32_16x16x32_bf16 v[100:103], v[68:71], v[44:47], v[100:103]
    ds_read_b64_tr_b16 v[56:57], v30 offset:32768
    v_mfma_f32_16x16x32_bf16 v[104:107], v[72:75], v[44:47], v[104:107]
    ds_read_b64_tr_b16 v[58:59], v30 offset:33792
    v_mfma_f32_16x16x32_bf16 v[108:111], v[76:79], v[44:47], v[108:111]
    ds_read_b64_tr_b16 v[60:61], v31 offset:32768
    ds_read_b64_tr_b16 v[62:63], v31 offset:33792
    s_barrier
    s_waitcnt lgkmcnt(0)
    v_mfma_f32_16x16x32_bf16 v[80:83], v[48:51], v[32:35], v[80:83]
    ds_read_b128 v[40:43], v27 offset:24576
    v_mfma_f32_16x16x32_bf16 v[84:87], v[52:55], v[32:35], v[84:87]
    ds_read_b128 v[44:47], v27 offset:26624
    v_mfma_f32_16x16x32_bf16 v[88:91], v[56:59], v[32:35], v[88:91]
    ds_read_b64_tr_b16 v[64:65], v28 offset:40960
    v_mfma_f32_16x16x32_bf16 v[92:95], v[60:63], v[32:35], v[92:95]
    ds_read_b64_tr_b16 v[66:67], v28 offset:41984
    ds_read_b64_tr_b16 v[68:69], v29 offset:40960
    v_mfma_f32_16x16x32_bf16 v[96:99], v[48:51], v[36:39], v[96:99]
    ds_read_b64_tr_b16 v[70:71], v29 offset:41984
    v_mfma_f32_16x16x32_bf16 v[100:103], v[52:55], v[36:39], v[100:103]
    ds_read_b64_tr_b16 v[72:73], v30 offset:40960
    v_mfma_f32_16x16x32_bf16 v[104:107], v[56:59], v[36:39], v[104:107]
    ds_read_b64_tr_b16 v[74:75], v30 offset:41984
    v_mfma_f32_16x16x32_bf16 v[108:111], v[60:63], v[36:39], v[108:111]
    ds_read_b64_tr_b16 v[76:77], v31 offset:40960
    ds_read_b64_tr_b16 v[78:79], v31 offset:41984
    s_waitcnt lgkmcnt(0)
    v_mfma_f32_16x16x32_bf16 v[80:83], v[64:67], v[40:43], v[80:83]
    ds_read_b128 v[32:35], v18 offset:0
    v_mfma_f32_16x16x32_bf16 v[84:87], v[68:71], v[40:43], v[84:87]
    ds_read_b128 v[36:39], v18 offset:2048
    v_mfma_f32_16x16x32_bf16 v[88:91], v[72:75], v[40:43], v[88:91]
    ds_read_b64_tr_b16 v[48:49], v20 offset:8192
    v_mfma_f32_16x16x32_bf16 v[92:95], v[76:79], v[40:43], v[92:95]
    ds_read_b64_tr_b16 v[50:51], v20 offset:9216
    ds_read_b64_tr_b16 v[52:53], v21 offset:8192
    v_mfma_f32_16x16x32_bf16 v[96:99], v[64:67], v[44:47], v[96:99]
    ds_read_b64_tr_b16 v[54:55], v21 offset:9216
    v_mfma_f32_16x16x32_bf16 v[100:103], v[68:71], v[44:47], v[100:103]
    ds_read_b64_tr_b16 v[56:57], v22 offset:8192
    v_mfma_f32_16x16x32_bf16 v[104:107], v[72:75], v[44:47], v[104:107]
    ds_read_b64_tr_b16 v[58:59], v22 offset:9216
    v_mfma_f32_16x16x32_bf16 v[108:111], v[76:79], v[44:47], v[108:111]
    ds_read_b64_tr_b16 v[60:61], v23 offset:8192
    ds_read_b64_tr_b16 v[62:63], v23 offset:9216
    s_barrier
    s_add_u32 s31, s31, 1
    s_cmp_lt_u32 s31, 2
    s_cbranch_scc1 Lcloop_wo0_kernel_3
    s_waitcnt lgkmcnt(0)
    v_mfma_f32_16x16x32_bf16 v[80:83], v[48:51], v[32:35], v[80:83]
    ds_read_b128 v[40:43], v19 offset:0
    v_mfma_f32_16x16x32_bf16 v[84:87], v[52:55], v[32:35], v[84:87]
    ds_read_b128 v[44:47], v19 offset:2048
    v_mfma_f32_16x16x32_bf16 v[88:91], v[56:59], v[32:35], v[88:91]
    ds_read_b64_tr_b16 v[64:65], v20 offset:16384
    v_mfma_f32_16x16x32_bf16 v[92:95], v[60:63], v[32:35], v[92:95]
    ds_read_b64_tr_b16 v[66:67], v20 offset:17408
    ds_read_b64_tr_b16 v[68:69], v21 offset:16384
    v_mfma_f32_16x16x32_bf16 v[96:99], v[48:51], v[36:39], v[96:99]
    ds_read_b64_tr_b16 v[70:71], v21 offset:17408
    v_mfma_f32_16x16x32_bf16 v[100:103], v[52:55], v[36:39], v[100:103]
    ds_read_b64_tr_b16 v[72:73], v22 offset:16384
    v_mfma_f32_16x16x32_bf16 v[104:107], v[56:59], v[36:39], v[104:107]
    ds_read_b64_tr_b16 v[74:75], v22 offset:17408
    v_mfma_f32_16x16x32_bf16 v[108:111], v[60:63], v[36:39], v[108:111]
    ds_read_b64_tr_b16 v[76:77], v23 offset:16384
    ds_read_b64_tr_b16 v[78:79], v23 offset:17408
    s_waitcnt lgkmcnt(0)
    v_mfma_f32_16x16x32_bf16 v[80:83], v[64:67], v[40:43], v[80:83]
    ds_read_b128 v[32:35], v18 offset:24576
    v_mfma_f32_16x16x32_bf16 v[84:87], v[68:71], v[40:43], v[84:87]
    ds_read_b128 v[36:39], v18 offset:26624
    v_mfma_f32_16x16x32_bf16 v[88:91], v[72:75], v[40:43], v[88:91]
    ds_read_b64_tr_b16 v[48:49], v20 offset:32768
    v_mfma_f32_16x16x32_bf16 v[92:95], v[76:79], v[40:43], v[92:95]
    ds_read_b64_tr_b16 v[50:51], v20 offset:33792
    ds_read_b64_tr_b16 v[52:53], v21 offset:32768
    v_mfma_f32_16x16x32_bf16 v[96:99], v[64:67], v[44:47], v[96:99]
    ds_read_b64_tr_b16 v[54:55], v21 offset:33792
    v_mfma_f32_16x16x32_bf16 v[100:103], v[68:71], v[44:47], v[100:103]
    ds_read_b64_tr_b16 v[56:57], v22 offset:32768
    v_mfma_f32_16x16x32_bf16 v[104:107], v[72:75], v[44:47], v[104:107]
    ds_read_b64_tr_b16 v[58:59], v22 offset:33792
    v_mfma_f32_16x16x32_bf16 v[108:111], v[76:79], v[44:47], v[108:111]
    ds_read_b64_tr_b16 v[60:61], v23 offset:32768
    ds_read_b64_tr_b16 v[62:63], v23 offset:33792
    s_barrier
    s_waitcnt lgkmcnt(0)
    v_mfma_f32_16x16x32_bf16 v[80:83], v[48:51], v[32:35], v[80:83]
    ds_read_b128 v[40:43], v19 offset:24576
    v_mfma_f32_16x16x32_bf16 v[84:87], v[52:55], v[32:35], v[84:87]
    ds_read_b128 v[44:47], v19 offset:26624
    v_mfma_f32_16x16x32_bf16 v[88:91], v[56:59], v[32:35], v[88:91]
    ds_read_b64_tr_b16 v[64:65], v20 offset:40960
    v_mfma_f32_16x16x32_bf16 v[92:95], v[60:63], v[32:35], v[92:95]
    ds_read_b64_tr_b16 v[66:67], v20 offset:41984
    ds_read_b64_tr_b16 v[68:69], v21 offset:40960
    v_mfma_f32_16x16x32_bf16 v[96:99], v[48:51], v[36:39], v[96:99]
    ds_read_b64_tr_b16 v[70:71], v21 offset:41984
    v_mfma_f32_16x16x32_bf16 v[100:103], v[52:55], v[36:39], v[100:103]
    ds_read_b64_tr_b16 v[72:73], v22 offset:40960
    v_mfma_f32_16x16x32_bf16 v[104:107], v[56:59], v[36:39], v[104:107]
    ds_read_b64_tr_b16 v[74:75], v22 offset:41984
    v_mfma_f32_16x16x32_bf16 v[108:111], v[60:63], v[36:39], v[108:111]
    ds_read_b64_tr_b16 v[76:77], v23 offset:40960
    ds_read_b64_tr_b16 v[78:79], v23 offset:41984
    s_waitcnt lgkmcnt(0)
    v_mfma_f32_16x16x32_bf16 v[80:83], v[64:67], v[40:43], v[80:83]
    v_mfma_f32_16x16x32_bf16 v[84:87], v[68:71], v[40:43], v[84:87]
    v_mfma_f32_16x16x32_bf16 v[88:91], v[72:75], v[40:43], v[88:91]
    v_mfma_f32_16x16x32_bf16 v[92:95], v[76:79], v[40:43], v[92:95]
    v_mfma_f32_16x16x32_bf16 v[96:99], v[64:67], v[44:47], v[96:99]
    v_mfma_f32_16x16x32_bf16 v[100:103], v[68:71], v[44:47], v[100:103]
    v_mfma_f32_16x16x32_bf16 v[104:107], v[72:75], v[44:47], v[104:107]
    v_mfma_f32_16x16x32_bf16 v[108:111], v[76:79], v[44:47], v[108:111]
    s_barrier
    s_nop 7
    s_nop 7
    v_lshrrev_b32 v3, 1, v2
    v_and_b32 v4, 1, v2
    v_lshrrev_b32 v5, 4, v1
    v_and_b32 v6, 15, v1
    v_mul_u32_u24 v7, 4608, v2
    v_mul_u32_u24 v8, 144, v6
    v_add_u32 v7, v7, v8
    v_lshl_add_u32 v7, v5, 3, v7
    v_cvt_pk_bf16_f32 v32, v80, v81
    v_cvt_pk_bf16_f32 v33, v82, v83
    ds_write_b64 v7, v[32:33] offset:0
    v_cvt_pk_bf16_f32 v40, v84, v85
    v_cvt_pk_bf16_f32 v41, v86, v87
    ds_write_b64 v7, v[40:41] offset:32
    v_cvt_pk_bf16_f32 v48, v88, v89
    v_cvt_pk_bf16_f32 v49, v90, v91
    ds_write_b64 v7, v[48:49] offset:64
    v_cvt_pk_bf16_f32 v56, v92, v93
    v_cvt_pk_bf16_f32 v57, v94, v95
    ds_write_b64 v7, v[56:57] offset:96
    v_cvt_pk_bf16_f32 v32, v96, v97
    v_cvt_pk_bf16_f32 v33, v98, v99
    ds_write_b64 v7, v[32:33] offset:2304
    v_cvt_pk_bf16_f32 v40, v100, v101
    v_cvt_pk_bf16_f32 v41, v102, v103
    ds_write_b64 v7, v[40:41] offset:2336
    v_cvt_pk_bf16_f32 v48, v104, v105
    v_cvt_pk_bf16_f32 v49, v106, v107
    ds_write_b64 v7, v[48:49] offset:2368
    v_cvt_pk_bf16_f32 v56, v108, v109
    v_cvt_pk_bf16_f32 v57, v110, v111
    ds_write_b64 v7, v[56:57] offset:2400
    s_waitcnt lgkmcnt(0)
    v_lshrrev_b32 v8, 3, v1
    v_and_b32 v9, 7, v1
    v_mul_u32_u24 v7, 4608, v2
    v_mul_u32_u24 v10, 144, v8
    v_add_u32 v7, v7, v10
    v_lshl_add_u32 v7, v9, 4, v7
    v_mul_u32_u24 v10, 32, v3
    v_add_u32 v10, v10, v8
    v_add_u32 v10, s27, v10
    v_lshlrev_b32 v11, 6, v4
    v_lshl_add_u32 v11, v9, 3, v11
    v_add_u32 v11, s28, v11
    v_mul_u32_u24 v12, 1280, v10
    v_lshl_add_u32 v12, v11, 1, v12
    ds_read_b128 v[80:83], v7 offset:0
    ds_read_b128 v[84:87], v7 offset:1152
    ds_read_b128 v[88:91], v7 offset:2304
    ds_read_b128 v[92:95], v7 offset:3456
    s_load_dwordx2 s[36:37], s[0:1], 0
    s_waitcnt lgkmcnt(0)
    s_mov_b32 s20, s36
    s_mov_b32 s21, s37
    s_mov_b32 s22, 2621440
    s_mov_b32 s23, 0x00020000
    v_mul_u32_u24 v13, 1280, v10
    v_lshl_add_u32 v13, v11, 1, v13
    v_add_u32 v14, 0, v13
    buffer_load_dwordx4 v[32:35], v14, s[20:23], 0 offen
    v_add_u32 v14, 10240, v13
    buffer_load_dwordx4 v[36:39], v14, s[20:23], 0 offen
    v_add_u32 v14, 20480, v13
    buffer_load_dwordx4 v[40:43], v14, s[20:23], 0 offen
    v_add_u32 v14, 30720, v13
    buffer_load_dwordx4 v[44:47], v14, s[20:23], 0 offen
    s_waitcnt vmcnt(0) lgkmcnt(0)
    v_lshlrev_b32 v48, 16, v80
    v_and_b32 v49, 0xffff0000, v80
    v_lshlrev_b32 v50, 16, v32
    v_and_b32 v51, 0xffff0000, v32
    v_add_f32 v48, v48, v50
    v_add_f32 v49, v49, v51
    v_cvt_pk_bf16_f32 v80, v48, v49
    v_lshlrev_b32 v48, 16, v81
    v_and_b32 v49, 0xffff0000, v81
    v_lshlrev_b32 v50, 16, v33
    v_and_b32 v51, 0xffff0000, v33
    v_add_f32 v48, v48, v50
    v_add_f32 v49, v49, v51
    v_cvt_pk_bf16_f32 v81, v48, v49
    v_lshlrev_b32 v48, 16, v82
    v_and_b32 v49, 0xffff0000, v82
    v_lshlrev_b32 v50, 16, v34
    v_and_b32 v51, 0xffff0000, v34
    v_add_f32 v48, v48, v50
    v_add_f32 v49, v49, v51
    v_cvt_pk_bf16_f32 v82, v48, v49
    v_lshlrev_b32 v48, 16, v83
    v_and_b32 v49, 0xffff0000, v83
    v_lshlrev_b32 v50, 16, v35
    v_and_b32 v51, 0xffff0000, v35
    v_add_f32 v48, v48, v50
    v_add_f32 v49, v49, v51
    v_cvt_pk_bf16_f32 v83, v48, v49
    v_lshlrev_b32 v48, 16, v84
    v_and_b32 v49, 0xffff0000, v84
    v_lshlrev_b32 v50, 16, v36
    v_and_b32 v51, 0xffff0000, v36
    v_add_f32 v48, v48, v50
    v_add_f32 v49, v49, v51
    v_cvt_pk_bf16_f32 v84, v48, v49
    v_lshlrev_b32 v48, 16, v85
    v_and_b32 v49, 0xffff0000, v85
    v_lshlrev_b32 v50, 16, v37
    v_and_b32 v51, 0xffff0000, v37
    v_add_f32 v48, v48, v50
    v_add_f32 v49, v49, v51
    v_cvt_pk_bf16_f32 v85, v48, v49
    v_lshlrev_b32 v48, 16, v86
    v_and_b32 v49, 0xffff0000, v86
    v_lshlrev_b32 v50, 16, v38
    v_and_b32 v51, 0xffff0000, v38
    v_add_f32 v48, v48, v50
    v_add_f32 v49, v49, v51
    v_cvt_pk_bf16_f32 v86, v48, v49
    v_lshlrev_b32 v48, 16, v87
    v_and_b32 v49, 0xffff0000, v87
    v_lshlrev_b32 v50, 16, v39
    v_and_b32 v51, 0xffff0000, v39
    v_add_f32 v48, v48, v50
    v_add_f32 v49, v49, v51
    v_cvt_pk_bf16_f32 v87, v48, v49
    v_lshlrev_b32 v48, 16, v88
    v_and_b32 v49, 0xffff0000, v88
    v_lshlrev_b32 v50, 16, v40
    v_and_b32 v51, 0xffff0000, v40
    v_add_f32 v48, v48, v50
    v_add_f32 v49, v49, v51
    v_cvt_pk_bf16_f32 v88, v48, v49
    v_lshlrev_b32 v48, 16, v89
    v_and_b32 v49, 0xffff0000, v89
    v_lshlrev_b32 v50, 16, v41
    v_and_b32 v51, 0xffff0000, v41
    v_add_f32 v48, v48, v50
    v_add_f32 v49, v49, v51
    v_cvt_pk_bf16_f32 v89, v48, v49
    v_lshlrev_b32 v48, 16, v90
    v_and_b32 v49, 0xffff0000, v90
    v_lshlrev_b32 v50, 16, v42
    v_and_b32 v51, 0xffff0000, v42
    v_add_f32 v48, v48, v50
    v_add_f32 v49, v49, v51
    v_cvt_pk_bf16_f32 v90, v48, v49
    v_lshlrev_b32 v48, 16, v91
    v_and_b32 v49, 0xffff0000, v91
    v_lshlrev_b32 v50, 16, v43
    v_and_b32 v51, 0xffff0000, v43
    v_add_f32 v48, v48, v50
    v_add_f32 v49, v49, v51
    v_cvt_pk_bf16_f32 v91, v48, v49
    v_lshlrev_b32 v48, 16, v92
    v_and_b32 v49, 0xffff0000, v92
    v_lshlrev_b32 v50, 16, v44
    v_and_b32 v51, 0xffff0000, v44
    v_add_f32 v48, v48, v50
    v_add_f32 v49, v49, v51
    v_cvt_pk_bf16_f32 v92, v48, v49
    v_lshlrev_b32 v48, 16, v93
    v_and_b32 v49, 0xffff0000, v93
    v_lshlrev_b32 v50, 16, v45
    v_and_b32 v51, 0xffff0000, v45
    v_add_f32 v48, v48, v50
    v_add_f32 v49, v49, v51
    v_cvt_pk_bf16_f32 v93, v48, v49
    v_lshlrev_b32 v48, 16, v94
    v_and_b32 v49, 0xffff0000, v94
    v_lshlrev_b32 v50, 16, v46
    v_and_b32 v51, 0xffff0000, v46
    v_add_f32 v48, v48, v50
    v_add_f32 v49, v49, v51
    v_cvt_pk_bf16_f32 v94, v48, v49
    v_lshlrev_b32 v48, 16, v95
    v_and_b32 v49, 0xffff0000, v95
    v_lshlrev_b32 v50, 16, v47
    v_and_b32 v51, 0xffff0000, v47
    v_add_f32 v48, v48, v50
    v_add_f32 v49, v49, v51
    v_cvt_pk_bf16_f32 v95, v48, v49
    s_load_dwordx2 s[38:39], s[0:1], 88
    s_waitcnt lgkmcnt(0)
    s_add_u32 s32, s38, 38010880
    s_addc_u32 s33, s39, 0
    s_mov_b32 s34, 163840
    s_mov_b32 s35, 0x00020000
    v_mul_u32_u24 v14, 80, v10
    v_lshrrev_b32 v15, 6, v11
    v_lshl_add_u32 v14, v15, 3, v14
    v_lshlrev_b32 v50, 16, v80
    v_and_b32 v51, 0xffff0000, v80
    v_add_f32 v48, v50, v51
    v_mul_f32 v49, v50, v50
    v_fmac_f32 v49, v51, v51
    v_lshlrev_b32 v50, 16, v81
    v_and_b32 v51, 0xffff0000, v81
    v_add_f32 v48, v48, v50
    v_fmac_f32 v49, v50, v50
    v_add_f32 v48, v48, v51
    v_fmac_f32 v49, v51, v51
    v_lshlrev_b32 v50, 16, v82
    v_and_b32 v51, 0xffff0000, v82
    v_add_f32 v48, v48, v50
    v_fmac_f32 v49, v50, v50
    v_add_f32 v48, v48, v51
    v_fmac_f32 v49, v51, v51
    v_lshlrev_b32 v50, 16, v83
    v_and_b32 v51, 0xffff0000, v83
    v_add_f32 v48, v48, v50
    v_fmac_f32 v49, v50, v50
    v_add_f32 v48, v48, v51
    v_fmac_f32 v49, v51, v51
    s_nop 1
    v_add_f32_dpp v50, v48, v48 quad_perm:[1,0,3,2] row_mask:0xf bank_mask:0xf
    v_add_f32_dpp v51, v49, v49 quad_perm:[1,0,3,2] row_mask:0xf bank_mask:0xf
    v_mov_b32 v48, v50
    v_mov_b32 v49, v51
    s_nop 1
    v_add_f32_dpp v50, v48, v48 quad_perm:[2,3,0,1] row_mask:0xf bank_mask:0xf
    v_add_f32_dpp v51, v49, v49 quad_perm:[2,3,0,1] row_mask:0xf bank_mask:0xf
    v_mov_b32 v48, v50
    v_mov_b32 v49, v51
    s_nop 1
    v_add_f32_dpp v50, v48, v48 row_half_mirror row_mask:0xf bank_mask:0xf
    v_add_f32_dpp v51, v49, v49 row_half_mirror row_mask:0xf bank_mask:0xf
    v_mov_b32 v48, v50
    v_mov_b32 v49, v51
    v_and_b32 v15, 7, v1
    v_cmp_eq_u32 vcc, 0, v15
    s_and_saveexec_b64 s[40:41], vcc
    buffer_store_dwordx2 v[48:49], v14, s[32:35], 0 offen offset:0
    s_mov_b64 exec, s[40:41]
    s_nop 1
    v_lshlrev_b32 v50, 16, v84
    v_and_b32 v51, 0xffff0000, v84
    v_add_f32 v48, v50, v51
    v_mul_f32 v49, v50, v50
    v_fmac_f32 v49, v51, v51
    v_lshlrev_b32 v50, 16, v85
    v_and_b32 v51, 0xffff0000, v85
    v_add_f32 v48, v48, v50
    v_fmac_f32 v49, v50, v50
    v_add_f32 v48, v48, v51
    v_fmac_f32 v49, v51, v51
    v_lshlrev_b32 v50, 16, v86
    v_and_b32 v51, 0xffff0000, v86
    v_add_f32 v48, v48, v50
    v_fmac_f32 v49, v50, v50
    v_add_f32 v48, v48, v51
    v_fmac_f32 v49, v51, v51
    v_lshlrev_b32 v50, 16, v87
    v_and_b32 v51, 0xffff0000, v87
    v_add_f32 v48, v48, v50
    v_fmac_f32 v49, v50, v50
    v_add_f32 v48, v48, v51
    v_fmac_f32 v49, v51, v51
    s_nop 1
    v_add_f32_dpp v50, v48, v48 quad_perm:[1,0,3,2] row_mask:0xf bank_mask:0xf
    v_add_f32_dpp v51, v49, v49 quad_perm:[1,0,3,2] row_mask:0xf bank_mask:0xf
    v_mov_b32 v48, v50
    v_mov_b32 v49, v51
    s_nop 1
    v_add_f32_dpp v50, v48, v48 quad_perm:[2,3,0,1] row_mask:0xf bank_mask:0xf
    v_add_f32_dpp v51, v49, v49 quad_perm:[2,3,0,1] row_mask:0xf bank_mask:0xf
    v_mov_b32 v48, v50
    v_mov_b32 v49, v51
    s_nop 1
    v_add_f32_dpp v50, v48, v48 row_half_mirror row_mask:0xf bank_mask:0xf
    v_add_f32_dpp v51, v49, v49 row_half_mirror row_mask:0xf bank_mask:0xf
    v_mov_b32 v48, v50
    v_mov_b32 v49, v51
    v_and_b32 v15, 7, v1
    v_cmp_eq_u32 vcc, 0, v15
    s_and_saveexec_b64 s[40:41], vcc
    buffer_store_dwordx2 v[48:49], v14, s[32:35], 0 offen offset:640
    s_mov_b64 exec, s[40:41]
    s_nop 1
    v_lshlrev_b32 v50, 16, v88
    v_and_b32 v51, 0xffff0000, v88
    v_add_f32 v48, v50, v51
    v_mul_f32 v49, v50, v50
    v_fmac_f32 v49, v51, v51
    v_lshlrev_b32 v50, 16, v89
    v_and_b32 v51, 0xffff0000, v89
    v_add_f32 v48, v48, v50
    v_fmac_f32 v49, v50, v50
    v_add_f32 v48, v48, v51
    v_fmac_f32 v49, v51, v51
    v_lshlrev_b32 v50, 16, v90
    v_and_b32 v51, 0xffff0000, v90
    v_add_f32 v48, v48, v50
    v_fmac_f32 v49, v50, v50
    v_add_f32 v48, v48, v51
    v_fmac_f32 v49, v51, v51
    v_lshlrev_b32 v50, 16, v91
    v_and_b32 v51, 0xffff0000, v91
    v_add_f32 v48, v48, v50
    v_fmac_f32 v49, v50, v50
    v_add_f32 v48, v48, v51
    v_fmac_f32 v49, v51, v51
    s_nop 1
    v_add_f32_dpp v50, v48, v48 quad_perm:[1,0,3,2] row_mask:0xf bank_mask:0xf
    v_add_f32_dpp v51, v49, v49 quad_perm:[1,0,3,2] row_mask:0xf bank_mask:0xf
    v_mov_b32 v48, v50
    v_mov_b32 v49, v51
    s_nop 1
    v_add_f32_dpp v50, v48, v48 quad_perm:[2,3,0,1] row_mask:0xf bank_mask:0xf
    v_add_f32_dpp v51, v49, v49 quad_perm:[2,3,0,1] row_mask:0xf bank_mask:0xf
    v_mov_b32 v48, v50
    v_mov_b32 v49, v51
    s_nop 1
    v_add_f32_dpp v50, v48, v48 row_half_mirror row_mask:0xf bank_mask:0xf
    v_add_f32_dpp v51, v49, v49 row_half_mirror row_mask:0xf bank_mask:0xf
    v_mov_b32 v48, v50
    v_mov_b32 v49, v51
    v_and_b32 v15, 7, v1
    v_cmp_eq_u32 vcc, 0, v15
    s_and_saveexec_b64 s[40:41], vcc
    buffer_store_dwordx2 v[48:49], v14, s[32:35], 0 offen offset:1280
    s_mov_b64 exec, s[40:41]
    s_nop 1
    v_lshlrev_b32 v50, 16, v92
    v_and_b32 v51, 0xffff0000, v92
    v_add_f32 v48, v50, v51
    v_mul_f32 v49, v50, v50
    v_fmac_f32 v49, v51, v51
    v_lshlrev_b32 v50, 16, v93
    v_and_b32 v51, 0xffff0000, v93
    v_add_f32 v48, v48, v50
    v_fmac_f32 v49, v50, v50
    v_add_f32 v48, v48, v51
    v_fmac_f32 v49, v51, v51
    v_lshlrev_b32 v50, 16, v94
    v_and_b32 v51, 0xffff0000, v94
    v_add_f32 v48, v48, v50
    v_fmac_f32 v49, v50, v50
    v_add_f32 v48, v48, v51
    v_fmac_f32 v49, v51, v51
    v_lshlrev_b32 v50, 16, v95
    v_and_b32 v51, 0xffff0000, v95
    v_add_f32 v48, v48, v50
    v_fmac_f32 v49, v50, v50
    v_add_f32 v48, v48, v51
    v_fmac_f32 v49, v51, v51
    s_nop 1
    v_add_f32_dpp v50, v48, v48 quad_perm:[1,0,3,2] row_mask:0xf bank_mask:0xf
    v_add_f32_dpp v51, v49, v49 quad_perm:[1,0,3,2] row_mask:0xf bank_mask:0xf
    v_mov_b32 v48, v50
    v_mov_b32 v49, v51
    s_nop 1
    v_add_f32_dpp v50, v48, v48 quad_perm:[2,3,0,1] row_mask:0xf bank_mask:0xf
    v_add_f32_dpp v51, v49, v49 quad_perm:[2,3,0,1] row_mask:0xf bank_mask:0xf
    v_mov_b32 v48, v50
    v_mov_b32 v49, v51
    s_nop 1
    v_add_f32_dpp v50, v48, v48 row_half_mirror row_mask:0xf bank_mask:0xf
    v_add_f32_dpp v51, v49, v49 row_half_mirror row_mask:0xf bank_mask:0xf
    v_mov_b32 v48, v50
    v_mov_b32 v49, v51
    v_and_b32 v15, 7, v1
    v_cmp_eq_u32 vcc, 0, v15
    s_and_saveexec_b64 s[40:41], vcc
    buffer_store_dwordx2 v[48:49], v14, s[32:35], 0 offen offset:1920
    s_mov_b64 exec, s[40:41]
    s_nop 1
    buffer_store_dwordx4 v[80:83], v12, s[16:19], 0 offen
    v_add_u32 v12, 10240, v12
    buffer_store_dwordx4 v[84:87], v12, s[16:19], 0 offen
    v_add_u32 v12, 10240, v12
    buffer_store_dwordx4 v[88:91], v12, s[16:19], 0 offen
    v_add_u32 v12, 10240, v12
    buffer_store_dwordx4 v[92:95], v12, s[16:19], 0 offen
Lend_wo0_kernel_1:
    s_endpgm
Lloader_wo0_kernel_2:
    v_subrev_u32 v0, 256, v0
    v_and_b32 v1, 63, v0
    s_sub_u32 s42, s41, 4
    v_lshrrev_b32 v3, 3, v1
    v_and_b32 v4, 7, v1
    v_xor_b32 v4, v4, v3
    s_mul_i32 s43, s42, 16
    s_add_u32 s43, s43, s27
    v_add_u32 v5, s43, v3
    v_mul_u32_u24 v5, 1280, v5
    v_lshl_add_u32 v8, v4, 4, v5
    v_add_u32 v9, 10240, v8
    v_lshrrev_b32 v3, 4, v1
    v_and_b32 v4, 15, v1
    v_lshrrev_b32 v5, 1, v4
    v_and_b32 v6, 1, v4
    s_mul_i32 s43, s42, 4
    s_add_u32 s44, s43, 0
    s_lshr_b32 s44, s44, 1
    s_and_b32 s44, s44, 1
    s_lshl_b32 s44, s44, 2
    v_add_u32 v7, s44, v3
    v_xor_b32 v7, v5, v7
    v_lshl_add_u32 v7, v7, 1, v6
    v_lshlrev_b32 v7, 4, v7
    s_add_u32 s44, s43, 0
    s_lshl_b32 s44, s44, 2
    v_add_u32 v12, s44, v3
    v_mul_u32_u24 v12, 1280, v12
    v_add_u32 v12, v12, v7
    v_lshl_add_u32 v12, s28, 1, v12
    s_add_u32 s44, s43, 1
    s_lshr_b32 s44, s44, 1
    s_and_b32 s44, s44, 1
    s_lshl_b32 s44, s44, 2
    v_add_u32 v7, s44, v3
    v_xor_b32 v7, v5, v7
    v_lshl_add_u32 v7, v7, 1, v6
    v_lshlrev_b32 v7, 4, v7
    s_add_u32 s44, s43, 1
    s_lshl_b32 s44, s44, 2
    v_add_u32 v13, s44, v3
    v_mul_u32_u24 v13, 1280, v13
    v_add_u32 v13, v13, v7
    v_lshl_add_u32 v13, s28, 1, v13
    s_add_u32 s44, s43, 2
    s_lshr_b32 s44, s44, 1
    s_and_b32 s44, s44, 1
    s_lshl_b32 s44, s44, 2
    v_add_u32 v7, s44, v3
    v_xor_b32 v7, v5, v7
    v_lshl_add_u32 v7, v7, 1, v6
    v_lshlrev_b32 v7, 4, v7
    s_add_u32 s44, s43, 2
    s_lshl_b32 s44, s44, 2
    v_add_u32 v14, s44, v3
    v_mul_u32_u24 v14, 1280, v14
    v_add_u32 v14, v14, v7
    v_lshl_add_u32 v14, s28, 1, v14
    s_add_u32 s44, s43, 3
    s_lshr_b32 s44, s44, 1
    s_and_b32 s44, s44, 1
    s_lshl_b32 s44, s44, 2
    v_add_u32 v7, s44, v3
    v_xor_b32 v7, v5, v7
    v_lshl_add_u32 v7, v7, 1, v6
    v_lshlrev_b32 v7, 4, v7
    s_add_u32 s44, s43, 3
    s_lshl_b32 s44, s44, 2
    v_add_u32 v15, s44, v3
    v_mul_u32_u24 v15, 1280, v15
    v_add_u32 v15, v15, v7
    v_lshl_add_u32 v15, s28, 1, v15
    s_mul_i32 s45, s42, 2048
    s_mul_i32 s46, s42, 4096
    s_add_u32 s46, s46, 8192
    s_mov_b32 s29, 0
    s_mov_b32 s30, 0
    s_add_u32 m0, s45, 0
    s_nop 0
    buffer_load_dwordx4 v8, s[8:11], s29 offen lds
    s_add_u32 m0, s45, 1024
    s_nop 0
    buffer_load_dwordx4 v9, s[8:11], s29 offen lds
    s_add_u32 m0, s46, 0
    s_nop 0
    buffer_load_dwordx4 v12, s[12:15], s30 offen lds
    s_add_u32 m0, s46, 1024
    s_nop 0
    buffer_load_dwordx4 v13, s[12:15], s30 offen lds
    s_add_u32 m0, s46, 2048
    s_nop 0
    buffer_load_dwordx4 v14, s[12:15], s30 offen lds
    s_add_u32 m0, s46, 3072
    s_nop 0
    buffer_load_dwordx4 v15, s[12:15], s30 offen lds
    s_add_u32 s29, s29, 128
    s_add_u32 s30, s30, 81920
    s_add_u32 m0, s45, 24576
    s_nop 0
    buffer_load_dwordx4 v8, s[8:11], s29 offen lds
    s_add_u32 m0, s45, 25600
    s_nop 0
    buffer_load_dwordx4 v9, s[8:11], s29 offen lds
    s_add_u32 m0, s46, 24576
    s_nop 0
    buffer_load_dwordx4 v12, s[12:15], s30 offen lds
    s_add_u32 m0, s46, 25600
    s_nop 0
    buffer_load_dwordx4 v13, s[12:15], s30 offen lds
    s_add_u32 m0, s46, 26624
    s_nop 0
    buffer_load_dwordx4 v14, s[12:15], s30 offen lds
    s_add_u32 m0, s46, 27648
    s_nop 0
    buffer_load_dwordx4 v15, s[12:15], s30 offen lds
    s_add_u32 s29, s29, 128
    s_add_u32 s30, s30, 81920
    s_add_u32 m0, s45, 49152
    s_nop 0
    buffer_load_dwordx4 v8, s[8:11], s29 offen lds
    s_add_u32 m0, s45, 50176
    s_nop 0
    buffer_load_dwordx4 v9, s[8:11], s29 offen lds
    s_add_u32 m0, s46, 49152
    s_nop 0
    buffer_load_dwordx4 v12, s[12:15], s30 offen lds
    s_add_u32 m0, s46, 50176
    s_nop 0
    buffer_load_dwordx4 v13, s[12:15], s30 offen lds
    s_add_u32 m0, s46, 51200
    s_nop 0
    buffer_load_dwordx4 v14, s[12:15], s30 offen lds
    s_add_u32 m0, s46, 52224
    s_nop 0
    buffer_load_dwordx4 v15, s[12:15], s30 offen lds
    s_add_u32 s29, s29, 128
    s_add_u32 s30, s30, 81920
    s_waitcnt vmcnt(6)
    s_barrier
    s_mov_b32 s31, 0
Llloop_wo0_kernel_4:
    s_add_u32 m0, s45, 73728
    s_nop 0
    buffer_load_dwordx4 v8, s[8:11], s29 offen lds
    s_add_u32 m0, s45, 74752
    s_nop 0
    buffer_load_dwordx4 v9, s[8:11], s29 offen lds
    s_add_u32 m0, s46, 73728
    s_nop 0
    buffer_load_dwordx4 v12, s[12:15], s30 offen lds
    s_add_u32 m0, s46, 74752
    s_nop 0
    buffer_load_dwordx4 v13, s[12:15], s30 offen lds
    s_add_u32 m0, s46, 75776
    s_nop 0
    buffer_load_dwordx4 v14, s[12:15], s30 offen lds
    s_add_u32 m0, s46, 76800
    s_nop 0
    buffer_load_dwordx4 v15, s[12:15], s30 offen lds
    s_add_u32 s29, s29, 128
    s_add_u32 s30, s30, 81920
    s_waitcnt vmcnt(6)
    s_barrier
    s_add_u32 m0, s45, 0
    s_nop 0
    buffer_load_dwordx4 v8, s[8:11], s29 offen lds
    s_add_u32 m0, s45, 1024
    s_nop 0
    buffer_load_dwordx4 v9, s[8:11], s29 offen lds
    s_add_u32 m0, s46, 0
    s_nop 0
    buffer_load_dwordx4 v12, s[12:15], s30 offen lds
    s_add_u32 m0, s46, 1024
    s_nop 0
    buffer_load_dwordx4 v13, s[12:15], s30 offen lds
    s_add_u32 m0, s46, 2048
    s_nop 0
    buffer_load_dwordx4 v14, s[12:15], s30 offen lds
    s_add_u32 m0, s46, 3072
    s_nop 0
    buffer_load_dwordx4 v15, s[12:15], s30 offen lds
    s_add_u32 s29, s29, 128
    s_add_u32 s30, s30, 81920
    s_waitcnt vmcnt(6)
    s_barrier
    s_add_u32 m0, s45, 24576
    s_nop 0
    buffer_load_dwordx4 v8, s[8:11], s29 offen lds
    s_add_u32 m0, s45, 25600
    s_nop 0
    buffer_load_dwordx4 v9, s[8:11], s29 offen lds
    s_add_u32 m0, s46, 24576
    s_nop 0
    buffer_load_dwordx4 v12, s[12:15], s30 offen lds
    s_add_u32 m0, s46, 25600
    s_nop 0
    buffer_load_dwordx4 v13, s[12:15], s30 offen lds
    s_add_u32 m0, s46, 26624
    s_nop 0
    buffer_load_dwordx4 v14, s[12:15], s30 offen lds
    s_add_u32 m0, s46, 27648
    s_nop 0
    buffer_load_dwordx4 v15, s[12:15], s30 offen lds
    s_add_u32 s29, s29, 128
    s_add_u32 s30, s30, 81920
    s_waitcnt vmcnt(6)
    s_barrier
    s_add_u32 m0, s45, 49152
    s_nop 0
    buffer_load_dwordx4 v8, s[8:11], s29 offen lds
    s_add_u32 m0, s45, 50176
    s_nop 0
    buffer_load_dwordx4 v9, s[8:11], s29 offen lds
    s_add_u32 m0, s46, 49152
    s_nop 0
    buffer_load_dwordx4 v12, s[12:15], s30 offen lds
    s_add_u32 m0, s46, 50176
    s_nop 0
    buffer_load_dwordx4 v13, s[12:15], s30 offen lds
    s_add_u32 m0, s46, 51200
    s_nop 0
    buffer_load_dwordx4 v14, s[12:15], s30 offen lds
    s_add_u32 m0, s46, 52224
    s_nop 0
    buffer_load_dwordx4 v15, s[12:15], s30 offen lds
    s_add_u32 s29, s29, 128
    s_add_u32 s30, s30, 81920
    s_waitcnt vmcnt(6)
    s_barrier
    s_add_u32 s31, s31, 1
    s_cmp_lt_u32 s31, 1
    s_cbranch_scc1 Llloop_wo0_kernel_4
    s_add_u32 m0, s45, 73728
    s_nop 0
    buffer_load_dwordx4 v8, s[8:11], s29 offen lds
    s_add_u32 m0, s45, 74752
    s_nop 0
    buffer_load_dwordx4 v9, s[8:11], s29 offen lds
    s_add_u32 m0, s46, 73728
    s_nop 0
    buffer_load_dwordx4 v12, s[12:15], s30 offen lds
    s_add_u32 m0, s46, 74752
    s_nop 0
    buffer_load_dwordx4 v13, s[12:15], s30 offen lds
    s_add_u32 m0, s46, 75776
    s_nop 0
    buffer_load_dwordx4 v14, s[12:15], s30 offen lds
    s_add_u32 m0, s46, 76800
    s_nop 0
    buffer_load_dwordx4 v15, s[12:15], s30 offen lds
    s_add_u32 s29, s29, 128
    s_add_u32 s30, s30, 81920
    s_waitcnt vmcnt(6)
    s_barrier
    s_add_u32 m0, s45, 0
    s_nop 0
    buffer_load_dwordx4 v8, s[8:11], s29 offen lds
    s_add_u32 m0, s45, 1024
    s_nop 0
    buffer_load_dwordx4 v9, s[8:11], s29 offen lds
    s_add_u32 m0, s46, 0
    s_nop 0
    buffer_load_dwordx4 v12, s[12:15], s30 offen lds
    s_add_u32 m0, s46, 1024
    s_nop 0
    buffer_load_dwordx4 v13, s[12:15], s30 offen lds
    s_add_u32 m0, s46, 2048
    s_nop 0
    buffer_load_dwordx4 v14, s[12:15], s30 offen lds
    s_add_u32 m0, s46, 3072
    s_nop 0
    buffer_load_dwordx4 v15, s[12:15], s30 offen lds
    s_add_u32 s29, s29, 128
    s_add_u32 s30, s30, 81920
    s_waitcnt vmcnt(6)
    s_barrier
    s_add_u32 m0, s45, 24576
    s_nop 0
    buffer_load_dwordx4 v8, s[8:11], s29 offen lds
    s_add_u32 m0, s45, 25600
    s_nop 0
    buffer_load_dwordx4 v9, s[8:11], s29 offen lds
    s_add_u32 m0, s46, 24576
    s_nop 0
    buffer_load_dwordx4 v12, s[12:15], s30 offen lds
    s_add_u32 m0, s46, 25600
    s_nop 0
    buffer_load_dwordx4 v13, s[12:15], s30 offen lds
    s_add_u32 m0, s46, 26624
    s_nop 0
    buffer_load_dwordx4 v14, s[12:15], s30 offen lds
    s_add_u32 m0, s46, 27648
    s_nop 0
    buffer_load_dwordx4 v15, s[12:15], s30 offen lds
    s_add_u32 s29, s29, 128
    s_add_u32 s30, s30, 81920
    s_waitcnt vmcnt(6)
    s_barrier
    s_waitcnt vmcnt(0)
    s_barrier
    s_waitcnt vmcnt(0)
    s_barrier
    s_waitcnt vmcnt(0)
    s_barrier
    s_endpgm
.section .rodata,"a"
.p2align 6
.amdhsa_kernel wo0_kernel
  .amdhsa_next_free_vgpr 112
  .amdhsa_next_free_sgpr 56
  .amdhsa_accum_offset 112
  .amdhsa_group_segment_fixed_size 0
  .amdhsa_kernarg_size 96
  .amdhsa_user_sgpr_count 2
  .amdhsa_user_sgpr_kernarg_segment_ptr 1
  .amdhsa_system_sgpr_workgroup_id_x 1
.end_amdhsa_kernel
.text

.globl win0_kernel
.p2align 8
.type win0_kernel,@function
win0_kernel:
    s_cmp_ge_u32 s2, 192
    s_cbranch_scc1 Lend_win0_kernel_1
    s_load_dwordx2 s[4:5], s[0:1], 88
    s_load_dwordx2 s[6:7], s[0:1], 40
    s_load_dwordx2 s[24:25], s[0:1], 88
    s_and_b32 s26, s2, 7
    s_lshr_b32 s27, s2, 3
    s_mul_i32 s26, s26, 24
    s_add_u32 s26, s26, s27
    s_mul_hi_u32 s27, s26, 357913942
    s_mul_i32 s28, s27, 12
    s_sub_u32 s28, s26, s28
    s_mul_i32 s27, s27, 128
    s_mul_i32 s28, s28, 128
    s_waitcnt lgkmcnt(0)
    s_mov_b32 s8, s4
    s_mov_b32 s9, s5
    s_mov_b32 s10, 2621440
    s_mov_b32 s11, 0x00020000
    s_mov_b32 s12, s6
    s_mov_b32 s13, s7
    s_mov_b32 s14, 1966080
    s_mov_b32 s15, 0x00020000
    s_add_u32 s16, s24, 15728640
    s_addc_u32 s17, s25, 0
    s_mov_b32 s18, 6291456
    s_mov_b32 s19, 0x00020000
    v_and_b32 v1, 63, v0
    v_lshrrev_b32 v2, 6, v0
    s_nop 0
    v_readfirstlane_b32 s41, v2
    s_nop 3
    s_cmp_ge_u32 s41, 4
    s_cbranch_scc1 Lloader_win0_kernel_2
    v_lshrrev_b32 v3, 1, v2
    v_and_b32 v4, 1, v2
    v_lshrrev_b32 v5, 4, v1
    v_and_b32 v6, 15, v1
    v_mul_u32_u24 v7, 64, v3
    v_add_u32 v7, v7, v6
    v_lshlrev_b32 v7, 7, v7
    v_add_u32 v18, 0, v5
    v_and_b32 v3, 7, v6
    v_xor_b32 v18, v18, v3
    v_lshl_add_u32 v18, v18, 4, v7
    v_add_u32 v26, 65536, v18
    v_add_u32 v19, 4, v5
    v_and_b32 v3, 7, v6
    v_xor_b32 v19, v19, v3
    v_lshl_add_u32 v19, v19, 4, v7
    v_add_u32 v27, 65536, v19
    v_lshrrev_b32 v3, 2, v6
    v_and_b32 v7, 1, v5
    v_lshl_add_u32 v7, v7, 2, v3
    v_lshl_add_u32 v32, v5, 3, v3
    v_lshlrev_b32 v32, 8, v32
    v_and_b32 v33, 3, v6
    v_lshl_add_u32 v32, v33, 3, v32
    v_lshlrev_b32 v33, 2, v4
    v_add_u32 v34, 0, v33
    v_xor_b32 v34, v34, v7
    v_lshl_add_u32 v20, v34, 5, v32
    v_add_u32 v28, 65536, v20
    v_add_u32 v34, 1, v33
    v_xor_b32 v34, v34, v7
    v_lshl_add_u32 v21, v34, 5, v32
    v_add_u32 v29, 65536, v21
    v_add_u32 v34, 2, v33
    v_xor_b32 v34, v34, v7
    v_lshl_add_u32 v22, v34, 5, v32
    v_add_u32 v30, 65536, v22
    v_add_u32 v34, 3, v33
    v_xor_b32 v34, v34, v7
    v_lshl_add_u32 v23, v34, 5, v32
    v_add_u32 v31, 65536, v23
    s_load_dwordx2 s[36:37], s[0:1], 88
    s_waitcnt lgkmcnt(0)
    s_add_u32 s20, s36, 38010880
    s_addc_u32 s21, s37, 0
    s_mov_b32 s22, 163840
    s_mov_b32 s23, 0x00020000
    v_lshrrev_b32 v3, 1, v2
    v_and_b32 v6, 15, v1
    v_mul_u32_u24 v3, 64, v3
    v_add_u32 v3, v3, v6
    v_add_u32 v3, s27, v3
    v_mul_u32_u24 v3, 80, v3
    buffer_load_dwordx4 v[32:35], v3, s[20:23], 0 offen offset:0
    buffer_load_dwordx4 v[36:39], v3, s[20:23], 0 offen offset:16
    buffer_load_dwordx4 v[40:43], v3, s[20:23], 0 offen offset:32
    buffer_load_dwordx4 v[44:47], v3, s[20:23], 0 offen offset:48
    buffer_load_dwordx4 v[48:51], v3, s[20:23], 0 offen offset:64
    buffer_load_dwordx4 v[52:55], v3, s[20:23], 0 offen offset:1280
    buffer_load_dwordx4 v[56:59], v3, s[20:23], 0 offen offset:1296
    buffer_load_dwordx4 v[60:63], v3, s[20:23], 0 offen offset:1312
    buffer_load_dwordx4 v[64:67], v3, s[20:23], 0 offen offset:1328
    buffer_load_dwordx4 v[68:71], v3, s[20:23], 0 offen offset:1344
    buffer_load_dwordx4 v[72:75], v3, s[20:23], 0 offen offset:2560
    buffer_load_dwordx4 v[76:79], v3, s[20:23], 0 offen offset:2576
    buffer_load_dwordx4 v[80:83], v3, s[20:23], 0 offen offset:2592
    buffer_load_dwordx4 v[84:87], v3, s[20:23], 0 offen offset:2608
    buffer_load_dwordx4 v[88:91], v3, s[20:23], 0 offen offset:2624
    buffer_load_dwordx4 v[92:95], v3, s[20:23], 0 offen offset:3840
    buffer_load_dwordx4 v[96:99], v3, s[20:23], 0 offen offset:3856
    buffer_load_dwordx4 v[100:103], v3, s[20:23], 0 offen offset:3872
    buffer_load_dwordx4 v[104:107], v3, s[20:23], 0 offen offset:3888
    buffer_load_dwordx4 v[108:111], v3, s[20:23], 0 offen offset:3904
    s_waitcnt vmcnt(0)
    v_add_f32 v8, v32, v34
    v_add_f32 v12, v33, v35
    v_add_f32 v8, v8, v36
    v_add_f32 v12, v12, v37
    v_add_f32 v8, v8, v38
    v_add_f32 v12, v12, v39
    v_add_f32 v8, v8, v40
    v_add_f32 v12, v12, v41
    v_add_f32 v8, v8, v42
    v_add_f32 v12, v12, v43
    v_add_f32 v8, v8, v44
    v_add_f32 v12, v12, v45
    v_add_f32 v8, v8, v46
    v_add_f32 v12, v12, v47
    v_add_f32 v8, v8, v48
    v_add_f32 v12, v12, v49
    v_add_f32 v8, v8, v50
    v_add_f32 v12, v12, v51
    v_mul_f32 v8, 0x3acccccd, v8
    v_mul_f32 v12, 0x3acccccd, v12
    v_fma_f32 v12, -v8, v8, v12
    v_max_f32 v12, 0, v12
    v_cvt_pk_bf16_f32 v8, v8, v8
    v_lshlrev_b32 v8, 16, v8
    v_cvt_pk_bf16_f32 v12, v12, v12
    v_lshlrev_b32 v12, 16, v12
    v_add_f32 v12, 0x3727c5ac, v12
    v_cvt_pk_bf16_f32 v12, v12, v12
    v_lshlrev_b32 v12, 16, v12
    v_sqrt_f32 v12, v12
    s_nop 0
    v_cvt_pk_bf16_f32 v12, v12, v12
    v_lshlrev_b32 v12, 16, v12
    v_rcp_f32 v12, v12
    v_add_f32 v9, v52, v54
    v_add_f32 v13, v53, v55
    v_add_f32 v9, v9, v56
    v_add_f32 v13, v13, v57
    v_add_f32 v9, v9, v58
    v_add_f32 v13, v13, v59
    v_add_f32 v9, v9, v60
    v_add_f32 v13, v13, v61
    v_add_f32 v9, v9, v62
    v_add_f32 v13, v13, v63
    v_add_f32 v9, v9, v64
    v_add_f32 v13, v13, v65
    v_add_f32 v9, v9, v66
    v_add_f32 v13, v13, v67
    v_add_f32 v9, v9, v68
    v_add_f32 v13, v13, v69
    v_add_f32 v9, v9, v70
    v_add_f32 v13, v13, v71
    v_mul_f32 v9, 0x3acccccd, v9
    v_mul_f32 v13, 0x3acccccd, v13
    v_fma_f32 v13, -v9, v9, v13
    v_max_f32 v13, 0, v13
    v_cvt_pk_bf16_f32 v9, v9, v9
    v_lshlrev_b32 v9, 16, v9
    v_cvt_pk_bf16_f32 v13, v13, v13
    v_lshlrev_b32 v13, 16, v13
    v_add_f32 v13, 0x3727c5ac, v13
    v_cvt_pk_bf16_f32 v13, v13, v13
    v_lshlrev_b32 v13, 16, v13
    v_sqrt_f32 v13, v13
    s_nop 0
    v_cvt_pk_bf16_f32 v13, v13, v13
    v_lshlrev_b32 v13, 16, v13
    v_rcp_f32 v13, v13
    v_add_f32 v10, v72, v74
    v_add_f32 v14, v73, v75
    v_add_f32 v10, v10, v76
    v_add_f32 v14, v14, v77
    v_add_f32 v10, v10, v78
    v_add_f32 v14, v14, v79
    v_add_f32 v10, v10, v80
    v_add_f32 v14, v14, v81
    v_add_f32 v10, v10, v82
    v_add_f32 v14, v14, v83
    v_add_f32 v10, v10, v84
    v_add_f32 v14, v14, v85
    v_add_f32 v10, v10, v86
    v_add_f32 v14, v14, v87
    v_add_f32 v10, v10, v88
    v_add_f32 v14, v14, v89
    v_add_f32 v10, v10, v90
    v_add_f32 v14, v14, v91
    v_mul_f32 v10, 0x3acccccd, v10
    v_mul_f32 v14, 0x3acccccd, v14
    v_fma_f32 v14, -v10, v10, v14
    v_max_f32 v14, 0, v14
    v_cvt_pk_bf16_f32 v10, v10, v10
    v_lshlrev_b32 v10, 16, v10
    v_cvt_pk_bf16_f32 v14, v14, v14
    v_lshlrev_b32 v14, 16, v14
    v_add_f32 v14, 0x3727c5ac, v14
    v_cvt_pk_bf16_f32 v14, v14, v14
    v_lshlrev_b32 v14, 16, v14
    v_sqrt_f32 v14, v14
    s_nop 0
    v_cvt_pk_bf16_f32 v14, v14, v14
    v_lshlrev_b32 v14, 16, v14
    v_rcp_f32 v14, v14
    v_add_f32 v11, v92, v94
    v_add_f32 v15, v93, v95
    v_add_f32 v11, v11, v96
    v_add_f32 v15, v15, v97
    v_add_f32 v11, v11, v98
    v_add_f32 v15, v15, v99
    v_add_f32 v11, v11, v100
    v_add_f32 v15, v15, v101
    v_add_f32 v11, v11, v102
    v_add_f32 v15, v15, v103
    v_add_f32 v11, v11, v104
    v_add_f32 v15, v15, v105
    v_add_f32 v11, v11, v106
    v_add_f32 v15, v15, v107
    v_add_f32 v11, v11, v108
    v_add_f32 v15, v15, v109
    v_add_f32 v11, v11, v110
    v_add_f32 v15, v15, v111
    v_mul_f32 v11, 0x3acccccd, v11
    v_mul_f32 v15, 0x3acccccd, v15
    v_fma_f32 v15, -v11, v11, v15
    v_max_f32 v15, 0, v15
    v_cvt_pk_bf16_f32 v11, v11, v11
    v_lshlrev_b32 v11, 16, v11
    v_cvt_pk_bf16_f32 v15, v15, v15
    v_lshlrev_b32 v15, 16, v15
    v_add_f32 v15, 0x3727c5ac, v15
    v_cvt_pk_bf16_f32 v15, v15, v15
    v_lshlrev_b32 v15, 16, v15
    v_sqrt_f32 v15, v15
    s_nop 0
    v_cvt_pk_bf16_f32 v15, v15, v15
    v_lshlrev_b32 v15, 16, v15
    v_rcp_f32 v15, v15
    s_nop 0
    v_mov_b32 v96, 0
    v_mov_b32 v97, 0
    v_mov_b32 v98, 0
    v_mov_b32 v99, 0
    v_mov_b32 v100, 0
    v_mov_b32 v101, 0
    v_mov_b32 v102, 0
    v_mov_b32 v103, 0
    v_mov_b32 v104, 0
    v_mov_b32 v105, 0
    v_mov_b32 v106, 0
    v_mov_b32 v107, 0
    v_mov_b32 v108, 0
    v_mov_b32 v109, 0
    v_mov_b32 v110, 0
    v_mov_b32 v111, 0
    v_mov_b32 v112, 0
    v_mov_b32 v113, 0
    v_mov_b32 v114, 0
    v_mov_b32 v115, 0
    v_mov_b32 v116, 0
    v_mov_b32 v117, 0
    v_mov_b32 v118, 0
    v_mov_b32 v119, 0
    v_mov_b32 v120, 0
    v_mov_b32 v121, 0
    v_mov_b32 v122, 0
    v_mov_b32 v123, 0
    v_mov_b32 v124, 0
    v_mov_b32 v125, 0
    v_mov_b32 v126, 0
    v_mov_b32 v127, 0
    v_mov_b32 v128, 0
    v_mov_b32 v129, 0
    v_mov_b32 v130, 0
    v_mov_b32 v131, 0
    v_mov_b32 v132, 0
    v_mov_b32 v133, 0
    v_mov_b32 v134, 0
    v_mov_b32 v135, 0
    v_mov_b32 v136, 0
    v_mov_b32 v137, 0
    v_mov_b32 v138, 0
    v_mov_b32 v139, 0
    v_mov_b32 v140, 0
    v_mov_b32 v141, 0
    v_mov_b32 v142, 0
    v_mov_b32 v143, 0
    v_mov_b32 v144, 0
    v_mov_b32 v145, 0
    v_mov_b32 v146, 0
    v_mov_b32 v147, 0
    v_mov_b32 v148, 0
    v_mov_b32 v149, 0
    v_mov_b32 v150, 0
    v_mov_b32 v151, 0
    v_mov_b32 v152, 0
    v_mov_b32 v153, 0
    v_mov_b32 v154, 0
    v_mov_b32 v155, 0
    v_mov_b32 v156, 0
    v_mov_b32 v157, 0
    v_mov_b32 v158, 0
    v_mov_b32 v159, 0
    s_barrier
    ds_read_b128 v[32:35], v18 offset:0
    ds_read_b128 v[36:39], v18 offset:2048
    ds_read_b128 v[40:43], v18 offset:4096
    ds_read_b128 v[44:47], v18 offset:6144
    ds_read_b64_tr_b16 v[64:65], v20 offset:16384
    ds_read_b64_tr_b16 v[66:67], v20 offset:17408
    ds_read_b64_tr_b16 v[68:69], v21 offset:16384
    ds_read_b64_tr_b16 v[70:71], v21 offset:17408
    ds_read_b64_tr_b16 v[72:73], v22 offset:16384
    ds_read_b64_tr_b16 v[74:75], v22 offset:17408
    ds_read_b64_tr_b16 v[76:77], v23 offset:16384
    ds_read_b64_tr_b16 v[78:79], v23 offset:17408
    s_mov_b32 s31, 0
Lcloop_win0_kernel_3:
    s_waitcnt lgkmcnt(0)
    v_mfma_f32_16x16x32_bf16 v[96:99], v[64:67], v[32:35], v[96:99]
    v_mfma_f32_16x16x32_bf16 v[100:103], v[68:71], v[32:35], v[100:103]
    ds_read_b128 v[48:51], v19 offset:0
    v_mfma_f32_16x16x32_bf16 v[104:107], v[72:75], v[32:35], v[104:107]
    ds_read_b128 v[52:55], v19 offset:2048
    v_mfma_f32_16x16x32_bf16 v[108:111], v[76:79], v[32:35], v[108:111]
    ds_read_b128 v[56:59], v19 offset:4096
    v_mfma_f32_16x16x32_bf16 v[112:115], v[64:67], v[36:39], v[112:115]
    v_mfma_f32_16x16x32_bf16 v[116:119], v[68:71], v[36:39], v[116:119]
    ds_read_b128 v[60:63], v19 offset:6144
    v_mfma_f32_16x16x32_bf16 v[120:123], v[72:75], v[36:39], v[120:123]
    ds_read_b64_tr_b16 v[80:81], v20 offset:24576
    v_mfma_f32_16x16x32_bf16 v[124:127], v[76:79], v[36:39], v[124:127]
    ds_read_b64_tr_b16 v[82:83], v20 offset:25600
    v_mfma_f32_16x16x32_bf16 v[128:131], v[64:67], v[40:43], v[128:131]
    v_mfma_f32_16x16x32_bf16 v[132:135], v[68:71], v[40:43], v[132:135]
    ds_read_b64_tr_b16 v[84:85], v21 offset:24576
    v_mfma_f32_16x16x32_bf16 v[136:139], v[72:75], v[40:43], v[136:139]
    ds_read_b64_tr_b16 v[86:87], v21 offset:25600
    v_mfma_f32_16x16x32_bf16 v[140:143], v[76:79], v[40:43], v[140:143]
    ds_read_b64_tr_b16 v[88:89], v22 offset:24576
    v_mfma_f32_16x16x32_bf16 v[144:147], v[64:67], v[44:47], v[144:147]
    v_mfma_f32_16x16x32_bf16 v[148:151], v[68:71], v[44:47], v[148:151]
    ds_read_b64_tr_b16 v[90:91], v22 offset:25600
    v_mfma_f32_16x16x32_bf16 v[152:155], v[72:75], v[44:47], v[152:155]
    ds_read_b64_tr_b16 v[92:93], v23 offset:24576
    v_mfma_f32_16x16x32_bf16 v[156:159], v[76:79], v[44:47], v[156:159]
    ds_read_b64_tr_b16 v[94:95], v23 offset:25600
    s_waitcnt lgkmcnt(0)
    v_mfma_f32_16x16x32_bf16 v[96:99], v[80:83], v[48:51], v[96:99]
    v_mfma_f32_16x16x32_bf16 v[100:103], v[84:87], v[48:51], v[100:103]
    ds_read_b128 v[32:35], v18 offset:32768
    v_mfma_f32_16x16x32_bf16 v[104:107], v[88:91], v[48:51], v[104:107]
    ds_read_b128 v[36:39], v18 offset:34816
    v_mfma_f32_16x16x32_bf16 v[108:111], v[92:95], v[48:51], v[108:111]
    ds_read_b128 v[40:43], v18 offset:36864
    v_mfma_f32_16x16x32_bf16 v[112:115], v[80:83], v[52:55], v[112:115]
    v_mfma_f32_16x16x32_bf16 v[116:119], v[84:87], v[52:55], v[116:119]
    ds_read_b128 v[44:47], v18 offset:38912
    v_mfma_f32_16x16x32_bf16 v[120:123], v[88:91], v[52:55], v[120:123]
    ds_read_b64_tr_b16 v[64:65], v20 offset:49152
    v_mfma_f32_16x16x32_bf16 v[124:127], v[92:95], v[52:55], v[124:127]
    ds_read_b64_tr_b16 v[66:67], v20 offset:50176
    v_mfma_f32_16x16x32_bf16 v[128:131], v[80:83], v[56:59], v[128:131]
    v_mfma_f32_16x16x32_bf16 v[132:135], v[84:87], v[56:59], v[132:135]
    ds_read_b64_tr_b16 v[68:69], v21 offset:49152
    v_mfma_f32_16x16x32_bf16 v[136:139], v[88:91], v[56:59], v[136:139]
    ds_read_b64_tr_b16 v[70:71], v21 offset:50176
    v_mfma_f32_16x16x32_bf16 v[140:143], v[92:95], v[56:59], v[140:143]
    ds_read_b64_tr_b16 v[72:73], v22 offset:49152
    v_mfma_f32_16x16x32_bf16 v[144:147], v[80:83], v[60:63], v[144:147]
    v_mfma_f32_16x16x32_bf16 v[148:151], v[84:87], v[60:63], v[148:151]
    ds_read_b64_tr_b16 v[74:75], v22 offset:50176
    v_mfma_f32_16x16x32_bf16 v[152:155], v[88:91], v[60:63], v[152:155]
    ds_read_b64_tr_b16 v[76:77], v23 offset:49152
    v_mfma_f32_16x16x32_bf16 v[156:159], v[92:95], v[60:63], v[156:159]
    ds_read_b64_tr_b16 v[78:79], v23 offset:50176
    s_barrier
    s_waitcnt lgkmcnt(0)
    v_mfma_f32_16x16x32_bf16 v[96:99], v[64:67], v[32:35], v[96:99]
    v_mfma_f32_16x16x32_bf16 v[100:103], v[68:71], v[32:35], v[100:103]
    ds_read_b128 v[48:51], v19 offset:32768
    v_mfma_f32_16x16x32_bf16 v[104:107], v[72:75], v[32:35], v[104:107]
    ds_read_b128 v[52:55], v19 offset:34816
    v_mfma_f32_16x16x32_bf16 v[108:111], v[76:79], v[32:35], v[108:111]
    ds_read_b128 v[56:59], v19 offset:36864
    v_mfma_f32_16x16x32_bf16 v[112:115], v[64:67], v[36:39], v[112:115]
    v_mfma_f32_16x16x32_bf16 v[116:119], v[68:71], v[36:39], v[116:119]
    ds_read_b128 v[60:63], v19 offset:38912
    v_mfma_f32_16x16x32_bf16 v[120:123], v[72:75], v[36:39], v[120:123]
    ds_read_b64_tr_b16 v[80:81], v20 offset:57344
    v_mfma_f32_16x16x32_bf16 v[124:127], v[76:79], v[36:39], v[124:127]
    ds_read_b64_tr_b16 v[82:83], v20 offset:58368
    v_mfma_f32_16x16x32_bf16 v[128:131], v[64:67], v[40:43], v[128:131]
    v_mfma_f32_16x16x32_bf16 v[132:135], v[68:71], v[40:43], v[132:135]
    ds_read_b64_tr_b16 v[84:85], v21 offset:57344
    v_mfma_f32_16x16x32_bf16 v[136:139], v[72:75], v[40:43], v[136:139]
    ds_read_b64_tr_b16 v[86:87], v21 offset:58368
    v_mfma_f32_16x16x32_bf16 v[140:143], v[76:79], v[40:43], v[140:143]
    ds_read_b64_tr_b16 v[88:89], v22 offset:57344
    v_mfma_f32_16x16x32_bf16 v[144:147], v[64:67], v[44:47], v[144:147]
    v_mfma_f32_16x16x32_bf16 v[148:151], v[68:71], v[44:47], v[148:151]
    ds_read_b64_tr_b16 v[90:91], v22 offset:58368
    v_mfma_f32_16x16x32_bf16 v[152:155], v[72:75], v[44:47], v[152:155]
    ds_read_b64_tr_b16 v[92:93], v23 offset:57344
    v_mfma_f32_16x16x32_bf16 v[156:159], v[76:79], v[44:47], v[156:159]
    ds_read_b64_tr_b16 v[94:95], v23 offset:58368
    s_waitcnt lgkmcnt(0)
    v_mfma_f32_16x16x32_bf16 v[96:99], v[80:83], v[48:51], v[96:99]
    v_mfma_f32_16x16x32_bf16 v[100:103], v[84:87], v[48:51], v[100:103]
    ds_read_b128 v[32:35], v26 offset:0
    v_mfma_f32_16x16x32_bf16 v[104:107], v[88:91], v[48:51], v[104:107]
    ds_read_b128 v[36:39], v26 offset:2048
    v_mfma_f32_16x16x32_bf16 v[108:111], v[92:95], v[48:51], v[108:111]
    ds_read_b128 v[40:43], v26 offset:4096
    v_mfma_f32_16x16x32_bf16 v[112:115], v[80:83], v[52:55], v[112:115]
    v_mfma_f32_16x16x32_bf16 v[116:119], v[84:87], v[52:55], v[116:119]
    ds_read_b128 v[44:47], v26 offset:6144
    v_mfma_f32_16x16x32_bf16 v[120:123], v[88:91], v[52:55], v[120:123]
    ds_read_b64_tr_b16 v[64:65], v28 offset:16384
    v_mfma_f32_16x16x32_bf16 v[124:127], v[92:95], v[52:55], v[124:127]
    ds_read_b64_tr_b16 v[66:67], v28 offset:17408
    v_mfma_f32_16x16x32_bf16 v[128:131], v[80:83], v[56:59], v[128:131]
    v_mfma_f32_16x16x32_bf16 v[132:135], v[84:87], v[56:59], v[132:135]
    ds_read_b64_tr_b16 v[68:69], v29 offset:16384
    v_mfma_f32_16x16x32_bf16 v[136:139], v[88:91], v[56:59], v[136:139]
    ds_read_b64_tr_b16 v[70:71], v29 offset:17408
    v_mfma_f32_16x16x32_bf16 v[140:143], v[92:95], v[56:59], v[140:143]
    ds_read_b64_tr_b16 v[72:73], v30 offset:16384
    v_mfma_f32_16x16x32_bf16 v[144:147], v[80:83], v[60:63], v[144:147]
    v_mfma_f32_16x16x32_bf16 v[148:151], v[84:87], v[60:63], v[148:151]
    ds_read_b64_tr_b16 v[74:75], v30 offset:17408
    v_mfma_f32_16x16x32_bf16 v[152:155], v[88:91], v[60:63], v[152:155]
    ds_read_b64_tr_b16 v[76:77], v31 offset:16384
    v_mfma_f32_16x16x32_bf16 v[156:159], v[92:95], v[60:63], v[156:159]
    ds_read_b64_tr_b16 v[78:79], v31 offset:17408
    s_barrier
    s_waitcnt lgkmcnt(0)
    v_mfma_f32_16x16x32_bf16 v[96:99], v[64:67], v[32:35], v[96:99]
    v_mfma_f32_16x16x32_bf16 v[100:103], v[68:71], v[32:35], v[100:103]
    ds_read_b128 v[48:51], v27 offset:0
    v_mfma_f32_16x16x32_bf16 v[104:107], v[72:75], v[32:35], v[104:107]
    ds_read_b128 v[52:55], v27 offset:2048
    v_mfma_f32_16x16x32_bf16 v[108:111], v[76:79], v[32:35], v[108:111]
    ds_read_b128 v[56:59], v27 offset:4096
    v_mfma_f32_16x16x32_bf16 v[112:115], v[64:67], v[36:39], v[112:115]
    v_mfma_f32_16x16x32_bf16 v[116:119], v[68:71], v[36:39], v[116:119]
    ds_read_b128 v[60:63], v27 offset:6144
    v_mfma_f32_16x16x32_bf16 v[120:123], v[72:75], v[36:39], v[120:123]
    ds_read_b64_tr_b16 v[80:81], v28 offset:24576
    v_mfma_f32_16x16x32_bf16 v[124:127], v[76:79], v[36:39], v[124:127]
    ds_read_b64_tr_b16 v[82:83], v28 offset:25600
    v_mfma_f32_16x16x32_bf16 v[128:131], v[64:67], v[40:43], v[128:131]
    v_mfma_f32_16x16x32_bf16 v[132:135], v[68:71], v[40:43], v[132:135]
    ds_read_b64_tr_b16 v[84:85], v29 offset:24576
    v_mfma_f32_16x16x32_bf16 v[136:139], v[72:75], v[40:43], v[136:139]
    ds_read_b64_tr_b16 v[86:87], v29 offset:25600
    v_mfma_f32_16x16x32_bf16 v[140:143], v[76:79], v[40:43], v[140:143]
    ds_read_b64_tr_b16 v[88:89], v30 offset:24576
    v_mfma_f32_16x16x32_bf16 v[144:147], v[64:67], v[44:47], v[144:147]
    v_mfma_f32_16x16x32_bf16 v[148:151], v[68:71], v[44:47], v[148:151]
    ds_read_b64_tr_b16 v[90:91], v30 offset:25600
    v_mfma_f32_16x16x32_bf16 v[152:155], v[72:75], v[44:47], v[152:155]
    ds_read_b64_tr_b16 v[92:93], v31 offset:24576
    v_mfma_f32_16x16x32_bf16 v[156:159], v[76:79], v[44:47], v[156:159]
    ds_read_b64_tr_b16 v[94:95], v31 offset:25600
    s_waitcnt lgkmcnt(0)
    v_mfma_f32_16x16x32_bf16 v[96:99], v[80:83], v[48:51], v[96:99]
    v_mfma_f32_16x16x32_bf16 v[100:103], v[84:87], v[48:51], v[100:103]
    ds_read_b128 v[32:35], v26 offset:32768
    v_mfma_f32_16x16x32_bf16 v[104:107], v[88:91], v[48:51], v[104:107]
    ds_read_b128 v[36:39], v26 offset:34816
    v_mfma_f32_16x16x32_bf16 v[108:111], v[92:95], v[48:51], v[108:111]
    ds_read_b128 v[40:43], v26 offset:36864
    v_mfma_f32_16x16x32_bf16 v[112:115], v[80:83], v[52:55], v[112:115]
    v_mfma_f32_16x16x32_bf16 v[116:119], v[84:87], v[52:55], v[116:119]
    ds_read_b128 v[44:47], v26 offset:38912
    v_mfma_f32_16x16x32_bf16 v[120:123], v[88:91], v[52:55], v[120:123]
    ds_read_b64_tr_b16 v[64:65], v28 offset:49152
    v_mfma_f32_16x16x32_bf16 v[124:127], v[92:95], v[52:55], v[124:127]
    ds_read_b64_tr_b16 v[66:67], v28 offset:50176
    v_mfma_f32_16x16x32_bf16 v[128:131], v[80:83], v[56:59], v[128:131]
    v_mfma_f32_16x16x32_bf16 v[132:135], v[84:87], v[56:59], v[132:135]
    ds_read_b64_tr_b16 v[68:69], v29 offset:49152
    v_mfma_f32_16x16x32_bf16 v[136:139], v[88:91], v[56:59], v[136:139]
    ds_read_b64_tr_b16 v[70:71], v29 offset:50176
    v_mfma_f32_16x16x32_bf16 v[140:143], v[92:95], v[56:59], v[140:143]
    ds_read_b64_tr_b16 v[72:73], v30 offset:49152
    v_mfma_f32_16x16x32_bf16 v[144:147], v[80:83], v[60:63], v[144:147]
    v_mfma_f32_16x16x32_bf16 v[148:151], v[84:87], v[60:63], v[148:151]
    ds_read_b64_tr_b16 v[74:75], v30 offset:50176
    v_mfma_f32_16x16x32_bf16 v[152:155], v[88:91], v[60:63], v[152:155]
    ds_read_b64_tr_b16 v[76:77], v31 offset:49152
    v_mfma_f32_16x16x32_bf16 v[156:159], v[92:95], v[60:63], v[156:159]
    ds_read_b64_tr_b16 v[78:79], v31 offset:50176
    s_barrier
    s_waitcnt lgkmcnt(0)
    v_mfma_f32_16x16x32_bf16 v[96:99], v[64:67], v[32:35], v[96:99]
    v_mfma_f32_16x16x32_bf16 v[100:103], v[68:71], v[32:35], v[100:103]
    ds_read_b128 v[48:51], v27 offset:32768
    v_mfma_f32_16x16x32_bf16 v[104:107], v[72:75], v[32:35], v[104:107]
    ds_read_b128 v[52:55], v27 offset:34816
    v_mfma_f32_16x16x32_bf16 v[108:111], v[76:79], v[32:35], v[108:111]
    ds_read_b128 v[56:59], v27 offset:36864
    v_mfma_f32_16x16x32_bf16 v[112:115], v[64:67], v[36:39], v[112:115]
    v_mfma_f32_16x16x32_bf16 v[116:119], v[68:71], v[36:39], v[116:119]
    ds_read_b128 v[60:63], v27 offset:38912
    v_mfma_f32_16x16x32_bf16 v[120:123], v[72:75], v[36:39], v[120:123]
    ds_read_b64_tr_b16 v[80:81], v28 offset:57344
    v_mfma_f32_16x16x32_bf16 v[124:127], v[76:79], v[36:39], v[124:127]
    ds_read_b64_tr_b16 v[82:83], v28 offset:58368
    v_mfma_f32_16x16x32_bf16 v[128:131], v[64:67], v[40:43], v[128:131]
    v_mfma_f32_16x16x32_bf16 v[132:135], v[68:71], v[40:43], v[132:135]
    ds_read_b64_tr_b16 v[84:85], v29 offset:57344
    v_mfma_f32_16x16x32_bf16 v[136:139], v[72:75], v[40:43], v[136:139]
    ds_read_b64_tr_b16 v[86:87], v29 offset:58368
    v_mfma_f32_16x16x32_bf16 v[140:143], v[76:79], v[40:43], v[140:143]
    ds_read_b64_tr_b16 v[88:89], v30 offset:57344
    v_mfma_f32_16x16x32_bf16 v[144:147], v[64:67], v[44:47], v[144:147]
    v_mfma_f32_16x16x32_bf16 v[148:151], v[68:71], v[44:47], v[148:151]
    ds_read_b64_tr_b16 v[90:91], v30 offset:58368
    v_mfma_f32_16x16x32_bf16 v[152:155], v[72:75], v[44:47], v[152:155]
    ds_read_b64_tr_b16 v[92:93], v31 offset:57344
    v_mfma_f32_16x16x32_bf16 v[156:159], v[76:79], v[44:47], v[156:159]
    ds_read_b64_tr_b16 v[94:95], v31 offset:58368
    s_waitcnt lgkmcnt(0)
    v_mfma_f32_16x16x32_bf16 v[96:99], v[80:83], v[48:51], v[96:99]
    v_mfma_f32_16x16x32_bf16 v[100:103], v[84:87], v[48:51], v[100:103]
    ds_read_b128 v[32:35], v18 offset:0
    v_mfma_f32_16x16x32_bf16 v[104:107], v[88:91], v[48:51], v[104:107]
    ds_read_b128 v[36:39], v18 offset:2048
    v_mfma_f32_16x16x32_bf16 v[108:111], v[92:95], v[48:51], v[108:111]
    ds_read_b128 v[40:43], v18 offset:4096
    v_mfma_f32_16x16x32_bf16 v[112:115], v[80:83], v[52:55], v[112:115]
    v_mfma_f32_16x16x32_bf16 v[116:119], v[84:87], v[52:55], v[116:119]
    ds_read_b128 v[44:47], v18 offset:6144
    v_mfma_f32_16x16x32_bf16 v[120:123], v[88:91], v[52:55], v[120:123]
    ds_read_b64_tr_b16 v[64:65], v20 offset:16384
    v_mfma_f32_16x16x32_bf16 v[124:127], v[92:95], v[52:55], v[124:127]
    ds_read_b64_tr_b16 v[66:67], v20 offset:17408
    v_mfma_f32_16x16x32_bf16 v[128:131], v[80:83], v[56:59], v[128:131]
    v_mfma_f32_16x16x32_bf16 v[132:135], v[84:87], v[56:59], v[132:135]
    ds_read_b64_tr_b16 v[68:69], v21 offset:16384
    v_mfma_f32_16x16x32_bf16 v[136:139], v[88:91], v[56:59], v[136:139]
    ds_read_b64_tr_b16 v[70:71], v21 offset:17408
    v_mfma_f32_16x16x32_bf16 v[140:143], v[92:95], v[56:59], v[140:143]
    ds_read_b64_tr_b16 v[72:73], v22 offset:16384
    v_mfma_f32_16x16x32_bf16 v[144:147], v[80:83], v[60:63], v[144:147]
    v_mfma_f32_16x16x32_bf16 v[148:151], v[84:87], v[60:63], v[148:151]
    ds_read_b64_tr_b16 v[74:75], v22 offset:17408
    v_mfma_f32_16x16x32_bf16 v[152:155], v[88:91], v[60:63], v[152:155]
    ds_read_b64_tr_b16 v[76:77], v23 offset:16384
    v_mfma_f32_16x16x32_bf16 v[156:159], v[92:95], v[60:63], v[156:159]
    ds_read_b64_tr_b16 v[78:79], v23 offset:17408
    s_barrier
    s_add_u32 s31, s31, 1
    s_cmp_lt_u32 s31, 2
    s_cbranch_scc1 Lcloop_win0_kernel_3
    s_waitcnt lgkmcnt(0)
    v_mfma_f32_16x16x32_bf16 v[96:99], v[64:67], v[32:35], v[96:99]
    v_mfma_f32_16x16x32_bf16 v[100:103], v[68:71], v[32:35], v[100:103]
    ds_read_b128 v[48:51], v19 offset:0
    v_mfma_f32_16x16x32_bf16 v[104:107], v[72:75], v[32:35], v[104:107]
    ds_read_b128 v[52:55], v19 offset:2048
    v_mfma_f32_16x16x32_bf16 v[108:111], v[76:79], v[32:35], v[108:111]
    ds_read_b128 v[56:59], v19 offset:4096
    v_mfma_f32_16x16x32_bf16 v[112:115], v[64:67], v[36:39], v[112:115]
    v_mfma_f32_16x16x32_bf16 v[116:119], v[68:71], v[36:39], v[116:119]
    ds_read_b128 v[60:63], v19 offset:6144
    v_mfma_f32_16x16x32_bf16 v[120:123], v[72:75], v[36:39], v[120:123]
    ds_read_b64_tr_b16 v[80:81], v20 offset:24576
    v_mfma_f32_16x16x32_bf16 v[124:127], v[76:79], v[36:39], v[124:127]
    ds_read_b64_tr_b16 v[82:83], v20 offset:25600
    v_mfma_f32_16x16x32_bf16 v[128:131], v[64:67], v[40:43], v[128:131]
    v_mfma_f32_16x16x32_bf16 v[132:135], v[68:71], v[40:43], v[132:135]
    ds_read_b64_tr_b16 v[84:85], v21 offset:24576
    v_mfma_f32_16x16x32_bf16 v[136:139], v[72:75], v[40:43], v[136:139]
    ds_read_b64_tr_b16 v[86:87], v21 offset:25600
    v_mfma_f32_16x16x32_bf16 v[140:143], v[76:79], v[40:43], v[140:143]
    ds_read_b64_tr_b16 v[88:89], v22 offset:24576
    v_mfma_f32_16x16x32_bf16 v[144:147], v[64:67], v[44:47], v[144:147]
    v_mfma_f32_16x16x32_bf16 v[148:151], v[68:71], v[44:47], v[148:151]
    ds_read_b64_tr_b16 v[90:91], v22 offset:25600
    v_mfma_f32_16x16x32_bf16 v[152:155], v[72:75], v[44:47], v[152:155]
    ds_read_b64_tr_b16 v[92:93], v23 offset:24576
    v_mfma_f32_16x16x32_bf16 v[156:159], v[76:79], v[44:47], v[156:159]
    ds_read_b64_tr_b16 v[94:95], v23 offset:25600
    s_waitcnt lgkmcnt(0)
    v_mfma_f32_16x16x32_bf16 v[96:99], v[80:83], v[48:51], v[96:99]
    v_mfma_f32_16x16x32_bf16 v[100:103], v[84:87], v[48:51], v[100:103]
    ds_read_b128 v[32:35], v18 offset:32768
    v_mfma_f32_16x16x32_bf16 v[104:107], v[88:91], v[48:51], v[104:107]
    ds_read_b128 v[36:39], v18 offset:34816
    v_mfma_f32_16x16x32_bf16 v[108:111], v[92:95], v[48:51], v[108:111]
    ds_read_b128 v[40:43], v18 offset:36864
    v_mfma_f32_16x16x32_bf16 v[112:115], v[80:83], v[52:55], v[112:115]
    v_mfma_f32_16x16x32_bf16 v[116:119], v[84:87], v[52:55], v[116:119]
    ds_read_b128 v[44:47], v18 offset:38912
    v_mfma_f32_16x16x32_bf16 v[120:123], v[88:91], v[52:55], v[120:123]
    ds_read_b64_tr_b16 v[64:65], v20 offset:49152
    v_mfma_f32_16x16x32_bf16 v[124:127], v[92:95], v[52:55], v[124:127]
    ds_read_b64_tr_b16 v[66:67], v20 offset:50176
    v_mfma_f32_16x16x32_bf16 v[128:131], v[80:83], v[56:59], v[128:131]
    v_mfma_f32_16x16x32_bf16 v[132:135], v[84:87], v[56:59], v[132:135]
    ds_read_b64_tr_b16 v[68:69], v21 offset:49152
    v_mfma_f32_16x16x32_bf16 v[136:139], v[88:91], v[56:59], v[136:139]
    ds_read_b64_tr_b16 v[70:71], v21 offset:50176
    v_mfma_f32_16x16x32_bf16 v[140:143], v[92:95], v[56:59], v[140:143]
    ds_read_b64_tr_b16 v[72:73], v22 offset:49152
    v_mfma_f32_16x16x32_bf16 v[144:147], v[80:83], v[60:63], v[144:147]
    v_mfma_f32_16x16x32_bf16 v[148:151], v[84:87], v[60:63], v[148:151]
    ds_read_b64_tr_b16 v[74:75], v22 offset:50176
    v_mfma_f32_16x16x32_bf16 v[152:155], v[88:91], v[60:63], v[152:155]
    ds_read_b64_tr_b16 v[76:77], v23 offset:49152
    v_mfma_f32_16x16x32_bf16 v[156:159], v[92:95], v[60:63], v[156:159]
    ds_read_b64_tr_b16 v[78:79], v23 offset:50176
    s_barrier
    s_waitcnt lgkmcnt(0)
    v_mfma_f32_16x16x32_bf16 v[96:99], v[64:67], v[32:35], v[96:99]
    v_mfma_f32_16x16x32_bf16 v[100:103], v[68:71], v[32:35], v[100:103]
    ds_read_b128 v[48:51], v19 offset:32768
    v_mfma_f32_16x16x32_bf16 v[104:107], v[72:75], v[32:35], v[104:107]
    ds_read_b128 v[52:55], v19 offset:34816
    v_mfma_f32_16x16x32_bf16 v[108:111], v[76:79], v[32:35], v[108:111]
    ds_read_b128 v[56:59], v19 offset:36864
    v_mfma_f32_16x16x32_bf16 v[112:115], v[64:67], v[36:39], v[112:115]
    v_mfma_f32_16x16x32_bf16 v[116:119], v[68:71], v[36:39], v[116:119]
    ds_read_b128 v[60:63], v19 offset:38912
    v_mfma_f32_16x16x32_bf16 v[120:123], v[72:75], v[36:39], v[120:123]
    ds_read_b64_tr_b16 v[80:81], v20 offset:57344
    v_mfma_f32_16x16x32_bf16 v[124:127], v[76:79], v[36:39], v[124:127]
    ds_read_b64_tr_b16 v[82:83], v20 offset:58368
    v_mfma_f32_16x16x32_bf16 v[128:131], v[64:67], v[40:43], v[128:131]
    v_mfma_f32_16x16x32_bf16 v[132:135], v[68:71], v[40:43], v[132:135]
    ds_read_b64_tr_b16 v[84:85], v21 offset:57344
    v_mfma_f32_16x16x32_bf16 v[136:139], v[72:75], v[40:43], v[136:139]
    ds_read_b64_tr_b16 v[86:87], v21 offset:58368
    v_mfma_f32_16x16x32_bf16 v[140:143], v[76:79], v[40:43], v[140:143]
    ds_read_b64_tr_b16 v[88:89], v22 offset:57344
    v_mfma_f32_16x16x32_bf16 v[144:147], v[64:67], v[44:47], v[144:147]
    v_mfma_f32_16x16x32_bf16 v[148:151], v[68:71], v[44:47], v[148:151]
    ds_read_b64_tr_b16 v[90:91], v22 offset:58368
    v_mfma_f32_16x16x32_bf16 v[152:155], v[72:75], v[44:47], v[152:155]
    ds_read_b64_tr_b16 v[92:93], v23 offset:57344
    v_mfma_f32_16x16x32_bf16 v[156:159], v[76:79], v[44:47], v[156:159]
    ds_read_b64_tr_b16 v[94:95], v23 offset:58368
    s_waitcnt lgkmcnt(0)
    v_mfma_f32_16x16x32_bf16 v[96:99], v[80:83], v[48:51], v[96:99]
    v_mfma_f32_16x16x32_bf16 v[100:103], v[84:87], v[48:51], v[100:103]
    v_mfma_f32_16x16x32_bf16 v[104:107], v[88:91], v[48:51], v[104:107]
    v_mfma_f32_16x16x32_bf16 v[108:111], v[92:95], v[48:51], v[108:111]
    v_mfma_f32_16x16x32_bf16 v[112:115], v[80:83], v[52:55], v[112:115]
    v_mfma_f32_16x16x32_bf16 v[116:119], v[84:87], v[52:55], v[116:119]
    v_mfma_f32_16x16x32_bf16 v[120:123], v[88:91], v[52:55], v[120:123]
    v_mfma_f32_16x16x32_bf16 v[124:127], v[92:95], v[52:55], v[124:127]
    v_mfma_f32_16x16x32_bf16 v[128:131], v[80:83], v[56:59], v[128:131]
    v_mfma_f32_16x16x32_bf16 v[132:135], v[84:87], v[56:59], v[132:135]
    v_mfma_f32_16x16x32_bf16 v[136:139], v[88:91], v[56:59], v[136:139]
    v_mfma_f32_16x16x32_bf16 v[140:143], v[92:95], v[56:59], v[140:143]
    v_mfma_f32_16x16x32_bf16 v[144:147], v[80:83], v[60:63], v[144:147]
    v_mfma_f32_16x16x32_bf16 v[148:151], v[84:87], v[60:63], v[148:151]
    v_mfma_f32_16x16x32_bf16 v[152:155], v[88:91], v[60:63], v[152:155]
    v_mfma_f32_16x16x32_bf16 v[156:159], v[92:95], v[60:63], v[156:159]
    s_barrier
    s_nop 7
    s_nop 7
    v_lshrrev_b32 v3, 1, v2
    v_and_b32 v4, 1, v2
    v_lshrrev_b32 v5, 4, v1
    v_and_b32 v6, 15, v1
    s_mov_b32 s47, 0x3dd2d3e8
    v_mov_b32 v28, 0x40135761
    s_load_dwordx2 s[36:37], s[0:1], 88
    s_waitcnt lgkmcnt(0)
    s_add_u32 s20, s36, 39911424
    s_addc_u32 s21, s37, 0
    s_mov_b32 s22, 6144
    s_mov_b32 s23, 0x00020000
    v_lshlrev_b32 v7, 6, v4
    v_lshl_add_u32 v7, v5, 2, v7
    v_add_u32 v7, s28, v7
    v_lshlrev_b32 v7, 2, v7
    buffer_load_dwordx4 v[64:67], v7, s[20:23], 0 offen offset:0
    buffer_load_dwordx4 v[68:71], v7, s[20:23], 0 offen offset:64
    buffer_load_dwordx4 v[72:75], v7, s[20:23], 0 offen offset:128
    buffer_load_dwordx4 v[76:79], v7, s[20:23], 0 offen offset:192
    s_waitcnt vmcnt(0)
    v_fma_f32 v96, -v8, v64, v96
    v_mul_f32 v96, v96, v12
    v_fma_f32 v97, -v8, v65, v97
    v_mul_f32 v97, v97, v12
    v_fma_f32 v98, -v8, v66, v98
    v_mul_f32 v98, v98, v12
    v_fma_f32 v99, -v8, v67, v99
    v_mul_f32 v99, v99, v12
    v_fma_f32 v100, -v8, v68, v100
    v_mul_f32 v100, v100, v12
    v_fma_f32 v101, -v8, v69, v101
    v_mul_f32 v101, v101, v12
    v_fma_f32 v102, -v8, v70, v102
    v_mul_f32 v102, v102, v12
    v_fma_f32 v103, -v8, v71, v103
    v_mul_f32 v103, v103, v12
    v_fma_f32 v104, -v8, v72, v104
    v_mul_f32 v104, v104, v12
    v_fma_f32 v105, -v8, v73, v105
    v_mul_f32 v105, v105, v12
    v_fma_f32 v106, -v8, v74, v106
    v_mul_f32 v106, v106, v12
    v_fma_f32 v107, -v8, v75, v107
    v_mul_f32 v107, v107, v12
    v_fma_f32 v108, -v8, v76, v108
    v_mul_f32 v108, v108, v12
    v_fma_f32 v109, -v8, v77, v109
    v_mul_f32 v109, v109, v12
    v_fma_f32 v110, -v8, v78, v110
    v_mul_f32 v110, v110, v12
    v_fma_f32 v111, -v8, v79, v111
    v_mul_f32 v111, v111, v12
    v_fma_f32 v112, -v9, v64, v112
    v_mul_f32 v112, v112, v13
    v_fma_f32 v113, -v9, v65, v113
    v_mul_f32 v113, v113, v13
    v_fma_f32 v114, -v9, v66, v114
    v_mul_f32 v114, v114, v13
    v_fma_f32 v115, -v9, v67, v115
    v_mul_f32 v115, v115, v13
    v_fma_f32 v116, -v9, v68, v116
    v_mul_f32 v116, v116, v13
    v_fma_f32 v117, -v9, v69, v117
    v_mul_f32 v117, v117, v13
    v_fma_f32 v118, -v9, v70, v118
    v_mul_f32 v118, v118, v13
    v_fma_f32 v119, -v9, v71, v119
    v_mul_f32 v119, v119, v13
    v_fma_f32 v120, -v9, v72, v120
    v_mul_f32 v120, v120, v13
    v_fma_f32 v121, -v9, v73, v121
    v_mul_f32 v121, v121, v13
    v_fma_f32 v122, -v9, v74, v122
    v_mul_f32 v122, v122, v13
    v_fma_f32 v123, -v9, v75, v123
    v_mul_f32 v123, v123, v13
    v_fma_f32 v124, -v9, v76, v124
    v_mul_f32 v124, v124, v13
    v_fma_f32 v125, -v9, v77, v125
    v_mul_f32 v125, v125, v13
    v_fma_f32 v126, -v9, v78, v126
    v_mul_f32 v126, v126, v13
    v_fma_f32 v127, -v9, v79, v127
    v_mul_f32 v127, v127, v13
    v_fma_f32 v128, -v10, v64, v128
    v_mul_f32 v128, v128, v14
    v_fma_f32 v129, -v10, v65, v129
    v_mul_f32 v129, v129, v14
    v_fma_f32 v130, -v10, v66, v130
    v_mul_f32 v130, v130, v14
    v_fma_f32 v131, -v10, v67, v131
    v_mul_f32 v131, v131, v14
    v_fma_f32 v132, -v10, v68, v132
    v_mul_f32 v132, v132, v14
    v_fma_f32 v133, -v10, v69, v133
    v_mul_f32 v133, v133, v14
    v_fma_f32 v134, -v10, v70, v134
    v_mul_f32 v134, v134, v14
    v_fma_f32 v135, -v10, v71, v135
    v_mul_f32 v135, v135, v14
    v_fma_f32 v136, -v10, v72, v136
    v_mul_f32 v136, v136, v14
    v_fma_f32 v137, -v10, v73, v137
    v_mul_f32 v137, v137, v14
    v_fma_f32 v138, -v10, v74, v138
    v_mul_f32 v138, v138, v14
    v_fma_f32 v139, -v10, v75, v139
    v_mul_f32 v139, v139, v14
    v_fma_f32 v140, -v10, v76, v140
    v_mul_f32 v140, v140, v14
    v_fma_f32 v141, -v10, v77, v141
    v_mul_f32 v141, v141, v14
    v_fma_f32 v142, -v10, v78, v142
    v_mul_f32 v142, v142, v14
    v_fma_f32 v143, -v10, v79, v143
    v_mul_f32 v143, v143, v14
    v_fma_f32 v144, -v11, v64, v144
    v_mul_f32 v144, v144, v15
    v_fma_f32 v145, -v11, v65, v145
    v_mul_f32 v145, v145, v15
    v_fma_f32 v146, -v11, v66, v146
    v_mul_f32 v146, v146, v15
    v_fma_f32 v147, -v11, v67, v147
    v_mul_f32 v147, v147, v15
    v_fma_f32 v148, -v11, v68, v148
    v_mul_f32 v148, v148, v15
    v_fma_f32 v149, -v11, v69, v149
    v_mul_f32 v149, v149, v15
    v_fma_f32 v150, -v11, v70, v150
    v_mul_f32 v150, v150, v15
    v_fma_f32 v151, -v11, v71, v151
    v_mul_f32 v151, v151, v15
    v_fma_f32 v152, -v11, v72, v152
    v_mul_f32 v152, v152, v15
    v_fma_f32 v153, -v11, v73, v153
    v_mul_f32 v153, v153, v15
    v_fma_f32 v154, -v11, v74, v154
    v_mul_f32 v154, v154, v15
    v_fma_f32 v155, -v11, v75, v155
    v_mul_f32 v155, v155, v15
    v_fma_f32 v156, -v11, v76, v156
    v_mul_f32 v156, v156, v15
    v_fma_f32 v157, -v11, v77, v157
    v_mul_f32 v157, v157, v15
    v_fma_f32 v158, -v11, v78, v158
    v_mul_f32 v158, v158, v15
    v_fma_f32 v159, -v11, v79, v159
    v_mul_f32 v159, v159, v15
    v_mul_u32_u24 v7, 9216, v2
    v_mul_u32_u24 v8, 144, v6
    v_add_u32 v7, v7, v8
    v_lshl_add_u32 v7, v5, 3, v7
    v_cvt_pk_bf16_f32 v32, v96, v97
    v_cvt_pk_bf16_f32 v33, v98, v99
    v_lshlrev_b32 v96, 16, v32
    v_and_b32 v97, 0xffff0000, v32
    v_lshlrev_b32 v98, 16, v33
    v_and_b32 v99, 0xffff0000, v33
    v_mul_f32 v34, v96, v96
    v_fma_f32 v34, v34, s47, v28
    v_mul_f32 v34, v34, v96
    v_exp_f32 v34, v34
    v_mul_f32 v35, v97, v97
    v_fma_f32 v35, v35, s47, v28
    v_mul_f32 v35, v35, v97
    v_exp_f32 v35, v35
    v_mul_f32 v36, v98, v98
    v_fma_f32 v36, v36, s47, v28
    v_mul_f32 v36, v36, v98
    v_exp_f32 v36, v36
    v_mul_f32 v37, v99, v99
    v_fma_f32 v37, v37, s47, v28
    v_mul_f32 v37, v37, v99
    v_exp_f32 v37, v37
    v_add_f32 v34, 1.0, v34
    v_rcp_f32 v34, v34
    v_add_f32 v35, 1.0, v35
    v_rcp_f32 v35, v35
    v_add_f32 v36, 1.0, v36
    v_rcp_f32 v36, v36
    v_add_f32 v37, 1.0, v37
    v_rcp_f32 v37, v37
    s_nop 0
    v_fma_f32 v96, -v96, v34, v96
    v_fma_f32 v97, -v97, v35, v97
    v_fma_f32 v98, -v98, v36, v98
    v_fma_f32 v99, -v99, v37, v99
    v_cvt_pk_bf16_f32 v32, v96, v97
    v_cvt_pk_bf16_f32 v33, v98, v99
    ds_write_b64 v7, v[32:33] offset:0
    v_cvt_pk_bf16_f32 v40, v100, v101
    v_cvt_pk_bf16_f32 v41, v102, v103
    v_lshlrev_b32 v100, 16, v40
    v_and_b32 v101, 0xffff0000, v40
    v_lshlrev_b32 v102, 16, v41
    v_and_b32 v103, 0xffff0000, v41
    v_mul_f32 v42, v100, v100
    v_fma_f32 v42, v42, s47, v28
    v_mul_f32 v42, v42, v100
    v_exp_f32 v42, v42
    v_mul_f32 v43, v101, v101
    v_fma_f32 v43, v43, s47, v28
    v_mul_f32 v43, v43, v101
    v_exp_f32 v43, v43
    v_mul_f32 v44, v102, v102
    v_fma_f32 v44, v44, s47, v28
    v_mul_f32 v44, v44, v102
    v_exp_f32 v44, v44
    v_mul_f32 v45, v103, v103
    v_fma_f32 v45, v45, s47, v28
    v_mul_f32 v45, v45, v103
    v_exp_f32 v45, v45
    v_add_f32 v42, 1.0, v42
    v_rcp_f32 v42, v42
    v_add_f32 v43, 1.0, v43
    v_rcp_f32 v43, v43
    v_add_f32 v44, 1.0, v44
    v_rcp_f32 v44, v44
    v_add_f32 v45, 1.0, v45
    v_rcp_f32 v45, v45
    s_nop 0
    v_fma_f32 v100, -v100, v42, v100
    v_fma_f32 v101, -v101, v43, v101
    v_fma_f32 v102, -v102, v44, v102
    v_fma_f32 v103, -v103, v45, v103
    v_cvt_pk_bf16_f32 v40, v100, v101
    v_cvt_pk_bf16_f32 v41, v102, v103
    ds_write_b64 v7, v[40:41] offset:32
    v_cvt_pk_bf16_f32 v48, v104, v105
    v_cvt_pk_bf16_f32 v49, v106, v107
    v_lshlrev_b32 v104, 16, v48
    v_and_b32 v105, 0xffff0000, v48
    v_lshlrev_b32 v106, 16, v49
    v_and_b32 v107, 0xffff0000, v49
    v_mul_f32 v50, v104, v104
    v_fma_f32 v50, v50, s47, v28
    v_mul_f32 v50, v50, v104
    v_exp_f32 v50, v50
    v_mul_f32 v51, v105, v105
    v_fma_f32 v51, v51, s47, v28
    v_mul_f32 v51, v51, v105
    v_exp_f32 v51, v51
    v_mul_f32 v52, v106, v106
    v_fma_f32 v52, v52, s47, v28
    v_mul_f32 v52, v52, v106
    v_exp_f32 v52, v52
    v_mul_f32 v53, v107, v107
    v_fma_f32 v53, v53, s47, v28
    v_mul_f32 v53, v53, v107
    v_exp_f32 v53, v53
    v_add_f32 v50, 1.0, v50
    v_rcp_f32 v50, v50
    v_add_f32 v51, 1.0, v51
    v_rcp_f32 v51, v51
    v_add_f32 v52, 1.0, v52
    v_rcp_f32 v52, v52
    v_add_f32 v53, 1.0, v53
    v_rcp_f32 v53, v53
    s_nop 0
    v_fma_f32 v104, -v104, v50, v104
    v_fma_f32 v105, -v105, v51, v105
    v_fma_f32 v106, -v106, v52, v106
    v_fma_f32 v107, -v107, v53, v107
    v_cvt_pk_bf16_f32 v48, v104, v105
    v_cvt_pk_bf16_f32 v49, v106, v107
    ds_write_b64 v7, v[48:49] offset:64
    v_cvt_pk_bf16_f32 v56, v108, v109
    v_cvt_pk_bf16_f32 v57, v110, v111
    v_lshlrev_b32 v108, 16, v56
    v_and_b32 v109, 0xffff0000, v56
    v_lshlrev_b32 v110, 16, v57
    v_and_b32 v111, 0xffff0000, v57
    v_mul_f32 v58, v108, v108
    v_fma_f32 v58, v58, s47, v28
    v_mul_f32 v58, v58, v108
    v_exp_f32 v58, v58
    v_mul_f32 v59, v109, v109
    v_fma_f32 v59, v59, s47, v28
    v_mul_f32 v59, v59, v109
    v_exp_f32 v59, v59
    v_mul_f32 v60, v110, v110
    v_fma_f32 v60, v60, s47, v28
    v_mul_f32 v60, v60, v110
    v_exp_f32 v60, v60
    v_mul_f32 v61, v111, v111
    v_fma_f32 v61, v61, s47, v28
    v_mul_f32 v61, v61, v111
    v_exp_f32 v61, v61
    v_add_f32 v58, 1.0, v58
    v_rcp_f32 v58, v58
    v_add_f32 v59, 1.0, v59
    v_rcp_f32 v59, v59
    v_add_f32 v60, 1.0, v60
    v_rcp_f32 v60, v60
    v_add_f32 v61, 1.0, v61
    v_rcp_f32 v61, v61
    s_nop 0
    v_fma_f32 v108, -v108, v58, v108
    v_fma_f32 v109, -v109, v59, v109
    v_fma_f32 v110, -v110, v60, v110
    v_fma_f32 v111, -v111, v61, v111
    v_cvt_pk_bf16_f32 v56, v108, v109
    v_cvt_pk_bf16_f32 v57, v110, v111
    ds_write_b64 v7, v[56:57] offset:96
    v_cvt_pk_bf16_f32 v32, v112, v113
    v_cvt_pk_bf16_f32 v33, v114, v115
    v_lshlrev_b32 v112, 16, v32
    v_and_b32 v113, 0xffff0000, v32
    v_lshlrev_b32 v114, 16, v33
    v_and_b32 v115, 0xffff0000, v33
    v_mul_f32 v34, v112, v112
    v_fma_f32 v34, v34, s47, v28
    v_mul_f32 v34, v34, v112
    v_exp_f32 v34, v34
    v_mul_f32 v35, v113, v113
    v_fma_f32 v35, v35, s47, v28
    v_mul_f32 v35, v35, v113
    v_exp_f32 v35, v35
    v_mul_f32 v36, v114, v114
    v_fma_f32 v36, v36, s47, v28
    v_mul_f32 v36, v36, v114
    v_exp_f32 v36, v36
    v_mul_f32 v37, v115, v115
    v_fma_f32 v37, v37, s47, v28
    v_mul_f32 v37, v37, v115
    v_exp_f32 v37, v37
    v_add_f32 v34, 1.0, v34
    v_rcp_f32 v34, v34
    v_add_f32 v35, 1.0, v35
    v_rcp_f32 v35, v35
    v_add_f32 v36, 1.0, v36
    v_rcp_f32 v36, v36
    v_add_f32 v37, 1.0, v37
    v_rcp_f32 v37, v37
    s_nop 0
    v_fma_f32 v112, -v112, v34, v112
    v_fma_f32 v113, -v113, v35, v113
    v_fma_f32 v114, -v114, v36, v114
    v_fma_f32 v115, -v115, v37, v115
    v_cvt_pk_bf16_f32 v32, v112, v113
    v_cvt_pk_bf16_f32 v33, v114, v115
    ds_write_b64 v7, v[32:33] offset:2304
    v_cvt_pk_bf16_f32 v40, v116, v117
    v_cvt_pk_bf16_f32 v41, v118, v119
    v_lshlrev_b32 v116, 16, v40
    v_and_b32 v117, 0xffff0000, v40
    v_lshlrev_b32 v118, 16, v41
    v_and_b32 v119, 0xffff0000, v41
    v_mul_f32 v42, v116, v116
    v_fma_f32 v42, v42, s47, v28
    v_mul_f32 v42, v42, v116
    v_exp_f32 v42, v42
    v_mul_f32 v43, v117, v117
    v_fma_f32 v43, v43, s47, v28
    v_mul_f32 v43, v43, v117
    v_exp_f32 v43, v43
    v_mul_f32 v44, v118, v118
    v_fma_f32 v44, v44, s47, v28
    v_mul_f32 v44, v44, v118
    v_exp_f32 v44, v44
    v_mul_f32 v45, v119, v119
    v_fma_f32 v45, v45, s47, v28
    v_mul_f32 v45, v45, v119
    v_exp_f32 v45, v45
    v_add_f32 v42, 1.0, v42
    v_rcp_f32 v42, v42
    v_add_f32 v43, 1.0, v43
    v_rcp_f32 v43, v43
    v_add_f32 v44, 1.0, v44
    v_rcp_f32 v44, v44
    v_add_f32 v45, 1.0, v45
    v_rcp_f32 v45, v45
    s_nop 0
    v_fma_f32 v116, -v116, v42, v116
    v_fma_f32 v117, -v117, v43, v117
    v_fma_f32 v118, -v118, v44, v118
    v_fma_f32 v119, -v119, v45, v119
    v_cvt_pk_bf16_f32 v40, v116, v117
    v_cvt_pk_bf16_f32 v41, v118, v119
    ds_write_b64 v7, v[40:41] offset:2336
    v_cvt_pk_bf16_f32 v48, v120, v121
    v_cvt_pk_bf16_f32 v49, v122, v123
    v_lshlrev_b32 v120, 16, v48
    v_and_b32 v121, 0xffff0000, v48
    v_lshlrev_b32 v122, 16, v49
    v_and_b32 v123, 0xffff0000, v49
    v_mul_f32 v50, v120, v120
    v_fma_f32 v50, v50, s47, v28
    v_mul_f32 v50, v50, v120
    v_exp_f32 v50, v50
    v_mul_f32 v51, v121, v121
    v_fma_f32 v51, v51, s47, v28
    v_mul_f32 v51, v51, v121
    v_exp_f32 v51, v51
    v_mul_f32 v52, v122, v122
    v_fma_f32 v52, v52, s47, v28
    v_mul_f32 v52, v52, v122
    v_exp_f32 v52, v52
    v_mul_f32 v53, v123, v123
    v_fma_f32 v53, v53, s47, v28
    v_mul_f32 v53, v53, v123
    v_exp_f32 v53, v53
    v_add_f32 v50, 1.0, v50
    v_rcp_f32 v50, v50
    v_add_f32 v51, 1.0, v51
    v_rcp_f32 v51, v51
    v_add_f32 v52, 1.0, v52
    v_rcp_f32 v52, v52
    v_add_f32 v53, 1.0, v53
    v_rcp_f32 v53, v53
    s_nop 0
    v_fma_f32 v120, -v120, v50, v120
    v_fma_f32 v121, -v121, v51, v121
    v_fma_f32 v122, -v122, v52, v122
    v_fma_f32 v123, -v123, v53, v123
    v_cvt_pk_bf16_f32 v48, v120, v121
    v_cvt_pk_bf16_f32 v49, v122, v123
    ds_write_b64 v7, v[48:49] offset:2368
    v_cvt_pk_bf16_f32 v56, v124, v125
    v_cvt_pk_bf16_f32 v57, v126, v127
    v_lshlrev_b32 v124, 16, v56
    v_and_b32 v125, 0xffff0000, v56
    v_lshlrev_b32 v126, 16, v57
    v_and_b32 v127, 0xffff0000, v57
    v_mul_f32 v58, v124, v124
    v_fma_f32 v58, v58, s47, v28
    v_mul_f32 v58, v58, v124
    v_exp_f32 v58, v58
    v_mul_f32 v59, v125, v125
    v_fma_f32 v59, v59, s47, v28
    v_mul_f32 v59, v59, v125
    v_exp_f32 v59, v59
    v_mul_f32 v60, v126, v126
    v_fma_f32 v60, v60, s47, v28
    v_mul_f32 v60, v60, v126
    v_exp_f32 v60, v60
    v_mul_f32 v61, v127, v127
    v_fma_f32 v61, v61, s47, v28
    v_mul_f32 v61, v61, v127
    v_exp_f32 v61, v61
    v_add_f32 v58, 1.0, v58
    v_rcp_f32 v58, v58
    v_add_f32 v59, 1.0, v59
    v_rcp_f32 v59, v59
    v_add_f32 v60, 1.0, v60
    v_rcp_f32 v60, v60
    v_add_f32 v61, 1.0, v61
    v_rcp_f32 v61, v61
    s_nop 0
    v_fma_f32 v124, -v124, v58, v124
    v_fma_f32 v125, -v125, v59, v125
    v_fma_f32 v126, -v126, v60, v126
    v_fma_f32 v127, -v127, v61, v127
    v_cvt_pk_bf16_f32 v56, v124, v125
    v_cvt_pk_bf16_f32 v57, v126, v127
    ds_write_b64 v7, v[56:57] offset:2400
    v_cvt_pk_bf16_f32 v32, v128, v129
    v_cvt_pk_bf16_f32 v33, v130, v131
    v_lshlrev_b32 v128, 16, v32
    v_and_b32 v129, 0xffff0000, v32
    v_lshlrev_b32 v130, 16, v33
    v_and_b32 v131, 0xffff0000, v33
    v_mul_f32 v34, v128, v128
    v_fma_f32 v34, v34, s47, v28
    v_mul_f32 v34, v34, v128
    v_exp_f32 v34, v34
    v_mul_f32 v35, v129, v129
    v_fma_f32 v35, v35, s47, v28
    v_mul_f32 v35, v35, v129
    v_exp_f32 v35, v35
    v_mul_f32 v36, v130, v130
    v_fma_f32 v36, v36, s47, v28
    v_mul_f32 v36, v36, v130
    v_exp_f32 v36, v36
    v_mul_f32 v37, v131, v131
    v_fma_f32 v37, v37, s47, v28
    v_mul_f32 v37, v37, v131
    v_exp_f32 v37, v37
    v_add_f32 v34, 1.0, v34
    v_rcp_f32 v34, v34
    v_add_f32 v35, 1.0, v35
    v_rcp_f32 v35, v35
    v_add_f32 v36, 1.0, v36
    v_rcp_f32 v36, v36
    v_add_f32 v37, 1.0, v37
    v_rcp_f32 v37, v37
    s_nop 0
    v_fma_f32 v128, -v128, v34, v128
    v_fma_f32 v129, -v129, v35, v129
    v_fma_f32 v130, -v130, v36, v130
    v_fma_f32 v131, -v131, v37, v131
    v_cvt_pk_bf16_f32 v32, v128, v129
    v_cvt_pk_bf16_f32 v33, v130, v131
    ds_write_b64 v7, v[32:33] offset:4608
    v_cvt_pk_bf16_f32 v40, v132, v133
    v_cvt_pk_bf16_f32 v41, v134, v135
    v_lshlrev_b32 v132, 16, v40
    v_and_b32 v133, 0xffff0000, v40
    v_lshlrev_b32 v134, 16, v41
    v_and_b32 v135, 0xffff0000, v41
    v_mul_f32 v42, v132, v132
    v_fma_f32 v42, v42, s47, v28
    v_mul_f32 v42, v42, v132
    v_exp_f32 v42, v42
    v_mul_f32 v43, v133, v133
    v_fma_f32 v43, v43, s47, v28
    v_mul_f32 v43, v43, v133
    v_exp_f32 v43, v43
    v_mul_f32 v44, v134, v134
    v_fma_f32 v44, v44, s47, v28
    v_mul_f32 v44, v44, v134
    v_exp_f32 v44, v44
    v_mul_f32 v45, v135, v135
    v_fma_f32 v45, v45, s47, v28
    v_mul_f32 v45, v45, v135
    v_exp_f32 v45, v45
    v_add_f32 v42, 1.0, v42
    v_rcp_f32 v42, v42
    v_add_f32 v43, 1.0, v43
    v_rcp_f32 v43, v43
    v_add_f32 v44, 1.0, v44
    v_rcp_f32 v44, v44
    v_add_f32 v45, 1.0, v45
    v_rcp_f32 v45, v45
    s_nop 0
    v_fma_f32 v132, -v132, v42, v132
    v_fma_f32 v133, -v133, v43, v133
    v_fma_f32 v134, -v134, v44, v134
    v_fma_f32 v135, -v135, v45, v135
    v_cvt_pk_bf16_f32 v40, v132, v133
    v_cvt_pk_bf16_f32 v41, v134, v135
    ds_write_b64 v7, v[40:41] offset:4640
    v_cvt_pk_bf16_f32 v48, v136, v137
    v_cvt_pk_bf16_f32 v49, v138, v139
    v_lshlrev_b32 v136, 16, v48
    v_and_b32 v137, 0xffff0000, v48
    v_lshlrev_b32 v138, 16, v49
    v_and_b32 v139, 0xffff0000, v49
    v_mul_f32 v50, v136, v136
    v_fma_f32 v50, v50, s47, v28
    v_mul_f32 v50, v50, v136
    v_exp_f32 v50, v50
    v_mul_f32 v51, v137, v137
    v_fma_f32 v51, v51, s47, v28
    v_mul_f32 v51, v51, v137
    v_exp_f32 v51, v51
    v_mul_f32 v52, v138, v138
    v_fma_f32 v52, v52, s47, v28
    v_mul_f32 v52, v52, v138
    v_exp_f32 v52, v52
    v_mul_f32 v53, v139, v139
    v_fma_f32 v53, v53, s47, v28
    v_mul_f32 v53, v53, v139
    v_exp_f32 v53, v53
    v_add_f32 v50, 1.0, v50
    v_rcp_f32 v50, v50
    v_add_f32 v51, 1.0, v51
    v_rcp_f32 v51, v51
    v_add_f32 v52, 1.0, v52
    v_rcp_f32 v52, v52
    v_add_f32 v53, 1.0, v53
    v_rcp_f32 v53, v53
    s_nop 0
    v_fma_f32 v136, -v136, v50, v136
    v_fma_f32 v137, -v137, v51, v137
    v_fma_f32 v138, -v138, v52, v138
    v_fma_f32 v139, -v139, v53, v139
    v_cvt_pk_bf16_f32 v48, v136, v137
    v_cvt_pk_bf16_f32 v49, v138, v139
    ds_write_b64 v7, v[48:49] offset:4672
    v_cvt_pk_bf16_f32 v56, v140, v141
    v_cvt_pk_bf16_f32 v57, v142, v143
    v_lshlrev_b32 v140, 16, v56
    v_and_b32 v141, 0xffff0000, v56
    v_lshlrev_b32 v142, 16, v57
    v_and_b32 v143, 0xffff0000, v57
    v_mul_f32 v58, v140, v140
    v_fma_f32 v58, v58, s47, v28
    v_mul_f32 v58, v58, v140
    v_exp_f32 v58, v58
    v_mul_f32 v59, v141, v141
    v_fma_f32 v59, v59, s47, v28
    v_mul_f32 v59, v59, v141
    v_exp_f32 v59, v59
    v_mul_f32 v60, v142, v142
    v_fma_f32 v60, v60, s47, v28
    v_mul_f32 v60, v60, v142
    v_exp_f32 v60, v60
    v_mul_f32 v61, v143, v143
    v_fma_f32 v61, v61, s47, v28
    v_mul_f32 v61, v61, v143
    v_exp_f32 v61, v61
    v_add_f32 v58, 1.0, v58
    v_rcp_f32 v58, v58
    v_add_f32 v59, 1.0, v59
    v_rcp_f32 v59, v59
    v_add_f32 v60, 1.0, v60
    v_rcp_f32 v60, v60
    v_add_f32 v61, 1.0, v61
    v_rcp_f32 v61, v61
    s_nop 0
    v_fma_f32 v140, -v140, v58, v140
    v_fma_f32 v141, -v141, v59, v141
    v_fma_f32 v142, -v142, v60, v142
    v_fma_f32 v143, -v143, v61, v143
    v_cvt_pk_bf16_f32 v56, v140, v141
    v_cvt_pk_bf16_f32 v57, v142, v143
    ds_write_b64 v7, v[56:57] offset:4704
    v_cvt_pk_bf16_f32 v32, v144, v145
    v_cvt_pk_bf16_f32 v33, v146, v147
    v_lshlrev_b32 v144, 16, v32
    v_and_b32 v145, 0xffff0000, v32
    v_lshlrev_b32 v146, 16, v33
    v_and_b32 v147, 0xffff0000, v33
    v_mul_f32 v34, v144, v144
    v_fma_f32 v34, v34, s47, v28
    v_mul_f32 v34, v34, v144
    v_exp_f32 v34, v34
    v_mul_f32 v35, v145, v145
    v_fma_f32 v35, v35, s47, v28
    v_mul_f32 v35, v35, v145
    v_exp_f32 v35, v35
    v_mul_f32 v36, v146, v146
    v_fma_f32 v36, v36, s47, v28
    v_mul_f32 v36, v36, v146
    v_exp_f32 v36, v36
    v_mul_f32 v37, v147, v147
    v_fma_f32 v37, v37, s47, v28
    v_mul_f32 v37, v37, v147
    v_exp_f32 v37, v37
    v_add_f32 v34, 1.0, v34
    v_rcp_f32 v34, v34
    v_add_f32 v35, 1.0, v35
    v_rcp_f32 v35, v35
    v_add_f32 v36, 1.0, v36
    v_rcp_f32 v36, v36
    v_add_f32 v37, 1.0, v37
    v_rcp_f32 v37, v37
    s_nop 0
    v_fma_f32 v144, -v144, v34, v144
    v_fma_f32 v145, -v145, v35, v145
    v_fma_f32 v146, -v146, v36, v146
    v_fma_f32 v147, -v147, v37, v147
    v_cvt_pk_bf16_f32 v32, v144, v145
    v_cvt_pk_bf16_f32 v33, v146, v147
    ds_write_b64 v7, v[32:33] offset:6912
    v_cvt_pk_bf16_f32 v40, v148, v149
    v_cvt_pk_bf16_f32 v41, v150, v151
    v_lshlrev_b32 v148, 16, v40
    v_and_b32 v149, 0xffff0000, v40
    v_lshlrev_b32 v150, 16, v41
    v_and_b32 v151, 0xffff0000, v41
    v_mul_f32 v42, v148, v148
    v_fma_f32 v42, v42, s47, v28
    v_mul_f32 v42, v42, v148
    v_exp_f32 v42, v42
    v_mul_f32 v43, v149, v149
    v_fma_f32 v43, v43, s47, v28
    v_mul_f32 v43, v43, v149
    v_exp_f32 v43, v43
    v_mul_f32 v44, v150, v150
    v_fma_f32 v44, v44, s47, v28
    v_mul_f32 v44, v44, v150
    v_exp_f32 v44, v44
    v_mul_f32 v45, v151, v151
    v_fma_f32 v45, v45, s47, v28
    v_mul_f32 v45, v45, v151
    v_exp_f32 v45, v45
    v_add_f32 v42, 1.0, v42
    v_rcp_f32 v42, v42
    v_add_f32 v43, 1.0, v43
    v_rcp_f32 v43, v43
    v_add_f32 v44, 1.0, v44
    v_rcp_f32 v44, v44
    v_add_f32 v45, 1.0, v45
    v_rcp_f32 v45, v45
    s_nop 0
    v_fma_f32 v148, -v148, v42, v148
    v_fma_f32 v149, -v149, v43, v149
    v_fma_f32 v150, -v150, v44, v150
    v_fma_f32 v151, -v151, v45, v151
    v_cvt_pk_bf16_f32 v40, v148, v149
    v_cvt_pk_bf16_f32 v41, v150, v151
    ds_write_b64 v7, v[40:41] offset:6944
    v_cvt_pk_bf16_f32 v48, v152, v153
    v_cvt_pk_bf16_f32 v49, v154, v155
    v_lshlrev_b32 v152, 16, v48
    v_and_b32 v153, 0xffff0000, v48
    v_lshlrev_b32 v154, 16, v49
    v_and_b32 v155, 0xffff0000, v49
    v_mul_f32 v50, v152, v152
    v_fma_f32 v50, v50, s47, v28
    v_mul_f32 v50, v50, v152
    v_exp_f32 v50, v50
    v_mul_f32 v51, v153, v153
    v_fma_f32 v51, v51, s47, v28
    v_mul_f32 v51, v51, v153
    v_exp_f32 v51, v51
    v_mul_f32 v52, v154, v154
    v_fma_f32 v52, v52, s47, v28
    v_mul_f32 v52, v52, v154
    v_exp_f32 v52, v52
    v_mul_f32 v53, v155, v155
    v_fma_f32 v53, v53, s47, v28
    v_mul_f32 v53, v53, v155
    v_exp_f32 v53, v53
    v_add_f32 v50, 1.0, v50
    v_rcp_f32 v50, v50
    v_add_f32 v51, 1.0, v51
    v_rcp_f32 v51, v51
    v_add_f32 v52, 1.0, v52
    v_rcp_f32 v52, v52
    v_add_f32 v53, 1.0, v53
    v_rcp_f32 v53, v53
    s_nop 0
    v_fma_f32 v152, -v152, v50, v152
    v_fma_f32 v153, -v153, v51, v153
    v_fma_f32 v154, -v154, v52, v154
    v_fma_f32 v155, -v155, v53, v155
    v_cvt_pk_bf16_f32 v48, v152, v153
    v_cvt_pk_bf16_f32 v49, v154, v155
    ds_write_b64 v7, v[48:49] offset:6976
    v_cvt_pk_bf16_f32 v56, v156, v157
    v_cvt_pk_bf16_f32 v57, v158, v159
    v_lshlrev_b32 v156, 16, v56
    v_and_b32 v157, 0xffff0000, v56
    v_lshlrev_b32 v158, 16, v57
    v_and_b32 v159, 0xffff0000, v57
    v_mul_f32 v58, v156, v156
    v_fma_f32 v58, v58, s47, v28
    v_mul_f32 v58, v58, v156
    v_exp_f32 v58, v58
    v_mul_f32 v59, v157, v157
    v_fma_f32 v59, v59, s47, v28
    v_mul_f32 v59, v59, v157
    v_exp_f32 v59, v59
    v_mul_f32 v60, v158, v158
    v_fma_f32 v60, v60, s47, v28
    v_mul_f32 v60, v60, v158
    v_exp_f32 v60, v60
    v_mul_f32 v61, v159, v159
    v_fma_f32 v61, v61, s47, v28
    v_mul_f32 v61, v61, v159
    v_exp_f32 v61, v61
    v_add_f32 v58, 1.0, v58
    v_rcp_f32 v58, v58
    v_add_f32 v59, 1.0, v59
    v_rcp_f32 v59, v59
    v_add_f32 v60, 1.0, v60
    v_rcp_f32 v60, v60
    v_add_f32 v61, 1.0, v61
    v_rcp_f32 v61, v61
    s_nop 0
    v_fma_f32 v156, -v156, v58, v156
    v_fma_f32 v157, -v157, v59, v157
    v_fma_f32 v158, -v158, v60, v158
    v_fma_f32 v159, -v159, v61, v159
    v_cvt_pk_bf16_f32 v56, v156, v157
    v_cvt_pk_bf16_f32 v57, v158, v159
    ds_write_b64 v7, v[56:57] offset:7008
    s_waitcnt lgkmcnt(0)
    v_lshrrev_b32 v8, 3, v1
    v_and_b32 v9, 7, v1
    v_mul_u32_u24 v7, 9216, v2
    v_mul_u32_u24 v10, 144, v8
    v_add_u32 v7, v7, v10
    v_lshl_add_u32 v7, v9, 4, v7
    v_mul_u32_u24 v10, 64, v3
    v_add_u32 v10, v10, v8
    v_add_u32 v10, s27, v10
    v_lshlrev_b32 v11, 6, v4
    v_lshl_add_u32 v11, v9, 3, v11
    v_add_u32 v11, s28, v11
    v_mul_u32_u24 v12, 3072, v10
    v_lshl_add_u32 v12, v11, 1, v12
    ds_read_b128 v[96:99], v7 offset:0
    ds_read_b128 v[100:103], v7 offset:1152
    ds_read_b128 v[104:107], v7 offset:2304
    ds_read_b128 v[108:111], v7 offset:3456
    ds_read_b128 v[112:115], v7 offset:4608
    ds_read_b128 v[116:119], v7 offset:5760
    ds_read_b128 v[120:123], v7 offset:6912
    ds_read_b128 v[124:127], v7 offset:8064
    s_waitcnt lgkmcnt(0)
    buffer_store_dwordx4 v[96:99], v12, s[16:19], 0 offen
    v_add_u32 v12, 24576, v12
    buffer_store_dwordx4 v[100:103], v12, s[16:19], 0 offen
    v_add_u32 v12, 24576, v12
    buffer_store_dwordx4 v[104:107], v12, s[16:19], 0 offen
    v_add_u32 v12, 24576, v12
    buffer_store_dwordx4 v[108:111], v12, s[16:19], 0 offen
    v_add_u32 v12, 24576, v12
    buffer_store_dwordx4 v[112:115], v12, s[16:19], 0 offen
    v_add_u32 v12, 24576, v12
    buffer_store_dwordx4 v[116:119], v12, s[16:19], 0 offen
    v_add_u32 v12, 24576, v12
    buffer_store_dwordx4 v[120:123], v12, s[16:19], 0 offen
    v_add_u32 v12, 24576, v12
    buffer_store_dwordx4 v[124:127], v12, s[16:19], 0 offen
Lend_win0_kernel_1:
    s_endpgm
Lloader_win0_kernel_2:
    v_subrev_u32 v0, 256, v0
    v_and_b32 v1, 63, v0
    s_sub_u32 s42, s41, 4
    v_lshrrev_b32 v3, 3, v1
    v_and_b32 v4, 7, v1
    v_xor_b32 v4, v4, v3
    s_mul_i32 s43, s42, 32
    s_add_u32 s43, s43, s27
    v_add_u32 v5, s43, v3
    v_mul_u32_u24 v5, 1280, v5
    v_lshl_add_u32 v8, v4, 4, v5
    v_add_u32 v9, 10240, v8
    v_add_u32 v10, 20480, v8
    v_add_u32 v11, 30720, v8
    v_lshrrev_b32 v3, 4, v1
    v_and_b32 v4, 15, v1
    v_lshrrev_b32 v5, 1, v4
    v_and_b32 v6, 1, v4
    s_mul_i32 s43, s42, 4
    s_add_u32 s44, s43, 0
    s_lshr_b32 s44, s44, 1
    s_and_b32 s44, s44, 1
    s_lshl_b32 s44, s44, 2
    v_add_u32 v7, s44, v3
    v_xor_b32 v7, v5, v7
    v_lshl_add_u32 v7, v7, 1, v6
    v_lshlrev_b32 v7, 4, v7
    s_add_u32 s44, s43, 0
    s_lshl_b32 s44, s44, 2
    v_add_u32 v12, s44, v3
    v_mul_u32_u24 v12, 3072, v12
    v_add_u32 v12, v12, v7
    v_lshl_add_u32 v12, s28, 1, v12
    s_add_u32 s44, s43, 1
    s_lshr_b32 s44, s44, 1
    s_and_b32 s44, s44, 1
    s_lshl_b32 s44, s44, 2
    v_add_u32 v7, s44, v3
    v_xor_b32 v7, v5, v7
    v_lshl_add_u32 v7, v7, 1, v6
    v_lshlrev_b32 v7, 4, v7
    s_add_u32 s44, s43, 1
    s_lshl_b32 s44, s44, 2
    v_add_u32 v13, s44, v3
    v_mul_u32_u24 v13, 3072, v13
    v_add_u32 v13, v13, v7
    v_lshl_add_u32 v13, s28, 1, v13
    s_add_u32 s44, s43, 2
    s_lshr_b32 s44, s44, 1
    s_and_b32 s44, s44, 1
    s_lshl_b32 s44, s44, 2
    v_add_u32 v7, s44, v3
    v_xor_b32 v7, v5, v7
    v_lshl_add_u32 v7, v7, 1, v6
    v_lshlrev_b32 v7, 4, v7
    s_add_u32 s44, s43, 2
    s_lshl_b32 s44, s44, 2
    v_add_u32 v14, s44, v3
    v_mul_u32_u24 v14, 3072, v14
    v_add_u32 v14, v14, v7
    v_lshl_add_u32 v14, s28, 1, v14
    s_add_u32 s44, s43, 3
    s_lshr_b32 s44, s44, 1
    s_and_b32 s44, s44, 1
    s_lshl_b32 s44, s44, 2
    v_add_u32 v7, s44, v3
    v_xor_b32 v7, v5, v7
    v_lshl_add_u32 v7, v7, 1, v6
    v_lshlrev_b32 v7, 4, v7
    s_add_u32 s44, s43, 3
    s_lshl_b32 s44, s44, 2
    v_add_u32 v15, s44, v3
    v_mul_u32_u24 v15, 3072, v15
    v_add_u32 v15, v15, v7
    v_lshl_add_u32 v15, s28, 1, v15
    s_mul_i32 s45, s42, 4096
    s_mul_i32 s46, s42, 4096
    s_add_u32 s46, s46, 16384
    s_mov_b32 s29, 0
    s_mov_b32 s30, 0
    s_add_u32 m0, s45, 0
    s_nop 0
    buffer_load_dwordx4 v8, s[8:11], s29 offen lds
    s_add_u32 m0, s45, 1024
    s_nop 0
    buffer_load_dwordx4 v9, s[8:11], s29 offen lds
    s_add_u32 m0, s45, 2048
    s_nop 0
    buffer_load_dwordx4 v10, s[8:11], s29 offen lds
    s_add_u32 m0, s45, 3072
    s_nop 0
    buffer_load_dwordx4 v11, s[8:11], s29 offen lds
    s_add_u32 m0, s46, 0
    s_nop 0
    buffer_load_dwordx4 v12, s[12:15], s30 offen lds
    s_add_u32 m0, s46, 1024
    s_nop 0
    buffer_load_dwordx4 v13, s[12:15], s30 offen lds
    s_add_u32 m0, s46, 2048
    s_nop 0
    buffer_load_dwordx4 v14, s[12:15], s30 offen lds
    s_add_u32 m0, s46, 3072
    s_nop 0
    buffer_load_dwordx4 v15, s[12:15], s30 offen lds
    s_add_u32 s29, s29, 128
    s_add_u32 s30, s30, 196608
    s_add_u32 m0, s45, 32768
    s_nop 0
    buffer_load_dwordx4 v8, s[8:11], s29 offen lds
    s_add_u32 m0, s45, 33792
    s_nop 0
    buffer_load_dwordx4 v9, s[8:11], s29 offen lds
    s_add_u32 m0, s45, 34816
    s_nop 0
    buffer_load_dwordx4 v10, s[8:11], s29 offen lds
    s_add_u32 m0, s45, 35840
    s_nop 0
    buffer_load_dwordx4 v11, s[8:11], s29 offen lds
    s_add_u32 m0, s46, 32768
    s_nop 0
    buffer_load_dwordx4 v12, s[12:15], s30 offen lds
    s_add_u32 m0, s46, 33792
    s_nop 0
    buffer_load_dwordx4 v13, s[12:15], s30 offen lds
    s_add_u32 m0, s46, 34816
    s_nop 0
    buffer_load_dwordx4 v14, s[12:15], s30 offen lds
    s_add_u32 m0, s46, 35840
    s_nop 0
    buffer_load_dwordx4 v15, s[12:15], s30 offen lds
    s_add_u32 s29, s29, 128
    s_add_u32 s30, s30, 196608
    s_add_u32 m0, s45, 65536
    s_nop 0
    buffer_load_dwordx4 v8, s[8:11], s29 offen lds
    s_add_u32 m0, s45, 66560
    s_nop 0
    buffer_load_dwordx4 v9, s[8:11], s29 offen lds
    s_add_u32 m0, s45, 67584
    s_nop 0
    buffer_load_dwordx4 v10, s[8:11], s29 offen lds
    s_add_u32 m0, s45, 68608
    s_nop 0
    buffer_load_dwordx4 v11, s[8:11], s29 offen lds
    s_add_u32 m0, s46, 65536
    s_nop 0
    buffer_load_dwordx4 v12, s[12:15], s30 offen lds
    s_add_u32 m0, s46, 66560
    s_nop 0
    buffer_load_dwordx4 v13, s[12:15], s30 offen lds
    s_add_u32 m0, s46, 67584
    s_nop 0
    buffer_load_dwordx4 v14, s[12:15], s30 offen lds
    s_add_u32 m0, s46, 68608
    s_nop 0
    buffer_load_dwordx4 v15, s[12:15], s30 offen lds
    s_add_u32 s29, s29, 128
    s_add_u32 s30, s30, 196608
    s_waitcnt vmcnt(8)
    s_barrier
    s_mov_b32 s31, 0
Llloop_win0_kernel_4:
    s_add_u32 m0, s45, 98304
    s_nop 0
    buffer_load_dwordx4 v8, s[8:11], s29 offen lds
    s_add_u32 m0, s45, 99328
    s_nop 0
    buffer_load_dwordx4 v9, s[8:11], s29 offen lds
    s_add_u32 m0, s45, 100352
    s_nop 0
    buffer_load_dwordx4 v10, s[8:11], s29 offen lds
    s_add_u32 m0, s45, 101376
    s_nop 0
    buffer_load_dwordx4 v11, s[8:11], s29 offen lds
    s_add_u32 m0, s46, 98304
    s_nop 0
    buffer_load_dwordx4 v12, s[12:15], s30 offen lds
    s_add_u32 m0, s46, 99328
    s_nop 0
    buffer_load_dwordx4 v13, s[12:15], s30 offen lds
    s_add_u32 m0, s46, 100352
    s_nop 0
    buffer_load_dwordx4 v14, s[12:15], s30 offen lds
    s_add_u32 m0, s46, 101376
    s_nop 0
    buffer_load_dwordx4 v15, s[12:15], s30 offen lds
    s_add_u32 s29, s29, 128
    s_add_u32 s30, s30, 196608
    s_waitcnt vmcnt(8)
    s_barrier
    s_add_u32 m0, s45, 0
    s_nop 0
    buffer_load_dwordx4 v8, s[8:11], s29 offen lds
    s_add_u32 m0, s45, 1024
    s_nop 0
    buffer_load_dwordx4 v9, s[8:11], s29 offen lds
    s_add_u32 m0, s45, 2048
    s_nop 0
    buffer_load_dwordx4 v10, s[8:11], s29 offen lds
    s_add_u32 m0, s45, 3072
    s_nop 0
    buffer_load_dwordx4 v11, s[8:11], s29 offen lds
    s_add_u32 m0, s46, 0
    s_nop 0
    buffer_load_dwordx4 v12, s[12:15], s30 offen lds
    s_add_u32 m0, s46, 1024
    s_nop 0
    buffer_load_dwordx4 v13, s[12:15], s30 offen lds
    s_add_u32 m0, s46, 2048
    s_nop 0
    buffer_load_dwordx4 v14, s[12:15], s30 offen lds
    s_add_u32 m0, s46, 3072
    s_nop 0
    buffer_load_dwordx4 v15, s[12:15], s30 offen lds
    s_add_u32 s29, s29, 128
    s_add_u32 s30, s30, 196608
    s_waitcnt vmcnt(8)
    s_barrier
    s_add_u32 m0, s45, 32768
    s_nop 0
    buffer_load_dwordx4 v8, s[8:11], s29 offen lds
    s_add_u32 m0, s45, 33792
    s_nop 0
    buffer_load_dwordx4 v9, s[8:11], s29 offen lds
    s_add_u32 m0, s45, 34816
    s_nop 0
    buffer_load_dwordx4 v10, s[8:11], s29 offen lds
    s_add_u32 m0, s45, 35840
    s_nop 0
    buffer_load_dwordx4 v11, s[8:11], s29 offen lds
    s_add_u32 m0, s46, 32768
    s_nop 0
    buffer_load_dwordx4 v12, s[12:15], s30 offen lds
    s_add_u32 m0, s46, 33792
    s_nop 0
    buffer_load_dwordx4 v13, s[12:15], s30 offen lds
    s_add_u32 m0, s46, 34816
    s_nop 0
    buffer_load_dwordx4 v14, s[12:15], s30 offen lds
    s_add_u32 m0, s46, 35840
    s_nop 0
    buffer_load_dwordx4 v15, s[12:15], s30 offen lds
    s_add_u32 s29, s29, 128
    s_add_u32 s30, s30, 196608
    s_waitcnt vmcnt(8)
    s_barrier
    s_add_u32 m0, s45, 65536
    s_nop 0
    buffer_load_dwordx4 v8, s[8:11], s29 offen lds
    s_add_u32 m0, s45, 66560
    s_nop 0
    buffer_load_dwordx4 v9, s[8:11], s29 offen lds
    s_add_u32 m0, s45, 67584
    s_nop 0
    buffer_load_dwordx4 v10, s[8:11], s29 offen lds
    s_add_u32 m0, s45, 68608
    s_nop 0
    buffer_load_dwordx4 v11, s[8:11], s29 offen lds
    s_add_u32 m0, s46, 65536
    s_nop 0
    buffer_load_dwordx4 v12, s[12:15], s30 offen lds
    s_add_u32 m0, s46, 66560
    s_nop 0
    buffer_load_dwordx4 v13, s[12:15], s30 offen lds
    s_add_u32 m0, s46, 67584
    s_nop 0
    buffer_load_dwordx4 v14, s[12:15], s30 offen lds
    s_add_u32 m0, s46, 68608
    s_nop 0
    buffer_load_dwordx4 v15, s[12:15], s30 offen lds
    s_add_u32 s29, s29, 128
    s_add_u32 s30, s30, 196608
    s_waitcnt vmcnt(8)
    s_barrier
    s_add_u32 s31, s31, 1
    s_cmp_lt_u32 s31, 1
    s_cbranch_scc1 Llloop_win0_kernel_4
    s_add_u32 m0, s45, 98304
    s_nop 0
    buffer_load_dwordx4 v8, s[8:11], s29 offen lds
    s_add_u32 m0, s45, 99328
    s_nop 0
    buffer_load_dwordx4 v9, s[8:11], s29 offen lds
    s_add_u32 m0, s45, 100352
    s_nop 0
    buffer_load_dwordx4 v10, s[8:11], s29 offen lds
    s_add_u32 m0, s45, 101376
    s_nop 0
    buffer_load_dwordx4 v11, s[8:11], s29 offen lds
    s_add_u32 m0, s46, 98304
    s_nop 0
    buffer_load_dwordx4 v12, s[12:15], s30 offen lds
    s_add_u32 m0, s46, 99328
    s_nop 0
    buffer_load_dwordx4 v13, s[12:15], s30 offen lds
    s_add_u32 m0, s46, 100352
    s_nop 0
    buffer_load_dwordx4 v14, s[12:15], s30 offen lds
    s_add_u32 m0, s46, 101376
    s_nop 0
    buffer_load_dwordx4 v15, s[12:15], s30 offen lds
    s_add_u32 s29, s29, 128
    s_add_u32 s30, s30, 196608
    s_waitcnt vmcnt(8)
    s_barrier
    s_add_u32 m0, s45, 0
    s_nop 0
    buffer_load_dwordx4 v8, s[8:11], s29 offen lds
    s_add_u32 m0, s45, 1024
    s_nop 0
    buffer_load_dwordx4 v9, s[8:11], s29 offen lds
    s_add_u32 m0, s45, 2048
    s_nop 0
    buffer_load_dwordx4 v10, s[8:11], s29 offen lds
    s_add_u32 m0, s45, 3072
    s_nop 0
    buffer_load_dwordx4 v11, s[8:11], s29 offen lds
    s_add_u32 m0, s46, 0
    s_nop 0
    buffer_load_dwordx4 v12, s[12:15], s30 offen lds
    s_add_u32 m0, s46, 1024
    s_nop 0
    buffer_load_dwordx4 v13, s[12:15], s30 offen lds
    s_add_u32 m0, s46, 2048
    s_nop 0
    buffer_load_dwordx4 v14, s[12:15], s30 offen lds
    s_add_u32 m0, s46, 3072
    s_nop 0
    buffer_load_dwordx4 v15, s[12:15], s30 offen lds
    s_add_u32 s29, s29, 128
    s_add_u32 s30, s30, 196608
    s_waitcnt vmcnt(8)
    s_barrier
    s_add_u32 m0, s45, 32768
    s_nop 0
    buffer_load_dwordx4 v8, s[8:11], s29 offen lds
    s_add_u32 m0, s45, 33792
    s_nop 0
    buffer_load_dwordx4 v9, s[8:11], s29 offen lds
    s_add_u32 m0, s45, 34816
    s_nop 0
    buffer_load_dwordx4 v10, s[8:11], s29 offen lds
    s_add_u32 m0, s45, 35840
    s_nop 0
    buffer_load_dwordx4 v11, s[8:11], s29 offen lds
    s_add_u32 m0, s46, 32768
    s_nop 0
    buffer_load_dwordx4 v12, s[12:15], s30 offen lds
    s_add_u32 m0, s46, 33792
    s_nop 0
    buffer_load_dwordx4 v13, s[12:15], s30 offen lds
    s_add_u32 m0, s46, 34816
    s_nop 0
    buffer_load_dwordx4 v14, s[12:15], s30 offen lds
    s_add_u32 m0, s46, 35840
    s_nop 0
    buffer_load_dwordx4 v15, s[12:15], s30 offen lds
    s_add_u32 s29, s29, 128
    s_add_u32 s30, s30, 196608
    s_waitcnt vmcnt(8)
    s_barrier
    s_waitcnt vmcnt(0)
    s_barrier
    s_waitcnt vmcnt(0)
    s_barrier
    s_waitcnt vmcnt(0)
    s_barrier
    s_endpgm
.section .rodata,"a"
.p2align 6
.amdhsa_kernel win0_kernel
  .amdhsa_next_free_vgpr 160
  .amdhsa_next_free_sgpr 56
  .amdhsa_accum_offset 160
  .amdhsa_group_segment_fixed_size 0
  .amdhsa_kernarg_size 96
  .amdhsa_user_sgpr_count 2
  .amdhsa_user_sgpr_kernarg_segment_ptr 1
  .amdhsa_system_sgpr_workgroup_id_x 1
.end_amdhsa_kernel
.text

.globl lnz_kernel
.p2align 8
.type lnz_kernel,@function
lnz_kernel:
    s_cmp_ge_u32 s2, 512
    s_cbranch_scc1 Lend_lnz_kernel_1
    s_load_dwordx2 s[4:5], s[0:1], 88
    s_load_dwordx2 s[6:7], s[0:1], 88
    s_waitcnt lgkmcnt(0)
    s_add_u32 s8, s4, 15728640
    s_addc_u32 s9, s5, 0
    s_mov_b32 s10, 6291456
    s_mov_b32 s11, 0x00020000
    s_add_u32 s12, s6, 22020096
    s_addc_u32 s13, s7, 0
    s_mov_b32 s14, 3145728
    s_mov_b32 s15, 0x00020000
    v_and_b32 v1, 63, v0
    v_lshrrev_b32 v2, 6, v0
    s_lshl_b32 s16, s2, 2
    v_add_u32 v2, s16, v2
    v_mul_u32_u24 v3, 3072, v2
    v_lshl_add_u32 v3, v1, 2, v3
    v_mul_u32_u24 v4, 1536, v2
    v_lshl_add_u32 v4, v1, 2, v4
    buffer_load_dword v8, v3, s[8:11], 0 offen offset:1536
    buffer_load_dword v9, v3, s[8:11], 0 offen offset:1792
    buffer_load_dword v10, v3, s[8:11], 0 offen offset:2048
    buffer_load_dword v11, v3, s[8:11], 0 offen offset:2304
    buffer_load_dword v12, v3, s[8:11], 0 offen offset:2560
    buffer_load_dword v13, v3, s[8:11], 0 offen offset:2816
    s_waitcnt vmcnt(0)
    v_lshlrev_b32 v16, 16, v8
    v_and_b32 v17, 0xffff0000, v8
    v_lshlrev_b32 v18, 16, v9
    v_and_b32 v19, 0xffff0000, v9
    v_lshlrev_b32 v20, 16, v10
    v_and_b32 v21, 0xffff0000, v10
    v_lshlrev_b32 v22, 16, v11
    v_and_b32 v23, 0xffff0000, v11
    v_lshlrev_b32 v24, 16, v12
    v_and_b32 v25, 0xffff0000, v12
    v_lshlrev_b32 v26, 16, v13
    v_and_b32 v27, 0xffff0000, v13
    v_add_f32 v5, v16, v17
    v_add_f32 v5, v5, v18
    v_add_f32 v5, v5, v19
    v_add_f32 v5, v5, v20
    v_add_f32 v5, v5, v21
    v_add_f32 v5, v5, v22
    v_add_f32 v5, v5, v23
    v_add_f32 v5, v5, v24
    v_add_f32 v5, v5, v25
    v_add_f32 v5, v5, v26
    v_add_f32 v5, v5, v27
    s_nop 1
    v_add_f32_dpp v6, v5, v5 row_ror:8 row_mask:0xf bank_mask:0xf
    v_mov_b32 v5, v6
    s_nop 1
    v_add_f32_dpp v6, v5, v5 row_ror:4 row_mask:0xf bank_mask:0xf
    v_mov_b32 v5, v6
    s_nop 1
    v_add_f32_dpp v6, v5, v5 row_ror:2 row_mask:0xf bank_mask:0xf
    v_mov_b32 v5, v6
    s_nop 1
    v_add_f32_dpp v6, v5, v5 row_ror:1 row_mask:0xf bank_mask:0xf
    v_mov_b32 v5, v6
    s_nop 1
    v_readlane_b32 s20, v5, 0
    v_readlane_b32 s21, v5, 16
    v_readlane_b32 s22, v5, 32
    v_readlane_b32 s23, v5, 48
    s_nop 1
    v_mov_b32 v5, s20
    v_add_f32 v5, s21, v5
    v_add_f32 v5, s22, v5
    v_add_f32 v5, s23, v5
    v_mul_f32 v7, 0x3aaaaaab, v5
    v_sub_f32 v28, v16, v7
    v_mul_f32 v5, v28, v28
    v_sub_f32 v28, v17, v7
    v_fmac_f32 v5, v28, v28
    v_sub_f32 v28, v18, v7
    v_fmac_f32 v5, v28, v28
    v_sub_f32 v28, v19, v7
    v_fmac_f32 v5, v28, v28
    v_sub_f32 v28, v20, v7
    v_fmac_f32 v5, v28, v28
    v_sub_f32 v28, v21, v7
    v_fmac_f32 v5, v28, v28
    v_sub_f32 v28, v22, v7
    v_fmac_f32 v5, v28, v28
    v_sub_f32 v28, v23, v7
    v_fmac_f32 v5, v28, v28
    v_sub_f32 v28, v24, v7
    v_fmac_f32 v5, v28, v28
    v_sub_f32 v28, v25, v7
    v_fmac_f32 v5, v28, v28
    v_sub_f32 v28, v26, v7
    v_fmac_f32 v5, v28, v28
    v_sub_f32 v28, v27, v7
    v_fmac_f32 v5, v28, v28
    s_nop 1
    v_add_f32_dpp v6, v5, v5 row_ror:8 row_mask:0xf bank_mask:0xf
    v_mov_b32 v5, v6
    s_nop 1
    v_add_f32_dpp v6, v5, v5 row_ror:4 row_mask:0xf bank_mask:0xf
    v_mov_b32 v5, v6
    s_nop 1
    v_add_f32_dpp v6, v5, v5 row_ror:2 row_mask:0xf bank_mask:0xf
    v_mov_b32 v5, v6
    s_nop 1
    v_add_f32_dpp v6, v5, v5 row_ror:1 row_mask:0xf bank_mask:0xf
    v_mov_b32 v5, v6
    s_nop 1
    v_readlane_b32 s20, v5, 0
    v_readlane_b32 s21, v5, 16
    v_readlane_b32 s22, v5, 32
    v_readlane_b32 s23, v5, 48
    s_nop 1
    v_mov_b32 v5, s20
    v_add_f32 v5, s21, v5
    v_add_f32 v5, s22, v5
    v_add_f32 v5, s23, v5
    v_mul_f32 v5, 0x3aaaaaab, v5
    v_cvt_pk_bf16_f32 v7, v7, v7
    v_lshlrev_b32 v7, 16, v7
    v_cvt_pk_bf16_f32 v5, v5, v5
    v_lshlrev_b32 v5, 16, v5
    v_add_f32 v5, 0x3727c5ac, v5
    v_cvt_pk_bf16_f32 v5, v5, v5
    v_lshlrev_b32 v5, 16, v5
    v_sqrt_f32 v5, v5
    s_nop 0
    v_cvt_pk_bf16_f32 v5, v5, v5
    v_lshlrev_b32 v5, 16, v5
    v_rcp_f32 v5, v5
    s_nop 0
    v_sub_f32 v16, v16, v7
    v_sub_f32 v17, v17, v7
    v_cvt_pk_bf16_f32 v6, v16, v17
    v_lshlrev_b32 v16, 16, v6
    v_and_b32 v17, 0xffff0000, v6
    v_mul_f32 v16, v16, v5
    v_mul_f32 v17, v17, v5
    v_cvt_pk_bf16_f32 v8, v16, v17
    buffer_store_dword v8, v4, s[12:15], 0 offen offset:0
    v_sub_f32 v18, v18, v7
    v_sub_f32 v19, v19, v7
    v_cvt_pk_bf16_f32 v6, v18, v19
    v_lshlrev_b32 v18, 16, v6
    v_and_b32 v19, 0xffff0000, v6
    v_mul_f32 v18, v18, v5
    v_mul_f32 v19, v19, v5
    v_cvt_pk_bf16_f32 v9, v18, v19
    buffer_store_dword v9, v4, s[12:15], 0 offen offset:256
    v_sub_f32 v20, v20, v7
    v_sub_f32 v21, v21, v7
    v_cvt_pk_bf16_f32 v6, v20, v21
    v_lshlrev_b32 v20, 16, v6
    v_and_b32 v21, 0xffff0000, v6
    v_mul_f32 v20, v20, v5
    v_mul_f32 v21, v21, v5
    v_cvt_pk_bf16_f32 v10, v20, v21
    buffer_store_dword v10, v4, s[12:15], 0 offen offset:512
    v_sub_f32 v22, v22, v7
    v_sub_f32 v23, v23, v7
    v_cvt_pk_bf16_f32 v6, v22, v23
    v_lshlrev_b32 v22, 16, v6
    v_and_b32 v23, 0xffff0000, v6
    v_mul_f32 v22, v22, v5
    v_mul_f32 v23, v23, v5
    v_cvt_pk_bf16_f32 v11, v22, v23
    buffer_store_dword v11, v4, s[12:15], 0 offen offset:768
    v_sub_f32 v24, v24, v7
    v_sub_f32 v25, v25, v7
    v_cvt_pk_bf16_f32 v6, v24, v25
    v_lshlrev_b32 v24, 16, v6
    v_and_b32 v25, 0xffff0000, v6
    v_mul_f32 v24, v24, v5
    v_mul_f32 v25, v25, v5
    v_cvt_pk_bf16_f32 v12, v24, v25
    buffer_store_dword v12, v4, s[12:15], 0 offen offset:1024
    v_sub_f32 v26, v26, v7
    v_sub_f32 v27, v27, v7
    v_cvt_pk_bf16_f32 v6, v26, v27
    v_lshlrev_b32 v26, 16, v6
    v_and_b32 v27, 0xffff0000, v6
    v_mul_f32 v26, v26, v5
    v_mul_f32 v27, v27, v5
    v_cvt_pk_bf16_f32 v13, v26, v27
    buffer_store_dword v13, v4, s[12:15], 0 offen offset:1280
Lend_lnz_kernel_1:
    s_endpgm
.section .rodata,"a"
.p2align 6
.amdhsa_kernel lnz_kernel
  .amdhsa_next_free_vgpr 30
  .amdhsa_next_free_sgpr 32
  .amdhsa_accum_offset 32
  .amdhsa_group_segment_fixed_size 0
  .amdhsa_kernarg_size 96
  .amdhsa_user_sgpr_count 2
  .amdhsa_user_sgpr_kernarg_segment_ptr 1
  .amdhsa_system_sgpr_workgroup_id_x 1
.end_amdhsa_kernel
.text

.globl sp_kernel
.p2align 8
.type sp_kernel,@function
sp_kernel:
    s_cmp_ge_u32 s2, 192
    s_cbranch_scc1 Lend_sp_kernel_1
    s_load_dwordx2 s[4:5], s[0:1], 48
    s_load_dwordx2 s[6:7], s[0:1], 88
    s_load_dwordx2 s[24:25], s[0:1], 88
    s_and_b32 s26, s2, 7
    s_lshr_b32 s27, s2, 3
    s_mul_i32 s26, s26, 24
    s_add_u32 s26, s26, s27
    s_mul_hi_u32 s27, s26, 715827883
    s_mul_i32 s28, s27, 6
    s_sub_u32 s28, s26, s28
    s_mul_i32 s27, s27, 64
    s_mul_i32 s28, s28, 128
    s_waitcnt lgkmcnt(0)
    s_mov_b32 s8, s4
    s_mov_b32 s9, s5
    s_mov_b32 s10, 8388608
    s_mov_b32 s11, 0x00020000
    s_add_u32 s12, s6, 22020096
    s_addc_u32 s13, s7, 0
    s_mov_b32 s14, 3145728
    s_mov_b32 s15, 0x00020000
    s_add_u32 s16, s24, 25165824
    s_addc_u32 s17, s25, 0
    s_mov_b32 s18, 3145728
    s_mov_b32 s19, 0x00020000
    v_and_b32 v1, 63, v0
    v_lshrrev_b32 v2, 6, v0
    s_nop 0
    v_readfirstlane_b32 s41, v2
    s_nop 3
    s_cmp_ge_u32 s41, 4
    s_cbranch_scc1 Lloader_sp_kernel_2
    v_lshrrev_b32 v3, 1, v2
    v_and_b32 v4, 1, v2
    v_lshrrev_b32 v5, 4, v1
    v_and_b32 v6, 15, v1
    v_mul_u32_u24 v7, 32, v3
    v_add_u32 v7, v7, v6
    v_lshlrev_b32 v7, 7, v7
    v_add_u32 v18, 0, v5
    v_and_b32 v3, 7, v6
    v_xor_b32 v18, v18, v3
    v_lshl_add_u32 v18, v18, 4, v7
    v_add_u32 v26, 49152, v18
    v_add_u32 v19, 4, v5
    v_and_b32 v3, 7, v6
    v_xor_b32 v19, v19, v3
    v_lshl_add_u32 v19, v19, 4, v7
    v_add_u32 v27, 49152, v19
    v_lshrrev_b32 v3, 2, v6
    v_and_b32 v7, 1, v5
    v_lshl_add_u32 v7, v7, 2, v3
    v_lshl_add_u32 v32, v5, 3, v3
    v_lshlrev_b32 v32, 8, v32
    v_and_b32 v33, 3, v6
    v_lshl_add_u32 v32, v33, 3, v32
    v_lshlrev_b32 v33, 2, v4
    v_add_u32 v34, 0, v33
    v_xor_b32 v34, v34, v7
    v_lshl_add_u32 v20, v34, 5, v32
    v_add_u32 v28, 49152, v20
    v_add_u32 v34, 1, v33
    v_xor_b32 v34, v34, v7
    v_lshl_add_u32 v21, v34, 5, v32
    v_add_u32 v29, 49152, v21
    v_add_u32 v34, 2, v33
    v_xor_b32 v34, v34, v7
    v_lshl_add_u32 v22, v34, 5, v32
    v_add_u32 v30, 49152, v22
    v_add_u32 v34, 3, v33
    v_xor_b32 v34, v34, v7
    v_lshl_add_u32 v23, v34, 5, v32
    v_add_u32 v31, 49152, v23
    v_mov_b32 v80, 0
    v_mov_b32 v81, 0
    v_mov_b32 v82, 0
    v_mov_b32 v83, 0
    v_mov_b32 v84, 0
    v_mov_b32 v85, 0
    v_mov_b32 v86, 0
    v_mov_b32 v87, 0
    v_mov_b32 v88, 0
    v_mov_b32 v89, 0
    v_mov_b32 v90, 0
    v_mov_b32 v91, 0
    v_mov_b32 v92, 0
    v_mov_b32 v93, 0
    v_mov_b32 v94, 0
    v_mov_b32 v95, 0
    v_mov_b32 v96, 0
    v_mov_b32 v97, 0
    v_mov_b32 v98, 0
    v_mov_b32 v99, 0
    v_mov_b32 v100, 0
    v_mov_b32 v101, 0
    v_mov_b32 v102, 0
    v_mov_b32 v103, 0
    v_mov_b32 v104, 0
    v_mov_b32 v105, 0
    v_mov_b32 v106, 0
    v_mov_b32 v107, 0
    v_mov_b32 v108, 0
    v_mov_b32 v109, 0
    v_mov_b32 v110, 0
    v_mov_b32 v111, 0
    s_barrier
    ds_read_b128 v[32:35], v18 offset:0
    ds_read_b128 v[36:39], v18 offset:2048
    ds_read_b64_tr_b16 v[48:49], v20 offset:8192
    ds_read_b64_tr_b16 v[50:51], v20 offset:9216
    ds_read_b64_tr_b16 v[52:53], v21 offset:8192
    ds_read_b64_tr_b16 v[54:55], v21 offset:9216
    ds_read_b64_tr_b16 v[56:57], v22 offset:8192
    ds_read_b64_tr_b16 v[58:59], v22 offset:9216
    ds_read_b64_tr_b16 v[60:61], v23 offset:8192
    ds_read_b64_tr_b16 v[62:63], v23 offset:9216
    s_mov_b32 s31, 0
Lcloop_sp_kernel_3:
    s_waitcnt lgkmcnt(0)
    v_mfma_f32_16x16x32_bf16 v[80:83], v[48:51], v[32:35], v[80:83]
    ds_read_b128 v[40:43], v19 offset:0
    v_mfma_f32_16x16x32_bf16 v[84:87], v[52:55], v[32:35], v[84:87]
    ds_read_b128 v[44:47], v19 offset:2048
    v_mfma_f32_16x16x32_bf16 v[88:91], v[56:59], v[32:35], v[88:91]
    ds_read_b64_tr_b16 v[64:65], v20 offset:16384
    v_mfma_f32_16x16x32_bf16 v[92:95], v[60:63], v[32:35], v[92:95]
    ds_read_b64_tr_b16 v[66:67], v20 offset:17408
    ds_read_b64_tr_b16 v[68:69], v21 offset:16384
    v_mfma_f32_16x16x32_bf16 v[96:99], v[48:51], v[36:39], v[96:99]
    ds_read_b64_tr_b16 v[70:71], v21 offset:17408
    v_mfma_f32_16x16x32_bf16 v[100:103], v[52:55], v[36:39], v[100:103]
    ds_read_b64_tr_b16 v[72:73], v22 offset:16384
    v_mfma_f32_16x16x32_bf16 v[104:107], v[56:59], v[36:39], v[104:107]
    ds_read_b64_tr_b16 v[74:75], v22 offset:17408
    v_mfma_f32_16x16x32_bf16 v[108:111], v[60:63], v[36:39], v[108:111]
    ds_read_b64_tr_b16 v[76:77], v23 offset:16384
    ds_read_b64_tr_b16 v[78:79], v23 offset:17408
    s_waitcnt lgkmcnt(0)
    v_mfma_f32_16x16x32_bf16 v[80:83], v[64:67], v[40:43], v[80:83]
    ds_read_b128 v[32:35], v18 offset:24576
    v_mfma_f32_16x16x32_bf16 v[84:87], v[68:71], v[40:43], v[84:87]
    ds_read_b128 v[36:39], v18 offset:26624
    v_mfma_f32_16x16x32_bf16 v[88:91], v[72:75], v[40:43], v[88:91]
    ds_read_b64_tr_b16 v[48:49], v20 offset:32768
    v_mfma_f32_16x16x32_bf16 v[92:95], v[76:79], v[40:43], v[92:95]
    ds_read_b64_tr_b16 v[50:51], v20 offset:33792
    ds_read_b64_tr_b16 v[52:53], v21 offset:32768
    v_mfma_f32_16x16x32_bf16 v[96:99], v[64:67], v[44:47], v[96:99]
    ds_read_b64_tr_b16 v[54:55], v21 offset:33792
    v_mfma_f32_16x16x32_bf16 v[100:103], v[68:71], v[44:47], v[100:103]
    ds_read_b64_tr_b16 v[56:57], v22 offset:32768
    v_mfma_f32_16x16x32_bf16 v[104:107], v[72:75], v[44:47], v[104:107]
    ds_read_b64_tr_b16 v[58:59], v22 offset:33792
    v_mfma_f32_16x16x32_bf16 v[108:111], v[76:79], v[44:47], v[108:111]
    ds_read_b64_tr_b16 v[60:61], v23 offset:32768
    ds_read_b64_tr_b16 v[62:63], v23 offset:33792
    s_barrier
    s_waitcnt lgkmcnt(0)
    v_mfma_f32_16x16x32_bf16 v[80:83], v[48:51], v[32:35], v[80:83]
    ds_read_b128 v[40:43], v19 offset:24576
    v_mfma_f32_16x16x32_bf16 v[84:87], v[52:55], v[32:35], v[84:87]
    ds_read_b128 v[44:47], v19 offset:26624
    v_mfma_f32_16x16x32_bf16 v[88:91], v[56:59], v[32:35], v[88:91]
    ds_read_b64_tr_b16 v[64:65], v20 offset:40960
    v_mfma_f32_16x16x32_bf16 v[92:95], v[60:63], v[32:35], v[92:95]
    ds_read_b64_tr_b16 v[66:67], v20 offset:41984
    ds_read_b64_tr_b16 v[68:69], v21 offset:40960
    v_mfma_f32_16x16x32_bf16 v[96:99], v[48:51], v[36:39], v[96:99]
    ds_read_b64_tr_b16 v[70:71], v21 offset:41984
    v_mfma_f32_16x16x32_bf16 v[100:103], v[52:55], v[36:39], v[100:103]
    ds_read_b64_tr_b16 v[72:73], v22 offset:40960
    v_mfma_f32_16x16x32_bf16 v[104:107], v[56:59], v[36:39], v[104:107]
    ds_read_b64_tr_b16 v[74:75], v22 offset:41984
    v_mfma_f32_16x16x32_bf16 v[108:111], v[60:63], v[36:39], v[108:111]
    ds_read_b64_tr_b16 v[76:77], v23 offset:40960
    ds_read_b64_tr_b16 v[78:79], v23 offset:41984
    s_waitcnt lgkmcnt(0)
    v_mfma_f32_16x16x32_bf16 v[80:83], v[64:67], v[40:43], v[80:83]
    ds_read_b128 v[32:35], v26 offset:0
    v_mfma_f32_16x16x32_bf16 v[84:87], v[68:71], v[40:43], v[84:87]
    ds_read_b128 v[36:39], v26 offset:2048
    v_mfma_f32_16x16x32_bf16 v[88:91], v[72:75], v[40:43], v[88:91]
    ds_read_b64_tr_b16 v[48:49], v28 offset:8192
    v_mfma_f32_16x16x32_bf16 v[92:95], v[76:79], v[40:43], v[92:95]
    ds_read_b64_tr_b16 v[50:51], v28 offset:9216
    ds_read_b64_tr_b16 v[52:53], v29 offset:8192
    v_mfma_f32_16x16x32_bf16 v[96:99], v[64:67], v[44:47], v[96:99]
    ds_read_b64_tr_b16 v[54:55], v29 offset:9216
    v_mfma_f32_16x16x32_bf16 v[100:103], v[68:71], v[44:47], v[100:103]
    ds_read_b64_tr_b16 v[56:57], v30 offset:8192
    v_mfma_f32_16x16x32_bf16 v[104:107], v[72:75], v[44:47], v[104:107]
    ds_read_b64_tr_b16 v[58:59], v30 offset:9216
    v_mfma_f32_16x16x32_bf16 v[108:111], v[76:79], v[44:47], v[108:111]
    ds_read_b64_tr_b16 v[60:61], v31 offset:8192
    ds_read_b64_tr_b16 v[62:63], v31 offset:9216
    s_barrier
    s_waitcnt lgkmcnt(0)
    v_mfma_f32_16x16x32_bf16 v[80:83], v[48:51], v[32:35], v[80:83]
    ds_read_b128 v[40:43], v27 offset:0
    v_mfma_f32_16x16x32_bf16 v[84:87], v[52:55], v[32:35], v[84:87]
    ds_read_b128 v[44:47], v27 offset:2048
    v_mfma_f32_16x16x32_bf16 v[88:91], v[56:59], v[32:35], v[88:91]
    ds_read_b64_tr_b16 v[64:65], v28 offset:16384
    v_mfma_f32_16x16x32_bf16 v[92:95], v[60:63], v[32:35], v[92:95]
    ds_read_b64_tr_b16 v[66:67], v28 offset:17408
    ds_read_b64_tr_b16 v[68:69], v29 offset:16384
    v_mfma_f32_16x16x32_bf16 v[96:99], v[48:51], v[36:39], v[96:99]
    ds_read_b64_tr_b16 v[70:71], v29 offset:17408
    v_mfma_f32_16x16x32_bf16 v[100:103], v[52:55], v[36:39], v[100:103]
    ds_read_b64_tr_b16 v[72:73], v30 offset:16384
    v_mfma_f32_16x16x32_bf16 v[104:107], v[56:59], v[36:39], v[104:107]
    ds_read_b64_tr_b16 v[74:75], v30 offset:17408
    v_mfma_f32_16x16x32_bf16 v[108:111], v[60:63], v[36:39], v[108:111]
    ds_read_b64_tr_b16 v[76:77], v31 offset:16384
    ds_read_b64_tr_b16 v[78:79], v31 offset:17408
    s_waitcnt lgkmcnt(0)
    v_mfma_f32_16x16x32_bf16 v[80:83], v[64:67], v[40:43], v[80:83]
    ds_read_b128 v[32:35], v26 offset:24576
    v_mfma_f32_16x16x32_bf16 v[84:87], v[68:71], v[40:43], v[84:87]
    ds_read_b128 v[36:39], v26 offset:26624
    v_mfma_f32_16x16x32_bf16 v[88:91], v[72:75], v[40:43], v[88:91]
    ds_read_b64_tr_b16 v[48:49], v28 offset:32768
    v_mfma_f32_16x16x32_bf16 v[92:95], v[76:79], v[40:43], v[92:95]
    ds_read_b64_tr_b16 v[50:51], v28 offset:33792
    ds_read_b64_tr_b16 v[52:53], v29 offset:32768
    v_mfma_f32_16x16x32_bf16 v[96:99], v[64:67], v[44:47], v[96:99]
    ds_read_b64_tr_b16 v[54:55], v29 offset:33792
    v_mfma_f32_16x16x32_bf16 v[100:103], v[68:71], v[44:47], v[100:103]
    ds_read_b64_tr_b16 v[56:57], v30 offset:32768
    v_mfma_f32_16x16x32_bf16 v[104:107], v[72:75], v[44:47], v[104:107]
    ds_read_b64_tr_b16 v[58:59], v30 offset:33792
    v_mfma_f32_16x16x32_bf16 v[108:111], v[76:79], v[44:47], v[108:111]
    ds_read_b64_tr_b16 v[60:61], v31 offset:32768
    ds_read_b64_tr_b16 v[62:63], v31 offset:33792
    s_barrier
    s_waitcnt lgkmcnt(0)
    v_mfma_f32_16x16x32_bf16 v[80:83], v[48:51], v[32:35], v[80:83]
    ds_read_b128 v[40:43], v27 offset:24576
    v_mfma_f32_16x16x32_bf16 v[84:87], v[52:55], v[32:35], v[84:87]
    ds_read_b128 v[44:47], v27 offset:26624
    v_mfma_f32_16x16x32_bf16 v[88:91], v[56:59], v[32:35], v[88:91]
    ds_read_b64_tr_b16 v[64:65], v28 offset:40960
    v_mfma_f32_16x16x32_bf16 v[92:95], v[60:63], v[32:35], v[92:95]
    ds_read_b64_tr_b16 v[66:67], v28 offset:41984
    ds_read_b64_tr_b16 v[68:69], v29 offset:40960
    v_mfma_f32_16x16x32_bf16 v[96:99], v[48:51], v[36:39], v[96:99]
    ds_read_b64_tr_b16 v[70:71], v29 offset:41984
    v_mfma_f32_16x16x32_bf16 v[100:103], v[52:55], v[36:39], v[100:103]
    ds_read_b64_tr_b16 v[72:73], v30 offset:40960
    v_mfma_f32_16x16x32_bf16 v[104:107], v[56:59], v[36:39], v[104:107]
    ds_read_b64_tr_b16 v[74:75], v30 offset:41984
    v_mfma_f32_16x16x32_bf16 v[108:111], v[60:63], v[36:39], v[108:111]
    ds_read_b64_tr_b16 v[76:77], v31 offset:40960
    ds_read_b64_tr_b16 v[78:79], v31 offset:41984
    s_waitcnt lgkmcnt(0)
    v_mfma_f32_16x16x32_bf16 v[80:83], v[64:67], v[40:43], v[80:83]
    ds_read_b128 v[32:35], v18 offset:0
    v_mfma_f32_16x16x32_bf16 v[84:87], v[68:71], v[40:43], v[84:87]
    ds_read_b128 v[36:39], v18 offset:2048
    v_mfma_f32_16x16x32_bf16 v[88:91], v[72:75], v[40:43], v[88:91]
    ds_read_b64_tr_b16 v[48:49], v20 offset:8192
    v_mfma_f32_16x16x32_bf16 v[92:95], v[76:79], v[40:43], v[92:95]
    ds_read_b64_tr_b16 v[50:51], v20 offset:9216
    ds_read_b64_tr_b16 v[52:53], v21 offset:8192
    v_mfma_f32_16x16x32_bf16 v[96:99], v[64:67], v[44:47], v[96:99]
    ds_read_b64_tr_b16 v[54:55], v21 offset:9216
    v_mfma_f32_16x16x32_bf16 v[100:103], v[68:71], v[44:47], v[100:103]
    ds_read_b64_tr_b16 v[56:57], v22 offset:8192
    v_mfma_f32_16x16x32_bf16 v[104:107], v[72:75], v[44:47], v[104:107]
    ds_read_b64_tr_b16 v[58:59], v22 offset:9216
    v_mfma_f32_16x16x32_bf16 v[108:111], v[76:79], v[44:47], v[108:111]
    ds_read_b64_tr_b16 v[60:61], v23 offset:8192
    ds_read_b64_tr_b16 v[62:63], v23 offset:9216
    s_barrier
    s_add_u32 s31, s31, 1
    s_cmp_lt_u32 s31, 7
    s_cbranch_scc1 Lcloop_sp_kernel_3
    s_waitcnt lgkmcnt(0)
    v_mfma_f32_16x16x32_bf16 v[80:83], v[48:51], v[32:35], v[80:83]
    ds_read_b128 v[40:43], v19 offset:0
    v_mfma_f32_16x16x32_bf16 v[84:87], v[52:55], v[32:35], v[84:87]
    ds_read_b128 v[44:47], v19 offset:2048
    v_mfma_f32_16x16x32_bf16 v[88:91], v[56:59], v[32:35], v[88:91]
    ds_read_b64_tr_b16 v[64:65], v20 offset:16384
    v_mfma_f32_16x16x32_bf16 v[92:95], v[60:63], v[32:35], v[92:95]
    ds_read_b64_tr_b16 v[66:67], v20 offset:17408
    ds_read_b64_tr_b16 v[68:69], v21 offset:16384
    v_mfma_f32_16x16x32_bf16 v[96:99], v[48:51], v[36:39], v[96:99]
    ds_read_b64_tr_b16 v[70:71], v21 offset:17408
    v_mfma_f32_16x16x32_bf16 v[100:103], v[52:55], v[36:39], v[100:103]
    ds_read_b64_tr_b16 v[72:73], v22 offset:16384
    v_mfma_f32_16x16x32_bf16 v[104:107], v[56:59], v[36:39], v[104:107]
    ds_read_b64_tr_b16 v[74:75], v22 offset:17408
    v_mfma_f32_16x16x32_bf16 v[108:111], v[60:63], v[36:39], v[108:111]
    ds_read_b64_tr_b16 v[76:77], v23 offset:16384
    ds_read_b64_tr_b16 v[78:79], v23 offset:17408
    s_waitcnt lgkmcnt(0)
    v_mfma_f32_16x16x32_bf16 v[80:83], v[64:67], v[40:43], v[80:83]
    ds_read_b128 v[32:35], v18 offset:24576
    v_mfma_f32_16x16x32_bf16 v[84:87], v[68:71], v[40:43], v[84:87]
    ds_read_b128 v[36:39], v18 offset:26624
    v_mfma_f32_16x16x32_bf16 v[88:91], v[72:75], v[40:43], v[88:91]
    ds_read_b64_tr_b16 v[48:49], v20 offset:32768
    v_mfma_f32_16x16x32_bf16 v[92:95], v[76:79], v[40:43], v[92:95]
    ds_read_b64_tr_b16 v[50:51], v20 offset:33792
    ds_read_b64_tr_b16 v[52:53], v21 offset:32768
    v_mfma_f32_16x16x32_bf16 v[96:99], v[64:67], v[44:47], v[96:99]
    ds_read_b64_tr_b16 v[54:55], v21 offset:33792
    v_mfma_f32_16x16x32_bf16 v[100:103], v[68:71], v[44:47], v[100:103]
    ds_read_b64_tr_b16 v[56:57], v22 offset:32768
    v_mfma_f32_16x16x32_bf16 v[104:107], v[72:75], v[44:47], v[104:107]
    ds_read_b64_tr_b16 v[58:59], v22 offset:33792
    v_mfma_f32_16x16x32_bf16 v[108:111], v[76:79], v[44:47], v[108:111]
    ds_read_b64_tr_b16 v[60:61], v23 offset:32768
    ds_read_b64_tr_b16 v[62:63], v23 offset:33792
    s_barrier
    s_waitcnt lgkmcnt(0)
    v_mfma_f32_16x16x32_bf16 v[80:83], v[48:51], v[32:35], v[80:83]
    ds_read_b128 v[40:43], v19 offset:24576
    v_mfma_f32_16x16x32_bf16 v[84:87], v[52:55], v[32:35], v[84:87]
    ds_read_b128 v[44:47], v19 offset:26624
    v_mfma_f32_16x16x32_bf16 v[88:91], v[56:59], v[32:35], v[88:91]
    ds_read_b64_tr_b16 v[64:65], v20 offset:40960
    v_mfma_f32_16x16x32_bf16 v[92:95], v[60:63], v[32:35], v[92:95]
    ds_read_b64_tr_b16 v[66:67], v20 offset:41984
    ds_read_b64_tr_b16 v[68:69], v21 offset:40960
    v_mfma_f32_16x16x32_bf16 v[96:99], v[48:51], v[36:39], v[96:99]
    ds_read_b64_tr_b16 v[70:71], v21 offset:41984
    v_mfma_f32_16x16x32_bf16 v[100:103], v[52:55], v[36:39], v[100:103]
    ds_read_b64_tr_b16 v[72:73], v22 offset:40960
    v_mfma_f32_16x16x32_bf16 v[104:107], v[56:59], v[36:39], v[104:107]
    ds_read_b64_tr_b16 v[74:75], v22 offset:41984
    v_mfma_f32_16x16x32_bf16 v[108:111], v[60:63], v[36:39], v[108:111]
    ds_read_b64_tr_b16 v[76:77], v23 offset:40960
    ds_read_b64_tr_b16 v[78:79], v23 offset:41984
    s_waitcnt lgkmcnt(0)
    v_mfma_f32_16x16x32_bf16 v[80:83], v[64:67], v[40:43], v[80:83]
    ds_read_b128 v[32:35], v26 offset:0
    v_mfma_f32_16x16x32_bf16 v[84:87], v[68:71], v[40:43], v[84:87]
    ds_read_b128 v[36:39], v26 offset:2048
    v_mfma_f32_16x16x32_bf16 v[88:91], v[72:75], v[40:43], v[88:91]
    ds_read_b64_tr_b16 v[48:49], v28 offset:8192
    v_mfma_f32_16x16x32_bf16 v[92:95], v[76:79], v[40:43], v[92:95]
    ds_read_b64_tr_b16 v[50:51], v28 offset:9216
    ds_read_b64_tr_b16 v[52:53], v29 offset:8192
    v_mfma_f32_16x16x32_bf16 v[96:99], v[64:67], v[44:47], v[96:99]
    ds_read_b64_tr_b16 v[54:55], v29 offset:9216
    v_mfma_f32_16x16x32_bf16 v[100:103], v[68:71], v[44:47], v[100:103]
    ds_read_b64_tr_b16 v[56:57], v30 offset:8192
    v_mfma_f32_16x16x32_bf16 v[104:107], v[72:75], v[44:47], v[104:107]
    ds_read_b64_tr_b16 v[58:59], v30 offset:9216
    v_mfma_f32_16x16x32_bf16 v[108:111], v[76:79], v[44:47], v[108:111]
    ds_read_b64_tr_b16 v[60:61], v31 offset:8192
    ds_read_b64_tr_b16 v[62:63], v31 offset:9216
    s_barrier
    s_waitcnt lgkmcnt(0)
    v_mfma_f32_16x16x32_bf16 v[80:83], v[48:51], v[32:35], v[80:83]
    ds_read_b128 v[40:43], v27 offset:0
    v_mfma_f32_16x16x32_bf16 v[84:87], v[52:55], v[32:35], v[84:87]
    ds_read_b128 v[44:47], v27 offset:2048
    v_mfma_f32_16x16x32_bf16 v[88:91], v[56:59], v[32:35], v[88:91]
    ds_read_b64_tr_b16 v[64:65], v28 offset:16384
    v_mfma_f32_16x16x32_bf16 v[92:95], v[60:63], v[32:35], v[92:95]
    ds_read_b64_tr_b16 v[66:67], v28 offset:17408
    ds_read_b64_tr_b16 v[68:69], v29 offset:16384
    v_mfma_f32_16x16x32_bf16 v[96:99], v[48:51], v[36:39], v[96:99]
    ds_read_b64_tr_b16 v[70:71], v29 offset:17408
    v_mfma_f32_16x16x32_bf16 v[100:103], v[52:55], v[36:39], v[100:103]
    ds_read_b64_tr_b16 v[72:73], v30 offset:16384
    v_mfma_f32_16x16x32_bf16 v[104:107], v[56:59], v[36:39], v[104:107]
    ds_read_b64_tr_b16 v[74:75], v30 offset:17408
    v_mfma_f32_16x16x32_bf16 v[108:111], v[60:63], v[36:39], v[108:111]
    ds_read_b64_tr_b16 v[76:77], v31 offset:16384
    ds_read_b64_tr_b16 v[78:79], v31 offset:17408
    s_waitcnt lgkmcnt(0)
    v_mfma_f32_16x16x32_bf16 v[80:83], v[64:67], v[40:43], v[80:83]
    ds_read_b128 v[32:35], v26 offset:24576
    v_mfma_f32_16x16x32_bf16 v[84:87], v[68:71], v[40:43], v[84:87]
    ds_read_b128 v[36:39], v26 offset:26624
    v_mfma_f32_16x16x32_bf16 v[88:91], v[72:75], v[40:43], v[88:91]
    ds_read_b64_tr_b16 v[48:49], v28 offset:32768
    v_mfma_f32_16x16x32_bf16 v[92:95], v[76:79], v[40:43], v[92:95]
    ds_read_b64_tr_b16 v[50:51], v28 offset:33792
    ds_read_b64_tr_b16 v[52:53], v29 offset:32768
    v_mfma_f32_16x16x32_bf16 v[96:99], v[64:67], v[44:47], v[96:99]
    ds_read_b64_tr_b16 v[54:55], v29 offset:33792
    v_mfma_f32_16x16x32_bf16 v[100:103], v[68:71], v[44:47], v[100:103]
    ds_read_b64_tr_b16 v[56:57], v30 offset:32768
    v_mfma_f32_16x16x32_bf16 v[104:107], v[72:75], v[44:47], v[104:107]
    ds_read_b64_tr_b16 v[58:59], v30 offset:33792
    v_mfma_f32_16x16x32_bf16 v[108:111], v[76:79], v[44:47], v[108:111]
    ds_read_b64_tr_b16 v[60:61], v31 offset:32768
    ds_read_b64_tr_b16 v[62:63], v31 offset:33792
    s_barrier
    s_waitcnt lgkmcnt(0)
    v_mfma_f32_16x16x32_bf16 v[80:83], v[48:51], v[32:35], v[80:83]
    ds_read_b128 v[40:43], v27 offset:24576
    v_mfma_f32_16x16x32_bf16 v[84:87], v[52:55], v[32:35], v[84:87]
    ds_read_b128 v[44:47], v27 offset:26624
    v_mfma_f32_16x16x32_bf16 v[88:91], v[56:59], v[32:35], v[88:91]
    ds_read_b64_tr_b16 v[64:65], v28 offset:40960
    v_mfma_f32_16x16x32_bf16 v[92:95], v[60:63], v[32:35], v[92:95]
    ds_read_b64_tr_b16 v[66:67], v28 offset:41984
    ds_read_b64_tr_b16 v[68:69], v29 offset:40960
    v_mfma_f32_16x16x32_bf16 v[96:99], v[48:51], v[36:39], v[96:99]
    ds_read_b64_tr_b16 v[70:71], v29 offset:41984
    v_mfma_f32_16x16x32_bf16 v[100:103], v[52:55], v[36:39], v[100:103]
    ds_read_b64_tr_b16 v[72:73], v30 offset:40960
    v_mfma_f32_16x16x32_bf16 v[104:107], v[56:59], v[36:39], v[104:107]
    ds_read_b64_tr_b16 v[74:75], v30 offset:41984
    v_mfma_f32_16x16x32_bf16 v[108:111], v[60:63], v[36:39], v[108:111]
    ds_read_b64_tr_b16 v[76:77], v31 offset:40960
    ds_read_b64_tr_b16 v[78:79], v31 offset:41984
    s_waitcnt lgkmcnt(0)
    v_mfma_f32_16x16x32_bf16 v[80:83], v[64:67], v[40:43], v[80:83]
    v_mfma_f32_16x16x32_bf16 v[84:87], v[68:71], v[40:43], v[84:87]
    v_mfma_f32_16x16x32_bf16 v[88:91], v[72:75], v[40:43], v[88:91]
    v_mfma_f32_16x16x32_bf16 v[92:95], v[76:79], v[40:43], v[92:95]
    v_mfma_f32_16x16x32_bf16 v[96:99], v[64:67], v[44:47], v[96:99]
    v_mfma_f32_16x16x32_bf16 v[100:103], v[68:71], v[44:47], v[100:103]
    v_mfma_f32_16x16x32_bf16 v[104:107], v[72:75], v[44:47], v[104:107]
    v_mfma_f32_16x16x32_bf16 v[108:111], v[76:79], v[44:47], v[108:111]
    s_barrier
    s_nop 7
    s_nop 7
    v_lshrrev_b32 v3, 1, v2
    v_and_b32 v4, 1, v2
    v_lshrrev_b32 v5, 4, v1
    v_and_b32 v6, 15, v1
    s_load_dwordx2 s[38:39], s[0:1], 56
    s_waitcnt lgkmcnt(0)
    s_mov_b32 s32, s38
    s_mov_b32 s33, s39
    s_mov_b32 s34, 4096
    s_mov_b32 s35, 0x00020000
    v_mul_u32_u24 v7, 32, v3
    v_add_u32 v7, v7, v6
    v_add_u32 v7, s27, v7
    v_lshlrev_b32 v7, 1, v7
    buffer_load_ushort v24, v7, s[32:35], 0 offen offset:0
    buffer_load_ushort v25, v7, s[32:35], 0 offen offset:32
    s_waitcnt vmcnt(0)
    v_lshlrev_b32 v24, 16, v24
    v_lshlrev_b32 v25, 16, v25
    v_mul_u32_u24 v7, 4608, v2
    v_mul_u32_u24 v8, 144, v6
    v_add_u32 v7, v7, v8
    v_lshl_add_u32 v7, v5, 3, v7
    v_cvt_pk_bf16_f32 v32, v80, v81
    v_cvt_pk_bf16_f32 v33, v82, v83
    v_lshlrev_b32 v80, 16, v32
    v_and_b32 v81, 0xffff0000, v32
    v_lshlrev_b32 v82, 16, v33
    v_and_b32 v83, 0xffff0000, v33
    v_add_f32 v80, v80, v24
    v_add_f32 v81, v81, v24
    v_add_f32 v82, v82, v24
    v_add_f32 v83, v83, v24
    v_cvt_pk_bf16_f32 v32, v80, v81
    v_cvt_pk_bf16_f32 v33, v82, v83
    ds_write_b64 v7, v[32:33] offset:0
    v_cvt_pk_bf16_f32 v40, v84, v85
    v_cvt_pk_bf16_f32 v41, v86, v87
    v_lshlrev_b32 v84, 16, v40
    v_and_b32 v85, 0xffff0000, v40
    v_lshlrev_b32 v86, 16, v41
    v_and_b32 v87, 0xffff0000, v41
    v_add_f32 v84, v84, v24
    v_add_f32 v85, v85, v24
    v_add_f32 v86, v86, v24
    v_add_f32 v87, v87, v24
    v_cvt_pk_bf16_f32 v40, v84, v85
    v_cvt_pk_bf16_f32 v41, v86, v87
    ds_write_b64 v7, v[40:41] offset:32
    v_cvt_pk_bf16_f32 v48, v88, v89
    v_cvt_pk_bf16_f32 v49, v90, v91
    v_lshlrev_b32 v88, 16, v48
    v_and_b32 v89, 0xffff0000, v48
    v_lshlrev_b32 v90, 16, v49
    v_and_b32 v91, 0xffff0000, v49
    v_add_f32 v88, v88, v24
    v_add_f32 v89, v89, v24
    v_add_f32 v90, v90, v24
    v_add_f32 v91, v91, v24
    v_cvt_pk_bf16_f32 v48, v88, v89
    v_cvt_pk_bf16_f32 v49, v90, v91
    ds_write_b64 v7, v[48:49] offset:64
    v_cvt_pk_bf16_f32 v56, v92, v93
    v_cvt_pk_bf16_f32 v57, v94, v95
    v_lshlrev_b32 v92, 16, v56
    v_and_b32 v93, 0xffff0000, v56
    v_lshlrev_b32 v94, 16, v57
    v_and_b32 v95, 0xffff0000, v57
    v_add_f32 v92, v92, v24
    v_add_f32 v93, v93, v24
    v_add_f32 v94, v94, v24
    v_add_f32 v95, v95, v24
    v_cvt_pk_bf16_f32 v56, v92, v93
    v_cvt_pk_bf16_f32 v57, v94, v95
    ds_write_b64 v7, v[56:57] offset:96
    v_cvt_pk_bf16_f32 v32, v96, v97
    v_cvt_pk_bf16_f32 v33, v98, v99
    v_lshlrev_b32 v96, 16, v32
    v_and_b32 v97, 0xffff0000, v32
    v_lshlrev_b32 v98, 16, v33
    v_and_b32 v99, 0xffff0000, v33
    v_add_f32 v96, v96, v25
    v_add_f32 v97, v97, v25
    v_add_f32 v98, v98, v25
    v_add_f32 v99, v99, v25
    v_cvt_pk_bf16_f32 v32, v96, v97
    v_cvt_pk_bf16_f32 v33, v98, v99
    ds_write_b64 v7, v[32:33] offset:2304
    v_cvt_pk_bf16_f32 v40, v100, v101
    v_cvt_pk_bf16_f32 v41, v102, v103
    v_lshlrev_b32 v100, 16, v40
    v_and_b32 v101, 0xffff0000, v40
    v_lshlrev_b32 v102, 16, v41
    v_and_b32 v103, 0xffff0000, v41
    v_add_f32 v100, v100, v25
    v_add_f32 v101, v101, v25
    v_add_f32 v102, v102, v25
    v_add_f32 v103, v103, v25
    v_cvt_pk_bf16_f32 v40, v100, v101
    v_cvt_pk_bf16_f32 v41, v102, v103
    ds_write_b64 v7, v[40:41] offset:2336
    v_cvt_pk_bf16_f32 v48, v104, v105
    v_cvt_pk_bf16_f32 v49, v106, v107
    v_lshlrev_b32 v104, 16, v48
    v_and_b32 v105, 0xffff0000, v48
    v_lshlrev_b32 v106, 16, v49
    v_and_b32 v107, 0xffff0000, v49
    v_add_f32 v104, v104, v25
    v_add_f32 v105, v105, v25
    v_add_f32 v106, v106, v25
    v_add_f32 v107, v107, v25
    v_cvt_pk_bf16_f32 v48, v104, v105
    v_cvt_pk_bf16_f32 v49, v106, v107
    ds_write_b64 v7, v[48:49] offset:2368
    v_cvt_pk_bf16_f32 v56, v108, v109
    v_cvt_pk_bf16_f32 v57, v110, v111
    v_lshlrev_b32 v108, 16, v56
    v_and_b32 v109, 0xffff0000, v56
    v_lshlrev_b32 v110, 16, v57
    v_and_b32 v111, 0xffff0000, v57
    v_add_f32 v108, v108, v25
    v_add_f32 v109, v109, v25
    v_add_f32 v110, v110, v25
    v_add_f32 v111, v111, v25
    v_cvt_pk_bf16_f32 v56, v108, v109
    v_cvt_pk_bf16_f32 v57, v110, v111
    ds_write_b64 v7, v[56:57] offset:2400
    s_waitcnt lgkmcnt(0)
    v_lshrrev_b32 v8, 3, v1
    v_and_b32 v9, 7, v1
    v_mul_u32_u24 v7, 4608, v2
    v_mul_u32_u24 v10, 144, v8
    v_add_u32 v7, v7, v10
    v_lshl_add_u32 v7, v9, 4, v7
    v_mul_u32_u24 v10, 32, v3
    v_add_u32 v10, v10, v8
    v_add_u32 v10, s27, v10
    v_lshlrev_b32 v11, 6, v4
    v_lshl_add_u32 v11, v9, 3, v11
    v_add_u32 v11, s28, v11
    v_mul_u32_u24 v12, 1536, v10
    v_lshl_add_u32 v12, v11, 1, v12
    ds_read_b128 v[80:83], v7 offset:0
    ds_read_b128 v[84:87], v7 offset:1152
    ds_read_b128 v[88:91], v7 offset:2304
    ds_read_b128 v[92:95], v7 offset:3456
    s_load_dwordx2 s[36:37], s[0:1], 88
    s_waitcnt lgkmcnt(0)
    s_add_u32 s20, s36, 15728640
    s_addc_u32 s21, s37, 0
    s_mov_b32 s22, 6291456
    s_mov_b32 s23, 0x00020000
    v_mul_u32_u24 v13, 3072, v10
    v_lshl_add_u32 v13, v11, 1, v13
    v_add_u32 v14, 0, v13
    buffer_load_dwordx4 v[32:35], v14, s[20:23], 0 offen
    v_add_u32 v14, 24576, v13
    buffer_load_dwordx4 v[36:39], v14, s[20:23], 0 offen
    v_add_u32 v14, 49152, v13
    buffer_load_dwordx4 v[40:43], v14, s[20:23], 0 offen
    v_add_u32 v14, 73728, v13
    buffer_load_dwordx4 v[44:47], v14, s[20:23], 0 offen
    s_waitcnt vmcnt(0) lgkmcnt(0)
    v_lshlrev_b32 v48, 16, v80
    v_and_b32 v49, 0xffff0000, v80
    v_lshlrev_b32 v50, 16, v32
    v_and_b32 v51, 0xffff0000, v32
    v_mul_f32 v48, v48, v50
    v_mul_f32 v49, v49, v51
    v_cvt_pk_bf16_f32 v80, v48, v49
    v_lshlrev_b32 v48, 16, v81
    v_and_b32 v49, 0xffff0000, v81
    v_lshlrev_b32 v50, 16, v33
    v_and_b32 v51, 0xffff0000, v33
    v_mul_f32 v48, v48, v50
    v_mul_f32 v49, v49, v51
    v_cvt_pk_bf16_f32 v81, v48, v49
    v_lshlrev_b32 v48, 16, v82
    v_and_b32 v49, 0xffff0000, v82
    v_lshlrev_b32 v50, 16, v34
    v_and_b32 v51, 0xffff0000, v34
    v_mul_f32 v48, v48, v50
    v_mul_f32 v49, v49, v51
    v_cvt_pk_bf16_f32 v82, v48, v49
    v_lshlrev_b32 v48, 16, v83
    v_and_b32 v49, 0xffff0000, v83
    v_lshlrev_b32 v50, 16, v35
    v_and_b32 v51, 0xffff0000, v35
    v_mul_f32 v48, v48, v50
    v_mul_f32 v49, v49, v51
    v_cvt_pk_bf16_f32 v83, v48, v49
    v_lshlrev_b32 v48, 16, v84
    v_and_b32 v49, 0xffff0000, v84
    v_lshlrev_b32 v50, 16, v36
    v_and_b32 v51, 0xffff0000, v36
    v_mul_f32 v48, v48, v50
    v_mul_f32 v49, v49, v51
    v_cvt_pk_bf16_f32 v84, v48, v49
    v_lshlrev_b32 v48, 16, v85
    v_and_b32 v49, 0xffff0000, v85
    v_lshlrev_b32 v50, 16, v37
    v_and_b32 v51, 0xffff0000, v37
    v_mul_f32 v48, v48, v50
    v_mul_f32 v49, v49, v51
    v_cvt_pk_bf16_f32 v85, v48, v49
    v_lshlrev_b32 v48, 16, v86
    v_and_b32 v49, 0xffff0000, v86
    v_lshlrev_b32 v50, 16, v38
    v_and_b32 v51, 0xffff0000, v38
    v_mul_f32 v48, v48, v50
    v_mul_f32 v49, v49, v51
    v_cvt_pk_bf16_f32 v86, v48, v49
    v_lshlrev_b32 v48, 16, v87
    v_and_b32 v49, 0xffff0000, v87
    v_lshlrev_b32 v50, 16, v39
    v_and_b32 v51, 0xffff0000, v39
    v_mul_f32 v48, v48, v50
    v_mul_f32 v49, v49, v51
    v_cvt_pk_bf16_f32 v87, v48, v49
    v_lshlrev_b32 v48, 16, v88
    v_and_b32 v49, 0xffff0000, v88
    v_lshlrev_b32 v50, 16, v40
    v_and_b32 v51, 0xffff0000, v40
    v_mul_f32 v48, v48, v50
    v_mul_f32 v49, v49, v51
    v_cvt_pk_bf16_f32 v88, v48, v49
    v_lshlrev_b32 v48, 16, v89
    v_and_b32 v49, 0xffff0000, v89
    v_lshlrev_b32 v50, 16, v41
    v_and_b32 v51, 0xffff0000, v41
    v_mul_f32 v48, v48, v50
    v_mul_f32 v49, v49, v51
    v_cvt_pk_bf16_f32 v89, v48, v49
    v_lshlrev_b32 v48, 16, v90
    v_and_b32 v49, 0xffff0000, v90
    v_lshlrev_b32 v50, 16, v42
    v_and_b32 v51, 0xffff0000, v42
    v_mul_f32 v48, v48, v50
    v_mul_f32 v49, v49, v51
    v_cvt_pk_bf16_f32 v90, v48, v49
    v_lshlrev_b32 v48, 16, v91
    v_and_b32 v49, 0xffff0000, v91
    v_lshlrev_b32 v50, 16, v43
    v_and_b32 v51, 0xffff0000, v43
    v_mul_f32 v48, v48, v50
    v_mul_f32 v49, v49, v51
    v_cvt_pk_bf16_f32 v91, v48, v49
    v_lshlrev_b32 v48, 16, v92
    v_and_b32 v49, 0xffff0000, v92
    v_lshlrev_b32 v50, 16, v44
    v_and_b32 v51, 0xffff0000, v44
    v_mul_f32 v48, v48, v50
    v_mul_f32 v49, v49, v51
    v_cvt_pk_bf16_f32 v92, v48, v49
    v_lshlrev_b32 v48, 16, v93
    v_and_b32 v49, 0xffff0000, v93
    v_lshlrev_b32 v50, 16, v45
    v_and_b32 v51, 0xffff0000, v45
    v_mul_f32 v48, v48, v50
    v_mul_f32 v49, v49, v51
    v_cvt_pk_bf16_f32 v93, v48, v49
    v_lshlrev_b32 v48, 16, v94
    v_and_b32 v49, 0xffff0000, v94
    v_lshlrev_b32 v50, 16, v46
    v_and_b32 v51, 0xffff0000, v46
    v_mul_f32 v48, v48, v50
    v_mul_f32 v49, v49, v51
    v_cvt_pk_bf16_f32 v94, v48, v49
    v_lshlrev_b32 v48, 16, v95
    v_and_b32 v49, 0xffff0000, v95
    v_lshlrev_b32 v50, 16, v47
    v_and_b32 v51, 0xffff0000, v47
    v_mul_f32 v48, v48, v50
    v_mul_f32 v49, v49, v51
    v_cvt_pk_bf16_f32 v95, v48, v49
    buffer_store_dwordx4 v[80:83], v12, s[16:19], 0 offen
    v_add_u32 v12, 12288, v12
    buffer_store_dwordx4 v[84:87], v12, s[16:19], 0 offen
    v_add_u32 v12, 12288, v12
    buffer_store_dwordx4 v[88:91], v12, s[16:19], 0 offen
    v_add_u32 v12, 12288, v12
    buffer_store_dwordx4 v[92:95], v12, s[16:19], 0 offen
Lend_sp_kernel_1:
    s_endpgm
Lloader_sp_kernel_2:
    v_subrev_u32 v0, 256, v0
    v_and_b32 v1, 63, v0
    s_sub_u32 s42, s41, 4
    v_lshrrev_b32 v3, 3, v1
    v_and_b32 v4, 7, v1
    v_xor_b32 v4, v4, v3
    s_mul_i32 s43, s42, 16
    s_add_u32 s43, s43, s27
    v_add_u32 v5, s43, v3
    v_mul_u32_u24 v5, 4096, v5
    v_lshl_add_u32 v8, v4, 4, v5
    v_add_u32 v9, 32768, v8
    v_lshrrev_b32 v3, 4, v1
    v_and_b32 v4, 15, v1
    v_lshrrev_b32 v5, 1, v4
    v_and_b32 v6, 1, v4
    s_mul_i32 s43, s42, 4
    s_add_u32 s44, s43, 0
    s_lshr_b32 s44, s44, 1
    s_and_b32 s44, s44, 1
    s_lshl_b32 s44, s44, 2
    v_add_u32 v7, s44, v3
    v_xor_b32 v7, v5, v7
    v_lshl_add_u32 v7, v7, 1, v6
    v_lshlrev_b32 v7, 4, v7
    s_add_u32 s44, s43, 0
    s_lshl_b32 s44, s44, 2
    v_add_u32 v12, s44, v3
    v_mul_u32_u24 v12, 1536, v12
    v_add_u32 v12, v12, v7
    v_lshl_add_u32 v12, s28, 1, v12
    s_add_u32 s44, s43, 1
    s_lshr_b32 s44, s44, 1
    s_and_b32 s44, s44, 1
    s_lshl_b32 s44, s44, 2
    v_add_u32 v7, s44, v3
    v_xor_b32 v7, v5, v7
    v_lshl_add_u32 v7, v7, 1, v6
    v_lshlrev_b32 v7, 4, v7
    s_add_u32 s44, s43, 1
    s_lshl_b32 s44, s44, 2
    v_add_u32 v13, s44, v3
    v_mul_u32_u24 v13, 1536, v13
    v_add_u32 v13, v13, v7
    v_lshl_add_u32 v13, s28, 1, v13
    s_add_u32 s44, s43, 2
    s_lshr_b32 s44, s44, 1
    s_and_b32 s44, s44, 1
    s_lshl_b32 s44, s44, 2
    v_add_u32 v7, s44, v3
    v_xor_b32 v7, v5, v7
    v_lshl_add_u32 v7, v7, 1, v6
    v_lshlrev_b32 v7, 4, v7
    s_add_u32 s44, s43, 2
    s_lshl_b32 s44, s44, 2
    v_add_u32 v14, s44, v3
    v_mul_u32_u24 v14, 1536, v14
    v_add_u32 v14, v14, v7
    v_lshl_add_u32 v14, s28, 1, v14
    s_add_u32 s44, s43, 3
    s_lshr_b32 s44, s44, 1
    s_and_b32 s44, s44, 1
    s_lshl_b32 s44, s44, 2
    v_add_u32 v7, s44, v3
    v_xor_b32 v7, v5, v7
    v_lshl_add_u32 v7, v7, 1, v6
    v_lshlrev_b32 v7, 4, v7
    s_add_u32 s44, s43, 3
    s_lshl_b32 s44, s44, 2
    v_add_u32 v15, s44, v3
    v_mul_u32_u24 v15, 1536, v15
    v_add_u32 v15, v15, v7
    v_lshl_add_u32 v15, s28, 1, v15
    s_mul_i32 s45, s42, 2048
    s_mul_i32 s46, s42, 4096
    s_add_u32 s46, s46, 8192
    s_mov_b32 s29, 0
    s_mov_b32 s30, 0
    s_add_u32 m0, s45, 0
    s_nop 0
    buffer_load_dwordx4 v8, s[8:11], s29 offen lds
    s_add_u32 m0, s45, 1024
    s_nop 0
    buffer_load_dwordx4 v9, s[8:11], s29 offen lds
    s_add_u32 m0, s46, 0
    s_nop 0
    buffer_load_dwordx4 v12, s[12:15], s30 offen lds
    s_add_u32 m0, s46, 1024
    s_nop 0
    buffer_load_dwordx4 v13, s[12:15], s30 offen lds
    s_add_u32 m0, s46, 2048
    s_nop 0
    buffer_load_dwordx4 v14, s[12:15], s30 offen lds
    s_add_u32 m0, s46, 3072
    s_nop 0
    buffer_load_dwordx4 v15, s[12:15], s30 offen lds
    s_add_u32 s29, s29, 128
    s_add_u32 s30, s30, 98304
    s_add_u32 m0, s45, 24576
    s_nop 0
    buffer_load_dwordx4 v8, s[8:11], s29 offen lds
    s_add_u32 m0, s45, 25600
    s_nop 0
    buffer_load_dwordx4 v9, s[8:11], s29 offen lds
    s_add_u32 m0, s46, 24576
    s_nop 0
    buffer_load_dwordx4 v12, s[12:15], s30 offen lds
    s_add_u32 m0, s46, 25600
    s_nop 0
    buffer_load_dwordx4 v13, s[12:15], s30 offen lds
    s_add_u32 m0, s46, 26624
    s_nop 0
    buffer_load_dwordx4 v14, s[12:15], s30 offen lds
    s_add_u32 m0, s46, 27648
    s_nop 0
    buffer_load_dwordx4 v15, s[12:15], s30 offen lds
    s_add_u32 s29, s29, 128
    s_add_u32 s30, s30, 98304
    s_add_u32 m0, s45, 49152
    s_nop 0
    buffer_load_dwordx4 v8, s[8:11], s29 offen lds
    s_add_u32 m0, s45, 50176
    s_nop 0
    buffer_load_dwordx4 v9, s[8:11], s29 offen lds
    s_add_u32 m0, s46, 49152
    s_nop 0
    buffer_load_dwordx4 v12, s[12:15], s30 offen lds
    s_add_u32 m0, s46, 50176
    s_nop 0
    buffer_load_dwordx4 v13, s[12:15], s30 offen lds
    s_add_u32 m0, s46, 51200
    s_nop 0
    buffer_load_dwordx4 v14, s[12:15], s30 offen lds
    s_add_u32 m0, s46, 52224
    s_nop 0
    buffer_load_dwordx4 v15, s[12:15], s30 offen lds
    s_add_u32 s29, s29, 128
    s_add_u32 s30, s30, 98304
    s_waitcnt vmcnt(6)
    s_barrier
    s_mov_b32 s31, 0
Llloop_sp_kernel_4:
    s_add_u32 m0, s45, 73728
    s_nop 0
    buffer_load_dwordx4 v8, s[8:11], s29 offen lds
    s_add_u32 m0, s45, 74752
    s_nop 0
    buffer_load_dwordx4 v9, s[8:11], s29 offen lds
    s_add_u32 m0, s46, 73728
    s_nop 0
    buffer_load_dwordx4 v12, s[12:15], s30 offen lds
    s_add_u32 m0, s46, 74752
    s_nop 0
    buffer_load_dwordx4 v13, s[12:15], s30 offen lds
    s_add_u32 m0, s46, 75776
    s_nop 0
    buffer_load_dwordx4 v14, s[12:15], s30 offen lds
    s_add_u32 m0, s46, 76800
    s_nop 0
    buffer_load_dwordx4 v15, s[12:15], s30 offen lds
    s_add_u32 s29, s29, 128
    s_add_u32 s30, s30, 98304
    s_waitcnt vmcnt(6)
    s_barrier
    s_add_u32 m0, s45, 0
    s_nop 0
    buffer_load_dwordx4 v8, s[8:11], s29 offen lds
    s_add_u32 m0, s45, 1024
    s_nop 0
    buffer_load_dwordx4 v9, s[8:11], s29 offen lds
    s_add_u32 m0, s46, 0
    s_nop 0
    buffer_load_dwordx4 v12, s[12:15], s30 offen lds
    s_add_u32 m0, s46, 1024
    s_nop 0
    buffer_load_dwordx4 v13, s[12:15], s30 offen lds
    s_add_u32 m0, s46, 2048
    s_nop 0
    buffer_load_dwordx4 v14, s[12:15], s30 offen lds
    s_add_u32 m0, s46, 3072
    s_nop 0
    buffer_load_dwordx4 v15, s[12:15], s30 offen lds
    s_add_u32 s29, s29, 128
    s_add_u32 s30, s30, 98304
    s_waitcnt vmcnt(6)
    s_barrier
    s_add_u32 m0, s45, 24576
    s_nop 0
    buffer_load_dwordx4 v8, s[8:11], s29 offen lds
    s_add_u32 m0, s45, 25600
    s_nop 0
    buffer_load_dwordx4 v9, s[8:11], s29 offen lds
    s_add_u32 m0, s46, 24576
    s_nop 0
    buffer_load_dwordx4 v12, s[12:15], s30 offen lds
    s_add_u32 m0, s46, 25600
    s_nop 0
    buffer_load_dwordx4 v13, s[12:15], s30 offen lds
    s_add_u32 m0, s46, 26624
    s_nop 0
    buffer_load_dwordx4 v14, s[12:15], s30 offen lds
    s_add_u32 m0, s46, 27648
    s_nop 0
    buffer_load_dwordx4 v15, s[12:15], s30 offen lds
    s_add_u32 s29, s29, 128
    s_add_u32 s30, s30, 98304
    s_waitcnt vmcnt(6)
    s_barrier
    s_add_u32 m0, s45, 49152
    s_nop 0
    buffer_load_dwordx4 v8, s[8:11], s29 offen lds
    s_add_u32 m0, s45, 50176
    s_nop 0
    buffer_load_dwordx4 v9, s[8:11], s29 offen lds
    s_add_u32 m0, s46, 49152
    s_nop 0
    buffer_load_dwordx4 v12, s[12:15], s30 offen lds
    s_add_u32 m0, s46, 50176
    s_nop 0
    buffer_load_dwordx4 v13, s[12:15], s30 offen lds
    s_add_u32 m0, s46, 51200
    s_nop 0
    buffer_load_dwordx4 v14, s[12:15], s30 offen lds
    s_add_u32 m0, s46, 52224
    s_nop 0
    buffer_load_dwordx4 v15, s[12:15], s30 offen lds
    s_add_u32 s29, s29, 128
    s_add_u32 s30, s30, 98304
    s_waitcnt vmcnt(6)
    s_barrier
    s_add_u32 s31, s31, 1
    s_cmp_lt_u32 s31, 7
    s_cbranch_scc1 Llloop_sp_kernel_4
    s_add_u32 m0, s45, 73728
    s_nop 0
    buffer_load_dwordx4 v8, s[8:11], s29 offen lds
    s_add_u32 m0, s45, 74752
    s_nop 0
    buffer_load_dwordx4 v9, s[8:11], s29 offen lds
    s_add_u32 m0, s46, 73728
    s_nop 0
    buffer_load_dwordx4 v12, s[12:15], s30 offen lds
    s_add_u32 m0, s46, 74752
    s_nop 0
    buffer_load_dwordx4 v13, s[12:15], s30 offen lds
    s_add_u32 m0, s46, 75776
    s_nop 0
    buffer_load_dwordx4 v14, s[12:15], s30 offen lds
    s_add_u32 m0, s46, 76800
    s_nop 0
    buffer_load_dwordx4 v15, s[12:15], s30 offen lds
    s_add_u32 s29, s29, 128
    s_add_u32 s30, s30, 98304
    s_waitcnt vmcnt(6)
    s_barrier
    s_waitcnt vmcnt(0)
    s_barrier
    s_waitcnt vmcnt(0)
    s_barrier
    s_waitcnt vmcnt(0)
    s_barrier
    s_endpgm
.section .rodata,"a"
.p2align 6
.amdhsa_kernel sp_kernel
  .amdhsa_next_free_vgpr 112
  .amdhsa_next_free_sgpr 56
  .amdhsa_accum_offset 112
  .amdhsa_group_segment_fixed_size 0
  .amdhsa_kernarg_size 96
  .amdhsa_user_sgpr_count 2
  .amdhsa_user_sgpr_kernarg_segment_ptr 1
  .amdhsa_system_sgpr_workgroup_id_x 1
.end_amdhsa_kernel
.text

.globl wout0_kernel
.p2align 8
.type wout0_kernel,@function
wout0_kernel:
    s_cmp_ge_u32 s2, 160
    s_cbranch_scc1 Lend_wout0_kernel_1
    s_load_dwordx2 s[4:5], s[0:1], 88
    s_load_dwordx2 s[6:7], s[0:1], 64
    s_load_dwordx2 s[24:25], s[0:1], 88
    s_and_b32 s26, s2, 7
    s_lshr_b32 s27, s2, 3
    s_mul_i32 s26, s26, 20
    s_add_u32 s26, s26, s27
    s_mul_hi_u32 s27, s26, 858993460
    s_mul_i32 s28, s27, 5
    s_sub_u32 s28, s26, s28
    s_mul_i32 s27, s27, 64
    s_mul_i32 s28, s28, 128
    s_waitcnt lgkmcnt(0)
    s_add_u32 s8, s4, 25165824
    s_addc_u32 s9, s5, 0
    s_mov_b32 s10, 3145728
    s_mov_b32 s11, 0x00020000
    s_mov_b32 s12, s6
    s_mov_b32 s13, s7
    s_mov_b32 s14, 983040
    s_mov_b32 s15, 0x00020000
    s_mov_b32 s16, s24
    s_mov_b32 s17, s25
    s_mov_b32 s18, 2621440
    s_mov_b32 s19, 0x00020000
    v_and_b32 v1, 63, v0
    v_lshrrev_b32 v2, 6, v0
    s_nop 0
    v_readfirstlane_b32 s41, v2
    s_nop 3
    s_cmp_ge_u32 s41, 4
    s_cbranch_scc1 Lloader_wout0_kernel_2
    v_lshrrev_b32 v3, 1, v2
    v_and_b32 v4, 1, v2
    v_lshrrev_b32 v5, 4, v1
    v_and_b32 v6, 15, v1
    v_mul_u32_u24 v7, 32, v3
    v_add_u32 v7, v7, v6
    v_lshlrev_b32 v7, 7, v7
    v_add_u32 v18, 0, v5
    v_and_b32 v3, 7, v6
    v_xor_b32 v18, v18, v3
    v_lshl_add_u32 v18, v18, 4, v7
    v_add_u32 v26, 49152, v18
    v_add_u32 v19, 4, v5
    v_and_b32 v3, 7, v6
    v_xor_b32 v19, v19, v3
    v_lshl_add_u32 v19, v19, 4, v7
    v_add_u32 v27, 49152, v19
    v_lshrrev_b32 v3, 2, v6
    v_and_b32 v7, 1, v5
    v_lshl_add_u32 v7, v7, 2, v3
    v_lshl_add_u32 v32, v5, 3, v3
    v_lshlrev_b32 v32, 8, v32
    v_and_b32 v33, 3, v6
    v_lshl_add_u32 v32, v33, 3, v32
    v_lshlrev_b32 v33, 2, v4
    v_add_u32 v34, 0, v33
    v_xor_b32 v34, v34, v7
    v_lshl_add_u32 v20, v34, 5, v32
    v_add_u32 v28, 49152, v20
    v_add_u32 v34, 1, v33
    v_xor_b32 v34, v34, v7
    v_lshl_add_u32 v21, v34, 5, v32
    v_add_u32 v29, 49152, v21
    v_add_u32 v34, 2, v33
    v_xor_b32 v34, v34, v7
    v_lshl_add_u32 v22, v34, 5, v32
    v_add_u32 v30, 49152, v22
    v_add_u32 v34, 3, v33
    v_xor_b32 v34, v34, v7
    v_lshl_add_u32 v23, v34, 5, v32
    v_add_u32 v31, 49152, v23
    v_mov_b32 v80, 0
    v_mov_b32 v81, 0
    v_mov_b32 v82, 0
    v_mov_b32 v83, 0
    v_mov_b32 v84, 0
    v_mov_b32 v85, 0
    v_mov_b32 v86, 0
    v_mov_b32 v87, 0
    v_mov_b32 v88, 0
    v_mov_b32 v89, 0
    v_mov_b32 v90, 0
    v_mov_b32 v91, 0
    v_mov_b32 v92, 0
    v_mov_b32 v93, 0
    v_mov_b32 v94, 0
    v_mov_b32 v95, 0
    v_mov_b32 v96, 0
    v_mov_b32 v97, 0
    v_mov_b32 v98, 0
    v_mov_b32 v99, 0
    v_mov_b32 v100, 0
    v_mov_b32 v101, 0
    v_mov_b32 v102, 0
    v_mov_b32 v103, 0
    v_mov_b32 v104, 0
    v_mov_b32 v105, 0
    v_mov_b32 v106, 0
    v_mov_b32 v107, 0
    v_mov_b32 v108, 0
    v_mov_b32 v109, 0
    v_mov_b32 v110, 0
    v_mov_b32 v111, 0
    s_barrier
    ds_read_b128 v[32:35], v18 offset:0
    ds_read_b128 v[36:39], v18 offset:2048
    ds_read_b64_tr_b16 v[48:49], v20 offset:8192
    ds_read_b64_tr_b16 v[50:51], v20 offset:9216
    ds_read_b64_tr_b16 v[52:53], v21 offset:8192
    ds_read_b64_tr_b16 v[54:55], v21 offset:9216
    ds_read_b64_tr_b16 v[56:57], v22 offset:8192
    ds_read_b64_tr_b16 v[58:59], v22 offset:9216
    ds_read_b64_tr_b16 v[60:61], v23 offset:8192
    ds_read_b64_tr_b16 v[62:63], v23 offset:9216
    s_mov_b32 s31, 0
Lcloop_wout0_kernel_3:
    s_waitcnt lgkmcnt(0)
    v_mfma_f32_16x16x32_bf16 v[80:83], v[48:51], v[32:35], v[80:83]
    ds_read_b128 v[40:43], v19 offset:0
    v_mfma_f32_16x16x32_bf16 v[84:87], v[52:55], v[32:35], v[84:87]
    ds_read_b128 v[44:47], v19 offset:2048
    v_mfma_f32_16x16x32_bf16 v[88:91], v[56:59], v[32:35], v[88:91]
    ds_read_b64_tr_b16 v[64:65], v20 offset:16384
    v_mfma_f32_16x16x32_bf16 v[92:95], v[60:63], v[32:35], v[92:95]
    ds_read_b64_tr_b16 v[66:67], v20 offset:17408
    ds_read_b64_tr_b16 v[68:69], v21 offset:16384
    v_mfma_f32_16x16x32_bf16 v[96:99], v[48:51], v[36:39], v[96:99]
    ds_read_b64_tr_b16 v[70:71], v21 offset:17408
    v_mfma_f32_16x16x32_bf16 v[100:103], v[52:55], v[36:39], v[100:103]
    ds_read_b64_tr_b16 v[72:73], v22 offset:16384
    v_mfma_f32_16x16x32_bf16 v[104:107], v[56:59], v[36:39], v[104:107]
    ds_read_b64_tr_b16 v[74:75], v22 offset:17408
    v_mfma_f32_16x16x32_bf16 v[108:111], v[60:63], v[36:39], v[108:111]
    ds_read_b64_tr_b16 v[76:77], v23 offset:16384
    ds_read_b64_tr_b16 v[78:79], v23 offset:17408
    s_waitcnt lgkmcnt(0)
    v_mfma_f32_16x16x32_bf16 v[80:83], v[64:67], v[40:43], v[80:83]
    ds_read_b128 v[32:35], v18 offset:24576
    v_mfma_f32_16x16x32_bf16 v[84:87], v[68:71], v[40:43], v[84:87]
    ds_read_b128 v[36:39], v18 offset:26624
    v_mfma_f32_16x16x32_bf16 v[88:91], v[72:75], v[40:43], v[88:91]
    ds_read_b64_tr_b16 v[48:49], v20 offset:32768
    v_mfma_f32_16x16x32_bf16 v[92:95], v[76:79], v[40:43], v[92:95]
    ds_read_b64_tr_b16 v[50:51], v20 offset:33792
    ds_read_b64_tr_b16 v[52:53], v21 offset:32768
    v_mfma_f32_16x16x32_bf16 v[96:99], v[64:67], v[44:47], v[96:99]
    ds_read_b64_tr_b16 v[54:55], v21 offset:33792
    v_mfma_f32_16x16x32_bf16 v[100:103], v[68:71], v[44:47], v[100:103]
    ds_read_b64_tr_b16 v[56:57], v22 offset:32768
    v_mfma_f32_16x16x32_bf16 v[104:107], v[72:75], v[44:47], v[104:107]
    ds_read_b64_tr_b16 v[58:59], v22 offset:33792
    v_mfma_f32_16x16x32_bf16 v[108:111], v[76:79], v[44:47], v[108:111]
    ds_read_b64_tr_b16 v[60:61], v23 offset:32768
    ds_read_b64_tr_b16 v[62:63], v23 offset:33792
    s_barrier
    s_waitcnt lgkmcnt(0)
    v_mfma_f32_16x16x32_bf16 v[80:83], v[48:51], v[32:35], v[80:83]
    ds_read_b128 v[40:43], v19 offset:24576
    v_mfma_f32_16x16x32_bf16 v[84:87], v[52:55], v[32:35], v[84:87]
    ds_read_b128 v[44:47], v19 offset:26624
    v_mfma_f32_16x16x32_bf16 v[88:91], v[56:59], v[32:35], v[88:91]
    ds_read_b64_tr_b16 v[64:65], v20 offset:40960
    v_mfma_f32_16x16x32_bf16 v[92:95], v[60:63], v[32:35], v[92:95]
    ds_read_b64_tr_b16 v[66:67], v20 offset:41984
    ds_read_b64_tr_b16 v[68:69], v21 offset:40960
    v_mfma_f32_16x16x32_bf16 v[96:99], v[48:51], v[36:39], v[96:99]
    ds_read_b64_tr_b16 v[70:71], v21 offset:41984
    v_mfma_f32_16x16x32_bf16 v[100:103], v[52:55], v[36:39], v[100:103]
    ds_read_b64_tr_b16 v[72:73], v22 offset:40960
    v_mfma_f32_16x16x32_bf16 v[104:107], v[56:59], v[36:39], v[104:107]
    ds_read_b64_tr_b16 v[74:75], v22 offset:41984
    v_mfma_f32_16x16x32_bf16 v[108:111], v[60:63], v[36:39], v[108:111]
    ds_read_b64_tr_b16 v[76:77], v23 offset:40960
    ds_read_b64_tr_b16 v[78:79], v23 offset:41984
    s_waitcnt lgkmcnt(0)
    v_mfma_f32_16x16x32_bf16 v[80:83], v[64:67], v[40:43], v[80:83]
    ds_read_b128 v[32:35], v26 offset:0
    v_mfma_f32_16x16x32_bf16 v[84:87], v[68:71], v[40:43], v[84:87]
    ds_read_b128 v[36:39], v26 offset:2048
    v_mfma_f32_16x16x32_bf16 v[88:91], v[72:75], v[40:43], v[88:91]
    ds_read_b64_tr_b16 v[48:49], v28 offset:8192
    v_mfma_f32_16x16x32_bf16 v[92:95], v[76:79], v[40:43], v[92:95]
    ds_read_b64_tr_b16 v[50:51], v28 offset:9216
    ds_read_b64_tr_b16 v[52:53], v29 offset:8192
    v_mfma_f32_16x16x32_bf16 v[96:99], v[64:67], v[44:47], v[96:99]
    ds_read_b64_tr_b16 v[54:55], v29 offset:9216
    v_mfma_f32_16x16x32_bf16 v[100:103], v[68:71], v[44:47], v[100:103]
    ds_read_b64_tr_b16 v[56:57], v30 offset:8192
    v_mfma_f32_16x16x32_bf16 v[104:107], v[72:75], v[44:47], v[104:107]
    ds_read_b64_tr_b16 v[58:59], v30 offset:9216
    v_mfma_f32_16x16x32_bf16 v[108:111], v[76:79], v[44:47], v[108:111]
    ds_read_b64_tr_b16 v[60:61], v31 offset:8192
    ds_read_b64_tr_b16 v[62:63], v31 offset:9216
    s_barrier
    s_waitcnt lgkmcnt(0)
    v_mfma_f32_16x16x32_bf16 v[80:83], v[48:51], v[32:35], v[80:83]
    ds_read_b128 v[40:43], v27 offset:0
    v_mfma_f32_16x16x32_bf16 v[84:87], v[52:55], v[32:35], v[84:87]
    ds_read_b128 v[44:47], v27 offset:2048
    v_mfma_f32_16x16x32_bf16 v[88:91], v[56:59], v[32:35], v[88:91]
    ds_read_b64_tr_b16 v[64:65], v28 offset:16384
    v_mfma_f32_16x16x32_bf16 v[92:95], v[60:63], v[32:35], v[92:95]
    ds_read_b64_tr_b16 v[66:67], v28 offset:17408
    ds_read_b64_tr_b16 v[68:69], v29 offset:16384
    v_mfma_f32_16x16x32_bf16 v[96:99], v[48:51], v[36:39], v[96:99]
    ds_read_b64_tr_b16 v[70:71], v29 offset:17408
    v_mfma_f32_16x16x32_bf16 v[100:103], v[52:55], v[36:39], v[100:103]
    ds_read_b64_tr_b16 v[72:73], v30 offset:16384
    v_mfma_f32_16x16x32_bf16 v[104:107], v[56:59], v[36:39], v[104:107]
    ds_read_b64_tr_b16 v[74:75], v30 offset:17408
    v_mfma_f32_16x16x32_bf16 v[108:111], v[60:63], v[36:39], v[108:111]
    ds_read_b64_tr_b16 v[76:77], v31 offset:16384
    ds_read_b64_tr_b16 v[78:79], v31 offset:17408
    s_waitcnt lgkmcnt(0)
    v_mfma_f32_16x16x32_bf16 v[80:83], v[64:67], v[40:43], v[80:83]
    ds_read_b128 v[32:35], v26 offset:24576
    v_mfma_f32_16x16x32_bf16 v[84:87], v[68:71], v[40:43], v[84:87]
    ds_read_b128 v[36:39], v26 offset:26624
    v_mfma_f32_16x16x32_bf16 v[88:91], v[72:75], v[40:43], v[88:91]
    ds_read_b64_tr_b16 v[48:49], v28 offset:32768
    v_mfma_f32_16x16x32_bf16 v[92:95], v[76:79], v[40:43], v[92:95]
    ds_read_b64_tr_b16 v[50:51], v28 offset:33792
    ds_read_b64_tr_b16 v[52:53], v29 offset:32768
    v_mfma_f32_16x16x32_bf16 v[96:99], v[64:67], v[44:47], v[96:99]
    ds_read_b64_tr_b16 v[54:55], v29 offset:33792
    v_mfma_f32_16x16x32_bf16 v[100:103], v[68:71], v[44:47], v[100:103]
    ds_read_b64_tr_b16 v[56:57], v30 offset:32768
    v_mfma_f32_16x16x32_bf16 v[104:107], v[72:75], v[44:47], v[104:107]
    ds_read_b64_tr_b16 v[58:59], v30 offset:33792
    v_mfma_f32_16x16x32_bf16 v[108:111], v[76:79], v[44:47], v[108:111]
    ds_read_b64_tr_b16 v[60:61], v31 offset:32768
    ds_read_b64_tr_b16 v[62:63], v31 offset:33792
    s_barrier
    s_waitcnt lgkmcnt(0)
    v_mfma_f32_16x16x32_bf16 v[80:83], v[48:51], v[32:35], v[80:83]
    ds_read_b128 v[40:43], v27 offset:24576
    v_mfma_f32_16x16x32_bf16 v[84:87], v[52:55], v[32:35], v[84:87]
    ds_read_b128 v[44:47], v27 offset:26624
    v_mfma_f32_16x16x32_bf16 v[88:91], v[56:59], v[32:35], v[88:91]
    ds_read_b64_tr_b16 v[64:65], v28 offset:40960
    v_mfma_f32_16x16x32_bf16 v[92:95], v[60:63], v[32:35], v[92:95]
    ds_read_b64_tr_b16 v[66:67], v28 offset:41984
    ds_read_b64_tr_b16 v[68:69], v29 offset:40960
    v_mfma_f32_16x16x32_bf16 v[96:99], v[48:51], v[36:39], v[96:99]
    ds_read_b64_tr_b16 v[70:71], v29 offset:41984
    v_mfma_f32_16x16x32_bf16 v[100:103], v[52:55], v[36:39], v[100:103]
    ds_read_b64_tr_b16 v[72:73], v30 offset:40960
    v_mfma_f32_16x16x32_bf16 v[104:107], v[56:59], v[36:39], v[104:107]
    ds_read_b64_tr_b16 v[74:75], v30 offset:41984
    v_mfma_f32_16x16x32_bf16 v[108:111], v[60:63], v[36:39], v[108:111]
    ds_read_b64_tr_b16 v[76:77], v31 offset:40960
    ds_read_b64_tr_b16 v[78:79], v31 offset:41984
    s_waitcnt lgkmcnt(0)
    v_mfma_f32_16x16x32_bf16 v[80:83], v[64:67], v[40:43], v[80:83]
    ds_read_b128 v[32:35], v18 offset:0
    v_mfma_f32_16x16x32_bf16 v[84:87], v[68:71], v[40:43], v[84:87]
    ds_read_b128 v[36:39], v18 offset:2048
    v_mfma_f32_16x16x32_bf16 v[88:91], v[72:75], v[40:43], v[88:91]
    ds_read_b64_tr_b16 v[48:49], v20 offset:8192
    v_mfma_f32_16x16x32_bf16 v[92:95], v[76:79], v[40:43], v[92:95]
    ds_read_b64_tr_b16 v[50:51], v20 offset:9216
    ds_read_b64_tr_b16 v[52:53], v21 offset:8192
    v_mfma_f32_16x16x32_bf16 v[96:99], v[64:67], v[44:47], v[96:99]
    ds_read_b64_tr_b16 v[54:55], v21 offset:9216
    v_mfma_f32_16x16x32_bf16 v[100:103], v[68:71], v[44:47], v[100:103]
    ds_read_b64_tr_b16 v[56:57], v22 offset:8192
    v_mfma_f32_16x16x32_bf16 v[104:107], v[72:75], v[44:47], v[104:107]
    ds_read_b64_tr_b16 v[58:59], v22 offset:9216
    v_mfma_f32_16x16x32_bf16 v[108:111], v[76:79], v[44:47], v[108:111]
    ds_read_b64_tr_b16 v[60:61], v23 offset:8192
    ds_read_b64_tr_b16 v[62:63], v23 offset:9216
    s_barrier
    s_add_u32 s31, s31, 1
    s_cmp_lt_u32 s31, 2
    s_cbranch_scc1 Lcloop_wout0_kernel_3
    s_waitcnt lgkmcnt(0)
    v_mfma_f32_16x16x32_bf16 v[80:83], v[48:51], v[32:35], v[80:83]
    ds_read_b128 v[40:43], v19 offset:0
    v_mfma_f32_16x16x32_bf16 v[84:87], v[52:55], v[32:35], v[84:87]
    ds_read_b128 v[44:47], v19 offset:2048
    v_mfma_f32_16x16x32_bf16 v[88:91], v[56:59], v[32:35], v[88:91]
    ds_read_b64_tr_b16 v[64:65], v20 offset:16384
    v_mfma_f32_16x16x32_bf16 v[92:95], v[60:63], v[32:35], v[92:95]
    ds_read_b64_tr_b16 v[66:67], v20 offset:17408
    ds_read_b64_tr_b16 v[68:69], v21 offset:16384
    v_mfma_f32_16x16x32_bf16 v[96:99], v[48:51], v[36:39], v[96:99]
    ds_read_b64_tr_b16 v[70:71], v21 offset:17408
    v_mfma_f32_16x16x32_bf16 v[100:103], v[52:55], v[36:39], v[100:103]
    ds_read_b64_tr_b16 v[72:73], v22 offset:16384
    v_mfma_f32_16x16x32_bf16 v[104:107], v[56:59], v[36:39], v[104:107]
    ds_read_b64_tr_b16 v[74:75], v22 offset:17408
    v_mfma_f32_16x16x32_bf16 v[108:111], v[60:63], v[36:39], v[108:111]
    ds_read_b64_tr_b16 v[76:77], v23 offset:16384
    ds_read_b64_tr_b16 v[78:79], v23 offset:17408
    s_waitcnt lgkmcnt(0)
    v_mfma_f32_16x16x32_bf16 v[80:83], v[64:67], v[40:43], v[80:83]
    ds_read_b128 v[32:35], v18 offset:24576
    v_mfma_f32_16x16x32_bf16 v[84:87], v[68:71], v[40:43], v[84:87]
    ds_read_b128 v[36:39], v18 offset:26624
    v_mfma_f32_16x16x32_bf16 v[88:91], v[72:75], v[40:43], v[88:91]
    ds_read_b64_tr_b16 v[48:49], v20 offset:32768
    v_mfma_f32_16x16x32_bf16 v[92:95], v[76:79], v[40:43], v[92:95]
    ds_read_b64_tr_b16 v[50:51], v20 offset:33792
    ds_read_b64_tr_b16 v[52:53], v21 offset:32768
    v_mfma_f32_16x16x32_bf16 v[96:99], v[64:67], v[44:47], v[96:99]
    ds_read_b64_tr_b16 v[54:55], v21 offset:33792
    v_mfma_f32_16x16x32_bf16 v[100:103], v[68:71], v[44:47], v[100:103]
    ds_read_b64_tr_b16 v[56:57], v22 offset:32768
    v_mfma_f32_16x16x32_bf16 v[104:107], v[72:75], v[44:47], v[104:107]
    ds_read_b64_tr_b16 v[58:59], v22 offset:33792
    v_mfma_f32_16x16x32_bf16 v[108:111], v[76:79], v[44:47], v[108:111]
    ds_read_b64_tr_b16 v[60:61], v23 offset:32768
    ds_read_b64_tr_b16 v[62:63], v23 offset:33792
    s_barrier
    s_waitcnt lgkmcnt(0)
    v_mfma_f32_16x16x32_bf16 v[80:83], v[48:51], v[32:35], v[80:83]
    ds_read_b128 v[40:43], v19 offset:24576
    v_mfma_f32_16x16x32_bf16 v[84:87], v[52:55], v[32:35], v[84:87]
    ds_read_b128 v[44:47], v19 offset:26624
    v_mfma_f32_16x16x32_bf16 v[88:91], v[56:59], v[32:35], v[88:91]
    ds_read_b64_tr_b16 v[64:65], v20 offset:40960
    v_mfma_f32_16x16x32_bf16 v[92:95], v[60:63], v[32:35], v[92:95]
    ds_read_b64_tr_b16 v[66:67], v20 offset:41984
    ds_read_b64_tr_b16 v[68:69], v21 offset:40960
    v_mfma_f32_16x16x32_bf16 v[96:99], v[48:51], v[36:39], v[96:99]
    ds_read_b64_tr_b16 v[70:71], v21 offset:41984
    v_mfma_f32_16x16x32_bf16 v[100:103], v[52:55], v[36:39], v[100:103]
    ds_read_b64_tr_b16 v[72:73], v22 offset:40960
    v_mfma_f32_16x16x32_bf16 v[104:107], v[56:59], v[36:39], v[104:107]
    ds_read_b64_tr_b16 v[74:75], v22 offset:41984
    v_mfma_f32_16x16x32_bf16 v[108:111], v[60:63], v[36:39], v[108:111]
    ds_read_b64_tr_b16 v[76:77], v23 offset:40960
    ds_read_b64_tr_b16 v[78:79], v23 offset:41984
    s_waitcnt lgkmcnt(0)
    v_mfma_f32_16x16x32_bf16 v[80:83], v[64:67], v[40:43], v[80:83]
    ds_read_b128 v[32:35], v26 offset:0
    v_mfma_f32_16x16x32_bf16 v[84:87], v[68:71], v[40:43], v[84:87]
    ds_read_b128 v[36:39], v26 offset:2048
    v_mfma_f32_16x16x32_bf16 v[88:91], v[72:75], v[40:43], v[88:91]
    ds_read_b64_tr_b16 v[48:49], v28 offset:8192
    v_mfma_f32_16x16x32_bf16 v[92:95], v[76:79], v[40:43], v[92:95]
    ds_read_b64_tr_b16 v[50:51], v28 offset:9216
    ds_read_b64_tr_b16 v[52:53], v29 offset:8192
    v_mfma_f32_16x16x32_bf16 v[96:99], v[64:67], v[44:47], v[96:99]
    ds_read_b64_tr_b16 v[54:55], v29 offset:9216
    v_mfma_f32_16x16x32_bf16 v[100:103], v[68:71], v[44:47], v[100:103]
    ds_read_b64_tr_b16 v[56:57], v30 offset:8192
    v_mfma_f32_16x16x32_bf16 v[104:107], v[72:75], v[44:47], v[104:107]
    ds_read_b64_tr_b16 v[58:59], v30 offset:9216
    v_mfma_f32_16x16x32_bf16 v[108:111], v[76:79], v[44:47], v[108:111]
    ds_read_b64_tr_b16 v[60:61], v31 offset:8192
    ds_read_b64_tr_b16 v[62:63], v31 offset:9216
    s_barrier
    s_waitcnt lgkmcnt(0)
    v_mfma_f32_16x16x32_bf16 v[80:83], v[48:51], v[32:35], v[80:83]
    ds_read_b128 v[40:43], v27 offset:0
    v_mfma_f32_16x16x32_bf16 v[84:87], v[52:55], v[32:35], v[84:87]
    ds_read_b128 v[44:47], v27 offset:2048
    v_mfma_f32_16x16x32_bf16 v[88:91], v[56:59], v[32:35], v[88:91]
    ds_read_b64_tr_b16 v[64:65], v28 offset:16384
    v_mfma_f32_16x16x32_bf16 v[92:95], v[60:63], v[32:35], v[92:95]
    ds_read_b64_tr_b16 v[66:67], v28 offset:17408
    ds_read_b64_tr_b16 v[68:69], v29 offset:16384
    v_mfma_f32_16x16x32_bf16 v[96:99], v[48:51], v[36:39], v[96:99]
    ds_read_b64_tr_b16 v[70:71], v29 offset:17408
    v_mfma_f32_16x16x32_bf16 v[100:103], v[52:55], v[36:39], v[100:103]
    ds_read_b64_tr_b16 v[72:73], v30 offset:16384
    v_mfma_f32_16x16x32_bf16 v[104:107], v[56:59], v[36:39], v[104:107]
    ds_read_b64_tr_b16 v[74:75], v30 offset:17408
    v_mfma_f32_16x16x32_bf16 v[108:111], v[60:63], v[36:39], v[108:111]
    ds_read_b64_tr_b16 v[76:77], v31 offset:16384
    ds_read_b64_tr_b16 v[78:79], v31 offset:17408
    s_waitcnt lgkmcnt(0)
    v_mfma_f32_16x16x32_bf16 v[80:83], v[64:67], v[40:43], v[80:83]
    ds_read_b128 v[32:35], v26 offset:24576
    v_mfma_f32_16x16x32_bf16 v[84:87], v[68:71], v[40:43], v[84:87]
    ds_read_b128 v[36:39], v26 offset:26624
    v_mfma_f32_16x16x32_bf16 v[88:91], v[72:75], v[40:43], v[88:91]
    ds_read_b64_tr_b16 v[48:49], v28 offset:32768
    v_mfma_f32_16x16x32_bf16 v[92:95], v[76:79], v[40:43], v[92:95]
    ds_read_b64_tr_b16 v[50:51], v28 offset:33792
    ds_read_b64_tr_b16 v[52:53], v29 offset:32768
    v_mfma_f32_16x16x32_bf16 v[96:99], v[64:67], v[44:47], v[96:99]
    ds_read_b64_tr_b16 v[54:55], v29 offset:33792
    v_mfma_f32_16x16x32_bf16 v[100:103], v[68:71], v[44:47], v[100:103]
    ds_read_b64_tr_b16 v[56:57], v30 offset:32768
    v_mfma_f32_16x16x32_bf16 v[104:107], v[72:75], v[44:47], v[104:107]
    ds_read_b64_tr_b16 v[58:59], v30 offset:33792
    v_mfma_f32_16x16x32_bf16 v[108:111], v[76:79], v[44:47], v[108:111]
    ds_read_b64_tr_b16 v[60:61], v31 offset:32768
    ds_read_b64_tr_b16 v[62:63], v31 offset:33792
    s_barrier
    s_waitcnt lgkmcnt(0)
    v_mfma_f32_16x16x32_bf16 v[80:83], v[48:51], v[32:35], v[80:83]
    ds_read_b128 v[40:43], v27 offset:24576
    v_mfma_f32_16x16x32_bf16 v[84:87], v[52:55], v[32:35], v[84:87]
    ds_read_b128 v[44:47], v27 offset:26624
    v_mfma_f32_16x16x32_bf16 v[88:91], v[56:59], v[32:35], v[88:91]
    ds_read_b64_tr_b16 v[64:65], v28 offset:40960
    v_mfma_f32_16x16x32_bf16 v[92:95], v[60:63], v[32:35], v[92:95]
    ds_read_b64_tr_b16 v[66:67], v28 offset:41984
    ds_read_b64_tr_b16 v[68:69], v29 offset:40960
    v_mfma_f32_16x16x32_bf16 v[96:99], v[48:51], v[36:39], v[96:99]
    ds_read_b64_tr_b16 v[70:71], v29 offset:41984
    v_mfma_f32_16x16x32_bf16 v[100:103], v[52:55], v[36:39], v[100:103]
    ds_read_b64_tr_b16 v[72:73], v30 offset:40960
    v_mfma_f32_16x16x32_bf16 v[104:107], v[56:59], v[36:39], v[104:107]
    ds_read_b64_tr_b16 v[74:75], v30 offset:41984
    v_mfma_f32_16x16x32_bf16 v[108:111], v[60:63], v[36:39], v[108:111]
    ds_read_b64_tr_b16 v[76:77], v31 offset:40960
    ds_read_b64_tr_b16 v[78:79], v31 offset:41984
    s_waitcnt lgkmcnt(0)
    v_mfma_f32_16x16x32_bf16 v[80:83], v[64:67], v[40:43], v[80:83]
    v_mfma_f32_16x16x32_bf16 v[84:87], v[68:71], v[40:43], v[84:87]
    v_mfma_f32_16x16x32_bf16 v[88:91], v[72:75], v[40:43], v[88:91]
    v_mfma_f32_16x16x32_bf16 v[92:95], v[76:79], v[40:43], v[92:95]
    v_mfma_f32_16x16x32_bf16 v[96:99], v[64:67], v[44:47], v[96:99]
    v_mfma_f32_16x16x32_bf16 v[100:103], v[68:71], v[44:47], v[100:103]
    v_mfma_f32_16x16x32_bf16 v[104:107], v[72:75], v[44:47], v[104:107]
    v_mfma_f32_16x16x32_bf16 v[108:111], v[76:79], v[44:47], v[108:111]
    s_barrier
    s_nop 7
    s_nop 7
    v_lshrrev_b32 v3, 1, v2
    v_and_b32 v4, 1, v2
    v_lshrrev_b32 v5, 4, v1
    v_and_b32 v6, 15, v1
    v_mul_u32_u24 v7, 4608, v2
    v_mul_u32_u24 v8, 144, v6
    v_add_u32 v7, v7, v8
    v_lshl_add_u32 v7, v5, 3, v7
    v_cvt_pk_bf16_f32 v32, v80, v81
    v_cvt_pk_bf16_f32 v33, v82, v83
    ds_write_b64 v7, v[32:33] offset:0
    v_cvt_pk_bf16_f32 v40, v84, v85
    v_cvt_pk_bf16_f32 v41, v86, v87
    ds_write_b64 v7, v[40:41] offset:32
    v_cvt_pk_bf16_f32 v48, v88, v89
    v_cvt_pk_bf16_f32 v49, v90, v91
    ds_write_b64 v7, v[48:49] offset:64
    v_cvt_pk_bf16_f32 v56, v92, v93
    v_cvt_pk_bf16_f32 v57, v94, v95
    ds_write_b64 v7, v[56:57] offset:96
    v_cvt_pk_bf16_f32 v32, v96, v97
    v_cvt_pk_bf16_f32 v33, v98, v99
    ds_write_b64 v7, v[32:33] offset:2304
    v_cvt_pk_bf16_f32 v40, v100, v101
    v_cvt_pk_bf16_f32 v41, v102, v103
    ds_write_b64 v7, v[40:41] offset:2336
    v_cvt_pk_bf16_f32 v48, v104, v105
    v_cvt_pk_bf16_f32 v49, v106, v107
    ds_write_b64 v7, v[48:49] offset:2368
    v_cvt_pk_bf16_f32 v56, v108, v109
    v_cvt_pk_bf16_f32 v57, v110, v111
    ds_write_b64 v7, v[56:57] offset:2400
    s_waitcnt lgkmcnt(0)
    v_lshrrev_b32 v8, 3, v1
    v_and_b32 v9, 7, v1
    v_mul_u32_u24 v7, 4608, v2
    v_mul_u32_u24 v10, 144, v8
    v_add_u32 v7, v7, v10
    v_lshl_add_u32 v7, v9, 4, v7
    v_mul_u32_u24 v10, 32, v3
    v_add_u32 v10, v10, v8
    v_add_u32 v10, s27, v10
    v_lshlrev_b32 v11, 6, v4
    v_lshl_add_u32 v11, v9, 3, v11
    v_add_u32 v11, s28, v11
    v_mul_u32_u24 v12, 1280, v10
    v_lshl_add_u32 v12, v11, 1, v12
    ds_read_b128 v[80:83], v7 offset:0
    ds_read_b128 v[84:87], v7 offset:1152
    ds_read_b128 v[88:91], v7 offset:2304
    ds_read_b128 v[92:95], v7 offset:3456
    s_load_dwordx2 s[36:37], s[0:1], 88
    s_waitcnt lgkmcnt(0)
    s_mov_b32 s20, s36
    s_mov_b32 s21, s37
    s_mov_b32 s22, 2621440
    s_mov_b32 s23, 0x00020000
    v_mul_u32_u24 v13, 1280, v10
    v_lshl_add_u32 v13, v11, 1, v13
    v_add_u32 v14, 0, v13
    buffer_load_dwordx4 v[32:35], v14, s[20:23], 0 offen
    v_add_u32 v14, 10240, v13
    buffer_load_dwordx4 v[36:39], v14, s[20:23], 0 offen
    v_add_u32 v14, 20480, v13
    buffer_load_dwordx4 v[40:43], v14, s[20:23], 0 offen
    v_add_u32 v14, 30720, v13
    buffer_load_dwordx4 v[44:47], v14, s[20:23], 0 offen
    s_waitcnt vmcnt(0) lgkmcnt(0)
    v_lshlrev_b32 v48, 16, v80
    v_and_b32 v49, 0xffff0000, v80
    v_lshlrev_b32 v50, 16, v32
    v_and_b32 v51, 0xffff0000, v32
    v_add_f32 v48, v48, v50
    v_add_f32 v49, v49, v51
    v_cvt_pk_bf16_f32 v80, v48, v49
    v_lshlrev_b32 v48, 16, v81
    v_and_b32 v49, 0xffff0000, v81
    v_lshlrev_b32 v50, 16, v33
    v_and_b32 v51, 0xffff0000, v33
    v_add_f32 v48, v48, v50
    v_add_f32 v49, v49, v51
    v_cvt_pk_bf16_f32 v81, v48, v49
    v_lshlrev_b32 v48, 16, v82
    v_and_b32 v49, 0xffff0000, v82
    v_lshlrev_b32 v50, 16, v34
    v_and_b32 v51, 0xffff0000, v34
    v_add_f32 v48, v48, v50
    v_add_f32 v49, v49, v51
    v_cvt_pk_bf16_f32 v82, v48, v49
    v_lshlrev_b32 v48, 16, v83
    v_and_b32 v49, 0xffff0000, v83
    v_lshlrev_b32 v50, 16, v35
    v_and_b32 v51, 0xffff0000, v35
    v_add_f32 v48, v48, v50
    v_add_f32 v49, v49, v51
    v_cvt_pk_bf16_f32 v83, v48, v49
    v_lshlrev_b32 v48, 16, v84
    v_and_b32 v49, 0xffff0000, v84
    v_lshlrev_b32 v50, 16, v36
    v_and_b32 v51, 0xffff0000, v36
    v_add_f32 v48, v48, v50
    v_add_f32 v49, v49, v51
    v_cvt_pk_bf16_f32 v84, v48, v49
    v_lshlrev_b32 v48, 16, v85
    v_and_b32 v49, 0xffff0000, v85
    v_lshlrev_b32 v50, 16, v37
    v_and_b32 v51, 0xffff0000, v37
    v_add_f32 v48, v48, v50
    v_add_f32 v49, v49, v51
    v_cvt_pk_bf16_f32 v85, v48, v49
    v_lshlrev_b32 v48, 16, v86
    v_and_b32 v49, 0xffff0000, v86
    v_lshlrev_b32 v50, 16, v38
    v_and_b32 v51, 0xffff0000, v38
    v_add_f32 v48, v48, v50
    v_add_f32 v49, v49, v51
    v_cvt_pk_bf16_f32 v86, v48, v49
    v_lshlrev_b32 v48, 16, v87
    v_and_b32 v49, 0xffff0000, v87
    v_lshlrev_b32 v50, 16, v39
    v_and_b32 v51, 0xffff0000, v39
    v_add_f32 v48, v48, v50
    v_add_f32 v49, v49, v51
    v_cvt_pk_bf16_f32 v87, v48, v49
    v_lshlrev_b32 v48, 16, v88
    v_and_b32 v49, 0xffff0000, v88
    v_lshlrev_b32 v50, 16, v40
    v_and_b32 v51, 0xffff0000, v40
    v_add_f32 v48, v48, v50
    v_add_f32 v49, v49, v51
    v_cvt_pk_bf16_f32 v88, v48, v49
    v_lshlrev_b32 v48, 16, v89
    v_and_b32 v49, 0xffff0000, v89
    v_lshlrev_b32 v50, 16, v41
    v_and_b32 v51, 0xffff0000, v41
    v_add_f32 v48, v48, v50
    v_add_f32 v49, v49, v51
    v_cvt_pk_bf16_f32 v89, v48, v49
    v_lshlrev_b32 v48, 16, v90
    v_and_b32 v49, 0xffff0000, v90
    v_lshlrev_b32 v50, 16, v42
    v_and_b32 v51, 0xffff0000, v42
    v_add_f32 v48, v48, v50
    v_add_f32 v49, v49, v51
    v_cvt_pk_bf16_f32 v90, v48, v49
    v_lshlrev_b32 v48, 16, v91
    v_and_b32 v49, 0xffff0000, v91
    v_lshlrev_b32 v50, 16, v43
    v_and_b32 v51, 0xffff0000, v43
    v_add_f32 v48, v48, v50
    v_add_f32 v49, v49, v51
    v_cvt_pk_bf16_f32 v91, v48, v49
    v_lshlrev_b32 v48, 16, v92
    v_and_b32 v49, 0xffff0000, v92
    v_lshlrev_b32 v50, 16, v44
    v_and_b32 v51, 0xffff0000, v44
    v_add_f32 v48, v48, v50
    v_add_f32 v49, v49, v51
    v_cvt_pk_bf16_f32 v92, v48, v49
    v_lshlrev_b32 v48, 16, v93
    v_and_b32 v49, 0xffff0000, v93
    v_lshlrev_b32 v50, 16, v45
    v_and_b32 v51, 0xffff0000, v45
    v_add_f32 v48, v48, v50
    v_add_f32 v49, v49, v51
    v_cvt_pk_bf16_f32 v93, v48, v49
    v_lshlrev_b32 v48, 16, v94
    v_and_b32 v49, 0xffff0000, v94
    v_lshlrev_b32 v50, 16, v46
    v_and_b32 v51, 0xffff0000, v46
    v_add_f32 v48, v48, v50
    v_add_f32 v49, v49, v51
    v_cvt_pk_bf16_f32 v94, v48, v49
    v_lshlrev_b32 v48, 16, v95
    v_and_b32 v49, 0xffff0000, v95
    v_lshlrev_b32 v50, 16, v47
    v_and_b32 v51, 0xffff0000, v47
    v_add_f32 v48, v48, v50
    v_add_f32 v49, v49, v51
    v_cvt_pk_bf16_f32 v95, v48, v49
    s_load_dwordx2 s[38:39], s[0:1], 88
    s_waitcnt lgkmcnt(0)
    s_add_u32 s32, s38, 38273024
    s_addc_u32 s33, s39, 0
    s_mov_b32 s34, 163840
    s_mov_b32 s35, 0x00020000
    v_mul_u32_u24 v14, 80, v10
    v_lshrrev_b32 v15, 6, v11
    v_lshl_add_u32 v14, v15, 3, v14
    v_lshlrev_b32 v50, 16, v80
    v_and_b32 v51, 0xffff0000, v80
    v_add_f32 v48, v50, v51
    v_mul_f32 v49, v50, v50
    v_fmac_f32 v49, v51, v51
    v_lshlrev_b32 v50, 16, v81
    v_and_b32 v51, 0xffff0000, v81
    v_add_f32 v48, v48, v50
    v_fmac_f32 v49, v50, v50
    v_add_f32 v48, v48, v51
    v_fmac_f32 v49, v51, v51
    v_lshlrev_b32 v50, 16, v82
    v_and_b32 v51, 0xffff0000, v82
    v_add_f32 v48, v48, v50
    v_fmac_f32 v49, v50, v50
    v_add_f32 v48, v48, v51
    v_fmac_f32 v49, v51, v51
    v_lshlrev_b32 v50, 16, v83
    v_and_b32 v51, 0xffff0000, v83
    v_add_f32 v48, v48, v50
    v_fmac_f32 v49, v50, v50
    v_add_f32 v48, v48, v51
    v_fmac_f32 v49, v51, v51
    s_nop 1
    v_add_f32_dpp v50, v48, v48 quad_perm:[1,0,3,2] row_mask:0xf bank_mask:0xf
    v_add_f32_dpp v51, v49, v49 quad_perm:[1,0,3,2] row_mask:0xf bank_mask:0xf
    v_mov_b32 v48, v50
    v_mov_b32 v49, v51
    s_nop 1
    v_add_f32_dpp v50, v48, v48 quad_perm:[2,3,0,1] row_mask:0xf bank_mask:0xf
    v_add_f32_dpp v51, v49, v49 quad_perm:[2,3,0,1] row_mask:0xf bank_mask:0xf
    v_mov_b32 v48, v50
    v_mov_b32 v49, v51
    s_nop 1
    v_add_f32_dpp v50, v48, v48 row_half_mirror row_mask:0xf bank_mask:0xf
    v_add_f32_dpp v51, v49, v49 row_half_mirror row_mask:0xf bank_mask:0xf
    v_mov_b32 v48, v50
    v_mov_b32 v49, v51
    v_and_b32 v15, 7, v1
    v_cmp_eq_u32 vcc, 0, v15
    s_and_saveexec_b64 s[40:41], vcc
    buffer_store_dwordx2 v[48:49], v14, s[32:35], 0 offen offset:0
    s_mov_b64 exec, s[40:41]
    s_nop 1
    v_lshlrev_b32 v50, 16, v84
    v_and_b32 v51, 0xffff0000, v84
    v_add_f32 v48, v50, v51
    v_mul_f32 v49, v50, v50
    v_fmac_f32 v49, v51, v51
    v_lshlrev_b32 v50, 16, v85
    v_and_b32 v51, 0xffff0000, v85
    v_add_f32 v48, v48, v50
    v_fmac_f32 v49, v50, v50
    v_add_f32 v48, v48, v51
    v_fmac_f32 v49, v51, v51
    v_lshlrev_b32 v50, 16, v86
    v_and_b32 v51, 0xffff0000, v86
    v_add_f32 v48, v48, v50
    v_fmac_f32 v49, v50, v50
    v_add_f32 v48, v48, v51
    v_fmac_f32 v49, v51, v51
    v_lshlrev_b32 v50, 16, v87
    v_and_b32 v51, 0xffff0000, v87
    v_add_f32 v48, v48, v50
    v_fmac_f32 v49, v50, v50
    v_add_f32 v48, v48, v51
    v_fmac_f32 v49, v51, v51
    s_nop 1
    v_add_f32_dpp v50, v48, v48 quad_perm:[1,0,3,2] row_mask:0xf bank_mask:0xf
    v_add_f32_dpp v51, v49, v49 quad_perm:[1,0,3,2] row_mask:0xf bank_mask:0xf
    v_mov_b32 v48, v50
    v_mov_b32 v49, v51
    s_nop 1
    v_add_f32_dpp v50, v48, v48 quad_perm:[2,3,0,1] row_mask:0xf bank_mask:0xf
    v_add_f32_dpp v51, v49, v49 quad_perm:[2,3,0,1] row_mask:0xf bank_mask:0xf
    v_mov_b32 v48, v50
    v_mov_b32 v49, v51
    s_nop 1
    v_add_f32_dpp v50, v48, v48 row_half_mirror row_mask:0xf bank_mask:0xf
    v_add_f32_dpp v51, v49, v49 row_half_mirror row_mask:0xf bank_mask:0xf
    v_mov_b32 v48, v50
    v_mov_b32 v49, v51
    v_and_b32 v15, 7, v1
    v_cmp_eq_u32 vcc, 0, v15
    s_and_saveexec_b64 s[40:41], vcc
    buffer_store_dwordx2 v[48:49], v14, s[32:35], 0 offen offset:640
    s_mov_b64 exec, s[40:41]
    s_nop 1
    v_lshlrev_b32 v50, 16, v88
    v_and_b32 v51, 0xffff0000, v88
    v_add_f32 v48, v50, v51
    v_mul_f32 v49, v50, v50
    v_fmac_f32 v49, v51, v51
    v_lshlrev_b32 v50, 16, v89
    v_and_b32 v51, 0xffff0000, v89
    v_add_f32 v48, v48, v50
    v_fmac_f32 v49, v50, v50
    v_add_f32 v48, v48, v51
    v_fmac_f32 v49, v51, v51
    v_lshlrev_b32 v50, 16, v90
    v_and_b32 v51, 0xffff0000, v90
    v_add_f32 v48, v48, v50
    v_fmac_f32 v49, v50, v50
    v_add_f32 v48, v48, v51
    v_fmac_f32 v49, v51, v51
    v_lshlrev_b32 v50, 16, v91
    v_and_b32 v51, 0xffff0000, v91
    v_add_f32 v48, v48, v50
    v_fmac_f32 v49, v50, v50
    v_add_f32 v48, v48, v51
    v_fmac_f32 v49, v51, v51
    s_nop 1
    v_add_f32_dpp v50, v48, v48 quad_perm:[1,0,3,2] row_mask:0xf bank_mask:0xf
    v_add_f32_dpp v51, v49, v49 quad_perm:[1,0,3,2] row_mask:0xf bank_mask:0xf
    v_mov_b32 v48, v50
    v_mov_b32 v49, v51
    s_nop 1
    v_add_f32_dpp v50, v48, v48 quad_perm:[2,3,0,1] row_mask:0xf bank_mask:0xf
    v_add_f32_dpp v51, v49, v49 quad_perm:[2,3,0,1] row_mask:0xf bank_mask:0xf
    v_mov_b32 v48, v50
    v_mov_b32 v49, v51
    s_nop 1
    v_add_f32_dpp v50, v48, v48 row_half_mirror row_mask:0xf bank_mask:0xf
    v_add_f32_dpp v51, v49, v49 row_half_mirror row_mask:0xf bank_mask:0xf
    v_mov_b32 v48, v50
    v_mov_b32 v49, v51
    v_and_b32 v15, 7, v1
    v_cmp_eq_u32 vcc, 0, v15
    s_and_saveexec_b64 s[40:41], vcc
    buffer_store_dwordx2 v[48:49], v14, s[32:35], 0 offen offset:1280
    s_mov_b64 exec, s[40:41]
    s_nop 1
    v_lshlrev_b32 v50, 16, v92
    v_and_b32 v51, 0xffff0000, v92
    v_add_f32 v48, v50, v51
    v_mul_f32 v49, v50, v50
    v_fmac_f32 v49, v51, v51
    v_lshlrev_b32 v50, 16, v93
    v_and_b32 v51, 0xffff0000, v93
    v_add_f32 v48, v48, v50
    v_fmac_f32 v49, v50, v50
    v_add_f32 v48, v48, v51
    v_fmac_f32 v49, v51, v51
    v_lshlrev_b32 v50, 16, v94
    v_and_b32 v51, 0xffff0000, v94
    v_add_f32 v48, v48, v50
    v_fmac_f32 v49, v50, v50
    v_add_f32 v48, v48, v51
    v_fmac_f32 v49, v51, v51
    v_lshlrev_b32 v50, 16, v95
    v_and_b32 v51, 0xffff0000, v95
    v_add_f32 v48, v48, v50
    v_fmac_f32 v49, v50, v50
    v_add_f32 v48, v48, v51
    v_fmac_f32 v49, v51, v51
    s_nop 1
    v_add_f32_dpp v50, v48, v48 quad_perm:[1,0,3,2] row_mask:0xf bank_mask:0xf
    v_add_f32_dpp v51, v49, v49 quad_perm:[1,0,3,2] row_mask:0xf bank_mask:0xf
    v_mov_b32 v48, v50
    v_mov_b32 v49, v51
    s_nop 1
    v_add_f32_dpp v50, v48, v48 quad_perm:[2,3,0,1] row_mask:0xf bank_mask:0xf
    v_add_f32_dpp v51, v49, v49 quad_perm:[2,3,0,1] row_mask:0xf bank_mask:0xf
    v_mov_b32 v48, v50
    v_mov_b32 v49, v51
    s_nop 1
    v_add_f32_dpp v50, v48, v48 row_half_mirror row_mask:0xf bank_mask:0xf
    v_add_f32_dpp v51, v49, v49 row_half_mirror row_mask:0xf bank_mask:0xf
    v_mov_b32 v48, v50
    v_mov_b32 v49, v51
    v_and_b32 v15, 7, v1
    v_cmp_eq_u32 vcc, 0, v15
    s_and_saveexec_b64 s[40:41], vcc
    buffer_store_dwordx2 v[48:49], v14, s[32:35], 0 offen offset:1920
    s_mov_b64 exec, s[40:41]
    s_nop 1
    buffer_store_dwordx4 v[80:83], v12, s[16:19], 0 offen
    v_add_u32 v12, 10240, v12
    buffer_store_dwordx4 v[84:87], v12, s[16:19], 0 offen
    v_add_u32 v12, 10240, v12
    buffer_store_dwordx4 v[88:91], v12, s[16:19], 0 offen
    v_add_u32 v12, 10240, v12
    buffer_store_dwordx4 v[92:95], v12, s[16:19], 0 offen
Lend_wout0_kernel_1:
    s_endpgm
Lloader_wout0_kernel_2:
    v_subrev_u32 v0, 256, v0
    v_and_b32 v1, 63, v0
    s_sub_u32 s42, s41, 4
    v_lshrrev_b32 v3, 3, v1
    v_and_b32 v4, 7, v1
    v_xor_b32 v4, v4, v3
    s_mul_i32 s43, s42, 16
    s_add_u32 s43, s43, s27
    v_add_u32 v5, s43, v3
    v_mul_u32_u24 v5, 1536, v5
    v_lshl_add_u32 v8, v4, 4, v5
    v_add_u32 v9, 12288, v8
    v_lshrrev_b32 v3, 4, v1
    v_and_b32 v4, 15, v1
    v_lshrrev_b32 v5, 1, v4
    v_and_b32 v6, 1, v4
    s_mul_i32 s43, s42, 4
    s_add_u32 s44, s43, 0
    s_lshr_b32 s44, s44, 1
    s_and_b32 s44, s44, 1
    s_lshl_b32 s44, s44, 2
    v_add_u32 v7, s44, v3
    v_xor_b32 v7, v5, v7
    v_lshl_add_u32 v7, v7, 1, v6
    v_lshlrev_b32 v7, 4, v7
    s_add_u32 s44, s43, 0
    s_lshl_b32 s44, s44, 2
    v_add_u32 v12, s44, v3
    v_mul_u32_u24 v12, 1280, v12
    v_add_u32 v12, v12, v7
    v_lshl_add_u32 v12, s28, 1, v12
    s_add_u32 s44, s43, 1
    s_lshr_b32 s44, s44, 1
    s_and_b32 s44, s44, 1
    s_lshl_b32 s44, s44, 2
    v_add_u32 v7, s44, v3
    v_xor_b32 v7, v5, v7
    v_lshl_add_u32 v7, v7, 1, v6
    v_lshlrev_b32 v7, 4, v7
    s_add_u32 s44, s43, 1
    s_lshl_b32 s44, s44, 2
    v_add_u32 v13, s44, v3
    v_mul_u32_u24 v13, 1280, v13
    v_add_u32 v13, v13, v7
    v_lshl_add_u32 v13, s28, 1, v13
    s_add_u32 s44, s43, 2
    s_lshr_b32 s44, s44, 1
    s_and_b32 s44, s44, 1
    s_lshl_b32 s44, s44, 2
    v_add_u32 v7, s44, v3
    v_xor_b32 v7, v5, v7
    v_lshl_add_u32 v7, v7, 1, v6
    v_lshlrev_b32 v7, 4, v7
    s_add_u32 s44, s43, 2
    s_lshl_b32 s44, s44, 2
    v_add_u32 v14, s44, v3
    v_mul_u32_u24 v14, 1280, v14
    v_add_u32 v14, v14, v7
    v_lshl_add_u32 v14, s28, 1, v14
    s_add_u32 s44, s43, 3
    s_lshr_b32 s44, s44, 1
    s_and_b32 s44, s44, 1
    s_lshl_b32 s44, s44, 2
    v_add_u32 v7, s44, v3
    v_xor_b32 v7, v5, v7
    v_lshl_add_u32 v7, v7, 1, v6
    v_lshlrev_b32 v7, 4, v7
    s_add_u32 s44, s43, 3
    s_lshl_b32 s44, s44, 2
    v_add_u32 v15, s44, v3
    v_mul_u32_u24 v15, 1280, v15
    v_add_u32 v15, v15, v7
    v_lshl_add_u32 v15, s28, 1, v15
    s_mul_i32 s45, s42, 2048
    s_mul_i32 s46, s42, 4096
    s_add_u32 s46, s46, 8192
    s_mov_b32 s29, 0
    s_mov_b32 s30, 0
    s_add_u32 m0, s45, 0
    s_nop 0
    buffer_load_dwordx4 v8, s[8:11], s29 offen lds
    s_add_u32 m0, s45, 1024
    s_nop 0
    buffer_load_dwordx4 v9, s[8:11], s29 offen lds
    s_add_u32 m0, s46, 0
    s_nop 0
    buffer_load_dwordx4 v12, s[12:15], s30 offen lds
    s_add_u32 m0, s46, 1024
    s_nop 0
    buffer_load_dwordx4 v13, s[12:15], s30 offen lds
    s_add_u32 m0, s46, 2048
    s_nop 0
    buffer_load_dwordx4 v14, s[12:15], s30 offen lds
    s_add_u32 m0, s46, 3072
    s_nop 0
    buffer_load_dwordx4 v15, s[12:15], s30 offen lds
    s_add_u32 s29, s29, 128
    s_add_u32 s30, s30, 81920
    s_add_u32 m0, s45, 24576
    s_nop 0
    buffer_load_dwordx4 v8, s[8:11], s29 offen lds
    s_add_u32 m0, s45, 25600
    s_nop 0
    buffer_load_dwordx4 v9, s[8:11], s29 offen lds
    s_add_u32 m0, s46, 24576
    s_nop 0
    buffer_load_dwordx4 v12, s[12:15], s30 offen lds
    s_add_u32 m0, s46, 25600
    s_nop 0
    buffer_load_dwordx4 v13, s[12:15], s30 offen lds
    s_add_u32 m0, s46, 26624
    s_nop 0
    buffer_load_dwordx4 v14, s[12:15], s30 offen lds
    s_add_u32 m0, s46, 27648
    s_nop 0
    buffer_load_dwordx4 v15, s[12:15], s30 offen lds
    s_add_u32 s29, s29, 128
    s_add_u32 s30, s30, 81920
    s_add_u32 m0, s45, 49152
    s_nop 0
    buffer_load_dwordx4 v8, s[8:11], s29 offen lds
    s_add_u32 m0, s45, 50176
    s_nop 0
    buffer_load_dwordx4 v9, s[8:11], s29 offen lds
    s_add_u32 m0, s46, 49152
    s_nop 0
    buffer_load_dwordx4 v12, s[12:15], s30 offen lds
    s_add_u32 m0, s46, 50176
    s_nop 0
    buffer_load_dwordx4 v13, s[12:15], s30 offen lds
    s_add_u32 m0, s46, 51200
    s_nop 0
    buffer_load_dwordx4 v14, s[12:15], s30 offen lds
    s_add_u32 m0, s46, 52224
    s_nop 0
    buffer_load_dwordx4 v15, s[12:15], s30 offen lds
    s_add_u32 s29, s29, 128
    s_add_u32 s30, s30, 81920
    s_waitcnt vmcnt(6)
    s_barrier
    s_mov_b32 s31, 0
Llloop_wout0_kernel_4:
    s_add_u32 m0, s45, 73728
    s_nop 0
    buffer_load_dwordx4 v8, s[8:11], s29 offen lds
    s_add_u32 m0, s45, 74752
    s_nop 0
    buffer_load_dwordx4 v9, s[8:11], s29 offen lds
    s_add_u32 m0, s46, 73728
    s_nop 0
    buffer_load_dwordx4 v12, s[12:15], s30 offen lds
    s_add_u32 m0, s46, 74752
    s_nop 0
    buffer_load_dwordx4 v13, s[12:15], s30 offen lds
    s_add_u32 m0, s46, 75776
    s_nop 0
    buffer_load_dwordx4 v14, s[12:15], s30 offen lds
    s_add_u32 m0, s46, 76800
    s_nop 0
    buffer_load_dwordx4 v15, s[12:15], s30 offen lds
    s_add_u32 s29, s29, 128
    s_add_u32 s30, s30, 81920
    s_waitcnt vmcnt(6)
    s_barrier
    s_add_u32 m0, s45, 0
    s_nop 0
    buffer_load_dwordx4 v8, s[8:11], s29 offen lds
    s_add_u32 m0, s45, 1024
    s_nop 0
    buffer_load_dwordx4 v9, s[8:11], s29 offen lds
    s_add_u32 m0, s46, 0
    s_nop 0
    buffer_load_dwordx4 v12, s[12:15], s30 offen lds
    s_add_u32 m0, s46, 1024
    s_nop 0
    buffer_load_dwordx4 v13, s[12:15], s30 offen lds
    s_add_u32 m0, s46, 2048
    s_nop 0
    buffer_load_dwordx4 v14, s[12:15], s30 offen lds
    s_add_u32 m0, s46, 3072
    s_nop 0
    buffer_load_dwordx4 v15, s[12:15], s30 offen lds
    s_add_u32 s29, s29, 128
    s_add_u32 s30, s30, 81920
    s_waitcnt vmcnt(6)
    s_barrier
    s_add_u32 m0, s45, 24576
    s_nop 0
    buffer_load_dwordx4 v8, s[8:11], s29 offen lds
    s_add_u32 m0, s45, 25600
    s_nop 0
    buffer_load_dwordx4 v9, s[8:11], s29 offen lds
    s_add_u32 m0, s46, 24576
    s_nop 0
    buffer_load_dwordx4 v12, s[12:15], s30 offen lds
    s_add_u32 m0, s46, 25600
    s_nop 0
    buffer_load_dwordx4 v13, s[12:15], s30 offen lds
    s_add_u32 m0, s46, 26624
    s_nop 0
    buffer_load_dwordx4 v14, s[12:15], s30 offen lds
    s_add_u32 m0, s46, 27648
    s_nop 0
    buffer_load_dwordx4 v15, s[12:15], s30 offen lds
    s_add_u32 s29, s29, 128
    s_add_u32 s30, s30, 81920
    s_waitcnt vmcnt(6)
    s_barrier
    s_add_u32 m0, s45, 49152
    s_nop 0
    buffer_load_dwordx4 v8, s[8:11], s29 offen lds
    s_add_u32 m0, s45, 50176
    s_nop 0
    buffer_load_dwordx4 v9, s[8:11], s29 offen lds
    s_add_u32 m0, s46, 49152
    s_nop 0
    buffer_load_dwordx4 v12, s[12:15], s30 offen lds
    s_add_u32 m0, s46, 50176
    s_nop 0
    buffer_load_dwordx4 v13, s[12:15], s30 offen lds
    s_add_u32 m0, s46, 51200
    s_nop 0
    buffer_load_dwordx4 v14, s[12:15], s30 offen lds
    s_add_u32 m0, s46, 52224
    s_nop 0
    buffer_load_dwordx4 v15, s[12:15], s30 offen lds
    s_add_u32 s29, s29, 128
    s_add_u32 s30, s30, 81920
    s_waitcnt vmcnt(6)
    s_barrier
    s_add_u32 s31, s31, 1
    s_cmp_lt_u32 s31, 2
    s_cbranch_scc1 Llloop_wout0_kernel_4
    s_add_u32 m0, s45, 73728
    s_nop 0
    buffer_load_dwordx4 v8, s[8:11], s29 offen lds
    s_add_u32 m0, s45, 74752
    s_nop 0
    buffer_load_dwordx4 v9, s[8:11], s29 offen lds
    s_add_u32 m0, s46, 73728
    s_nop 0
    buffer_load_dwordx4 v12, s[12:15], s30 offen lds
    s_add_u32 m0, s46, 74752
    s_nop 0
    buffer_load_dwordx4 v13, s[12:15], s30 offen lds
    s_add_u32 m0, s46, 75776
    s_nop 0
    buffer_load_dwordx4 v14, s[12:15], s30 offen lds
    s_add_u32 m0, s46, 76800
    s_nop 0
    buffer_load_dwordx4 v15, s[12:15], s30 offen lds
    s_add_u32 s29, s29, 128
    s_add_u32 s30, s30, 81920
    s_waitcnt vmcnt(6)
    s_barrier
    s_waitcnt vmcnt(0)
    s_barrier
    s_waitcnt vmcnt(0)
    s_barrier
    s_waitcnt vmcnt(0)
    s_barrier
    s_endpgm
.section .rodata,"a"
.p2align 6
.amdhsa_kernel wout0_kernel
  .amdhsa_next_free_vgpr 112
  .amdhsa_next_free_sgpr 56
  .amdhsa_accum_offset 112
  .amdhsa_group_segment_fixed_size 0
  .amdhsa_kernarg_size 96
  .amdhsa_user_sgpr_count 2
  .amdhsa_user_sgpr_kernarg_segment_ptr 1
  .amdhsa_system_sgpr_workgroup_id_x 1
.end_amdhsa_kernel
.text

.globl qkv1_kernel
.p2align 8
.type qkv1_kernel,@function
qkv1_kernel:
    s_cmp_ge_u32 s2, 240
    s_cbranch_scc1 Lend_qkv1_kernel_1
    s_load_dwordx2 s[4:5], s[0:1], 88
    s_load_dwordx2 s[6:7], s[0:1], 8
    s_load_dwordx2 s[24:25], s[0:1], 88
    s_and_b32 s26, s2, 7
    s_lshr_b32 s27, s2, 3
    s_mul_i32 s26, s26, 30
    s_add_u32 s26, s26, s27
    s_mul_hi_u32 s27, s26, 286331154
    s_mul_i32 s28, s27, 15
    s_sub_u32 s28, s26, s28
    s_mul_i32 s27, s27, 128
    s_mul_i32 s28, s28, 128
    s_waitcnt lgkmcnt(0)
    s_mov_b32 s8, s4
    s_mov_b32 s9, s5
    s_mov_b32 s10, 2621440
    s_mov_b32 s11, 0x00020000
    s_mov_b32 s12, s6
    s_mov_b32 s13, s7
    s_mov_b32 s14, 2457600
    s_mov_b32 s15, 0x00020000
    s_add_u32 s16, s24, 5242880
    s_addc_u32 s17, s25, 0
    s_mov_b32 s18, 7864320
    s_mov_b32 s19, 0x00020000
    v_and_b32 v1, 63, v0
    v_lshrrev_b32 v2, 6, v0
    s_nop 0
    v_readfirstlane_b32 s41, v2
    s_nop 3
    s_cmp_ge_u32 s41, 4
    s_cbranch_scc1 Lloader_qkv1_kernel_2
    v_lshrrev_b32 v3, 1, v2
    v_and_b32 v4, 1, v2
    v_lshrrev_b32 v5, 4, v1
    v_and_b32 v6, 15, v1
    v_mul_u32_u24 v7, 64, v3
    v_add_u32 v7, v7, v6
    v_lshlrev_b32 v7, 7, v7
    v_add_u32 v18, 0, v5
    v_and_b32 v3, 7, v6
    v_xor_b32 v18, v18, v3
    v_lshl_add_u32 v18, v18, 4, v7
    v_add_u32 v26, 65536, v18
    v_add_u32 v19, 4, v5
    v_and_b32 v3, 7, v6
    v_xor_b32 v19, v19, v3
    v_lshl_add_u32 v19, v19, 4, v7
    v_add_u32 v27, 65536, v19
    v_lshrrev_b32 v3, 2, v6
    v_and_b32 v7, 1, v5
    v_lshl_add_u32 v7, v7, 2, v3
    v_lshl_add_u32 v32, v5, 3, v3
    v_lshlrev_b32 v32, 8, v32
    v_and_b32 v33, 3, v6
    v_lshl_add_u32 v32, v33, 3, v32
    v_lshlrev_b32 v33, 2, v4
    v_add_u32 v34, 0, v33
    v_xor_b32 v34, v34, v7
    v_lshl_add_u32 v20, v34, 5, v32
    v_add_u32 v28, 65536, v20
    v_add_u32 v34, 1, v33
    v_xor_b32 v34, v34, v7
    v_lshl_add_u32 v21, v34, 5, v32
    v_add_u32 v29, 65536, v21
    v_add_u32 v34, 2, v33
    v_xor_b32 v34, v34, v7
    v_lshl_add_u32 v22, v34, 5, v32
    v_add_u32 v30, 65536, v22
    v_add_u32 v34, 3, v33
    v_xor_b32 v34, v34, v7
    v_lshl_add_u32 v23, v34, 5, v32
    v_add_u32 v31, 65536, v23
    s_load_dwordx2 s[36:37], s[0:1], 88
    s_waitcnt lgkmcnt(0)
    s_add_u32 s20, s36, 38273024
    s_addc_u32 s21, s37, 0
    s_mov_b32 s22, 163840
    s_mov_b32 s23, 0x00020000
    v_lshrrev_b32 v3, 1, v2
    v_and_b32 v6, 15, v1
    v_mul_u32_u24 v3, 64, v3
    v_add_u32 v3, v3, v6
    v_add_u32 v3, s27, v3
    v_mul_u32_u24 v3, 80, v3
    buffer_load_dwordx4 v[32:35], v3, s[20:23], 0 offen offset:0
    buffer_load_dwordx4 v[36:39], v3, s[20:23], 0 offen offset:16
    buffer_load_dwordx4 v[40:43], v3, s[20:23], 0 offen offset:32
    buffer_load_dwordx4 v[44:47], v3, s[20:23], 0 offen offset:48
    buffer_load_dwordx4 v[48:51], v3, s[20:23], 0 offen offset:64
    buffer_load_dwordx4 v[52:55], v3, s[20:23], 0 offen offset:1280
    buffer_load_dwordx4 v[56:59], v3, s[20:23], 0 offen offset:1296
    buffer_load_dwordx4 v[60:63], v3, s[20:23], 0 offen offset:1312
    buffer_load_dwordx4 v[64:67], v3, s[20:23], 0 offen offset:1328
    buffer_load_dwordx4 v[68:71], v3, s[20:23], 0 offen offset:1344
    buffer_load_dwordx4 v[72:75], v3, s[20:23], 0 offen offset:2560
    buffer_load_dwordx4 v[76:79], v3, s[20:23], 0 offen offset:2576
    buffer_load_dwordx4 v[80:83], v3, s[20:23], 0 offen offset:2592
    buffer_load_dwordx4 v[84:87], v3, s[20:23], 0 offen offset:2608
    buffer_load_dwordx4 v[88:91], v3, s[20:23], 0 offen offset:2624
    buffer_load_dwordx4 v[92:95], v3, s[20:23], 0 offen offset:3840
    buffer_load_dwordx4 v[96:99], v3, s[20:23], 0 offen offset:3856
    buffer_load_dwordx4 v[100:103], v3, s[20:23], 0 offen offset:3872
    buffer_load_dwordx4 v[104:107], v3, s[20:23], 0 offen offset:3888
    buffer_load_dwordx4 v[108:111], v3, s[20:23], 0 offen offset:3904
    s_waitcnt vmcnt(0)
    v_add_f32 v8, v32, v34
    v_add_f32 v12, v33, v35
    v_add_f32 v8, v8, v36
    v_add_f32 v12, v12, v37
    v_add_f32 v8, v8, v38
    v_add_f32 v12, v12, v39
    v_add_f32 v8, v8, v40
    v_add_f32 v12, v12, v41
    v_add_f32 v8, v8, v42
    v_add_f32 v12, v12, v43
    v_add_f32 v8, v8, v44
    v_add_f32 v12, v12, v45
    v_add_f32 v8, v8, v46
    v_add_f32 v12, v12, v47
    v_add_f32 v8, v8, v48
    v_add_f32 v12, v12, v49
    v_add_f32 v8, v8, v50
    v_add_f32 v12, v12, v51
    v_mul_f32 v8, 0x3acccccd, v8
    v_mul_f32 v12, 0x3acccccd, v12
    v_fma_f32 v12, -v8, v8, v12
    v_max_f32 v12, 0, v12
    v_cvt_pk_bf16_f32 v8, v8, v8
    v_lshlrev_b32 v8, 16, v8
    v_cvt_pk_bf16_f32 v12, v12, v12
    v_lshlrev_b32 v12, 16, v12
    v_add_f32 v12, 0x3727c5ac, v12
    v_cvt_pk_bf16_f32 v12, v12, v12
    v_lshlrev_b32 v12, 16, v12
    v_sqrt_f32 v12, v12
    s_nop 0
    v_cvt_pk_bf16_f32 v12, v12, v12
    v_lshlrev_b32 v12, 16, v12
    v_rcp_f32 v12, v12
    v_add_f32 v9, v52, v54
    v_add_f32 v13, v53, v55
    v_add_f32 v9, v9, v56
    v_add_f32 v13, v13, v57
    v_add_f32 v9, v9, v58
    v_add_f32 v13, v13, v59
    v_add_f32 v9, v9, v60
    v_add_f32 v13, v13, v61
    v_add_f32 v9, v9, v62
    v_add_f32 v13, v13, v63
    v_add_f32 v9, v9, v64
    v_add_f32 v13, v13, v65
    v_add_f32 v9, v9, v66
    v_add_f32 v13, v13, v67
    v_add_f32 v9, v9, v68
    v_add_f32 v13, v13, v69
    v_add_f32 v9, v9, v70
    v_add_f32 v13, v13, v71
    v_mul_f32 v9, 0x3acccccd, v9
    v_mul_f32 v13, 0x3acccccd, v13
    v_fma_f32 v13, -v9, v9, v13
    v_max_f32 v13, 0, v13
    v_cvt_pk_bf16_f32 v9, v9, v9
    v_lshlrev_b32 v9, 16, v9
    v_cvt_pk_bf16_f32 v13, v13, v13
    v_lshlrev_b32 v13, 16, v13
    v_add_f32 v13, 0x3727c5ac, v13
    v_cvt_pk_bf16_f32 v13, v13, v13
    v_lshlrev_b32 v13, 16, v13
    v_sqrt_f32 v13, v13
    s_nop 0
    v_cvt_pk_bf16_f32 v13, v13, v13
    v_lshlrev_b32 v13, 16, v13
    v_rcp_f32 v13, v13
    v_add_f32 v10, v72, v74
    v_add_f32 v14, v73, v75
    v_add_f32 v10, v10, v76
    v_add_f32 v14, v14, v77
    v_add_f32 v10, v10, v78
    v_add_f32 v14, v14, v79
    v_add_f32 v10, v10, v80
    v_add_f32 v14, v14, v81
    v_add_f32 v10, v10, v82
    v_add_f32 v14, v14, v83
    v_add_f32 v10, v10, v84
    v_add_f32 v14, v14, v85
    v_add_f32 v10, v10, v86
    v_add_f32 v14, v14, v87
    v_add_f32 v10, v10, v88
    v_add_f32 v14, v14, v89
    v_add_f32 v10, v10, v90
    v_add_f32 v14, v14, v91
    v_mul_f32 v10, 0x3acccccd, v10
    v_mul_f32 v14, 0x3acccccd, v14
    v_fma_f32 v14, -v10, v10, v14
    v_max_f32 v14, 0, v14
    v_cvt_pk_bf16_f32 v10, v10, v10
    v_lshlrev_b32 v10, 16, v10
    v_cvt_pk_bf16_f32 v14, v14, v14
    v_lshlrev_b32 v14, 16, v14
    v_add_f32 v14, 0x3727c5ac, v14
    v_cvt_pk_bf16_f32 v14, v14, v14
    v_lshlrev_b32 v14, 16, v14
    v_sqrt_f32 v14, v14
    s_nop 0
    v_cvt_pk_bf16_f32 v14, v14, v14
    v_lshlrev_b32 v14, 16, v14
    v_rcp_f32 v14, v14
    v_add_f32 v11, v92, v94
    v_add_f32 v15, v93, v95
    v_add_f32 v11, v11, v96
    v_add_f32 v15, v15, v97
    v_add_f32 v11, v11, v98
    v_add_f32 v15, v15, v99
    v_add_f32 v11, v11, v100
    v_add_f32 v15, v15, v101
    v_add_f32 v11, v11, v102
    v_add_f32 v15, v15, v103
    v_add_f32 v11, v11, v104
    v_add_f32 v15, v15, v105
    v_add_f32 v11, v11, v106
    v_add_f32 v15, v15, v107
    v_add_f32 v11, v11, v108
    v_add_f32 v15, v15, v109
    v_add_f32 v11, v11, v110
    v_add_f32 v15, v15, v111
    v_mul_f32 v11, 0x3acccccd, v11
    v_mul_f32 v15, 0x3acccccd, v15
    v_fma_f32 v15, -v11, v11, v15
    v_max_f32 v15, 0, v15
    v_cvt_pk_bf16_f32 v11, v11, v11
    v_lshlrev_b32 v11, 16, v11
    v_cvt_pk_bf16_f32 v15, v15, v15
    v_lshlrev_b32 v15, 16, v15
    v_add_f32 v15, 0x3727c5ac, v15
    v_cvt_pk_bf16_f32 v15, v15, v15
    v_lshlrev_b32 v15, 16, v15
    v_sqrt_f32 v15, v15
    s_nop 0
    v_cvt_pk_bf16_f32 v15, v15, v15
    v_lshlrev_b32 v15, 16, v15
    v_rcp_f32 v15, v15
    s_nop 0
    v_mov_b32 v96, 0
    v_mov_b32 v97, 0
    v_mov_b32 v98, 0
    v_mov_b32 v99, 0
    v_mov_b32 v100, 0
    v_mov_b32 v101, 0
    v_mov_b32 v102, 0
    v_mov_b32 v103, 0
    v_mov_b32 v104, 0
    v_mov_b32 v105, 0
    v_mov_b32 v106, 0
    v_mov_b32 v107, 0
    v_mov_b32 v108, 0
    v_mov_b32 v109, 0
    v_mov_b32 v110, 0
    v_mov_b32 v111, 0
    v_mov_b32 v112, 0
    v_mov_b32 v113, 0
    v_mov_b32 v114, 0
    v_mov_b32 v115, 0
    v_mov_b32 v116, 0
    v_mov_b32 v117, 0
    v_mov_b32 v118, 0
    v_mov_b32 v119, 0
    v_mov_b32 v120, 0
    v_mov_b32 v121, 0
    v_mov_b32 v122, 0
    v_mov_b32 v123, 0
    v_mov_b32 v124, 0
    v_mov_b32 v125, 0
    v_mov_b32 v126, 0
    v_mov_b32 v127, 0
    v_mov_b32 v128, 0
    v_mov_b32 v129, 0
    v_mov_b32 v130, 0
    v_mov_b32 v131, 0
    v_mov_b32 v132, 0
    v_mov_b32 v133, 0
    v_mov_b32 v134, 0
    v_mov_b32 v135, 0
    v_mov_b32 v136, 0
    v_mov_b32 v137, 0
    v_mov_b32 v138, 0
    v_mov_b32 v139, 0
    v_mov_b32 v140, 0
    v_mov_b32 v141, 0
    v_mov_b32 v142, 0
    v_mov_b32 v143, 0
    v_mov_b32 v144, 0
    v_mov_b32 v145, 0
    v_mov_b32 v146, 0
    v_mov_b32 v147, 0
    v_mov_b32 v148, 0
    v_mov_b32 v149, 0
    v_mov_b32 v150, 0
    v_mov_b32 v151, 0
    v_mov_b32 v152, 0
    v_mov_b32 v153, 0
    v_mov_b32 v154, 0
    v_mov_b32 v155, 0
    v_mov_b32 v156, 0
    v_mov_b32 v157, 0
    v_mov_b32 v158, 0
    v_mov_b32 v159, 0
    s_barrier
    ds_read_b128 v[32:35], v18 offset:0
    ds_read_b128 v[36:39], v18 offset:2048
    ds_read_b128 v[40:43], v18 offset:4096
    ds_read_b128 v[44:47], v18 offset:6144
    ds_read_b64_tr_b16 v[64:65], v20 offset:16384
    ds_read_b64_tr_b16 v[66:67], v20 offset:17408
    ds_read_b64_tr_b16 v[68:69], v21 offset:16384
    ds_read_b64_tr_b16 v[70:71], v21 offset:17408
    ds_read_b64_tr_b16 v[72:73], v22 offset:16384
    ds_read_b64_tr_b16 v[74:75], v22 offset:17408
    ds_read_b64_tr_b16 v[76:77], v23 offset:16384
    ds_read_b64_tr_b16 v[78:79], v23 offset:17408
    s_mov_b32 s31, 0
Lcloop_qkv1_kernel_3:
    s_waitcnt lgkmcnt(0)
    v_mfma_f32_16x16x32_bf16 v[96:99], v[64:67], v[32:35], v[96:99]
    v_mfma_f32_16x16x32_bf16 v[100:103], v[68:71], v[32:35], v[100:103]
    ds_read_b128 v[48:51], v19 offset:0
    v_mfma_f32_16x16x32_bf16 v[104:107], v[72:75], v[32:35], v[104:107]
    ds_read_b128 v[52:55], v19 offset:2048
    v_mfma_f32_16x16x32_bf16 v[108:111], v[76:79], v[32:35], v[108:111]
    ds_read_b128 v[56:59], v19 offset:4096
    v_mfma_f32_16x16x32_bf16 v[112:115], v[64:67], v[36:39], v[112:115]
    v_mfma_f32_16x16x32_bf16 v[116:119], v[68:71], v[36:39], v[116:119]
    ds_read_b128 v[60:63], v19 offset:6144
    v_mfma_f32_16x16x32_bf16 v[120:123], v[72:75], v[36:39], v[120:123]
    ds_read_b64_tr_b16 v[80:81], v20 offset:24576
    v_mfma_f32_16x16x32_bf16 v[124:127], v[76:79], v[36:39], v[124:127]
    ds_read_b64_tr_b16 v[82:83], v20 offset:25600
    v_mfma_f32_16x16x32_bf16 v[128:131], v[64:67], v[40:43], v[128:131]
    v_mfma_f32_16x16x32_bf16 v[132:135], v[68:71], v[40:43], v[132:135]
    ds_read_b64_tr_b16 v[84:85], v21 offset:24576
    v_mfma_f32_16x16x32_bf16 v[136:139], v[72:75], v[40:43], v[136:139]
    ds_read_b64_tr_b16 v[86:87], v21 offset:25600
    v_mfma_f32_16x16x32_bf16 v[140:143], v[76:79], v[40:43], v[140:143]
    ds_read_b64_tr_b16 v[88:89], v22 offset:24576
    v_mfma_f32_16x16x32_bf16 v[144:147], v[64:67], v[44:47], v[144:147]
    v_mfma_f32_16x16x32_bf16 v[148:151], v[68:71], v[44:47], v[148:151]
    ds_read_b64_tr_b16 v[90:91], v22 offset:25600
    v_mfma_f32_16x16x32_bf16 v[152:155], v[72:75], v[44:47], v[152:155]
    ds_read_b64_tr_b16 v[92:93], v23 offset:24576
    v_mfma_f32_16x16x32_bf16 v[156:159], v[76:79], v[44:47], v[156:159]
    ds_read_b64_tr_b16 v[94:95], v23 offset:25600
    s_waitcnt lgkmcnt(0)
    v_mfma_f32_16x16x32_bf16 v[96:99], v[80:83], v[48:51], v[96:99]
    v_mfma_f32_16x16x32_bf16 v[100:103], v[84:87], v[48:51], v[100:103]
    ds_read_b128 v[32:35], v18 offset:32768
    v_mfma_f32_16x16x32_bf16 v[104:107], v[88:91], v[48:51], v[104:107]
    ds_read_b128 v[36:39], v18 offset:34816
    v_mfma_f32_16x16x32_bf16 v[108:111], v[92:95], v[48:51], v[108:111]
    ds_read_b128 v[40:43], v18 offset:36864
    v_mfma_f32_16x16x32_bf16 v[112:115], v[80:83], v[52:55], v[112:115]
    v_mfma_f32_16x16x32_bf16 v[116:119], v[84:87], v[52:55], v[116:119]
    ds_read_b128 v[44:47], v18 offset:38912
    v_mfma_f32_16x16x32_bf16 v[120:123], v[88:91], v[52:55], v[120:123]
    ds_read_b64_tr_b16 v[64:65], v20 offset:49152
    v_mfma_f32_16x16x32_bf16 v[124:127], v[92:95], v[52:55], v[124:127]
    ds_read_b64_tr_b16 v[66:67], v20 offset:50176
    v_mfma_f32_16x16x32_bf16 v[128:131], v[80:83], v[56:59], v[128:131]
    v_mfma_f32_16x16x32_bf16 v[132:135], v[84:87], v[56:59], v[132:135]
    ds_read_b64_tr_b16 v[68:69], v21 offset:49152
    v_mfma_f32_16x16x32_bf16 v[136:139], v[88:91], v[56:59], v[136:139]
    ds_read_b64_tr_b16 v[70:71], v21 offset:50176
    v_mfma_f32_16x16x32_bf16 v[140:143], v[92:95], v[56:59], v[140:143]
    ds_read_b64_tr_b16 v[72:73], v22 offset:49152
    v_mfma_f32_16x16x32_bf16 v[144:147], v[80:83], v[60:63], v[144:147]
    v_mfma_f32_16x16x32_bf16 v[148:151], v[84:87], v[60:63], v[148:151]
    ds_read_b64_tr_b16 v[74:75], v22 offset:50176
    v_mfma_f32_16x16x32_bf16 v[152:155], v[88:91], v[60:63], v[152:155]
    ds_read_b64_tr_b16 v[76:77], v23 offset:49152
    v_mfma_f32_16x16x32_bf16 v[156:159], v[92:95], v[60:63], v[156:159]
    ds_read_b64_tr_b16 v[78:79], v23 offset:50176
    s_barrier
    s_waitcnt lgkmcnt(0)
    v_mfma_f32_16x16x32_bf16 v[96:99], v[64:67], v[32:35], v[96:99]
    v_mfma_f32_16x16x32_bf16 v[100:103], v[68:71], v[32:35], v[100:103]
    ds_read_b128 v[48:51], v19 offset:32768
    v_mfma_f32_16x16x32_bf16 v[104:107], v[72:75], v[32:35], v[104:107]
    ds_read_b128 v[52:55], v19 offset:34816
    v_mfma_f32_16x16x32_bf16 v[108:111], v[76:79], v[32:35], v[108:111]
    ds_read_b128 v[56:59], v19 offset:36864
    v_mfma_f32_16x16x32_bf16 v[112:115], v[64:67], v[36:39], v[112:115]
    v_mfma_f32_16x16x32_bf16 v[116:119], v[68:71], v[36:39], v[116:119]
    ds_read_b128 v[60:63], v19 offset:38912
    v_mfma_f32_16x16x32_bf16 v[120:123], v[72:75], v[36:39], v[120:123]
    ds_read_b64_tr_b16 v[80:81], v20 offset:57344
    v_mfma_f32_16x16x32_bf16 v[124:127], v[76:79], v[36:39], v[124:127]
    ds_read_b64_tr_b16 v[82:83], v20 offset:58368
    v_mfma_f32_16x16x32_bf16 v[128:131], v[64:67], v[40:43], v[128:131]
    v_mfma_f32_16x16x32_bf16 v[132:135], v[68:71], v[40:43], v[132:135]
    ds_read_b64_tr_b16 v[84:85], v21 offset:57344
    v_mfma_f32_16x16x32_bf16 v[136:139], v[72:75], v[40:43], v[136:139]
    ds_read_b64_tr_b16 v[86:87], v21 offset:58368
    v_mfma_f32_16x16x32_bf16 v[140:143], v[76:79], v[40:43], v[140:143]
    ds_read_b64_tr_b16 v[88:89], v22 offset:57344
    v_mfma_f32_16x16x32_bf16 v[144:147], v[64:67], v[44:47], v[144:147]
    v_mfma_f32_16x16x32_bf16 v[148:151], v[68:71], v[44:47], v[148:151]
    ds_read_b64_tr_b16 v[90:91], v22 offset:58368
    v_mfma_f32_16x16x32_bf16 v[152:155], v[72:75], v[44:47], v[152:155]
    ds_read_b64_tr_b16 v[92:93], v23 offset:57344
    v_mfma_f32_16x16x32_bf16 v[156:159], v[76:79], v[44:47], v[156:159]
    ds_read_b64_tr_b16 v[94:95], v23 offset:58368
    s_waitcnt lgkmcnt(0)
    v_mfma_f32_16x16x32_bf16 v[96:99], v[80:83], v[48:51], v[96:99]
    v_mfma_f32_16x16x32_bf16 v[100:103], v[84:87], v[48:51], v[100:103]
    ds_read_b128 v[32:35], v26 offset:0
    v_mfma_f32_16x16x32_bf16 v[104:107], v[88:91], v[48:51], v[104:107]
    ds_read_b128 v[36:39], v26 offset:2048
    v_mfma_f32_16x16x32_bf16 v[108:111], v[92:95], v[48:51], v[108:111]
    ds_read_b128 v[40:43], v26 offset:4096
    v_mfma_f32_16x16x32_bf16 v[112:115], v[80:83], v[52:55], v[112:115]
    v_mfma_f32_16x16x32_bf16 v[116:119], v[84:87], v[52:55], v[116:119]
    ds_read_b128 v[44:47], v26 offset:6144
    v_mfma_f32_16x16x32_bf16 v[120:123], v[88:91], v[52:55], v[120:123]
    ds_read_b64_tr_b16 v[64:65], v28 offset:16384
    v_mfma_f32_16x16x32_bf16 v[124:127], v[92:95], v[52:55], v[124:127]
    ds_read_b64_tr_b16 v[66:67], v28 offset:17408
    v_mfma_f32_16x16x32_bf16 v[128:131], v[80:83], v[56:59], v[128:131]
    v_mfma_f32_16x16x32_bf16 v[132:135], v[84:87], v[56:59], v[132:135]
    ds_read_b64_tr_b16 v[68:69], v29 offset:16384
    v_mfma_f32_16x16x32_bf16 v[136:139], v[88:91], v[56:59], v[136:139]
    ds_read_b64_tr_b16 v[70:71], v29 offset:17408
    v_mfma_f32_16x16x32_bf16 v[140:143], v[92:95], v[56:59], v[140:143]
    ds_read_b64_tr_b16 v[72:73], v30 offset:16384
    v_mfma_f32_16x16x32_bf16 v[144:147], v[80:83], v[60:63], v[144:147]
    v_mfma_f32_16x16x32_bf16 v[148:151], v[84:87], v[60:63], v[148:151]
    ds_read_b64_tr_b16 v[74:75], v30 offset:17408
    v_mfma_f32_16x16x32_bf16 v[152:155], v[88:91], v[60:63], v[152:155]
    ds_read_b64_tr_b16 v[76:77], v31 offset:16384
    v_mfma_f32_16x16x32_bf16 v[156:159], v[92:95], v[60:63], v[156:159]
    ds_read_b64_tr_b16 v[78:79], v31 offset:17408
    s_barrier
    s_waitcnt lgkmcnt(0)
    v_mfma_f32_16x16x32_bf16 v[96:99], v[64:67], v[32:35], v[96:99]
    v_mfma_f32_16x16x32_bf16 v[100:103], v[68:71], v[32:35], v[100:103]
    ds_read_b128 v[48:51], v27 offset:0
    v_mfma_f32_16x16x32_bf16 v[104:107], v[72:75], v[32:35], v[104:107]
    ds_read_b128 v[52:55], v27 offset:2048
    v_mfma_f32_16x16x32_bf16 v[108:111], v[76:79], v[32:35], v[108:111]
    ds_read_b128 v[56:59], v27 offset:4096
    v_mfma_f32_16x16x32_bf16 v[112:115], v[64:67], v[36:39], v[112:115]
    v_mfma_f32_16x16x32_bf16 v[116:119], v[68:71], v[36:39], v[116:119]
    ds_read_b128 v[60:63], v27 offset:6144
    v_mfma_f32_16x16x32_bf16 v[120:123], v[72:75], v[36:39], v[120:123]
    ds_read_b64_tr_b16 v[80:81], v28 offset:24576
    v_mfma_f32_16x16x32_bf16 v[124:127], v[76:79], v[36:39], v[124:127]
    ds_read_b64_tr_b16 v[82:83], v28 offset:25600
    v_mfma_f32_16x16x32_bf16 v[128:131], v[64:67], v[40:43], v[128:131]
    v_mfma_f32_16x16x32_bf16 v[132:135], v[68:71], v[40:43], v[132:135]
    ds_read_b64_tr_b16 v[84:85], v29 offset:24576
    v_mfma_f32_16x16x32_bf16 v[136:139], v[72:75], v[40:43], v[136:139]
    ds_read_b64_tr_b16 v[86:87], v29 offset:25600
    v_mfma_f32_16x16x32_bf16 v[140:143], v[76:79], v[40:43], v[140:143]
    ds_read_b64_tr_b16 v[88:89], v30 offset:24576
    v_mfma_f32_16x16x32_bf16 v[144:147], v[64:67], v[44:47], v[144:147]
    v_mfma_f32_16x16x32_bf16 v[148:151], v[68:71], v[44:47], v[148:151]
    ds_read_b64_tr_b16 v[90:91], v30 offset:25600
    v_mfma_f32_16x16x32_bf16 v[152:155], v[72:75], v[44:47], v[152:155]
    ds_read_b64_tr_b16 v[92:93], v31 offset:24576
    v_mfma_f32_16x16x32_bf16 v[156:159], v[76:79], v[44:47], v[156:159]
    ds_read_b64_tr_b16 v[94:95], v31 offset:25600
    s_waitcnt lgkmcnt(0)
    v_mfma_f32_16x16x32_bf16 v[96:99], v[80:83], v[48:51], v[96:99]
    v_mfma_f32_16x16x32_bf16 v[100:103], v[84:87], v[48:51], v[100:103]
    ds_read_b128 v[32:35], v26 offset:32768
    v_mfma_f32_16x16x32_bf16 v[104:107], v[88:91], v[48:51], v[104:107]
    ds_read_b128 v[36:39], v26 offset:34816
    v_mfma_f32_16x16x32_bf16 v[108:111], v[92:95], v[48:51], v[108:111]
    ds_read_b128 v[40:43], v26 offset:36864
    v_mfma_f32_16x16x32_bf16 v[112:115], v[80:83], v[52:55], v[112:115]
    v_mfma_f32_16x16x32_bf16 v[116:119], v[84:87], v[52:55], v[116:119]
    ds_read_b128 v[44:47], v26 offset:38912
    v_mfma_f32_16x16x32_bf16 v[120:123], v[88:91], v[52:55], v[120:123]
    ds_read_b64_tr_b16 v[64:65], v28 offset:49152
    v_mfma_f32_16x16x32_bf16 v[124:127], v[92:95], v[52:55], v[124:127]
    ds_read_b64_tr_b16 v[66:67], v28 offset:50176
    v_mfma_f32_16x16x32_bf16 v[128:131], v[80:83], v[56:59], v[128:131]
    v_mfma_f32_16x16x32_bf16 v[132:135], v[84:87], v[56:59], v[132:135]
    ds_read_b64_tr_b16 v[68:69], v29 offset:49152
    v_mfma_f32_16x16x32_bf16 v[136:139], v[88:91], v[56:59], v[136:139]
    ds_read_b64_tr_b16 v[70:71], v29 offset:50176
    v_mfma_f32_16x16x32_bf16 v[140:143], v[92:95], v[56:59], v[140:143]
    ds_read_b64_tr_b16 v[72:73], v30 offset:49152
    v_mfma_f32_16x16x32_bf16 v[144:147], v[80:83], v[60:63], v[144:147]
    v_mfma_f32_16x16x32_bf16 v[148:151], v[84:87], v[60:63], v[148:151]
    ds_read_b64_tr_b16 v[74:75], v30 offset:50176
    v_mfma_f32_16x16x32_bf16 v[152:155], v[88:91], v[60:63], v[152:155]
    ds_read_b64_tr_b16 v[76:77], v31 offset:49152
    v_mfma_f32_16x16x32_bf16 v[156:159], v[92:95], v[60:63], v[156:159]
    ds_read_b64_tr_b16 v[78:79], v31 offset:50176
    s_barrier
    s_waitcnt lgkmcnt(0)
    v_mfma_f32_16x16x32_bf16 v[96:99], v[64:67], v[32:35], v[96:99]
    v_mfma_f32_16x16x32_bf16 v[100:103], v[68:71], v[32:35], v[100:103]
    ds_read_b128 v[48:51], v27 offset:32768
    v_mfma_f32_16x16x32_bf16 v[104:107], v[72:75], v[32:35], v[104:107]
    ds_read_b128 v[52:55], v27 offset:34816
    v_mfma_f32_16x16x32_bf16 v[108:111], v[76:79], v[32:35], v[108:111]
    ds_read_b128 v[56:59], v27 offset:36864
    v_mfma_f32_16x16x32_bf16 v[112:115], v[64:67], v[36:39], v[112:115]
    v_mfma_f32_16x16x32_bf16 v[116:119], v[68:71], v[36:39], v[116:119]
    ds_read_b128 v[60:63], v27 offset:38912
    v_mfma_f32_16x16x32_bf16 v[120:123], v[72:75], v[36:39], v[120:123]
    ds_read_b64_tr_b16 v[80:81], v28 offset:57344
    v_mfma_f32_16x16x32_bf16 v[124:127], v[76:79], v[36:39], v[124:127]
    ds_read_b64_tr_b16 v[82:83], v28 offset:58368
    v_mfma_f32_16x16x32_bf16 v[128:131], v[64:67], v[40:43], v[128:131]
    v_mfma_f32_16x16x32_bf16 v[132:135], v[68:71], v[40:43], v[132:135]
    ds_read_b64_tr_b16 v[84:85], v29 offset:57344
    v_mfma_f32_16x16x32_bf16 v[136:139], v[72:75], v[40:43], v[136:139]
    ds_read_b64_tr_b16 v[86:87], v29 offset:58368
    v_mfma_f32_16x16x32_bf16 v[140:143], v[76:79], v[40:43], v[140:143]
    ds_read_b64_tr_b16 v[88:89], v30 offset:57344
    v_mfma_f32_16x16x32_bf16 v[144:147], v[64:67], v[44:47], v[144:147]
    v_mfma_f32_16x16x32_bf16 v[148:151], v[68:71], v[44:47], v[148:151]
    ds_read_b64_tr_b16 v[90:91], v30 offset:58368
    v_mfma_f32_16x16x32_bf16 v[152:155], v[72:75], v[44:47], v[152:155]
    ds_read_b64_tr_b16 v[92:93], v31 offset:57344
    v_mfma_f32_16x16x32_bf16 v[156:159], v[76:79], v[44:47], v[156:159]
    ds_read_b64_tr_b16 v[94:95], v31 offset:58368
    s_waitcnt lgkmcnt(0)
    v_mfma_f32_16x16x32_bf16 v[96:99], v[80:83], v[48:51], v[96:99]
    v_mfma_f32_16x16x32_bf16 v[100:103], v[84:87], v[48:51], v[100:103]
    ds_read_b128 v[32:35], v18 offset:0
    v_mfma_f32_16x16x32_bf16 v[104:107], v[88:91], v[48:51], v[104:107]
    ds_read_b128 v[36:39], v18 offset:2048
    v_mfma_f32_16x16x32_bf16 v[108:111], v[92:95], v[48:51], v[108:111]
    ds_read_b128 v[40:43], v18 offset:4096
    v_mfma_f32_16x16x32_bf16 v[112:115], v[80:83], v[52:55], v[112:115]
    v_mfma_f32_16x16x32_bf16 v[116:119], v[84:87], v[52:55], v[116:119]
    ds_read_b128 v[44:47], v18 offset:6144
    v_mfma_f32_16x16x32_bf16 v[120:123], v[88:91], v[52:55], v[120:123]
    ds_read_b64_tr_b16 v[64:65], v20 offset:16384
    v_mfma_f32_16x16x32_bf16 v[124:127], v[92:95], v[52:55], v[124:127]
    ds_read_b64_tr_b16 v[66:67], v20 offset:17408
    v_mfma_f32_16x16x32_bf16 v[128:131], v[80:83], v[56:59], v[128:131]
    v_mfma_f32_16x16x32_bf16 v[132:135], v[84:87], v[56:59], v[132:135]
    ds_read_b64_tr_b16 v[68:69], v21 offset:16384
    v_mfma_f32_16x16x32_bf16 v[136:139], v[88:91], v[56:59], v[136:139]
    ds_read_b64_tr_b16 v[70:71], v21 offset:17408
    v_mfma_f32_16x16x32_bf16 v[140:143], v[92:95], v[56:59], v[140:143]
    ds_read_b64_tr_b16 v[72:73], v22 offset:16384
    v_mfma_f32_16x16x32_bf16 v[144:147], v[80:83], v[60:63], v[144:147]
    v_mfma_f32_16x16x32_bf16 v[148:151], v[84:87], v[60:63], v[148:151]
    ds_read_b64_tr_b16 v[74:75], v22 offset:17408
    v_mfma_f32_16x16x32_bf16 v[152:155], v[88:91], v[60:63], v[152:155]
    ds_read_b64_tr_b16 v[76:77], v23 offset:16384
    v_mfma_f32_16x16x32_bf16 v[156:159], v[92:95], v[60:63], v[156:159]
    ds_read_b64_tr_b16 v[78:79], v23 offset:17408
    s_barrier
    s_add_u32 s31, s31, 1
    s_cmp_lt_u32 s31, 2
    s_cbranch_scc1 Lcloop_qkv1_kernel_3
    s_waitcnt lgkmcnt(0)
    v_mfma_f32_16x16x32_bf16 v[96:99], v[64:67], v[32:35], v[96:99]
    v_mfma_f32_16x16x32_bf16 v[100:103], v[68:71], v[32:35], v[100:103]
    ds_read_b128 v[48:51], v19 offset:0
    v_mfma_f32_16x16x32_bf16 v[104:107], v[72:75], v[32:35], v[104:107]
    ds_read_b128 v[52:55], v19 offset:2048
    v_mfma_f32_16x16x32_bf16 v[108:111], v[76:79], v[32:35], v[108:111]
    ds_read_b128 v[56:59], v19 offset:4096
    v_mfma_f32_16x16x32_bf16 v[112:115], v[64:67], v[36:39], v[112:115]
    v_mfma_f32_16x16x32_bf16 v[116:119], v[68:71], v[36:39], v[116:119]
    ds_read_b128 v[60:63], v19 offset:6144
    v_mfma_f32_16x16x32_bf16 v[120:123], v[72:75], v[36:39], v[120:123]
    ds_read_b64_tr_b16 v[80:81], v20 offset:24576
    v_mfma_f32_16x16x32_bf16 v[124:127], v[76:79], v[36:39], v[124:127]
    ds_read_b64_tr_b16 v[82:83], v20 offset:25600
    v_mfma_f32_16x16x32_bf16 v[128:131], v[64:67], v[40:43], v[128:131]
    v_mfma_f32_16x16x32_bf16 v[132:135], v[68:71], v[40:43], v[132:135]
    ds_read_b64_tr_b16 v[84:85], v21 offset:24576
    v_mfma_f32_16x16x32_bf16 v[136:139], v[72:75], v[40:43], v[136:139]
    ds_read_b64_tr_b16 v[86:87], v21 offset:25600
    v_mfma_f32_16x16x32_bf16 v[140:143], v[76:79], v[40:43], v[140:143]
    ds_read_b64_tr_b16 v[88:89], v22 offset:24576
    v_mfma_f32_16x16x32_bf16 v[144:147], v[64:67], v[44:47], v[144:147]
    v_mfma_f32_16x16x32_bf16 v[148:151], v[68:71], v[44:47], v[148:151]
    ds_read_b64_tr_b16 v[90:91], v22 offset:25600
    v_mfma_f32_16x16x32_bf16 v[152:155], v[72:75], v[44:47], v[152:155]
    ds_read_b64_tr_b16 v[92:93], v23 offset:24576
    v_mfma_f32_16x16x32_bf16 v[156:159], v[76:79], v[44:47], v[156:159]
    ds_read_b64_tr_b16 v[94:95], v23 offset:25600
    s_waitcnt lgkmcnt(0)
    v_mfma_f32_16x16x32_bf16 v[96:99], v[80:83], v[48:51], v[96:99]
    v_mfma_f32_16x16x32_bf16 v[100:103], v[84:87], v[48:51], v[100:103]
    ds_read_b128 v[32:35], v18 offset:32768
    v_mfma_f32_16x16x32_bf16 v[104:107], v[88:91], v[48:51], v[104:107]
    ds_read_b128 v[36:39], v18 offset:34816
    v_mfma_f32_16x16x32_bf16 v[108:111], v[92:95], v[48:51], v[108:111]
    ds_read_b128 v[40:43], v18 offset:36864
    v_mfma_f32_16x16x32_bf16 v[112:115], v[80:83], v[52:55], v[112:115]
    v_mfma_f32_16x16x32_bf16 v[116:119], v[84:87], v[52:55], v[116:119]
    ds_read_b128 v[44:47], v18 offset:38912
    v_mfma_f32_16x16x32_bf16 v[120:123], v[88:91], v[52:55], v[120:123]
    ds_read_b64_tr_b16 v[64:65], v20 offset:49152
    v_mfma_f32_16x16x32_bf16 v[124:127], v[92:95], v[52:55], v[124:127]
    ds_read_b64_tr_b16 v[66:67], v20 offset:50176
    v_mfma_f32_16x16x32_bf16 v[128:131], v[80:83], v[56:59], v[128:131]
    v_mfma_f32_16x16x32_bf16 v[132:135], v[84:87], v[56:59], v[132:135]
    ds_read_b64_tr_b16 v[68:69], v21 offset:49152
    v_mfma_f32_16x16x32_bf16 v[136:139], v[88:91], v[56:59], v[136:139]
    ds_read_b64_tr_b16 v[70:71], v21 offset:50176
    v_mfma_f32_16x16x32_bf16 v[140:143], v[92:95], v[56:59], v[140:143]
    ds_read_b64_tr_b16 v[72:73], v22 offset:49152
    v_mfma_f32_16x16x32_bf16 v[144:147], v[80:83], v[60:63], v[144:147]
    v_mfma_f32_16x16x32_bf16 v[148:151], v[84:87], v[60:63], v[148:151]
    ds_read_b64_tr_b16 v[74:75], v22 offset:50176
    v_mfma_f32_16x16x32_bf16 v[152:155], v[88:91], v[60:63], v[152:155]
    ds_read_b64_tr_b16 v[76:77], v23 offset:49152
    v_mfma_f32_16x16x32_bf16 v[156:159], v[92:95], v[60:63], v[156:159]
    ds_read_b64_tr_b16 v[78:79], v23 offset:50176
    s_barrier
    s_waitcnt lgkmcnt(0)
    v_mfma_f32_16x16x32_bf16 v[96:99], v[64:67], v[32:35], v[96:99]
    v_mfma_f32_16x16x32_bf16 v[100:103], v[68:71], v[32:35], v[100:103]
    ds_read_b128 v[48:51], v19 offset:32768
    v_mfma_f32_16x16x32_bf16 v[104:107], v[72:75], v[32:35], v[104:107]
    ds_read_b128 v[52:55], v19 offset:34816
    v_mfma_f32_16x16x32_bf16 v[108:111], v[76:79], v[32:35], v[108:111]
    ds_read_b128 v[56:59], v19 offset:36864
    v_mfma_f32_16x16x32_bf16 v[112:115], v[64:67], v[36:39], v[112:115]
    v_mfma_f32_16x16x32_bf16 v[116:119], v[68:71], v[36:39], v[116:119]
    ds_read_b128 v[60:63], v19 offset:38912
    v_mfma_f32_16x16x32_bf16 v[120:123], v[72:75], v[36:39], v[120:123]
    ds_read_b64_tr_b16 v[80:81], v20 offset:57344
    v_mfma_f32_16x16x32_bf16 v[124:127], v[76:79], v[36:39], v[124:127]
    ds_read_b64_tr_b16 v[82:83], v20 offset:58368
    v_mfma_f32_16x16x32_bf16 v[128:131], v[64:67], v[40:43], v[128:131]
    v_mfma_f32_16x16x32_bf16 v[132:135], v[68:71], v[40:43], v[132:135]
    ds_read_b64_tr_b16 v[84:85], v21 offset:57344
    v_mfma_f32_16x16x32_bf16 v[136:139], v[72:75], v[40:43], v[136:139]
    ds_read_b64_tr_b16 v[86:87], v21 offset:58368
    v_mfma_f32_16x16x32_bf16 v[140:143], v[76:79], v[40:43], v[140:143]
    ds_read_b64_tr_b16 v[88:89], v22 offset:57344
    v_mfma_f32_16x16x32_bf16 v[144:147], v[64:67], v[44:47], v[144:147]
    v_mfma_f32_16x16x32_bf16 v[148:151], v[68:71], v[44:47], v[148:151]
    ds_read_b64_tr_b16 v[90:91], v22 offset:58368
    v_mfma_f32_16x16x32_bf16 v[152:155], v[72:75], v[44:47], v[152:155]
    ds_read_b64_tr_b16 v[92:93], v23 offset:57344
    v_mfma_f32_16x16x32_bf16 v[156:159], v[76:79], v[44:47], v[156:159]
    ds_read_b64_tr_b16 v[94:95], v23 offset:58368
    s_waitcnt lgkmcnt(0)
    v_mfma_f32_16x16x32_bf16 v[96:99], v[80:83], v[48:51], v[96:99]
    v_mfma_f32_16x16x32_bf16 v[100:103], v[84:87], v[48:51], v[100:103]
    v_mfma_f32_16x16x32_bf16 v[104:107], v[88:91], v[48:51], v[104:107]
    v_mfma_f32_16x16x32_bf16 v[108:111], v[92:95], v[48:51], v[108:111]
    v_mfma_f32_16x16x32_bf16 v[112:115], v[80:83], v[52:55], v[112:115]
    v_mfma_f32_16x16x32_bf16 v[116:119], v[84:87], v[52:55], v[116:119]
    v_mfma_f32_16x16x32_bf16 v[120:123], v[88:91], v[52:55], v[120:123]
    v_mfma_f32_16x16x32_bf16 v[124:127], v[92:95], v[52:55], v[124:127]
    v_mfma_f32_16x16x32_bf16 v[128:131], v[80:83], v[56:59], v[128:131]
    v_mfma_f32_16x16x32_bf16 v[132:135], v[84:87], v[56:59], v[132:135]
    v_mfma_f32_16x16x32_bf16 v[136:139], v[88:91], v[56:59], v[136:139]
    v_mfma_f32_16x16x32_bf16 v[140:143], v[92:95], v[56:59], v[140:143]
    v_mfma_f32_16x16x32_bf16 v[144:147], v[80:83], v[60:63], v[144:147]
    v_mfma_f32_16x16x32_bf16 v[148:151], v[84:87], v[60:63], v[148:151]
    v_mfma_f32_16x16x32_bf16 v[152:155], v[88:91], v[60:63], v[152:155]
    v_mfma_f32_16x16x32_bf16 v[156:159], v[92:95], v[60:63], v[156:159]
    s_barrier
    s_nop 7
    s_nop 7
    v_lshrrev_b32 v3, 1, v2
    v_and_b32 v4, 1, v2
    v_lshrrev_b32 v5, 4, v1
    v_and_b32 v6, 15, v1
    s_load_dwordx2 s[36:37], s[0:1], 88
    s_waitcnt lgkmcnt(0)
    s_add_u32 s20, s36, 39845888
    s_addc_u32 s21, s37, 0
    s_mov_b32 s22, 7680
    s_mov_b32 s23, 0x00020000
    v_lshlrev_b32 v7, 6, v4
    v_lshl_add_u32 v7, v5, 2, v7
    v_add_u32 v7, s28, v7
    v_lshlrev_b32 v7, 2, v7
    buffer_load_dwordx4 v[64:67], v7, s[20:23], 0 offen offset:0
    buffer_load_dwordx4 v[68:71], v7, s[20:23], 0 offen offset:64
    buffer_load_dwordx4 v[72:75], v7, s[20:23], 0 offen offset:128
    buffer_load_dwordx4 v[76:79], v7, s[20:23], 0 offen offset:192
    s_waitcnt vmcnt(0)
    v_fma_f32 v96, -v8, v64, v96
    v_mul_f32 v96, v96, v12
    v_fma_f32 v97, -v8, v65, v97
    v_mul_f32 v97, v97, v12
    v_fma_f32 v98, -v8, v66, v98
    v_mul_f32 v98, v98, v12
    v_fma_f32 v99, -v8, v67, v99
    v_mul_f32 v99, v99, v12
    v_fma_f32 v100, -v8, v68, v100
    v_mul_f32 v100, v100, v12
    v_fma_f32 v101, -v8, v69, v101
    v_mul_f32 v101, v101, v12
    v_fma_f32 v102, -v8, v70, v102
    v_mul_f32 v102, v102, v12
    v_fma_f32 v103, -v8, v71, v103
    v_mul_f32 v103, v103, v12
    v_fma_f32 v104, -v8, v72, v104
    v_mul_f32 v104, v104, v12
    v_fma_f32 v105, -v8, v73, v105
    v_mul_f32 v105, v105, v12
    v_fma_f32 v106, -v8, v74, v106
    v_mul_f32 v106, v106, v12
    v_fma_f32 v107, -v8, v75, v107
    v_mul_f32 v107, v107, v12
    v_fma_f32 v108, -v8, v76, v108
    v_mul_f32 v108, v108, v12
    v_fma_f32 v109, -v8, v77, v109
    v_mul_f32 v109, v109, v12
    v_fma_f32 v110, -v8, v78, v110
    v_mul_f32 v110, v110, v12
    v_fma_f32 v111, -v8, v79, v111
    v_mul_f32 v111, v111, v12
    v_fma_f32 v112, -v9, v64, v112
    v_mul_f32 v112, v112, v13
    v_fma_f32 v113, -v9, v65, v113
    v_mul_f32 v113, v113, v13
    v_fma_f32 v114, -v9, v66, v114
    v_mul_f32 v114, v114, v13
    v_fma_f32 v115, -v9, v67, v115
    v_mul_f32 v115, v115, v13
    v_fma_f32 v116, -v9, v68, v116
    v_mul_f32 v116, v116, v13
    v_fma_f32 v117, -v9, v69, v117
    v_mul_f32 v117, v117, v13
    v_fma_f32 v118, -v9, v70, v118
    v_mul_f32 v118, v118, v13
    v_fma_f32 v119, -v9, v71, v119
    v_mul_f32 v119, v119, v13
    v_fma_f32 v120, -v9, v72, v120
    v_mul_f32 v120, v120, v13
    v_fma_f32 v121, -v9, v73, v121
    v_mul_f32 v121, v121, v13
    v_fma_f32 v122, -v9, v74, v122
    v_mul_f32 v122, v122, v13
    v_fma_f32 v123, -v9, v75, v123
    v_mul_f32 v123, v123, v13
    v_fma_f32 v124, -v9, v76, v124
    v_mul_f32 v124, v124, v13
    v_fma_f32 v125, -v9, v77, v125
    v_mul_f32 v125, v125, v13
    v_fma_f32 v126, -v9, v78, v126
    v_mul_f32 v126, v126, v13
    v_fma_f32 v127, -v9, v79, v127
    v_mul_f32 v127, v127, v13
    v_fma_f32 v128, -v10, v64, v128
    v_mul_f32 v128, v128, v14
    v_fma_f32 v129, -v10, v65, v129
    v_mul_f32 v129, v129, v14
    v_fma_f32 v130, -v10, v66, v130
    v_mul_f32 v130, v130, v14
    v_fma_f32 v131, -v10, v67, v131
    v_mul_f32 v131, v131, v14
    v_fma_f32 v132, -v10, v68, v132
    v_mul_f32 v132, v132, v14
    v_fma_f32 v133, -v10, v69, v133
    v_mul_f32 v133, v133, v14
    v_fma_f32 v134, -v10, v70, v134
    v_mul_f32 v134, v134, v14
    v_fma_f32 v135, -v10, v71, v135
    v_mul_f32 v135, v135, v14
    v_fma_f32 v136, -v10, v72, v136
    v_mul_f32 v136, v136, v14
    v_fma_f32 v137, -v10, v73, v137
    v_mul_f32 v137, v137, v14
    v_fma_f32 v138, -v10, v74, v138
    v_mul_f32 v138, v138, v14
    v_fma_f32 v139, -v10, v75, v139
    v_mul_f32 v139, v139, v14
    v_fma_f32 v140, -v10, v76, v140
    v_mul_f32 v140, v140, v14
    v_fma_f32 v141, -v10, v77, v141
    v_mul_f32 v141, v141, v14
    v_fma_f32 v142, -v10, v78, v142
    v_mul_f32 v142, v142, v14
    v_fma_f32 v143, -v10, v79, v143
    v_mul_f32 v143, v143, v14
    v_fma_f32 v144, -v11, v64, v144
    v_mul_f32 v144, v144, v15
    v_fma_f32 v145, -v11, v65, v145
    v_mul_f32 v145, v145, v15
    v_fma_f32 v146, -v11, v66, v146
    v_mul_f32 v146, v146, v15
    v_fma_f32 v147, -v11, v67, v147
    v_mul_f32 v147, v147, v15
    v_fma_f32 v148, -v11, v68, v148
    v_mul_f32 v148, v148, v15
    v_fma_f32 v149, -v11, v69, v149
    v_mul_f32 v149, v149, v15
    v_fma_f32 v150, -v11, v70, v150
    v_mul_f32 v150, v150, v15
    v_fma_f32 v151, -v11, v71, v151
    v_mul_f32 v151, v151, v15
    v_fma_f32 v152, -v11, v72, v152
    v_mul_f32 v152, v152, v15
    v_fma_f32 v153, -v11, v73, v153
    v_mul_f32 v153, v153, v15
    v_fma_f32 v154, -v11, v74, v154
    v_mul_f32 v154, v154, v15
    v_fma_f32 v155, -v11, v75, v155
    v_mul_f32 v155, v155, v15
    v_fma_f32 v156, -v11, v76, v156
    v_mul_f32 v156, v156, v15
    v_fma_f32 v157, -v11, v77, v157
    v_mul_f32 v157, v157, v15
    v_fma_f32 v158, -v11, v78, v158
    v_mul_f32 v158, v158, v15
    v_fma_f32 v159, -v11, v79, v159
    v_mul_f32 v159, v159, v15
    v_mul_u32_u24 v7, 9216, v2
    v_mul_u32_u24 v8, 144, v6
    v_add_u32 v7, v7, v8
    v_lshl_add_u32 v7, v5, 3, v7
    v_cvt_pk_bf16_f32 v32, v96, v97
    v_cvt_pk_bf16_f32 v33, v98, v99
    ds_write_b64 v7, v[32:33] offset:0
    v_cvt_pk_bf16_f32 v40, v100, v101
    v_cvt_pk_bf16_f32 v41, v102, v103
    ds_write_b64 v7, v[40:41] offset:32
    v_cvt_pk_bf16_f32 v48, v104, v105
    v_cvt_pk_bf16_f32 v49, v106, v107
    ds_write_b64 v7, v[48:49] offset:64
    v_cvt_pk_bf16_f32 v56, v108, v109
    v_cvt_pk_bf16_f32 v57, v110, v111
    ds_write_b64 v7, v[56:57] offset:96
    v_cvt_pk_bf16_f32 v32, v112, v113
    v_cvt_pk_bf16_f32 v33, v114, v115
    ds_write_b64 v7, v[32:33] offset:2304
    v_cvt_pk_bf16_f32 v40, v116, v117
    v_cvt_pk_bf16_f32 v41, v118, v119
    ds_write_b64 v7, v[40:41] offset:2336
    v_cvt_pk_bf16_f32 v48, v120, v121
    v_cvt_pk_bf16_f32 v49, v122, v123
    ds_write_b64 v7, v[48:49] offset:2368
    v_cvt_pk_bf16_f32 v56, v124, v125
    v_cvt_pk_bf16_f32 v57, v126, v127
    ds_write_b64 v7, v[56:57] offset:2400
    v_cvt_pk_bf16_f32 v32, v128, v129
    v_cvt_pk_bf16_f32 v33, v130, v131
    ds_write_b64 v7, v[32:33] offset:4608
    v_cvt_pk_bf16_f32 v40, v132, v133
    v_cvt_pk_bf16_f32 v41, v134, v135
    ds_write_b64 v7, v[40:41] offset:4640
    v_cvt_pk_bf16_f32 v48, v136, v137
    v_cvt_pk_bf16_f32 v49, v138, v139
    ds_write_b64 v7, v[48:49] offset:4672
    v_cvt_pk_bf16_f32 v56, v140, v141
    v_cvt_pk_bf16_f32 v57, v142, v143
    ds_write_b64 v7, v[56:57] offset:4704
    v_cvt_pk_bf16_f32 v32, v144, v145
    v_cvt_pk_bf16_f32 v33, v146, v147
    ds_write_b64 v7, v[32:33] offset:6912
    v_cvt_pk_bf16_f32 v40, v148, v149
    v_cvt_pk_bf16_f32 v41, v150, v151
    ds_write_b64 v7, v[40:41] offset:6944
    v_cvt_pk_bf16_f32 v48, v152, v153
    v_cvt_pk_bf16_f32 v49, v154, v155
    ds_write_b64 v7, v[48:49] offset:6976
    v_cvt_pk_bf16_f32 v56, v156, v157
    v_cvt_pk_bf16_f32 v57, v158, v159
    ds_write_b64 v7, v[56:57] offset:7008
    s_waitcnt lgkmcnt(0)
    v_lshrrev_b32 v8, 3, v1
    v_and_b32 v9, 7, v1
    v_mul_u32_u24 v7, 9216, v2
    v_mul_u32_u24 v10, 144, v8
    v_add_u32 v7, v7, v10
    v_lshl_add_u32 v7, v9, 4, v7
    v_mul_u32_u24 v10, 64, v3
    v_add_u32 v10, v10, v8
    v_add_u32 v10, s27, v10
    v_lshlrev_b32 v11, 6, v4
    v_lshl_add_u32 v11, v9, 3, v11
    v_add_u32 v11, s28, v11
    v_mul_u32_u24 v12, 3840, v10
    v_lshl_add_u32 v12, v11, 1, v12
    ds_read_b128 v[96:99], v7 offset:0
    ds_read_b128 v[100:103], v7 offset:1152
    ds_read_b128 v[104:107], v7 offset:2304
    ds_read_b128 v[108:111], v7 offset:3456
    ds_read_b128 v[112:115], v7 offset:4608
    ds_read_b128 v[116:119], v7 offset:5760
    ds_read_b128 v[120:123], v7 offset:6912
    ds_read_b128 v[124:127], v7 offset:8064
    s_waitcnt lgkmcnt(0)
    buffer_store_dwordx4 v[96:99], v12, s[16:19], 0 offen
    v_add_u32 v12, 30720, v12
    buffer_store_dwordx4 v[100:103], v12, s[16:19], 0 offen
    v_add_u32 v12, 30720, v12
    buffer_store_dwordx4 v[104:107], v12, s[16:19], 0 offen
    v_add_u32 v12, 30720, v12
    buffer_store_dwordx4 v[108:111], v12, s[16:19], 0 offen
    v_add_u32 v12, 30720, v12
    buffer_store_dwordx4 v[112:115], v12, s[16:19], 0 offen
    v_add_u32 v12, 30720, v12
    buffer_store_dwordx4 v[116:119], v12, s[16:19], 0 offen
    v_add_u32 v12, 30720, v12
    buffer_store_dwordx4 v[120:123], v12, s[16:19], 0 offen
    v_add_u32 v12, 30720, v12
    buffer_store_dwordx4 v[124:127], v12, s[16:19], 0 offen
Lend_qkv1_kernel_1:
    s_endpgm
Lloader_qkv1_kernel_2:
    v_subrev_u32 v0, 256, v0
    v_and_b32 v1, 63, v0
    s_sub_u32 s42, s41, 4
    v_lshrrev_b32 v3, 3, v1
    v_and_b32 v4, 7, v1
    v_xor_b32 v4, v4, v3
    s_mul_i32 s43, s42, 32
    s_add_u32 s43, s43, s27
    v_add_u32 v5, s43, v3
    v_mul_u32_u24 v5, 1280, v5
    v_lshl_add_u32 v8, v4, 4, v5
    v_add_u32 v9, 10240, v8
    v_add_u32 v10, 20480, v8
    v_add_u32 v11, 30720, v8
    v_lshrrev_b32 v3, 4, v1
    v_and_b32 v4, 15, v1
    v_lshrrev_b32 v5, 1, v4
    v_and_b32 v6, 1, v4
    s_mul_i32 s43, s42, 4
    s_add_u32 s44, s43, 0
    s_lshr_b32 s44, s44, 1
    s_and_b32 s44, s44, 1
    s_lshl_b32 s44, s44, 2
    v_add_u32 v7, s44, v3
    v_xor_b32 v7, v5, v7
    v_lshl_add_u32 v7, v7, 1, v6
    v_lshlrev_b32 v7, 4, v7
    s_add_u32 s44, s43, 0
    s_lshl_b32 s44, s44, 2
    v_add_u32 v12, s44, v3
    v_mul_u32_u24 v12, 3840, v12
    v_add_u32 v12, v12, v7
    v_lshl_add_u32 v12, s28, 1, v12
    s_add_u32 s44, s43, 1
    s_lshr_b32 s44, s44, 1
    s_and_b32 s44, s44, 1
    s_lshl_b32 s44, s44, 2
    v_add_u32 v7, s44, v3
    v_xor_b32 v7, v5, v7
    v_lshl_add_u32 v7, v7, 1, v6
    v_lshlrev_b32 v7, 4, v7
    s_add_u32 s44, s43, 1
    s_lshl_b32 s44, s44, 2
    v_add_u32 v13, s44, v3
    v_mul_u32_u24 v13, 3840, v13
    v_add_u32 v13, v13, v7
    v_lshl_add_u32 v13, s28, 1, v13
    s_add_u32 s44, s43, 2
    s_lshr_b32 s44, s44, 1
    s_and_b32 s44, s44, 1
    s_lshl_b32 s44, s44, 2
    v_add_u32 v7, s44, v3
    v_xor_b32 v7, v5, v7
    v_lshl_add_u32 v7, v7, 1, v6
    v_lshlrev_b32 v7, 4, v7
    s_add_u32 s44, s43, 2
    s_lshl_b32 s44, s44, 2
    v_add_u32 v14, s44, v3
    v_mul_u32_u24 v14, 3840, v14
    v_add_u32 v14, v14, v7
    v_lshl_add_u32 v14, s28, 1, v14
    s_add_u32 s44, s43, 3
    s_lshr_b32 s44, s44, 1
    s_and_b32 s44, s44, 1
    s_lshl_b32 s44, s44, 2
    v_add_u32 v7, s44, v3
    v_xor_b32 v7, v5, v7
    v_lshl_add_u32 v7, v7, 1, v6
    v_lshlrev_b32 v7, 4, v7
    s_add_u32 s44, s43, 3
    s_lshl_b32 s44, s44, 2
    v_add_u32 v15, s44, v3
    v_mul_u32_u24 v15, 3840, v15
    v_add_u32 v15, v15, v7
    v_lshl_add_u32 v15, s28, 1, v15
    s_mul_i32 s45, s42, 4096
    s_mul_i32 s46, s42, 4096
    s_add_u32 s46, s46, 16384
    s_mov_b32 s29, 0
    s_mov_b32 s30, 0
    s_add_u32 m0, s45, 0
    s_nop 0
    buffer_load_dwordx4 v8, s[8:11], s29 offen lds
    s_add_u32 m0, s45, 1024
    s_nop 0
    buffer_load_dwordx4 v9, s[8:11], s29 offen lds
    s_add_u32 m0, s45, 2048
    s_nop 0
    buffer_load_dwordx4 v10, s[8:11], s29 offen lds
    s_add_u32 m0, s45, 3072
    s_nop 0
    buffer_load_dwordx4 v11, s[8:11], s29 offen lds
    s_add_u32 m0, s46, 0
    s_nop 0
    buffer_load_dwordx4 v12, s[12:15], s30 offen lds
    s_add_u32 m0, s46, 1024
    s_nop 0
    buffer_load_dwordx4 v13, s[12:15], s30 offen lds
    s_add_u32 m0, s46, 2048
    s_nop 0
    buffer_load_dwordx4 v14, s[12:15], s30 offen lds
    s_add_u32 m0, s46, 3072
    s_nop 0
    buffer_load_dwordx4 v15, s[12:15], s30 offen lds
    s_add_u32 s29, s29, 128
    s_add_u32 s30, s30, 245760
    s_add_u32 m0, s45, 32768
    s_nop 0
    buffer_load_dwordx4 v8, s[8:11], s29 offen lds
    s_add_u32 m0, s45, 33792
    s_nop 0
    buffer_load_dwordx4 v9, s[8:11], s29 offen lds
    s_add_u32 m0, s45, 34816
    s_nop 0
    buffer_load_dwordx4 v10, s[8:11], s29 offen lds
    s_add_u32 m0, s45, 35840
    s_nop 0
    buffer_load_dwordx4 v11, s[8:11], s29 offen lds
    s_add_u32 m0, s46, 32768
    s_nop 0
    buffer_load_dwordx4 v12, s[12:15], s30 offen lds
    s_add_u32 m0, s46, 33792
    s_nop 0
    buffer_load_dwordx4 v13, s[12:15], s30 offen lds
    s_add_u32 m0, s46, 34816
    s_nop 0
    buffer_load_dwordx4 v14, s[12:15], s30 offen lds
    s_add_u32 m0, s46, 35840
    s_nop 0
    buffer_load_dwordx4 v15, s[12:15], s30 offen lds
    s_add_u32 s29, s29, 128
    s_add_u32 s30, s30, 245760
    s_add_u32 m0, s45, 65536
    s_nop 0
    buffer_load_dwordx4 v8, s[8:11], s29 offen lds
    s_add_u32 m0, s45, 66560
    s_nop 0
    buffer_load_dwordx4 v9, s[8:11], s29 offen lds
    s_add_u32 m0, s45, 67584
    s_nop 0
    buffer_load_dwordx4 v10, s[8:11], s29 offen lds
    s_add_u32 m0, s45, 68608
    s_nop 0
    buffer_load_dwordx4 v11, s[8:11], s29 offen lds
    s_add_u32 m0, s46, 65536
    s_nop 0
    buffer_load_dwordx4 v12, s[12:15], s30 offen lds
    s_add_u32 m0, s46, 66560
    s_nop 0
    buffer_load_dwordx4 v13, s[12:15], s30 offen lds
    s_add_u32 m0, s46, 67584
    s_nop 0
    buffer_load_dwordx4 v14, s[12:15], s30 offen lds
    s_add_u32 m0, s46, 68608
    s_nop 0
    buffer_load_dwordx4 v15, s[12:15], s30 offen lds
    s_add_u32 s29, s29, 128
    s_add_u32 s30, s30, 245760
    s_waitcnt vmcnt(8)
    s_barrier
    s_mov_b32 s31, 0
Llloop_qkv1_kernel_4:
    s_add_u32 m0, s45, 98304
    s_nop 0
    buffer_load_dwordx4 v8, s[8:11], s29 offen lds
    s_add_u32 m0, s45, 99328
    s_nop 0
    buffer_load_dwordx4 v9, s[8:11], s29 offen lds
    s_add_u32 m0, s45, 100352
    s_nop 0
    buffer_load_dwordx4 v10, s[8:11], s29 offen lds
    s_add_u32 m0, s45, 101376
    s_nop 0
    buffer_load_dwordx4 v11, s[8:11], s29 offen lds
    s_add_u32 m0, s46, 98304
    s_nop 0
    buffer_load_dwordx4 v12, s[12:15], s30 offen lds
    s_add_u32 m0, s46, 99328
    s_nop 0
    buffer_load_dwordx4 v13, s[12:15], s30 offen lds
    s_add_u32 m0, s46, 100352
    s_nop 0
    buffer_load_dwordx4 v14, s[12:15], s30 offen lds
    s_add_u32 m0, s46, 101376
    s_nop 0
    buffer_load_dwordx4 v15, s[12:15], s30 offen lds
    s_add_u32 s29, s29, 128
    s_add_u32 s30, s30, 245760
    s_waitcnt vmcnt(8)
    s_barrier
    s_add_u32 m0, s45, 0
    s_nop 0
    buffer_load_dwordx4 v8, s[8:11], s29 offen lds
    s_add_u32 m0, s45, 1024
    s_nop 0
    buffer_load_dwordx4 v9, s[8:11], s29 offen lds
    s_add_u32 m0, s45, 2048
    s_nop 0
    buffer_load_dwordx4 v10, s[8:11], s29 offen lds
    s_add_u32 m0, s45, 3072
    s_nop 0
    buffer_load_dwordx4 v11, s[8:11], s29 offen lds
    s_add_u32 m0, s46, 0
    s_nop 0
    buffer_load_dwordx4 v12, s[12:15], s30 offen lds
    s_add_u32 m0, s46, 1024
    s_nop 0
    buffer_load_dwordx4 v13, s[12:15], s30 offen lds
    s_add_u32 m0, s46, 2048
    s_nop 0
    buffer_load_dwordx4 v14, s[12:15], s30 offen lds
    s_add_u32 m0, s46, 3072
    s_nop 0
    buffer_load_dwordx4 v15, s[12:15], s30 offen lds
    s_add_u32 s29, s29, 128
    s_add_u32 s30, s30, 245760
    s_waitcnt vmcnt(8)
    s_barrier
    s_add_u32 m0, s45, 32768
    s_nop 0
    buffer_load_dwordx4 v8, s[8:11], s29 offen lds
    s_add_u32 m0, s45, 33792
    s_nop 0
    buffer_load_dwordx4 v9, s[8:11], s29 offen lds
    s_add_u32 m0, s45, 34816
    s_nop 0
    buffer_load_dwordx4 v10, s[8:11], s29 offen lds
    s_add_u32 m0, s45, 35840
    s_nop 0
    buffer_load_dwordx4 v11, s[8:11], s29 offen lds
    s_add_u32 m0, s46, 32768
    s_nop 0
    buffer_load_dwordx4 v12, s[12:15], s30 offen lds
    s_add_u32 m0, s46, 33792
    s_nop 0
    buffer_load_dwordx4 v13, s[12:15], s30 offen lds
    s_add_u32 m0, s46, 34816
    s_nop 0
    buffer_load_dwordx4 v14, s[12:15], s30 offen lds
    s_add_u32 m0, s46, 35840
    s_nop 0
    buffer_load_dwordx4 v15, s[12:15], s30 offen lds
    s_add_u32 s29, s29, 128
    s_add_u32 s30, s30, 245760
    s_waitcnt vmcnt(8)
    s_barrier
    s_add_u32 m0, s45, 65536
    s_nop 0
    buffer_load_dwordx4 v8, s[8:11], s29 offen lds
    s_add_u32 m0, s45, 66560
    s_nop 0
    buffer_load_dwordx4 v9, s[8:11], s29 offen lds
    s_add_u32 m0, s45, 67584
    s_nop 0
    buffer_load_dwordx4 v10, s[8:11], s29 offen lds
    s_add_u32 m0, s45, 68608
    s_nop 0
    buffer_load_dwordx4 v11, s[8:11], s29 offen lds
    s_add_u32 m0, s46, 65536
    s_nop 0
    buffer_load_dwordx4 v12, s[12:15], s30 offen lds
    s_add_u32 m0, s46, 66560
    s_nop 0
    buffer_load_dwordx4 v13, s[12:15], s30 offen lds
    s_add_u32 m0, s46, 67584
    s_nop 0
    buffer_load_dwordx4 v14, s[12:15], s30 offen lds
    s_add_u32 m0, s46, 68608
    s_nop 0
    buffer_load_dwordx4 v15, s[12:15], s30 offen lds
    s_add_u32 s29, s29, 128
    s_add_u32 s30, s30, 245760
    s_waitcnt vmcnt(8)
    s_barrier
    s_add_u32 s31, s31, 1
    s_cmp_lt_u32 s31, 1
    s_cbranch_scc1 Llloop_qkv1_kernel_4
    s_add_u32 m0, s45, 98304
    s_nop 0
    buffer_load_dwordx4 v8, s[8:11], s29 offen lds
    s_add_u32 m0, s45, 99328
    s_nop 0
    buffer_load_dwordx4 v9, s[8:11], s29 offen lds
    s_add_u32 m0, s45, 100352
    s_nop 0
    buffer_load_dwordx4 v10, s[8:11], s29 offen lds
    s_add_u32 m0, s45, 101376
    s_nop 0
    buffer_load_dwordx4 v11, s[8:11], s29 offen lds
    s_add_u32 m0, s46, 98304
    s_nop 0
    buffer_load_dwordx4 v12, s[12:15], s30 offen lds
    s_add_u32 m0, s46, 99328
    s_nop 0
    buffer_load_dwordx4 v13, s[12:15], s30 offen lds
    s_add_u32 m0, s46, 100352
    s_nop 0
    buffer_load_dwordx4 v14, s[12:15], s30 offen lds
    s_add_u32 m0, s46, 101376
    s_nop 0
    buffer_load_dwordx4 v15, s[12:15], s30 offen lds
    s_add_u32 s29, s29, 128
    s_add_u32 s30, s30, 245760
    s_waitcnt vmcnt(8)
    s_barrier
    s_add_u32 m0, s45, 0
    s_nop 0
    buffer_load_dwordx4 v8, s[8:11], s29 offen lds
    s_add_u32 m0, s45, 1024
    s_nop 0
    buffer_load_dwordx4 v9, s[8:11], s29 offen lds
    s_add_u32 m0, s45, 2048
    s_nop 0
    buffer_load_dwordx4 v10, s[8:11], s29 offen lds
    s_add_u32 m0, s45, 3072
    s_nop 0
    buffer_load_dwordx4 v11, s[8:11], s29 offen lds
    s_add_u32 m0, s46, 0
    s_nop 0
    buffer_load_dwordx4 v12, s[12:15], s30 offen lds
    s_add_u32 m0, s46, 1024
    s_nop 0
    buffer_load_dwordx4 v13, s[12:15], s30 offen lds
    s_add_u32 m0, s46, 2048
    s_nop 0
    buffer_load_dwordx4 v14, s[12:15], s30 offen lds
    s_add_u32 m0, s46, 3072
    s_nop 0
    buffer_load_dwordx4 v15, s[12:15], s30 offen lds
    s_add_u32 s29, s29, 128
    s_add_u32 s30, s30, 245760
    s_waitcnt vmcnt(8)
    s_barrier
    s_add_u32 m0, s45, 32768
    s_nop 0
    buffer_load_dwordx4 v8, s[8:11], s29 offen lds
    s_add_u32 m0, s45, 33792
    s_nop 0
    buffer_load_dwordx4 v9, s[8:11], s29 offen lds
    s_add_u32 m0, s45, 34816
    s_nop 0
    buffer_load_dwordx4 v10, s[8:11], s29 offen lds
    s_add_u32 m0, s45, 35840
    s_nop 0
    buffer_load_dwordx4 v11, s[8:11], s29 offen lds
    s_add_u32 m0, s46, 32768
    s_nop 0
    buffer_load_dwordx4 v12, s[12:15], s30 offen lds
    s_add_u32 m0, s46, 33792
    s_nop 0
    buffer_load_dwordx4 v13, s[12:15], s30 offen lds
    s_add_u32 m0, s46, 34816
    s_nop 0
    buffer_load_dwordx4 v14, s[12:15], s30 offen lds
    s_add_u32 m0, s46, 35840
    s_nop 0
    buffer_load_dwordx4 v15, s[12:15], s30 offen lds
    s_add_u32 s29, s29, 128
    s_add_u32 s30, s30, 245760
    s_waitcnt vmcnt(8)
    s_barrier
    s_waitcnt vmcnt(0)
    s_barrier
    s_waitcnt vmcnt(0)
    s_barrier
    s_waitcnt vmcnt(0)
    s_barrier
    s_endpgm
.section .rodata,"a"
.p2align 6
.amdhsa_kernel qkv1_kernel
  .amdhsa_next_free_vgpr 160
  .amdhsa_next_free_sgpr 56
  .amdhsa_accum_offset 160
  .amdhsa_group_segment_fixed_size 0
  .amdhsa_kernarg_size 96
  .amdhsa_user_sgpr_count 2
  .amdhsa_user_sgpr_kernarg_segment_ptr 1
  .amdhsa_system_sgpr_workgroup_id_x 1
.end_amdhsa_kernel
.text

.globl wo1_kernel
.p2align 8
.type wo1_kernel,@function
wo1_kernel:
    s_cmp_ge_u32 s2, 160
    s_cbranch_scc1 Lend_wo1_kernel_1
    s_load_dwordx2 s[4:5], s[0:1], 88
    s_load_dwordx2 s[6:7], s[0:1], 24
    s_load_dwordx2 s[24:25], s[0:1], 88
    s_and_b32 s26, s2, 7
    s_lshr_b32 s27, s2, 3
    s_mul_i32 s26, s26, 20
    s_add_u32 s26, s26, s27
    s_mul_hi_u32 s27, s26, 858993460
    s_mul_i32 s28, s27, 5
    s_sub_u32 s28, s26, s28
    s_mul_i32 s27, s27, 64
    s_mul_i32 s28, s28, 128
    s_waitcnt lgkmcnt(0)
    s_add_u32 s8, s4, 13107200
    s_addc_u32 s9, s5, 0
    s_mov_b32 s10, 2621440
    s_mov_b32 s11, 0x00020000
    s_mov_b32 s12, s6
    s_mov_b32 s13, s7
    s_mov_b32 s14, 819200
    s_mov_b32 s15, 0x00020000
    s_mov_b32 s16, s24
    s_mov_b32 s17, s25
    s_mov_b32 s18, 2621440
    s_mov_b32 s19, 0x00020000
    v_and_b32 v1, 63, v0
    v_lshrrev_b32 v2, 6, v0
    s_nop 0
    v_readfirstlane_b32 s41, v2
    s_nop 3
    s_cmp_ge_u32 s41, 4
    s_cbranch_scc1 Lloader_wo1_kernel_2
    v_lshrrev_b32 v3, 1, v2
    v_and_b32 v4, 1, v2
    v_lshrrev_b32 v5, 4, v1
    v_and_b32 v6, 15, v1
    v_mul_u32_u24 v7, 32, v3
    v_add_u32 v7, v7, v6
    v_lshlrev_b32 v7, 7, v7
    v_add_u32 v18, 0, v5
    v_and_b32 v3, 7, v6
    v_xor_b32 v18, v18, v3
    v_lshl_add_u32 v18, v18, 4, v7
    v_add_u32 v26, 49152, v18
    v_add_u32 v19, 4, v5
    v_and_b32 v3, 7, v6
    v_xor_b32 v19, v19, v3
    v_lshl_add_u32 v19, v19, 4, v7
    v_add_u32 v27, 49152, v19
    v_lshrrev_b32 v3, 2, v6
    v_and_b32 v7, 1, v5
    v_lshl_add_u32 v7, v7, 2, v3
    v_lshl_add_u32 v32, v5, 3, v3
    v_lshlrev_b32 v32, 8, v32
    v_and_b32 v33, 3, v6
    v_lshl_add_u32 v32, v33, 3, v32
    v_lshlrev_b32 v33, 2, v4
    v_add_u32 v34, 0, v33
    v_xor_b32 v34, v34, v7
    v_lshl_add_u32 v20, v34, 5, v32
    v_add_u32 v28, 49152, v20
    v_add_u32 v34, 1, v33
    v_xor_b32 v34, v34, v7
    v_lshl_add_u32 v21, v34, 5, v32
    v_add_u32 v29, 49152, v21
    v_add_u32 v34, 2, v33
    v_xor_b32 v34, v34, v7
    v_lshl_add_u32 v22, v34, 5, v32
    v_add_u32 v30, 49152, v22
    v_add_u32 v34, 3, v33
    v_xor_b32 v34, v34, v7
    v_lshl_add_u32 v23, v34, 5, v32
    v_add_u32 v31, 49152, v23
    v_mov_b32 v80, 0
    v_mov_b32 v81, 0
    v_mov_b32 v82, 0
    v_mov_b32 v83, 0
    v_mov_b32 v84, 0
    v_mov_b32 v85, 0
    v_mov_b32 v86, 0
    v_mov_b32 v87, 0
    v_mov_b32 v88, 0
    v_mov_b32 v89, 0
    v_mov_b32 v90, 0
    v_mov_b32 v91, 0
    v_mov_b32 v92, 0
    v_mov_b32 v93, 0
    v_mov_b32 v94, 0
    v_mov_b32 v95, 0
    v_mov_b32 v96, 0
    v_mov_b32 v97, 0
    v_mov_b32 v98, 0
    v_mov_b32 v99, 0
    v_mov_b32 v100, 0
    v_mov_b32 v101, 0
    v_mov_b32 v102, 0
    v_mov_b32 v103, 0
    v_mov_b32 v104, 0
    v_mov_b32 v105, 0
    v_mov_b32 v106, 0
    v_mov_b32 v107, 0
    v_mov_b32 v108, 0
    v_mov_b32 v109, 0
    v_mov_b32 v110, 0
    v_mov_b32 v111, 0
    s_barrier
    ds_read_b128 v[32:35], v18 offset:0
    ds_read_b128 v[36:39], v18 offset:2048
    ds_read_b64_tr_b16 v[48:49], v20 offset:8192
    ds_read_b64_tr_b16 v[50:51], v20 offset:9216
    ds_read_b64_tr_b16 v[52:53], v21 offset:8192
    ds_read_b64_tr_b16 v[54:55], v21 offset:9216
    ds_read_b64_tr_b16 v[56:57], v22 offset:8192
    ds_read_b64_tr_b16 v[58:59], v22 offset:9216
    ds_read_b64_tr_b16 v[60:61], v23 offset:8192
    ds_read_b64_tr_b16 v[62:63], v23 offset:9216
    s_mov_b32 s31, 0
Lcloop_wo1_kernel_3:
    s_waitcnt lgkmcnt(0)
    v_mfma_f32_16x16x32_bf16 v[80:83], v[48:51], v[32:35], v[80:83]
    ds_read_b128 v[40:43], v19 offset:0
    v_mfma_f32_16x16x32_bf16 v[84:87], v[52:55], v[32:35], v[84:87]
    ds_read_b128 v[44:47], v19 offset:2048
    v_mfma_f32_16x16x32_bf16 v[88:91], v[56:59], v[32:35], v[88:91]
    ds_read_b64_tr_b16 v[64:65], v20 offset:16384
    v_mfma_f32_16x16x32_bf16 v[92:95], v[60:63], v[32:35], v[92:95]
    ds_read_b64_tr_b16 v[66:67], v20 offset:17408
    ds_read_b64_tr_b16 v[68:69], v21 offset:16384
    v_mfma_f32_16x16x32_bf16 v[96:99], v[48:51], v[36:39], v[96:99]
    ds_read_b64_tr_b16 v[70:71], v21 offset:17408
    v_mfma_f32_16x16x32_bf16 v[100:103], v[52:55], v[36:39], v[100:103]
    ds_read_b64_tr_b16 v[72:73], v22 offset:16384
    v_mfma_f32_16x16x32_bf16 v[104:107], v[56:59], v[36:39], v[104:107]
    ds_read_b64_tr_b16 v[74:75], v22 offset:17408
    v_mfma_f32_16x16x32_bf16 v[108:111], v[60:63], v[36:39], v[108:111]
    ds_read_b64_tr_b16 v[76:77], v23 offset:16384
    ds_read_b64_tr_b16 v[78:79], v23 offset:17408
    s_waitcnt lgkmcnt(0)
    v_mfma_f32_16x16x32_bf16 v[80:83], v[64:67], v[40:43], v[80:83]
    ds_read_b128 v[32:35], v18 offset:24576
    v_mfma_f32_16x16x32_bf16 v[84:87], v[68:71], v[40:43], v[84:87]
    ds_read_b128 v[36:39], v18 offset:26624
    v_mfma_f32_16x16x32_bf16 v[88:91], v[72:75], v[40:43], v[88:91]
    ds_read_b64_tr_b16 v[48:49], v20 offset:32768
    v_mfma_f32_16x16x32_bf16 v[92:95], v[76:79], v[40:43], v[92:95]
    ds_read_b64_tr_b16 v[50:51], v20 offset:33792
    ds_read_b64_tr_b16 v[52:53], v21 offset:32768
    v_mfma_f32_16x16x32_bf16 v[96:99], v[64:67], v[44:47], v[96:99]
    ds_read_b64_tr_b16 v[54:55], v21 offset:33792
    v_mfma_f32_16x16x32_bf16 v[100:103], v[68:71], v[44:47], v[100:103]
    ds_read_b64_tr_b16 v[56:57], v22 offset:32768
    v_mfma_f32_16x16x32_bf16 v[104:107], v[72:75], v[44:47], v[104:107]
    ds_read_b64_tr_b16 v[58:59], v22 offset:33792
    v_mfma_f32_16x16x32_bf16 v[108:111], v[76:79], v[44:47], v[108:111]
    ds_read_b64_tr_b16 v[60:61], v23 offset:32768
    ds_read_b64_tr_b16 v[62:63], v23 offset:33792
    s_barrier
    s_waitcnt lgkmcnt(0)
    v_mfma_f32_16x16x32_bf16 v[80:83], v[48:51], v[32:35], v[80:83]
    ds_read_b128 v[40:43], v19 offset:24576
    v_mfma_f32_16x16x32_bf16 v[84:87], v[52:55], v[32:35], v[84:87]
    ds_read_b128 v[44:47], v19 offset:26624
    v_mfma_f32_16x16x32_bf16 v[88:91], v[56:59], v[32:35], v[88:91]
    ds_read_b64_tr_b16 v[64:65], v20 offset:40960
    v_mfma_f32_16x16x32_bf16 v[92:95], v[60:63], v[32:35], v[92:95]
    ds_read_b64_tr_b16 v[66:67], v20 offset:41984
    ds_read_b64_tr_b16 v[68:69], v21 offset:40960
    v_mfma_f32_16x16x32_bf16 v[96:99], v[48:51], v[36:39], v[96:99]
    ds_read_b64_tr_b16 v[70:71], v21 offset:41984
    v_mfma_f32_16x16x32_bf16 v[100:103], v[52:55], v[36:39], v[100:103]
    ds_read_b64_tr_b16 v[72:73], v22 offset:40960
    v_mfma_f32_16x16x32_bf16 v[104:107], v[56:59], v[36:39], v[104:107]
    ds_read_b64_tr_b16 v[74:75], v22 offset:41984
    v_mfma_f32_16x16x32_bf16 v[108:111], v[60:63], v[36:39], v[108:111]
    ds_read_b64_tr_b16 v[76:77], v23 offset:40960
    ds_read_b64_tr_b16 v[78:79], v23 offset:41984
    s_waitcnt lgkmcnt(0)
    v_mfma_f32_16x16x32_bf16 v[80:83], v[64:67], v[40:43], v[80:83]
    ds_read_b128 v[32:35], v26 offset:0
    v_mfma_f32_16x16x32_bf16 v[84:87], v[68:71], v[40:43], v[84:87]
    ds_read_b128 v[36:39], v26 offset:2048
    v_mfma_f32_16x16x32_bf16 v[88:91], v[72:75], v[40:43], v[88:91]
    ds_read_b64_tr_b16 v[48:49], v28 offset:8192
    v_mfma_f32_16x16x32_bf16 v[92:95], v[76:79], v[40:43], v[92:95]
    ds_read_b64_tr_b16 v[50:51], v28 offset:9216
    ds_read_b64_tr_b16 v[52:53], v29 offset:8192
    v_mfma_f32_16x16x32_bf16 v[96:99], v[64:67], v[44:47], v[96:99]
    ds_read_b64_tr_b16 v[54:55], v29 offset:9216
    v_mfma_f32_16x16x32_bf16 v[100:103], v[68:71], v[44:47], v[100:103]
    ds_read_b64_tr_b16 v[56:57], v30 offset:8192
    v_mfma_f32_16x16x32_bf16 v[104:107], v[72:75], v[44:47], v[104:107]
    ds_read_b64_tr_b16 v[58:59], v30 offset:9216
    v_mfma_f32_16x16x32_bf16 v[108:111], v[76:79], v[44:47], v[108:111]
    ds_read_b64_tr_b16 v[60:61], v31 offset:8192
    ds_read_b64_tr_b16 v[62:63], v31 offset:9216
    s_barrier
    s_waitcnt lgkmcnt(0)
    v_mfma_f32_16x16x32_bf16 v[80:83], v[48:51], v[32:35], v[80:83]
    ds_read_b128 v[40:43], v27 offset:0
    v_mfma_f32_16x16x32_bf16 v[84:87], v[52:55], v[32:35], v[84:87]
    ds_read_b128 v[44:47], v27 offset:2048
    v_mfma_f32_16x16x32_bf16 v[88:91], v[56:59], v[32:35], v[88:91]
    ds_read_b64_tr_b16 v[64:65], v28 offset:16384
    v_mfma_f32_16x16x32_bf16 v[92:95], v[60:63], v[32:35], v[92:95]
    ds_read_b64_tr_b16 v[66:67], v28 offset:17408
    ds_read_b64_tr_b16 v[68:69], v29 offset:16384
    v_mfma_f32_16x16x32_bf16 v[96:99], v[48:51], v[36:39], v[96:99]
    ds_read_b64_tr_b16 v[70:71], v29 offset:17408
    v_mfma_f32_16x16x32_bf16 v[100:103], v[52:55], v[36:39], v[100:103]
    ds_read_b64_tr_b16 v[72:73], v30 offset:16384
    v_mfma_f32_16x16x32_bf16 v[104:107], v[56:59], v[36:39], v[104:107]
    ds_read_b64_tr_b16 v[74:75], v30 offset:17408
    v_mfma_f32_16x16x32_bf16 v[108:111], v[60:63], v[36:39], v[108:111]
    ds_read_b64_tr_b16 v[76:77], v31 offset:16384
    ds_read_b64_tr_b16 v[78:79], v31 offset:17408
    s_waitcnt lgkmcnt(0)
    v_mfma_f32_16x16x32_bf16 v[80:83], v[64:67], v[40:43], v[80:83]
    ds_read_b128 v[32:35], v26 offset:24576
    v_mfma_f32_16x16x32_bf16 v[84:87], v[68:71], v[40:43], v[84:87]
    ds_read_b128 v[36:39], v26 offset:26624
    v_mfma_f32_16x16x32_bf16 v[88:91], v[72:75], v[40:43], v[88:91]
    ds_read_b64_tr_b16 v[48:49], v28 offset:32768
    v_mfma_f32_16x16x32_bf16 v[92:95], v[76:79], v[40:43], v[92:95]
    ds_read_b64_tr_b16 v[50:51], v28 offset:33792
    ds_read_b64_tr_b16 v[52:53], v29 offset:32768
    v_mfma_f32_16x16x32_bf16 v[96:99], v[64:67], v[44:47], v[96:99]
    ds_read_b64_tr_b16 v[54:55], v29 offset:33792
    v_mfma_f32_16x16x32_bf16 v[100:103], v[68:71], v[44:47], v[100:103]
    ds_read_b64_tr_b16 v[56:57], v30 offset:32768
    v_mfma_f32_16x16x32_bf16 v[104:107], v[72:75], v[44:47], v[104:107]
    ds_read_b64_tr_b16 v[58:59], v30 offset:33792
    v_mfma_f32_16x16x32_bf16 v[108:111], v[76:79], v[44:47], v[108:111]
    ds_read_b64_tr_b16 v[60:61], v31 offset:32768
    ds_read_b64_tr_b16 v[62:63], v31 offset:33792
    s_barrier
    s_waitcnt lgkmcnt(0)
    v_mfma_f32_16x16x32_bf16 v[80:83], v[48:51], v[32:35], v[80:83]
    ds_read_b128 v[40:43], v27 offset:24576
    v_mfma_f32_16x16x32_bf16 v[84:87], v[52:55], v[32:35], v[84:87]
    ds_read_b128 v[44:47], v27 offset:26624
    v_mfma_f32_16x16x32_bf16 v[88:91], v[56:59], v[32:35], v[88:91]
    ds_read_b64_tr_b16 v[64:65], v28 offset:40960
    v_mfma_f32_16x16x32_bf16 v[92:95], v[60:63], v[32:35], v[92:95]
    ds_read_b64_tr_b16 v[66:67], v28 offset:41984
    ds_read_b64_tr_b16 v[68:69], v29 offset:40960
    v_mfma_f32_16x16x32_bf16 v[96:99], v[48:51], v[36:39], v[96:99]
    ds_read_b64_tr_b16 v[70:71], v29 offset:41984
    v_mfma_f32_16x16x32_bf16 v[100:103], v[52:55], v[36:39], v[100:103]
    ds_read_b64_tr_b16 v[72:73], v30 offset:40960
    v_mfma_f32_16x16x32_bf16 v[104:107], v[56:59], v[36:39], v[104:107]
    ds_read_b64_tr_b16 v[74:75], v30 offset:41984
    v_mfma_f32_16x16x32_bf16 v[108:111], v[60:63], v[36:39], v[108:111]
    ds_read_b64_tr_b16 v[76:77], v31 offset:40960
    ds_read_b64_tr_b16 v[78:79], v31 offset:41984
    s_waitcnt lgkmcnt(0)
    v_mfma_f32_16x16x32_bf16 v[80:83], v[64:67], v[40:43], v[80:83]
    ds_read_b128 v[32:35], v18 offset:0
    v_mfma_f32_16x16x32_bf16 v[84:87], v[68:71], v[40:43], v[84:87]
    ds_read_b128 v[36:39], v18 offset:2048
    v_mfma_f32_16x16x32_bf16 v[88:91], v[72:75], v[40:43], v[88:91]
    ds_read_b64_tr_b16 v[48:49], v20 offset:8192
    v_mfma_f32_16x16x32_bf16 v[92:95], v[76:79], v[40:43], v[92:95]
    ds_read_b64_tr_b16 v[50:51], v20 offset:9216
    ds_read_b64_tr_b16 v[52:53], v21 offset:8192
    v_mfma_f32_16x16x32_bf16 v[96:99], v[64:67], v[44:47], v[96:99]
    ds_read_b64_tr_b16 v[54:55], v21 offset:9216
    v_mfma_f32_16x16x32_bf16 v[100:103], v[68:71], v[44:47], v[100:103]
    ds_read_b64_tr_b16 v[56:57], v22 offset:8192
    v_mfma_f32_16x16x32_bf16 v[104:107], v[72:75], v[44:47], v[104:107]
    ds_read_b64_tr_b16 v[58:59], v22 offset:9216
    v_mfma_f32_16x16x32_bf16 v[108:111], v[76:79], v[44:47], v[108:111]
    ds_read_b64_tr_b16 v[60:61], v23 offset:8192
    ds_read_b64_tr_b16 v[62:63], v23 offset:9216
    s_barrier
    s_add_u32 s31, s31, 1
    s_cmp_lt_u32 s31, 2
    s_cbranch_scc1 Lcloop_wo1_kernel_3
    s_waitcnt lgkmcnt(0)
    v_mfma_f32_16x16x32_bf16 v[80:83], v[48:51], v[32:35], v[80:83]
    ds_read_b128 v[40:43], v19 offset:0
    v_mfma_f32_16x16x32_bf16 v[84:87], v[52:55], v[32:35], v[84:87]
    ds_read_b128 v[44:47], v19 offset:2048
    v_mfma_f32_16x16x32_bf16 v[88:91], v[56:59], v[32:35], v[88:91]
    ds_read_b64_tr_b16 v[64:65], v20 offset:16384
    v_mfma_f32_16x16x32_bf16 v[92:95], v[60:63], v[32:35], v[92:95]
    ds_read_b64_tr_b16 v[66:67], v20 offset:17408
    ds_read_b64_tr_b16 v[68:69], v21 offset:16384
    v_mfma_f32_16x16x32_bf16 v[96:99], v[48:51], v[36:39], v[96:99]
    ds_read_b64_tr_b16 v[70:71], v21 offset:17408
    v_mfma_f32_16x16x32_bf16 v[100:103], v[52:55], v[36:39], v[100:103]
    ds_read_b64_tr_b16 v[72:73], v22 offset:16384
    v_mfma_f32_16x16x32_bf16 v[104:107], v[56:59], v[36:39], v[104:107]
    ds_read_b64_tr_b16 v[74:75], v22 offset:17408
    v_mfma_f32_16x16x32_bf16 v[108:111], v[60:63], v[36:39], v[108:111]
    ds_read_b64_tr_b16 v[76:77], v23 offset:16384
    ds_read_b64_tr_b16 v[78:79], v23 offset:17408
    s_waitcnt lgkmcnt(0)
    v_mfma_f32_16x16x32_bf16 v[80:83], v[64:67], v[40:43], v[80:83]
    ds_read_b128 v[32:35], v18 offset:24576
    v_mfma_f32_16x16x32_bf16 v[84:87], v[68:71], v[40:43], v[84:87]
    ds_read_b128 v[36:39], v18 offset:26624
    v_mfma_f32_16x16x32_bf16 v[88:91], v[72:75], v[40:43], v[88:91]
    ds_read_b64_tr_b16 v[48:49], v20 offset:32768
    v_mfma_f32_16x16x32_bf16 v[92:95], v[76:79], v[40:43], v[92:95]
    ds_read_b64_tr_b16 v[50:51], v20 offset:33792
    ds_read_b64_tr_b16 v[52:53], v21 offset:32768
    v_mfma_f32_16x16x32_bf16 v[96:99], v[64:67], v[44:47], v[96:99]
    ds_read_b64_tr_b16 v[54:55], v21 offset:33792
    v_mfma_f32_16x16x32_bf16 v[100:103], v[68:71], v[44:47], v[100:103]
    ds_read_b64_tr_b16 v[56:57], v22 offset:32768
    v_mfma_f32_16x16x32_bf16 v[104:107], v[72:75], v[44:47], v[104:107]
    ds_read_b64_tr_b16 v[58:59], v22 offset:33792
    v_mfma_f32_16x16x32_bf16 v[108:111], v[76:79], v[44:47], v[108:111]
    ds_read_b64_tr_b16 v[60:61], v23 offset:32768
    ds_read_b64_tr_b16 v[62:63], v23 offset:33792
    s_barrier
    s_waitcnt lgkmcnt(0)
    v_mfma_f32_16x16x32_bf16 v[80:83], v[48:51], v[32:35], v[80:83]
    ds_read_b128 v[40:43], v19 offset:24576
    v_mfma_f32_16x16x32_bf16 v[84:87], v[52:55], v[32:35], v[84:87]
    ds_read_b128 v[44:47], v19 offset:26624
    v_mfma_f32_16x16x32_bf16 v[88:91], v[56:59], v[32:35], v[88:91]
    ds_read_b64_tr_b16 v[64:65], v20 offset:40960
    v_mfma_f32_16x16x32_bf16 v[92:95], v[60:63], v[32:35], v[92:95]
    ds_read_b64_tr_b16 v[66:67], v20 offset:41984
    ds_read_b64_tr_b16 v[68:69], v21 offset:40960
    v_mfma_f32_16x16x32_bf16 v[96:99], v[48:51], v[36:39], v[96:99]
    ds_read_b64_tr_b16 v[70:71], v21 offset:41984
    v_mfma_f32_16x16x32_bf16 v[100:103], v[52:55], v[36:39], v[100:103]
    ds_read_b64_tr_b16 v[72:73], v22 offset:40960
    v_mfma_f32_16x16x32_bf16 v[104:107], v[56:59], v[36:39], v[104:107]
    ds_read_b64_tr_b16 v[74:75], v22 offset:41984
    v_mfma_f32_16x16x32_bf16 v[108:111], v[60:63], v[36:39], v[108:111]
    ds_read_b64_tr_b16 v[76:77], v23 offset:40960
    ds_read_b64_tr_b16 v[78:79], v23 offset:41984
    s_waitcnt lgkmcnt(0)
    v_mfma_f32_16x16x32_bf16 v[80:83], v[64:67], v[40:43], v[80:83]
    v_mfma_f32_16x16x32_bf16 v[84:87], v[68:71], v[40:43], v[84:87]
    v_mfma_f32_16x16x32_bf16 v[88:91], v[72:75], v[40:43], v[88:91]
    v_mfma_f32_16x16x32_bf16 v[92:95], v[76:79], v[40:43], v[92:95]
    v_mfma_f32_16x16x32_bf16 v[96:99], v[64:67], v[44:47], v[96:99]
    v_mfma_f32_16x16x32_bf16 v[100:103], v[68:71], v[44:47], v[100:103]
    v_mfma_f32_16x16x32_bf16 v[104:107], v[72:75], v[44:47], v[104:107]
    v_mfma_f32_16x16x32_bf16 v[108:111], v[76:79], v[44:47], v[108:111]
    s_barrier
    s_nop 7
    s_nop 7
    v_lshrrev_b32 v3, 1, v2
    v_and_b32 v4, 1, v2
    v_lshrrev_b32 v5, 4, v1
    v_and_b32 v6, 15, v1
    v_mul_u32_u24 v7, 4608, v2
    v_mul_u32_u24 v8, 144, v6
    v_add_u32 v7, v7, v8
    v_lshl_add_u32 v7, v5, 3, v7
    v_cvt_pk_bf16_f32 v32, v80, v81
    v_cvt_pk_bf16_f32 v33, v82, v83
    ds_write_b64 v7, v[32:33] offset:0
    v_cvt_pk_bf16_f32 v40, v84, v85
    v_cvt_pk_bf16_f32 v41, v86, v87
    ds_write_b64 v7, v[40:41] offset:32
    v_cvt_pk_bf16_f32 v48, v88, v89
    v_cvt_pk_bf16_f32 v49, v90, v91
    ds_write_b64 v7, v[48:49] offset:64
    v_cvt_pk_bf16_f32 v56, v92, v93
    v_cvt_pk_bf16_f32 v57, v94, v95
    ds_write_b64 v7, v[56:57] offset:96
    v_cvt_pk_bf16_f32 v32, v96, v97
    v_cvt_pk_bf16_f32 v33, v98, v99
    ds_write_b64 v7, v[32:33] offset:2304
    v_cvt_pk_bf16_f32 v40, v100, v101
    v_cvt_pk_bf16_f32 v41, v102, v103
    ds_write_b64 v7, v[40:41] offset:2336
    v_cvt_pk_bf16_f32 v48, v104, v105
    v_cvt_pk_bf16_f32 v49, v106, v107
    ds_write_b64 v7, v[48:49] offset:2368
    v_cvt_pk_bf16_f32 v56, v108, v109
    v_cvt_pk_bf16_f32 v57, v110, v111
    ds_write_b64 v7, v[56:57] offset:2400
    s_waitcnt lgkmcnt(0)
    v_lshrrev_b32 v8, 3, v1
    v_and_b32 v9, 7, v1
    v_mul_u32_u24 v7, 4608, v2
    v_mul_u32_u24 v10, 144, v8
    v_add_u32 v7, v7, v10
    v_lshl_add_u32 v7, v9, 4, v7
    v_mul_u32_u24 v10, 32, v3
    v_add_u32 v10, v10, v8
    v_add_u32 v10, s27, v10
    v_lshlrev_b32 v11, 6, v4
    v_lshl_add_u32 v11, v9, 3, v11
    v_add_u32 v11, s28, v11
    v_mul_u32_u24 v12, 1280, v10
    v_lshl_add_u32 v12, v11, 1, v12
    ds_read_b128 v[80:83], v7 offset:0
    ds_read_b128 v[84:87], v7 offset:1152
    ds_read_b128 v[88:91], v7 offset:2304
    ds_read_b128 v[92:95], v7 offset:3456
    s_load_dwordx2 s[36:37], s[0:1], 88
    s_waitcnt lgkmcnt(0)
    s_mov_b32 s20, s36
    s_mov_b32 s21, s37
    s_mov_b32 s22, 2621440
    s_mov_b32 s23, 0x00020000
    v_mul_u32_u24 v13, 1280, v10
    v_lshl_add_u32 v13, v11, 1, v13
    v_add_u32 v14, 0, v13
    buffer_load_dwordx4 v[32:35], v14, s[20:23], 0 offen
    v_add_u32 v14, 10240, v13
    buffer_load_dwordx4 v[36:39], v14, s[20:23], 0 offen
    v_add_u32 v14, 20480, v13
    buffer_load_dwordx4 v[40:43], v14, s[20:23], 0 offen
    v_add_u32 v14, 30720, v13
    buffer_load_dwordx4 v[44:47], v14, s[20:23], 0 offen
    s_waitcnt vmcnt(0) lgkmcnt(0)
    v_lshlrev_b32 v48, 16, v80
    v_and_b32 v49, 0xffff0000, v80
    v_lshlrev_b32 v50, 16, v32
    v_and_b32 v51, 0xffff0000, v32
    v_add_f32 v48, v48, v50
    v_add_f32 v49, v49, v51
    v_cvt_pk_bf16_f32 v80, v48, v49
    v_lshlrev_b32 v48, 16, v81
    v_and_b32 v49, 0xffff0000, v81
    v_lshlrev_b32 v50, 16, v33
    v_and_b32 v51, 0xffff0000, v33
    v_add_f32 v48, v48, v50
    v_add_f32 v49, v49, v51
    v_cvt_pk_bf16_f32 v81, v48, v49
    v_lshlrev_b32 v48, 16, v82
    v_and_b32 v49, 0xffff0000, v82
    v_lshlrev_b32 v50, 16, v34
    v_and_b32 v51, 0xffff0000, v34
    v_add_f32 v48, v48, v50
    v_add_f32 v49, v49, v51
    v_cvt_pk_bf16_f32 v82, v48, v49
    v_lshlrev_b32 v48, 16, v83
    v_and_b32 v49, 0xffff0000, v83
    v_lshlrev_b32 v50, 16, v35
    v_and_b32 v51, 0xffff0000, v35
    v_add_f32 v48, v48, v50
    v_add_f32 v49, v49, v51
    v_cvt_pk_bf16_f32 v83, v48, v49
    v_lshlrev_b32 v48, 16, v84
    v_and_b32 v49, 0xffff0000, v84
    v_lshlrev_b32 v50, 16, v36
    v_and_b32 v51, 0xffff0000, v36
    v_add_f32 v48, v48, v50
    v_add_f32 v49, v49, v51
    v_cvt_pk_bf16_f32 v84, v48, v49
    v_lshlrev_b32 v48, 16, v85
    v_and_b32 v49, 0xffff0000, v85
    v_lshlrev_b32 v50, 16, v37
    v_and_b32 v51, 0xffff0000, v37
    v_add_f32 v48, v48, v50
    v_add_f32 v49, v49, v51
    v_cvt_pk_bf16_f32 v85, v48, v49
    v_lshlrev_b32 v48, 16, v86
    v_and_b32 v49, 0xffff0000, v86
    v_lshlrev_b32 v50, 16, v38
    v_and_b32 v51, 0xffff0000, v38
    v_add_f32 v48, v48, v50
    v_add_f32 v49, v49, v51
    v_cvt_pk_bf16_f32 v86, v48, v49
    v_lshlrev_b32 v48, 16, v87
    v_and_b32 v49, 0xffff0000, v87
    v_lshlrev_b32 v50, 16, v39
    v_and_b32 v51, 0xffff0000, v39
    v_add_f32 v48, v48, v50
    v_add_f32 v49, v49, v51
    v_cvt_pk_bf16_f32 v87, v48, v49
    v_lshlrev_b32 v48, 16, v88
    v_and_b32 v49, 0xffff0000, v88
    v_lshlrev_b32 v50, 16, v40
    v_and_b32 v51, 0xffff0000, v40
    v_add_f32 v48, v48, v50
    v_add_f32 v49, v49, v51
    v_cvt_pk_bf16_f32 v88, v48, v49
    v_lshlrev_b32 v48, 16, v89
    v_and_b32 v49, 0xffff0000, v89
    v_lshlrev_b32 v50, 16, v41
    v_and_b32 v51, 0xffff0000, v41
    v_add_f32 v48, v48, v50
    v_add_f32 v49, v49, v51
    v_cvt_pk_bf16_f32 v89, v48, v49
    v_lshlrev_b32 v48, 16, v90
    v_and_b32 v49, 0xffff0000, v90
    v_lshlrev_b32 v50, 16, v42
    v_and_b32 v51, 0xffff0000, v42
    v_add_f32 v48, v48, v50
    v_add_f32 v49, v49, v51
    v_cvt_pk_bf16_f32 v90, v48, v49
    v_lshlrev_b32 v48, 16, v91
    v_and_b32 v49, 0xffff0000, v91
    v_lshlrev_b32 v50, 16, v43
    v_and_b32 v51, 0xffff0000, v43
    v_add_f32 v48, v48, v50
    v_add_f32 v49, v49, v51
    v_cvt_pk_bf16_f32 v91, v48, v49
    v_lshlrev_b32 v48, 16, v92
    v_and_b32 v49, 0xffff0000, v92
    v_lshlrev_b32 v50, 16, v44
    v_and_b32 v51, 0xffff0000, v44
    v_add_f32 v48, v48, v50
    v_add_f32 v49, v49, v51
    v_cvt_pk_bf16_f32 v92, v48, v49
    v_lshlrev_b32 v48, 16, v93
    v_and_b32 v49, 0xffff0000, v93
    v_lshlrev_b32 v50, 16, v45
    v_and_b32 v51, 0xffff0000, v45
    v_add_f32 v48, v48, v50
    v_add_f32 v49, v49, v51
    v_cvt_pk_bf16_f32 v93, v48, v49
    v_lshlrev_b32 v48, 16, v94
    v_and_b32 v49, 0xffff0000, v94
    v_lshlrev_b32 v50, 16, v46
    v_and_b32 v51, 0xffff0000, v46
    v_add_f32 v48, v48, v50
    v_add_f32 v49, v49, v51
    v_cvt_pk_bf16_f32 v94, v48, v49
    v_lshlrev_b32 v48, 16, v95
    v_and_b32 v49, 0xffff0000, v95
    v_lshlrev_b32 v50, 16, v47
    v_and_b32 v51, 0xffff0000, v47
    v_add_f32 v48, v48, v50
    v_add_f32 v49, v49, v51
    v_cvt_pk_bf16_f32 v95, v48, v49
    s_load_dwordx2 s[38:39], s[0:1], 88
    s_waitcnt lgkmcnt(0)
    s_add_u32 s32, s38, 38535168
    s_addc_u32 s33, s39, 0
    s_mov_b32 s34, 163840
    s_mov_b32 s35, 0x00020000
    v_mul_u32_u24 v14, 80, v10
    v_lshrrev_b32 v15, 6, v11
    v_lshl_add_u32 v14, v15, 3, v14
    v_lshlrev_b32 v50, 16, v80
    v_and_b32 v51, 0xffff0000, v80
    v_add_f32 v48, v50, v51
    v_mul_f32 v49, v50, v50
    v_fmac_f32 v49, v51, v51
    v_lshlrev_b32 v50, 16, v81
    v_and_b32 v51, 0xffff0000, v81
    v_add_f32 v48, v48, v50
    v_fmac_f32 v49, v50, v50
    v_add_f32 v48, v48, v51
    v_fmac_f32 v49, v51, v51
    v_lshlrev_b32 v50, 16, v82
    v_and_b32 v51, 0xffff0000, v82
    v_add_f32 v48, v48, v50
    v_fmac_f32 v49, v50, v50
    v_add_f32 v48, v48, v51
    v_fmac_f32 v49, v51, v51
    v_lshlrev_b32 v50, 16, v83
    v_and_b32 v51, 0xffff0000, v83
    v_add_f32 v48, v48, v50
    v_fmac_f32 v49, v50, v50
    v_add_f32 v48, v48, v51
    v_fmac_f32 v49, v51, v51
    s_nop 1
    v_add_f32_dpp v50, v48, v48 quad_perm:[1,0,3,2] row_mask:0xf bank_mask:0xf
    v_add_f32_dpp v51, v49, v49 quad_perm:[1,0,3,2] row_mask:0xf bank_mask:0xf
    v_mov_b32 v48, v50
    v_mov_b32 v49, v51
    s_nop 1
    v_add_f32_dpp v50, v48, v48 quad_perm:[2,3,0,1] row_mask:0xf bank_mask:0xf
    v_add_f32_dpp v51, v49, v49 quad_perm:[2,3,0,1] row_mask:0xf bank_mask:0xf
    v_mov_b32 v48, v50
    v_mov_b32 v49, v51
    s_nop 1
    v_add_f32_dpp v50, v48, v48 row_half_mirror row_mask:0xf bank_mask:0xf
    v_add_f32_dpp v51, v49, v49 row_half_mirror row_mask:0xf bank_mask:0xf
    v_mov_b32 v48, v50
    v_mov_b32 v49, v51
    v_and_b32 v15, 7, v1
    v_cmp_eq_u32 vcc, 0, v15
    s_and_saveexec_b64 s[40:41], vcc
    buffer_store_dwordx2 v[48:49], v14, s[32:35], 0 offen offset:0
    s_mov_b64 exec, s[40:41]
    s_nop 1
    v_lshlrev_b32 v50, 16, v84
    v_and_b32 v51, 0xffff0000, v84
    v_add_f32 v48, v50, v51
    v_mul_f32 v49, v50, v50
    v_fmac_f32 v49, v51, v51
    v_lshlrev_b32 v50, 16, v85
    v_and_b32 v51, 0xffff0000, v85
    v_add_f32 v48, v48, v50
    v_fmac_f32 v49, v50, v50
    v_add_f32 v48, v48, v51
    v_fmac_f32 v49, v51, v51
    v_lshlrev_b32 v50, 16, v86
    v_and_b32 v51, 0xffff0000, v86
    v_add_f32 v48, v48, v50
    v_fmac_f32 v49, v50, v50
    v_add_f32 v48, v48, v51
    v_fmac_f32 v49, v51, v51
    v_lshlrev_b32 v50, 16, v87
    v_and_b32 v51, 0xffff0000, v87
    v_add_f32 v48, v48, v50
    v_fmac_f32 v49, v50, v50
    v_add_f32 v48, v48, v51
    v_fmac_f32 v49, v51, v51
    s_nop 1
    v_add_f32_dpp v50, v48, v48 quad_perm:[1,0,3,2] row_mask:0xf bank_mask:0xf
    v_add_f32_dpp v51, v49, v49 quad_perm:[1,0,3,2] row_mask:0xf bank_mask:0xf
    v_mov_b32 v48, v50
    v_mov_b32 v49, v51
    s_nop 1
    v_add_f32_dpp v50, v48, v48 quad_perm:[2,3,0,1] row_mask:0xf bank_mask:0xf
    v_add_f32_dpp v51, v49, v49 quad_perm:[2,3,0,1] row_mask:0xf bank_mask:0xf
    v_mov_b32 v48, v50
    v_mov_b32 v49, v51
    s_nop 1
    v_add_f32_dpp v50, v48, v48 row_half_mirror row_mask:0xf bank_mask:0xf
    v_add_f32_dpp v51, v49, v49 row_half_mirror row_mask:0xf bank_mask:0xf
    v_mov_b32 v48, v50
    v_mov_b32 v49, v51
    v_and_b32 v15, 7, v1
    v_cmp_eq_u32 vcc, 0, v15
    s_and_saveexec_b64 s[40:41], vcc
    buffer_store_dwordx2 v[48:49], v14, s[32:35], 0 offen offset:640
    s_mov_b64 exec, s[40:41]
    s_nop 1
    v_lshlrev_b32 v50, 16, v88
    v_and_b32 v51, 0xffff0000, v88
    v_add_f32 v48, v50, v51
    v_mul_f32 v49, v50, v50
    v_fmac_f32 v49, v51, v51
    v_lshlrev_b32 v50, 16, v89
    v_and_b32 v51, 0xffff0000, v89
    v_add_f32 v48, v48, v50
    v_fmac_f32 v49, v50, v50
    v_add_f32 v48, v48, v51
    v_fmac_f32 v49, v51, v51
    v_lshlrev_b32 v50, 16, v90
    v_and_b32 v51, 0xffff0000, v90
    v_add_f32 v48, v48, v50
    v_fmac_f32 v49, v50, v50
    v_add_f32 v48, v48, v51
    v_fmac_f32 v49, v51, v51
    v_lshlrev_b32 v50, 16, v91
    v_and_b32 v51, 0xffff0000, v91
    v_add_f32 v48, v48, v50
    v_fmac_f32 v49, v50, v50
    v_add_f32 v48, v48, v51
    v_fmac_f32 v49, v51, v51
    s_nop 1
    v_add_f32_dpp v50, v48, v48 quad_perm:[1,0,3,2] row_mask:0xf bank_mask:0xf
    v_add_f32_dpp v51, v49, v49 quad_perm:[1,0,3,2] row_mask:0xf bank_mask:0xf
    v_mov_b32 v48, v50
    v_mov_b32 v49, v51
    s_nop 1
    v_add_f32_dpp v50, v48, v48 quad_perm:[2,3,0,1] row_mask:0xf bank_mask:0xf
    v_add_f32_dpp v51, v49, v49 quad_perm:[2,3,0,1] row_mask:0xf bank_mask:0xf
    v_mov_b32 v48, v50
    v_mov_b32 v49, v51
    s_nop 1
    v_add_f32_dpp v50, v48, v48 row_half_mirror row_mask:0xf bank_mask:0xf
    v_add_f32_dpp v51, v49, v49 row_half_mirror row_mask:0xf bank_mask:0xf
    v_mov_b32 v48, v50
    v_mov_b32 v49, v51
    v_and_b32 v15, 7, v1
    v_cmp_eq_u32 vcc, 0, v15
    s_and_saveexec_b64 s[40:41], vcc
    buffer_store_dwordx2 v[48:49], v14, s[32:35], 0 offen offset:1280
    s_mov_b64 exec, s[40:41]
    s_nop 1
    v_lshlrev_b32 v50, 16, v92
    v_and_b32 v51, 0xffff0000, v92
    v_add_f32 v48, v50, v51
    v_mul_f32 v49, v50, v50
    v_fmac_f32 v49, v51, v51
    v_lshlrev_b32 v50, 16, v93
    v_and_b32 v51, 0xffff0000, v93
    v_add_f32 v48, v48, v50
    v_fmac_f32 v49, v50, v50
    v_add_f32 v48, v48, v51
    v_fmac_f32 v49, v51, v51
    v_lshlrev_b32 v50, 16, v94
    v_and_b32 v51, 0xffff0000, v94
    v_add_f32 v48, v48, v50
    v_fmac_f32 v49, v50, v50
    v_add_f32 v48, v48, v51
    v_fmac_f32 v49, v51, v51
    v_lshlrev_b32 v50, 16, v95
    v_and_b32 v51, 0xffff0000, v95
    v_add_f32 v48, v48, v50
    v_fmac_f32 v49, v50, v50
    v_add_f32 v48, v48, v51
    v_fmac_f32 v49, v51, v51
    s_nop 1
    v_add_f32_dpp v50, v48, v48 quad_perm:[1,0,3,2] row_mask:0xf bank_mask:0xf
    v_add_f32_dpp v51, v49, v49 quad_perm:[1,0,3,2] row_mask:0xf bank_mask:0xf
    v_mov_b32 v48, v50
    v_mov_b32 v49, v51
    s_nop 1
    v_add_f32_dpp v50, v48, v48 quad_perm:[2,3,0,1] row_mask:0xf bank_mask:0xf
    v_add_f32_dpp v51, v49, v49 quad_perm:[2,3,0,1] row_mask:0xf bank_mask:0xf
    v_mov_b32 v48, v50
    v_mov_b32 v49, v51
    s_nop 1
    v_add_f32_dpp v50, v48, v48 row_half_mirror row_mask:0xf bank_mask:0xf
    v_add_f32_dpp v51, v49, v49 row_half_mirror row_mask:0xf bank_mask:0xf
    v_mov_b32 v48, v50
    v_mov_b32 v49, v51
    v_and_b32 v15, 7, v1
    v_cmp_eq_u32 vcc, 0, v15
    s_and_saveexec_b64 s[40:41], vcc
    buffer_store_dwordx2 v[48:49], v14, s[32:35], 0 offen offset:1920
    s_mov_b64 exec, s[40:41]
    s_nop 1
    buffer_store_dwordx4 v[80:83], v12, s[16:19], 0 offen
    v_add_u32 v12, 10240, v12
    buffer_store_dwordx4 v[84:87], v12, s[16:19], 0 offen
    v_add_u32 v12, 10240, v12
    buffer_store_dwordx4 v[88:91], v12, s[16:19], 0 offen
    v_add_u32 v12, 10240, v12
    buffer_store_dwordx4 v[92:95], v12, s[16:19], 0 offen
Lend_wo1_kernel_1:
    s_endpgm
Lloader_wo1_kernel_2:
    v_subrev_u32 v0, 256, v0
    v_and_b32 v1, 63, v0
    s_sub_u32 s42, s41, 4
    v_lshrrev_b32 v3, 3, v1
    v_and_b32 v4, 7, v1
    v_xor_b32 v4, v4, v3
    s_mul_i32 s43, s42, 16
    s_add_u32 s43, s43, s27
    v_add_u32 v5, s43, v3
    v_mul_u32_u24 v5, 1280, v5
    v_lshl_add_u32 v8, v4, 4, v5
    v_add_u32 v9, 10240, v8
    v_lshrrev_b32 v3, 4, v1
    v_and_b32 v4, 15, v1
    v_lshrrev_b32 v5, 1, v4
    v_and_b32 v6, 1, v4
    s_mul_i32 s43, s42, 4
    s_add_u32 s44, s43, 0
    s_lshr_b32 s44, s44, 1
    s_and_b32 s44, s44, 1
    s_lshl_b32 s44, s44, 2
    v_add_u32 v7, s44, v3
    v_xor_b32 v7, v5, v7
    v_lshl_add_u32 v7, v7, 1, v6
    v_lshlrev_b32 v7, 4, v7
    s_add_u32 s44, s43, 0
    s_lshl_b32 s44, s44, 2
    v_add_u32 v12, s44, v3
    v_mul_u32_u24 v12, 1280, v12
    v_add_u32 v12, v12, v7
    v_lshl_add_u32 v12, s28, 1, v12
    s_add_u32 s44, s43, 1
    s_lshr_b32 s44, s44, 1
    s_and_b32 s44, s44, 1
    s_lshl_b32 s44, s44, 2
    v_add_u32 v7, s44, v3
    v_xor_b32 v7, v5, v7
    v_lshl_add_u32 v7, v7, 1, v6
    v_lshlrev_b32 v7, 4, v7
    s_add_u32 s44, s43, 1
    s_lshl_b32 s44, s44, 2
    v_add_u32 v13, s44, v3
    v_mul_u32_u24 v13, 1280, v13
    v_add_u32 v13, v13, v7
    v_lshl_add_u32 v13, s28, 1, v13
    s_add_u32 s44, s43, 2
    s_lshr_b32 s44, s44, 1
    s_and_b32 s44, s44, 1
    s_lshl_b32 s44, s44, 2
    v_add_u32 v7, s44, v3
    v_xor_b32 v7, v5, v7
    v_lshl_add_u32 v7, v7, 1, v6
    v_lshlrev_b32 v7, 4, v7
    s_add_u32 s44, s43, 2
    s_lshl_b32 s44, s44, 2
    v_add_u32 v14, s44, v3
    v_mul_u32_u24 v14, 1280, v14
    v_add_u32 v14, v14, v7
    v_lshl_add_u32 v14, s28, 1, v14
    s_add_u32 s44, s43, 3
    s_lshr_b32 s44, s44, 1
    s_and_b32 s44, s44, 1
    s_lshl_b32 s44, s44, 2
    v_add_u32 v7, s44, v3
    v_xor_b32 v7, v5, v7
    v_lshl_add_u32 v7, v7, 1, v6
    v_lshlrev_b32 v7, 4, v7
    s_add_u32 s44, s43, 3
    s_lshl_b32 s44, s44, 2
    v_add_u32 v15, s44, v3
    v_mul_u32_u24 v15, 1280, v15
    v_add_u32 v15, v15, v7
    v_lshl_add_u32 v15, s28, 1, v15
    s_mul_i32 s45, s42, 2048
    s_mul_i32 s46, s42, 4096
    s_add_u32 s46, s46, 8192
    s_mov_b32 s29, 0
    s_mov_b32 s30, 0
    s_add_u32 m0, s45, 0
    s_nop 0
    buffer_load_dwordx4 v8, s[8:11], s29 offen lds
    s_add_u32 m0, s45, 1024
    s_nop 0
    buffer_load_dwordx4 v9, s[8:11], s29 offen lds
    s_add_u32 m0, s46, 0
    s_nop 0
    buffer_load_dwordx4 v12, s[12:15], s30 offen lds
    s_add_u32 m0, s46, 1024
    s_nop 0
    buffer_load_dwordx4 v13, s[12:15], s30 offen lds
    s_add_u32 m0, s46, 2048
    s_nop 0
    buffer_load_dwordx4 v14, s[12:15], s30 offen lds
    s_add_u32 m0, s46, 3072
    s_nop 0
    buffer_load_dwordx4 v15, s[12:15], s30 offen lds
    s_add_u32 s29, s29, 128
    s_add_u32 s30, s30, 81920
    s_add_u32 m0, s45, 24576
    s_nop 0
    buffer_load_dwordx4 v8, s[8:11], s29 offen lds
    s_add_u32 m0, s45, 25600
    s_nop 0
    buffer_load_dwordx4 v9, s[8:11], s29 offen lds
    s_add_u32 m0, s46, 24576
    s_nop 0
    buffer_load_dwordx4 v12, s[12:15], s30 offen lds
    s_add_u32 m0, s46, 25600
    s_nop 0
    buffer_load_dwordx4 v13, s[12:15], s30 offen lds
    s_add_u32 m0, s46, 26624
    s_nop 0
    buffer_load_dwordx4 v14, s[12:15], s30 offen lds
    s_add_u32 m0, s46, 27648
    s_nop 0
    buffer_load_dwordx4 v15, s[12:15], s30 offen lds
    s_add_u32 s29, s29, 128
    s_add_u32 s30, s30, 81920
    s_add_u32 m0, s45, 49152
    s_nop 0
    buffer_load_dwordx4 v8, s[8:11], s29 offen lds
    s_add_u32 m0, s45, 50176
    s_nop 0
    buffer_load_dwordx4 v9, s[8:11], s29 offen lds
    s_add_u32 m0, s46, 49152
    s_nop 0
    buffer_load_dwordx4 v12, s[12:15], s30 offen lds
    s_add_u32 m0, s46, 50176
    s_nop 0
    buffer_load_dwordx4 v13, s[12:15], s30 offen lds
    s_add_u32 m0, s46, 51200
    s_nop 0
    buffer_load_dwordx4 v14, s[12:15], s30 offen lds
    s_add_u32 m0, s46, 52224
    s_nop 0
    buffer_load_dwordx4 v15, s[12:15], s30 offen lds
    s_add_u32 s29, s29, 128
    s_add_u32 s30, s30, 81920
    s_waitcnt vmcnt(6)
    s_barrier
    s_mov_b32 s31, 0
Llloop_wo1_kernel_4:
    s_add_u32 m0, s45, 73728
    s_nop 0
    buffer_load_dwordx4 v8, s[8:11], s29 offen lds
    s_add_u32 m0, s45, 74752
    s_nop 0
    buffer_load_dwordx4 v9, s[8:11], s29 offen lds
    s_add_u32 m0, s46, 73728
    s_nop 0
    buffer_load_dwordx4 v12, s[12:15], s30 offen lds
    s_add_u32 m0, s46, 74752
    s_nop 0
    buffer_load_dwordx4 v13, s[12:15], s30 offen lds
    s_add_u32 m0, s46, 75776
    s_nop 0
    buffer_load_dwordx4 v14, s[12:15], s30 offen lds
    s_add_u32 m0, s46, 76800
    s_nop 0
    buffer_load_dwordx4 v15, s[12:15], s30 offen lds
    s_add_u32 s29, s29, 128
    s_add_u32 s30, s30, 81920
    s_waitcnt vmcnt(6)
    s_barrier
    s_add_u32 m0, s45, 0
    s_nop 0
    buffer_load_dwordx4 v8, s[8:11], s29 offen lds
    s_add_u32 m0, s45, 1024
    s_nop 0
    buffer_load_dwordx4 v9, s[8:11], s29 offen lds
    s_add_u32 m0, s46, 0
    s_nop 0
    buffer_load_dwordx4 v12, s[12:15], s30 offen lds
    s_add_u32 m0, s46, 1024
    s_nop 0
    buffer_load_dwordx4 v13, s[12:15], s30 offen lds
    s_add_u32 m0, s46, 2048
    s_nop 0
    buffer_load_dwordx4 v14, s[12:15], s30 offen lds
    s_add_u32 m0, s46, 3072
    s_nop 0
    buffer_load_dwordx4 v15, s[12:15], s30 offen lds
    s_add_u32 s29, s29, 128
    s_add_u32 s30, s30, 81920
    s_waitcnt vmcnt(6)
    s_barrier
    s_add_u32 m0, s45, 24576
    s_nop 0
    buffer_load_dwordx4 v8, s[8:11], s29 offen lds
    s_add_u32 m0, s45, 25600
    s_nop 0
    buffer_load_dwordx4 v9, s[8:11], s29 offen lds
    s_add_u32 m0, s46, 24576
    s_nop 0
    buffer_load_dwordx4 v12, s[12:15], s30 offen lds
    s_add_u32 m0, s46, 25600
    s_nop 0
    buffer_load_dwordx4 v13, s[12:15], s30 offen lds
    s_add_u32 m0, s46, 26624
    s_nop 0
    buffer_load_dwordx4 v14, s[12:15], s30 offen lds
    s_add_u32 m0, s46, 27648
    s_nop 0
    buffer_load_dwordx4 v15, s[12:15], s30 offen lds
    s_add_u32 s29, s29, 128
    s_add_u32 s30, s30, 81920
    s_waitcnt vmcnt(6)
    s_barrier
    s_add_u32 m0, s45, 49152
    s_nop 0
    buffer_load_dwordx4 v8, s[8:11], s29 offen lds
    s_add_u32 m0, s45, 50176
    s_nop 0
    buffer_load_dwordx4 v9, s[8:11], s29 offen lds
    s_add_u32 m0, s46, 49152
    s_nop 0
    buffer_load_dwordx4 v12, s[12:15], s30 offen lds
    s_add_u32 m0, s46, 50176
    s_nop 0
    buffer_load_dwordx4 v13, s[12:15], s30 offen lds
    s_add_u32 m0, s46, 51200
    s_nop 0
    buffer_load_dwordx4 v14, s[12:15], s30 offen lds
    s_add_u32 m0, s46, 52224
    s_nop 0
    buffer_load_dwordx4 v15, s[12:15], s30 offen lds
    s_add_u32 s29, s29, 128
    s_add_u32 s30, s30, 81920
    s_waitcnt vmcnt(6)
    s_barrier
    s_add_u32 s31, s31, 1
    s_cmp_lt_u32 s31, 1
    s_cbranch_scc1 Llloop_wo1_kernel_4
    s_add_u32 m0, s45, 73728
    s_nop 0
    buffer_load_dwordx4 v8, s[8:11], s29 offen lds
    s_add_u32 m0, s45, 74752
    s_nop 0
    buffer_load_dwordx4 v9, s[8:11], s29 offen lds
    s_add_u32 m0, s46, 73728
    s_nop 0
    buffer_load_dwordx4 v12, s[12:15], s30 offen lds
    s_add_u32 m0, s46, 74752
    s_nop 0
    buffer_load_dwordx4 v13, s[12:15], s30 offen lds
    s_add_u32 m0, s46, 75776
    s_nop 0
    buffer_load_dwordx4 v14, s[12:15], s30 offen lds
    s_add_u32 m0, s46, 76800
    s_nop 0
    buffer_load_dwordx4 v15, s[12:15], s30 offen lds
    s_add_u32 s29, s29, 128
    s_add_u32 s30, s30, 81920
    s_waitcnt vmcnt(6)
    s_barrier
    s_add_u32 m0, s45, 0
    s_nop 0
    buffer_load_dwordx4 v8, s[8:11], s29 offen lds
    s_add_u32 m0, s45, 1024
    s_nop 0
    buffer_load_dwordx4 v9, s[8:11], s29 offen lds
    s_add_u32 m0, s46, 0
    s_nop 0
    buffer_load_dwordx4 v12, s[12:15], s30 offen lds
    s_add_u32 m0, s46, 1024
    s_nop 0
    buffer_load_dwordx4 v13, s[12:15], s30 offen lds
    s_add_u32 m0, s46, 2048
    s_nop 0
    buffer_load_dwordx4 v14, s[12:15], s30 offen lds
    s_add_u32 m0, s46, 3072
    s_nop 0
    buffer_load_dwordx4 v15, s[12:15], s30 offen lds
    s_add_u32 s29, s29, 128
    s_add_u32 s30, s30, 81920
    s_waitcnt vmcnt(6)
    s_barrier
    s_add_u32 m0, s45, 24576
    s_nop 0
    buffer_load_dwordx4 v8, s[8:11], s29 offen lds
    s_add_u32 m0, s45, 25600
    s_nop 0
    buffer_load_dwordx4 v9, s[8:11], s29 offen lds
    s_add_u32 m0, s46, 24576
    s_nop 0
    buffer_load_dwordx4 v12, s[12:15], s30 offen lds
    s_add_u32 m0, s46, 25600
    s_nop 0
    buffer_load_dwordx4 v13, s[12:15], s30 offen lds
    s_add_u32 m0, s46, 26624
    s_nop 0
    buffer_load_dwordx4 v14, s[12:15], s30 offen lds
    s_add_u32 m0, s46, 27648
    s_nop 0
    buffer_load_dwordx4 v15, s[12:15], s30 offen lds
    s_add_u32 s29, s29, 128
    s_add_u32 s30, s30, 81920
    s_waitcnt vmcnt(6)
    s_barrier
    s_waitcnt vmcnt(0)
    s_barrier
    s_waitcnt vmcnt(0)
    s_barrier
    s_waitcnt vmcnt(0)
    s_barrier
    s_endpgm
.section .rodata,"a"
.p2align 6
.amdhsa_kernel wo1_kernel
  .amdhsa_next_free_vgpr 112
  .amdhsa_next_free_sgpr 56
  .amdhsa_accum_offset 112
  .amdhsa_group_segment_fixed_size 0
  .amdhsa_kernarg_size 96
  .amdhsa_user_sgpr_count 2
  .amdhsa_user_sgpr_kernarg_segment_ptr 1
  .amdhsa_system_sgpr_workgroup_id_x 1
.end_amdhsa_kernel
.text

.globl win1_kernel
.p2align 8
.type win1_kernel,@function
win1_kernel:
    s_cmp_ge_u32 s2, 192
    s_cbranch_scc1 Lend_win1_kernel_1
    s_load_dwordx2 s[4:5], s[0:1], 88
    s_load_dwordx2 s[6:7], s[0:1], 40
    s_load_dwordx2 s[24:25], s[0:1], 88
    s_and_b32 s26, s2, 7
    s_lshr_b32 s27, s2, 3
    s_mul_i32 s26, s26, 24
    s_add_u32 s26, s26, s27
    s_mul_hi_u32 s27, s26, 357913942
    s_mul_i32 s28, s27, 12
    s_sub_u32 s28, s26, s28
    s_mul_i32 s27, s27, 128
    s_mul_i32 s28, s28, 128
    s_waitcnt lgkmcnt(0)
    s_mov_b32 s8, s4
    s_mov_b32 s9, s5
    s_mov_b32 s10, 2621440
    s_mov_b32 s11, 0x00020000
    s_mov_b32 s12, s6
    s_mov_b32 s13, s7
    s_mov_b32 s14, 1966080
    s_mov_b32 s15, 0x00020000
    s_add_u32 s16, s24, 15728640
    s_addc_u32 s17, s25, 0
    s_mov_b32 s18, 6291456
    s_mov_b32 s19, 0x00020000
    v_and_b32 v1, 63, v0
    v_lshrrev_b32 v2, 6, v0
    s_nop 0
    v_readfirstlane_b32 s41, v2
    s_nop 3
    s_cmp_ge_u32 s41, 4
    s_cbranch_scc1 Lloader_win1_kernel_2
    v_lshrrev_b32 v3, 1, v2
    v_and_b32 v4, 1, v2
    v_lshrrev_b32 v5, 4, v1
    v_and_b32 v6, 15, v1
    v_mul_u32_u24 v7, 64, v3
    v_add_u32 v7, v7, v6
    v_lshlrev_b32 v7, 7, v7
    v_add_u32 v18, 0, v5
    v_and_b32 v3, 7, v6
    v_xor_b32 v18, v18, v3
    v_lshl_add_u32 v18, v18, 4, v7
    v_add_u32 v26, 65536, v18
    v_add_u32 v19, 4, v5
    v_and_b32 v3, 7, v6
    v_xor_b32 v19, v19, v3
    v_lshl_add_u32 v19, v19, 4, v7
    v_add_u32 v27, 65536, v19
    v_lshrrev_b32 v3, 2, v6
    v_and_b32 v7, 1, v5
    v_lshl_add_u32 v7, v7, 2, v3
    v_lshl_add_u32 v32, v5, 3, v3
    v_lshlrev_b32 v32, 8, v32
    v_and_b32 v33, 3, v6
    v_lshl_add_u32 v32, v33, 3, v32
    v_lshlrev_b32 v33, 2, v4
    v_add_u32 v34, 0, v33
    v_xor_b32 v34, v34, v7
    v_lshl_add_u32 v20, v34, 5, v32
    v_add_u32 v28, 65536, v20
    v_add_u32 v34, 1, v33
    v_xor_b32 v34, v34, v7
    v_lshl_add_u32 v21, v34, 5, v32
    v_add_u32 v29, 65536, v21
    v_add_u32 v34, 2, v33
    v_xor_b32 v34, v34, v7
    v_lshl_add_u32 v22, v34, 5, v32
    v_add_u32 v30, 65536, v22
    v_add_u32 v34, 3, v33
    v_xor_b32 v34, v34, v7
    v_lshl_add_u32 v23, v34, 5, v32
    v_add_u32 v31, 65536, v23
    s_load_dwordx2 s[36:37], s[0:1], 88
    s_waitcnt lgkmcnt(0)
    s_add_u32 s20, s36, 38535168
    s_addc_u32 s21, s37, 0
    s_mov_b32 s22, 163840
    s_mov_b32 s23, 0x00020000
    v_lshrrev_b32 v3, 1, v2
    v_and_b32 v6, 15, v1
    v_mul_u32_u24 v3, 64, v3
    v_add_u32 v3, v3, v6
    v_add_u32 v3, s27, v3
    v_mul_u32_u24 v3, 80, v3
    buffer_load_dwordx4 v[32:35], v3, s[20:23], 0 offen offset:0
    buffer_load_dwordx4 v[36:39], v3, s[20:23], 0 offen offset:16
    buffer_load_dwordx4 v[40:43], v3, s[20:23], 0 offen offset:32
    buffer_load_dwordx4 v[44:47], v3, s[20:23], 0 offen offset:48
    buffer_load_dwordx4 v[48:51], v3, s[20:23], 0 offen offset:64
    buffer_load_dwordx4 v[52:55], v3, s[20:23], 0 offen offset:1280
    buffer_load_dwordx4 v[56:59], v3, s[20:23], 0 offen offset:1296
    buffer_load_dwordx4 v[60:63], v3, s[20:23], 0 offen offset:1312
    buffer_load_dwordx4 v[64:67], v3, s[20:23], 0 offen offset:1328
    buffer_load_dwordx4 v[68:71], v3, s[20:23], 0 offen offset:1344
    buffer_load_dwordx4 v[72:75], v3, s[20:23], 0 offen offset:2560
    buffer_load_dwordx4 v[76:79], v3, s[20:23], 0 offen offset:2576
    buffer_load_dwordx4 v[80:83], v3, s[20:23], 0 offen offset:2592
    buffer_load_dwordx4 v[84:87], v3, s[20:23], 0 offen offset:2608
    buffer_load_dwordx4 v[88:91], v3, s[20:23], 0 offen offset:2624
    buffer_load_dwordx4 v[92:95], v3, s[20:23], 0 offen offset:3840
    buffer_load_dwordx4 v[96:99], v3, s[20:23], 0 offen offset:3856
    buffer_load_dwordx4 v[100:103], v3, s[20:23], 0 offen offset:3872
    buffer_load_dwordx4 v[104:107], v3, s[20:23], 0 offen offset:3888
    buffer_load_dwordx4 v[108:111], v3, s[20:23], 0 offen offset:3904
    s_waitcnt vmcnt(0)
    v_add_f32 v8, v32, v34
    v_add_f32 v12, v33, v35
    v_add_f32 v8, v8, v36
    v_add_f32 v12, v12, v37
    v_add_f32 v8, v8, v38
    v_add_f32 v12, v12, v39
    v_add_f32 v8, v8, v40
    v_add_f32 v12, v12, v41
    v_add_f32 v8, v8, v42
    v_add_f32 v12, v12, v43
    v_add_f32 v8, v8, v44
    v_add_f32 v12, v12, v45
    v_add_f32 v8, v8, v46
    v_add_f32 v12, v12, v47
    v_add_f32 v8, v8, v48
    v_add_f32 v12, v12, v49
    v_add_f32 v8, v8, v50
    v_add_f32 v12, v12, v51
    v_mul_f32 v8, 0x3acccccd, v8
    v_mul_f32 v12, 0x3acccccd, v12
    v_fma_f32 v12, -v8, v8, v12
    v_max_f32 v12, 0, v12
    v_cvt_pk_bf16_f32 v8, v8, v8
    v_lshlrev_b32 v8, 16, v8
    v_cvt_pk_bf16_f32 v12, v12, v12
    v_lshlrev_b32 v12, 16, v12
    v_add_f32 v12, 0x3727c5ac, v12
    v_cvt_pk_bf16_f32 v12, v12, v12
    v_lshlrev_b32 v12, 16, v12
    v_sqrt_f32 v12, v12
    s_nop 0
    v_cvt_pk_bf16_f32 v12, v12, v12
    v_lshlrev_b32 v12, 16, v12
    v_rcp_f32 v12, v12
    v_add_f32 v9, v52, v54
    v_add_f32 v13, v53, v55
    v_add_f32 v9, v9, v56
    v_add_f32 v13, v13, v57
    v_add_f32 v9, v9, v58
    v_add_f32 v13, v13, v59
    v_add_f32 v9, v9, v60
    v_add_f32 v13, v13, v61
    v_add_f32 v9, v9, v62
    v_add_f32 v13, v13, v63
    v_add_f32 v9, v9, v64
    v_add_f32 v13, v13, v65
    v_add_f32 v9, v9, v66
    v_add_f32 v13, v13, v67
    v_add_f32 v9, v9, v68
    v_add_f32 v13, v13, v69
    v_add_f32 v9, v9, v70
    v_add_f32 v13, v13, v71
    v_mul_f32 v9, 0x3acccccd, v9
    v_mul_f32 v13, 0x3acccccd, v13
    v_fma_f32 v13, -v9, v9, v13
    v_max_f32 v13, 0, v13
    v_cvt_pk_bf16_f32 v9, v9, v9
    v_lshlrev_b32 v9, 16, v9
    v_cvt_pk_bf16_f32 v13, v13, v13
    v_lshlrev_b32 v13, 16, v13
    v_add_f32 v13, 0x3727c5ac, v13
    v_cvt_pk_bf16_f32 v13, v13, v13
    v_lshlrev_b32 v13, 16, v13
    v_sqrt_f32 v13, v13
    s_nop 0
    v_cvt_pk_bf16_f32 v13, v13, v13
    v_lshlrev_b32 v13, 16, v13
    v_rcp_f32 v13, v13
    v_add_f32 v10, v72, v74
    v_add_f32 v14, v73, v75
    v_add_f32 v10, v10, v76
    v_add_f32 v14, v14, v77
    v_add_f32 v10, v10, v78
    v_add_f32 v14, v14, v79
    v_add_f32 v10, v10, v80
    v_add_f32 v14, v14, v81
    v_add_f32 v10, v10, v82
    v_add_f32 v14, v14, v83
    v_add_f32 v10, v10, v84
    v_add_f32 v14, v14, v85
    v_add_f32 v10, v10, v86
    v_add_f32 v14, v14, v87
    v_add_f32 v10, v10, v88
    v_add_f32 v14, v14, v89
    v_add_f32 v10, v10, v90
    v_add_f32 v14, v14, v91
    v_mul_f32 v10, 0x3acccccd, v10
    v_mul_f32 v14, 0x3acccccd, v14
    v_fma_f32 v14, -v10, v10, v14
    v_max_f32 v14, 0, v14
    v_cvt_pk_bf16_f32 v10, v10, v10
    v_lshlrev_b32 v10, 16, v10
    v_cvt_pk_bf16_f32 v14, v14, v14
    v_lshlrev_b32 v14, 16, v14
    v_add_f32 v14, 0x3727c5ac, v14
    v_cvt_pk_bf16_f32 v14, v14, v14
    v_lshlrev_b32 v14, 16, v14
    v_sqrt_f32 v14, v14
    s_nop 0
    v_cvt_pk_bf16_f32 v14, v14, v14
    v_lshlrev_b32 v14, 16, v14
    v_rcp_f32 v14, v14
    v_add_f32 v11, v92, v94
    v_add_f32 v15, v93, v95
    v_add_f32 v11, v11, v96
    v_add_f32 v15, v15, v97
    v_add_f32 v11, v11, v98
    v_add_f32 v15, v15, v99
    v_add_f32 v11, v11, v100
    v_add_f32 v15, v15, v101
    v_add_f32 v11, v11, v102
    v_add_f32 v15, v15, v103
    v_add_f32 v11, v11, v104
    v_add_f32 v15, v15, v105
    v_add_f32 v11, v11, v106
    v_add_f32 v15, v15, v107
    v_add_f32 v11, v11, v108
    v_add_f32 v15, v15, v109
    v_add_f32 v11, v11, v110
    v_add_f32 v15, v15, v111
    v_mul_f32 v11, 0x3acccccd, v11
    v_mul_f32 v15, 0x3acccccd, v15
    v_fma_f32 v15, -v11, v11, v15
    v_max_f32 v15, 0, v15
    v_cvt_pk_bf16_f32 v11, v11, v11
    v_lshlrev_b32 v11, 16, v11
    v_cvt_pk_bf16_f32 v15, v15, v15
    v_lshlrev_b32 v15, 16, v15
    v_add_f32 v15, 0x3727c5ac, v15
    v_cvt_pk_bf16_f32 v15, v15, v15
    v_lshlrev_b32 v15, 16, v15
    v_sqrt_f32 v15, v15
    s_nop 0
    v_cvt_pk_bf16_f32 v15, v15, v15
    v_lshlrev_b32 v15, 16, v15
    v_rcp_f32 v15, v15
    s_nop 0
    v_mov_b32 v96, 0
    v_mov_b32 v97, 0
    v_mov_b32 v98, 0
    v_mov_b32 v99, 0
    v_mov_b32 v100, 0
    v_mov_b32 v101, 0
    v_mov_b32 v102, 0
    v_mov_b32 v103, 0
    v_mov_b32 v104, 0
    v_mov_b32 v105, 0
    v_mov_b32 v106, 0
    v_mov_b32 v107, 0
    v_mov_b32 v108, 0
    v_mov_b32 v109, 0
    v_mov_b32 v110, 0
    v_mov_b32 v111, 0
    v_mov_b32 v112, 0
    v_mov_b32 v113, 0
    v_mov_b32 v114, 0
    v_mov_b32 v115, 0
    v_mov_b32 v116, 0
    v_mov_b32 v117, 0
    v_mov_b32 v118, 0
    v_mov_b32 v119, 0
    v_mov_b32 v120, 0
    v_mov_b32 v121, 0
    v_mov_b32 v122, 0
    v_mov_b32 v123, 0
    v_mov_b32 v124, 0
    v_mov_b32 v125, 0
    v_mov_b32 v126, 0
    v_mov_b32 v127, 0
    v_mov_b32 v128, 0
    v_mov_b32 v129, 0
    v_mov_b32 v130, 0
    v_mov_b32 v131, 0
    v_mov_b32 v132, 0
    v_mov_b32 v133, 0
    v_mov_b32 v134, 0
    v_mov_b32 v135, 0
    v_mov_b32 v136, 0
    v_mov_b32 v137, 0
    v_mov_b32 v138, 0
    v_mov_b32 v139, 0
    v_mov_b32 v140, 0
    v_mov_b32 v141, 0
    v_mov_b32 v142, 0
    v_mov_b32 v143, 0
    v_mov_b32 v144, 0
    v_mov_b32 v145, 0
    v_mov_b32 v146, 0
    v_mov_b32 v147, 0
    v_mov_b32 v148, 0
    v_mov_b32 v149, 0
    v_mov_b32 v150, 0
    v_mov_b32 v151, 0
    v_mov_b32 v152, 0
    v_mov_b32 v153, 0
    v_mov_b32 v154, 0
    v_mov_b32 v155, 0
    v_mov_b32 v156, 0
    v_mov_b32 v157, 0
    v_mov_b32 v158, 0
    v_mov_b32 v159, 0
    s_barrier
    ds_read_b128 v[32:35], v18 offset:0
    ds_read_b128 v[36:39], v18 offset:2048
    ds_read_b128 v[40:43], v18 offset:4096
    ds_read_b128 v[44:47], v18 offset:6144
    ds_read_b64_tr_b16 v[64:65], v20 offset:16384
    ds_read_b64_tr_b16 v[66:67], v20 offset:17408
    ds_read_b64_tr_b16 v[68:69], v21 offset:16384
    ds_read_b64_tr_b16 v[70:71], v21 offset:17408
    ds_read_b64_tr_b16 v[72:73], v22 offset:16384
    ds_read_b64_tr_b16 v[74:75], v22 offset:17408
    ds_read_b64_tr_b16 v[76:77], v23 offset:16384
    ds_read_b64_tr_b16 v[78:79], v23 offset:17408
    s_mov_b32 s31, 0
Lcloop_win1_kernel_3:
    s_waitcnt lgkmcnt(0)
    v_mfma_f32_16x16x32_bf16 v[96:99], v[64:67], v[32:35], v[96:99]
    v_mfma_f32_16x16x32_bf16 v[100:103], v[68:71], v[32:35], v[100:103]
    ds_read_b128 v[48:51], v19 offset:0
    v_mfma_f32_16x16x32_bf16 v[104:107], v[72:75], v[32:35], v[104:107]
    ds_read_b128 v[52:55], v19 offset:2048
    v_mfma_f32_16x16x32_bf16 v[108:111], v[76:79], v[32:35], v[108:111]
    ds_read_b128 v[56:59], v19 offset:4096
    v_mfma_f32_16x16x32_bf16 v[112:115], v[64:67], v[36:39], v[112:115]
    v_mfma_f32_16x16x32_bf16 v[116:119], v[68:71], v[36:39], v[116:119]
    ds_read_b128 v[60:63], v19 offset:6144
    v_mfma_f32_16x16x32_bf16 v[120:123], v[72:75], v[36:39], v[120:123]
    ds_read_b64_tr_b16 v[80:81], v20 offset:24576
    v_mfma_f32_16x16x32_bf16 v[124:127], v[76:79], v[36:39], v[124:127]
    ds_read_b64_tr_b16 v[82:83], v20 offset:25600
    v_mfma_f32_16x16x32_bf16 v[128:131], v[64:67], v[40:43], v[128:131]
    v_mfma_f32_16x16x32_bf16 v[132:135], v[68:71], v[40:43], v[132:135]
    ds_read_b64_tr_b16 v[84:85], v21 offset:24576
    v_mfma_f32_16x16x32_bf16 v[136:139], v[72:75], v[40:43], v[136:139]
    ds_read_b64_tr_b16 v[86:87], v21 offset:25600
    v_mfma_f32_16x16x32_bf16 v[140:143], v[76:79], v[40:43], v[140:143]
    ds_read_b64_tr_b16 v[88:89], v22 offset:24576
    v_mfma_f32_16x16x32_bf16 v[144:147], v[64:67], v[44:47], v[144:147]
    v_mfma_f32_16x16x32_bf16 v[148:151], v[68:71], v[44:47], v[148:151]
    ds_read_b64_tr_b16 v[90:91], v22 offset:25600
    v_mfma_f32_16x16x32_bf16 v[152:155], v[72:75], v[44:47], v[152:155]
    ds_read_b64_tr_b16 v[92:93], v23 offset:24576
    v_mfma_f32_16x16x32_bf16 v[156:159], v[76:79], v[44:47], v[156:159]
    ds_read_b64_tr_b16 v[94:95], v23 offset:25600
    s_waitcnt lgkmcnt(0)
    v_mfma_f32_16x16x32_bf16 v[96:99], v[80:83], v[48:51], v[96:99]
    v_mfma_f32_16x16x32_bf16 v[100:103], v[84:87], v[48:51], v[100:103]
    ds_read_b128 v[32:35], v18 offset:32768
    v_mfma_f32_16x16x32_bf16 v[104:107], v[88:91], v[48:51], v[104:107]
    ds_read_b128 v[36:39], v18 offset:34816
    v_mfma_f32_16x16x32_bf16 v[108:111], v[92:95], v[48:51], v[108:111]
    ds_read_b128 v[40:43], v18 offset:36864
    v_mfma_f32_16x16x32_bf16 v[112:115], v[80:83], v[52:55], v[112:115]
    v_mfma_f32_16x16x32_bf16 v[116:119], v[84:87], v[52:55], v[116:119]
    ds_read_b128 v[44:47], v18 offset:38912
    v_mfma_f32_16x16x32_bf16 v[120:123], v[88:91], v[52:55], v[120:123]
    ds_read_b64_tr_b16 v[64:65], v20 offset:49152
    v_mfma_f32_16x16x32_bf16 v[124:127], v[92:95], v[52:55], v[124:127]
    ds_read_b64_tr_b16 v[66:67], v20 offset:50176
    v_mfma_f32_16x16x32_bf16 v[128:131], v[80:83], v[56:59], v[128:131]
    v_mfma_f32_16x16x32_bf16 v[132:135], v[84:87], v[56:59], v[132:135]
    ds_read_b64_tr_b16 v[68:69], v21 offset:49152
    v_mfma_f32_16x16x32_bf16 v[136:139], v[88:91], v[56:59], v[136:139]
    ds_read_b64_tr_b16 v[70:71], v21 offset:50176
    v_mfma_f32_16x16x32_bf16 v[140:143], v[92:95], v[56:59], v[140:143]
    ds_read_b64_tr_b16 v[72:73], v22 offset:49152
    v_mfma_f32_16x16x32_bf16 v[144:147], v[80:83], v[60:63], v[144:147]
    v_mfma_f32_16x16x32_bf16 v[148:151], v[84:87], v[60:63], v[148:151]
    ds_read_b64_tr_b16 v[74:75], v22 offset:50176
    v_mfma_f32_16x16x32_bf16 v[152:155], v[88:91], v[60:63], v[152:155]
    ds_read_b64_tr_b16 v[76:77], v23 offset:49152
    v_mfma_f32_16x16x32_bf16 v[156:159], v[92:95], v[60:63], v[156:159]
    ds_read_b64_tr_b16 v[78:79], v23 offset:50176
    s_barrier
    s_waitcnt lgkmcnt(0)
    v_mfma_f32_16x16x32_bf16 v[96:99], v[64:67], v[32:35], v[96:99]
    v_mfma_f32_16x16x32_bf16 v[100:103], v[68:71], v[32:35], v[100:103]
    ds_read_b128 v[48:51], v19 offset:32768
    v_mfma_f32_16x16x32_bf16 v[104:107], v[72:75], v[32:35], v[104:107]
    ds_read_b128 v[52:55], v19 offset:34816
    v_mfma_f32_16x16x32_bf16 v[108:111], v[76:79], v[32:35], v[108:111]
    ds_read_b128 v[56:59], v19 offset:36864
    v_mfma_f32_16x16x32_bf16 v[112:115], v[64:67], v[36:39], v[112:115]
    v_mfma_f32_16x16x32_bf16 v[116:119], v[68:71], v[36:39], v[116:119]
    ds_read_b128 v[60:63], v19 offset:38912
    v_mfma_f32_16x16x32_bf16 v[120:123], v[72:75], v[36:39], v[120:123]
    ds_read_b64_tr_b16 v[80:81], v20 offset:57344
    v_mfma_f32_16x16x32_bf16 v[124:127], v[76:79], v[36:39], v[124:127]
    ds_read_b64_tr_b16 v[82:83], v20 offset:58368
    v_mfma_f32_16x16x32_bf16 v[128:131], v[64:67], v[40:43], v[128:131]
    v_mfma_f32_16x16x32_bf16 v[132:135], v[68:71], v[40:43], v[132:135]
    ds_read_b64_tr_b16 v[84:85], v21 offset:57344
    v_mfma_f32_16x16x32_bf16 v[136:139], v[72:75], v[40:43], v[136:139]
    ds_read_b64_tr_b16 v[86:87], v21 offset:58368
    v_mfma_f32_16x16x32_bf16 v[140:143], v[76:79], v[40:43], v[140:143]
    ds_read_b64_tr_b16 v[88:89], v22 offset:57344
    v_mfma_f32_16x16x32_bf16 v[144:147], v[64:67], v[44:47], v[144:147]
    v_mfma_f32_16x16x32_bf16 v[148:151], v[68:71], v[44:47], v[148:151]
    ds_read_b64_tr_b16 v[90:91], v22 offset:58368
    v_mfma_f32_16x16x32_bf16 v[152:155], v[72:75], v[44:47], v[152:155]
    ds_read_b64_tr_b16 v[92:93], v23 offset:57344
    v_mfma_f32_16x16x32_bf16 v[156:159], v[76:79], v[44:47], v[156:159]
    ds_read_b64_tr_b16 v[94:95], v23 offset:58368
    s_waitcnt lgkmcnt(0)
    v_mfma_f32_16x16x32_bf16 v[96:99], v[80:83], v[48:51], v[96:99]
    v_mfma_f32_16x16x32_bf16 v[100:103], v[84:87], v[48:51], v[100:103]
    ds_read_b128 v[32:35], v26 offset:0
    v_mfma_f32_16x16x32_bf16 v[104:107], v[88:91], v[48:51], v[104:107]
    ds_read_b128 v[36:39], v26 offset:2048
    v_mfma_f32_16x16x32_bf16 v[108:111], v[92:95], v[48:51], v[108:111]
    ds_read_b128 v[40:43], v26 offset:4096
    v_mfma_f32_16x16x32_bf16 v[112:115], v[80:83], v[52:55], v[112:115]
    v_mfma_f32_16x16x32_bf16 v[116:119], v[84:87], v[52:55], v[116:119]
    ds_read_b128 v[44:47], v26 offset:6144
    v_mfma_f32_16x16x32_bf16 v[120:123], v[88:91], v[52:55], v[120:123]
    ds_read_b64_tr_b16 v[64:65], v28 offset:16384
    v_mfma_f32_16x16x32_bf16 v[124:127], v[92:95], v[52:55], v[124:127]
    ds_read_b64_tr_b16 v[66:67], v28 offset:17408
    v_mfma_f32_16x16x32_bf16 v[128:131], v[80:83], v[56:59], v[128:131]
    v_mfma_f32_16x16x32_bf16 v[132:135], v[84:87], v[56:59], v[132:135]
    ds_read_b64_tr_b16 v[68:69], v29 offset:16384
    v_mfma_f32_16x16x32_bf16 v[136:139], v[88:91], v[56:59], v[136:139]
    ds_read_b64_tr_b16 v[70:71], v29 offset:17408
    v_mfma_f32_16x16x32_bf16 v[140:143], v[92:95], v[56:59], v[140:143]
    ds_read_b64_tr_b16 v[72:73], v30 offset:16384
    v_mfma_f32_16x16x32_bf16 v[144:147], v[80:83], v[60:63], v[144:147]
    v_mfma_f32_16x16x32_bf16 v[148:151], v[84:87], v[60:63], v[148:151]
    ds_read_b64_tr_b16 v[74:75], v30 offset:17408
    v_mfma_f32_16x16x32_bf16 v[152:155], v[88:91], v[60:63], v[152:155]
    ds_read_b64_tr_b16 v[76:77], v31 offset:16384
    v_mfma_f32_16x16x32_bf16 v[156:159], v[92:95], v[60:63], v[156:159]
    ds_read_b64_tr_b16 v[78:79], v31 offset:17408
    s_barrier
    s_waitcnt lgkmcnt(0)
    v_mfma_f32_16x16x32_bf16 v[96:99], v[64:67], v[32:35], v[96:99]
    v_mfma_f32_16x16x32_bf16 v[100:103], v[68:71], v[32:35], v[100:103]
    ds_read_b128 v[48:51], v27 offset:0
    v_mfma_f32_16x16x32_bf16 v[104:107], v[72:75], v[32:35], v[104:107]
    ds_read_b128 v[52:55], v27 offset:2048
    v_mfma_f32_16x16x32_bf16 v[108:111], v[76:79], v[32:35], v[108:111]
    ds_read_b128 v[56:59], v27 offset:4096
    v_mfma_f32_16x16x32_bf16 v[112:115], v[64:67], v[36:39], v[112:115]
    v_mfma_f32_16x16x32_bf16 v[116:119], v[68:71], v[36:39], v[116:119]
    ds_read_b128 v[60:63], v27 offset:6144
    v_mfma_f32_16x16x32_bf16 v[120:123], v[72:75], v[36:39], v[120:123]
    ds_read_b64_tr_b16 v[80:81], v28 offset:24576
    v_mfma_f32_16x16x32_bf16 v[124:127], v[76:79], v[36:39], v[124:127]
    ds_read_b64_tr_b16 v[82:83], v28 offset:25600
    v_mfma_f32_16x16x32_bf16 v[128:131], v[64:67], v[40:43], v[128:131]
    v_mfma_f32_16x16x32_bf16 v[132:135], v[68:71], v[40:43], v[132:135]
    ds_read_b64_tr_b16 v[84:85], v29 offset:24576
    v_mfma_f32_16x16x32_bf16 v[136:139], v[72:75], v[40:43], v[136:139]
    ds_read_b64_tr_b16 v[86:87], v29 offset:25600
    v_mfma_f32_16x16x32_bf16 v[140:143], v[76:79], v[40:43], v[140:143]
    ds_read_b64_tr_b16 v[88:89], v30 offset:24576
    v_mfma_f32_16x16x32_bf16 v[144:147], v[64:67], v[44:47], v[144:147]
    v_mfma_f32_16x16x32_bf16 v[148:151], v[68:71], v[44:47], v[148:151]
    ds_read_b64_tr_b16 v[90:91], v30 offset:25600
    v_mfma_f32_16x16x32_bf16 v[152:155], v[72:75], v[44:47], v[152:155]
    ds_read_b64_tr_b16 v[92:93], v31 offset:24576
    v_mfma_f32_16x16x32_bf16 v[156:159], v[76:79], v[44:47], v[156:159]
    ds_read_b64_tr_b16 v[94:95], v31 offset:25600
    s_waitcnt lgkmcnt(0)
    v_mfma_f32_16x16x32_bf16 v[96:99], v[80:83], v[48:51], v[96:99]
    v_mfma_f32_16x16x32_bf16 v[100:103], v[84:87], v[48:51], v[100:103]
    ds_read_b128 v[32:35], v26 offset:32768
    v_mfma_f32_16x16x32_bf16 v[104:107], v[88:91], v[48:51], v[104:107]
    ds_read_b128 v[36:39], v26 offset:34816
    v_mfma_f32_16x16x32_bf16 v[108:111], v[92:95], v[48:51], v[108:111]
    ds_read_b128 v[40:43], v26 offset:36864
    v_mfma_f32_16x16x32_bf16 v[112:115], v[80:83], v[52:55], v[112:115]
    v_mfma_f32_16x16x32_bf16 v[116:119], v[84:87], v[52:55], v[116:119]
    ds_read_b128 v[44:47], v26 offset:38912
    v_mfma_f32_16x16x32_bf16 v[120:123], v[88:91], v[52:55], v[120:123]
    ds_read_b64_tr_b16 v[64:65], v28 offset:49152
    v_mfma_f32_16x16x32_bf16 v[124:127], v[92:95], v[52:55], v[124:127]
    ds_read_b64_tr_b16 v[66:67], v28 offset:50176
    v_mfma_f32_16x16x32_bf16 v[128:131], v[80:83], v[56:59], v[128:131]
    v_mfma_f32_16x16x32_bf16 v[132:135], v[84:87], v[56:59], v[132:135]
    ds_read_b64_tr_b16 v[68:69], v29 offset:49152
    v_mfma_f32_16x16x32_bf16 v[136:139], v[88:91], v[56:59], v[136:139]
    ds_read_b64_tr_b16 v[70:71], v29 offset:50176
    v_mfma_f32_16x16x32_bf16 v[140:143], v[92:95], v[56:59], v[140:143]
    ds_read_b64_tr_b16 v[72:73], v30 offset:49152
    v_mfma_f32_16x16x32_bf16 v[144:147], v[80:83], v[60:63], v[144:147]
    v_mfma_f32_16x16x32_bf16 v[148:151], v[84:87], v[60:63], v[148:151]
    ds_read_b64_tr_b16 v[74:75], v30 offset:50176
    v_mfma_f32_16x16x32_bf16 v[152:155], v[88:91], v[60:63], v[152:155]
    ds_read_b64_tr_b16 v[76:77], v31 offset:49152
    v_mfma_f32_16x16x32_bf16 v[156:159], v[92:95], v[60:63], v[156:159]
    ds_read_b64_tr_b16 v[78:79], v31 offset:50176
    s_barrier
    s_waitcnt lgkmcnt(0)
    v_mfma_f32_16x16x32_bf16 v[96:99], v[64:67], v[32:35], v[96:99]
    v_mfma_f32_16x16x32_bf16 v[100:103], v[68:71], v[32:35], v[100:103]
    ds_read_b128 v[48:51], v27 offset:32768
    v_mfma_f32_16x16x32_bf16 v[104:107], v[72:75], v[32:35], v[104:107]
    ds_read_b128 v[52:55], v27 offset:34816
    v_mfma_f32_16x16x32_bf16 v[108:111], v[76:79], v[32:35], v[108:111]
    ds_read_b128 v[56:59], v27 offset:36864
    v_mfma_f32_16x16x32_bf16 v[112:115], v[64:67], v[36:39], v[112:115]
    v_mfma_f32_16x16x32_bf16 v[116:119], v[68:71], v[36:39], v[116:119]
    ds_read_b128 v[60:63], v27 offset:38912
    v_mfma_f32_16x16x32_bf16 v[120:123], v[72:75], v[36:39], v[120:123]
    ds_read_b64_tr_b16 v[80:81], v28 offset:57344
    v_mfma_f32_16x16x32_bf16 v[124:127], v[76:79], v[36:39], v[124:127]
    ds_read_b64_tr_b16 v[82:83], v28 offset:58368
    v_mfma_f32_16x16x32_bf16 v[128:131], v[64:67], v[40:43], v[128:131]
    v_mfma_f32_16x16x32_bf16 v[132:135], v[68:71], v[40:43], v[132:135]
    ds_read_b64_tr_b16 v[84:85], v29 offset:57344
    v_mfma_f32_16x16x32_bf16 v[136:139], v[72:75], v[40:43], v[136:139]
    ds_read_b64_tr_b16 v[86:87], v29 offset:58368
    v_mfma_f32_16x16x32_bf16 v[140:143], v[76:79], v[40:43], v[140:143]
    ds_read_b64_tr_b16 v[88:89], v30 offset:57344
    v_mfma_f32_16x16x32_bf16 v[144:147], v[64:67], v[44:47], v[144:147]
    v_mfma_f32_16x16x32_bf16 v[148:151], v[68:71], v[44:47], v[148:151]
    ds_read_b64_tr_b16 v[90:91], v30 offset:58368
    v_mfma_f32_16x16x32_bf16 v[152:155], v[72:75], v[44:47], v[152:155]
    ds_read_b64_tr_b16 v[92:93], v31 offset:57344
    v_mfma_f32_16x16x32_bf16 v[156:159], v[76:79], v[44:47], v[156:159]
    ds_read_b64_tr_b16 v[94:95], v31 offset:58368
    s_waitcnt lgkmcnt(0)
    v_mfma_f32_16x16x32_bf16 v[96:99], v[80:83], v[48:51], v[96:99]
    v_mfma_f32_16x16x32_bf16 v[100:103], v[84:87], v[48:51], v[100:103]
    ds_read_b128 v[32:35], v18 offset:0
    v_mfma_f32_16x16x32_bf16 v[104:107], v[88:91], v[48:51], v[104:107]
    ds_read_b128 v[36:39], v18 offset:2048
    v_mfma_f32_16x16x32_bf16 v[108:111], v[92:95], v[48:51], v[108:111]
    ds_read_b128 v[40:43], v18 offset:4096
    v_mfma_f32_16x16x32_bf16 v[112:115], v[80:83], v[52:55], v[112:115]
    v_mfma_f32_16x16x32_bf16 v[116:119], v[84:87], v[52:55], v[116:119]
    ds_read_b128 v[44:47], v18 offset:6144
    v_mfma_f32_16x16x32_bf16 v[120:123], v[88:91], v[52:55], v[120:123]
    ds_read_b64_tr_b16 v[64:65], v20 offset:16384
    v_mfma_f32_16x16x32_bf16 v[124:127], v[92:95], v[52:55], v[124:127]
    ds_read_b64_tr_b16 v[66:67], v20 offset:17408
    v_mfma_f32_16x16x32_bf16 v[128:131], v[80:83], v[56:59], v[128:131]
    v_mfma_f32_16x16x32_bf16 v[132:135], v[84:87], v[56:59], v[132:135]
    ds_read_b64_tr_b16 v[68:69], v21 offset:16384
    v_mfma_f32_16x16x32_bf16 v[136:139], v[88:91], v[56:59], v[136:139]
    ds_read_b64_tr_b16 v[70:71], v21 offset:17408
    v_mfma_f32_16x16x32_bf16 v[140:143], v[92:95], v[56:59], v[140:143]
    ds_read_b64_tr_b16 v[72:73], v22 offset:16384
    v_mfma_f32_16x16x32_bf16 v[144:147], v[80:83], v[60:63], v[144:147]
    v_mfma_f32_16x16x32_bf16 v[148:151], v[84:87], v[60:63], v[148:151]
    ds_read_b64_tr_b16 v[74:75], v22 offset:17408
    v_mfma_f32_16x16x32_bf16 v[152:155], v[88:91], v[60:63], v[152:155]
    ds_read_b64_tr_b16 v[76:77], v23 offset:16384
    v_mfma_f32_16x16x32_bf16 v[156:159], v[92:95], v[60:63], v[156:159]
    ds_read_b64_tr_b16 v[78:79], v23 offset:17408
    s_barrier
    s_add_u32 s31, s31, 1
    s_cmp_lt_u32 s31, 2
    s_cbranch_scc1 Lcloop_win1_kernel_3
    s_waitcnt lgkmcnt(0)
    v_mfma_f32_16x16x32_bf16 v[96:99], v[64:67], v[32:35], v[96:99]
    v_mfma_f32_16x16x32_bf16 v[100:103], v[68:71], v[32:35], v[100:103]
    ds_read_b128 v[48:51], v19 offset:0
    v_mfma_f32_16x16x32_bf16 v[104:107], v[72:75], v[32:35], v[104:107]
    ds_read_b128 v[52:55], v19 offset:2048
    v_mfma_f32_16x16x32_bf16 v[108:111], v[76:79], v[32:35], v[108:111]
    ds_read_b128 v[56:59], v19 offset:4096
    v_mfma_f32_16x16x32_bf16 v[112:115], v[64:67], v[36:39], v[112:115]
    v_mfma_f32_16x16x32_bf16 v[116:119], v[68:71], v[36:39], v[116:119]
    ds_read_b128 v[60:63], v19 offset:6144
    v_mfma_f32_16x16x32_bf16 v[120:123], v[72:75], v[36:39], v[120:123]
    ds_read_b64_tr_b16 v[80:81], v20 offset:24576
    v_mfma_f32_16x16x32_bf16 v[124:127], v[76:79], v[36:39], v[124:127]
    ds_read_b64_tr_b16 v[82:83], v20 offset:25600
    v_mfma_f32_16x16x32_bf16 v[128:131], v[64:67], v[40:43], v[128:131]
    v_mfma_f32_16x16x32_bf16 v[132:135], v[68:71], v[40:43], v[132:135]
    ds_read_b64_tr_b16 v[84:85], v21 offset:24576
    v_mfma_f32_16x16x32_bf16 v[136:139], v[72:75], v[40:43], v[136:139]
    ds_read_b64_tr_b16 v[86:87], v21 offset:25600
    v_mfma_f32_16x16x32_bf16 v[140:143], v[76:79], v[40:43], v[140:143]
    ds_read_b64_tr_b16 v[88:89], v22 offset:24576
    v_mfma_f32_16x16x32_bf16 v[144:147], v[64:67], v[44:47], v[144:147]
    v_mfma_f32_16x16x32_bf16 v[148:151], v[68:71], v[44:47], v[148:151]
    ds_read_b64_tr_b16 v[90:91], v22 offset:25600
    v_mfma_f32_16x16x32_bf16 v[152:155], v[72:75], v[44:47], v[152:155]
    ds_read_b64_tr_b16 v[92:93], v23 offset:24576
    v_mfma_f32_16x16x32_bf16 v[156:159], v[76:79], v[44:47], v[156:159]
    ds_read_b64_tr_b16 v[94:95], v23 offset:25600
    s_waitcnt lgkmcnt(0)
    v_mfma_f32_16x16x32_bf16 v[96:99], v[80:83], v[48:51], v[96:99]
    v_mfma_f32_16x16x32_bf16 v[100:103], v[84:87], v[48:51], v[100:103]
    ds_read_b128 v[32:35], v18 offset:32768
    v_mfma_f32_16x16x32_bf16 v[104:107], v[88:91], v[48:51], v[104:107]
    ds_read_b128 v[36:39], v18 offset:34816
    v_mfma_f32_16x16x32_bf16 v[108:111], v[92:95], v[48:51], v[108:111]
    ds_read_b128 v[40:43], v18 offset:36864
    v_mfma_f32_16x16x32_bf16 v[112:115], v[80:83], v[52:55], v[112:115]
    v_mfma_f32_16x16x32_bf16 v[116:119], v[84:87], v[52:55], v[116:119]
    ds_read_b128 v[44:47], v18 offset:38912
    v_mfma_f32_16x16x32_bf16 v[120:123], v[88:91], v[52:55], v[120:123]
    ds_read_b64_tr_b16 v[64:65], v20 offset:49152
    v_mfma_f32_16x16x32_bf16 v[124:127], v[92:95], v[52:55], v[124:127]
    ds_read_b64_tr_b16 v[66:67], v20 offset:50176
    v_mfma_f32_16x16x32_bf16 v[128:131], v[80:83], v[56:59], v[128:131]
    v_mfma_f32_16x16x32_bf16 v[132:135], v[84:87], v[56:59], v[132:135]
    ds_read_b64_tr_b16 v[68:69], v21 offset:49152
    v_mfma_f32_16x16x32_bf16 v[136:139], v[88:91], v[56:59], v[136:139]
    ds_read_b64_tr_b16 v[70:71], v21 offset:50176
    v_mfma_f32_16x16x32_bf16 v[140:143], v[92:95], v[56:59], v[140:143]
    ds_read_b64_tr_b16 v[72:73], v22 offset:49152
    v_mfma_f32_16x16x32_bf16 v[144:147], v[80:83], v[60:63], v[144:147]
    v_mfma_f32_16x16x32_bf16 v[148:151], v[84:87], v[60:63], v[148:151]
    ds_read_b64_tr_b16 v[74:75], v22 offset:50176
    v_mfma_f32_16x16x32_bf16 v[152:155], v[88:91], v[60:63], v[152:155]
    ds_read_b64_tr_b16 v[76:77], v23 offset:49152
    v_mfma_f32_16x16x32_bf16 v[156:159], v[92:95], v[60:63], v[156:159]
    ds_read_b64_tr_b16 v[78:79], v23 offset:50176
    s_barrier
    s_waitcnt lgkmcnt(0)
    v_mfma_f32_16x16x32_bf16 v[96:99], v[64:67], v[32:35], v[96:99]
    v_mfma_f32_16x16x32_bf16 v[100:103], v[68:71], v[32:35], v[100:103]
    ds_read_b128 v[48:51], v19 offset:32768
    v_mfma_f32_16x16x32_bf16 v[104:107], v[72:75], v[32:35], v[104:107]
    ds_read_b128 v[52:55], v19 offset:34816
    v_mfma_f32_16x16x32_bf16 v[108:111], v[76:79], v[32:35], v[108:111]
    ds_read_b128 v[56:59], v19 offset:36864
    v_mfma_f32_16x16x32_bf16 v[112:115], v[64:67], v[36:39], v[112:115]
    v_mfma_f32_16x16x32_bf16 v[116:119], v[68:71], v[36:39], v[116:119]
    ds_read_b128 v[60:63], v19 offset:38912
    v_mfma_f32_16x16x32_bf16 v[120:123], v[72:75], v[36:39], v[120:123]
    ds_read_b64_tr_b16 v[80:81], v20 offset:57344
    v_mfma_f32_16x16x32_bf16 v[124:127], v[76:79], v[36:39], v[124:127]
    ds_read_b64_tr_b16 v[82:83], v20 offset:58368
    v_mfma_f32_16x16x32_bf16 v[128:131], v[64:67], v[40:43], v[128:131]
    v_mfma_f32_16x16x32_bf16 v[132:135], v[68:71], v[40:43], v[132:135]
    ds_read_b64_tr_b16 v[84:85], v21 offset:57344
    v_mfma_f32_16x16x32_bf16 v[136:139], v[72:75], v[40:43], v[136:139]
    ds_read_b64_tr_b16 v[86:87], v21 offset:58368
    v_mfma_f32_16x16x32_bf16 v[140:143], v[76:79], v[40:43], v[140:143]
    ds_read_b64_tr_b16 v[88:89], v22 offset:57344
    v_mfma_f32_16x16x32_bf16 v[144:147], v[64:67], v[44:47], v[144:147]
    v_mfma_f32_16x16x32_bf16 v[148:151], v[68:71], v[44:47], v[148:151]
    ds_read_b64_tr_b16 v[90:91], v22 offset:58368
    v_mfma_f32_16x16x32_bf16 v[152:155], v[72:75], v[44:47], v[152:155]
    ds_read_b64_tr_b16 v[92:93], v23 offset:57344
    v_mfma_f32_16x16x32_bf16 v[156:159], v[76:79], v[44:47], v[156:159]
    ds_read_b64_tr_b16 v[94:95], v23 offset:58368
    s_waitcnt lgkmcnt(0)
    v_mfma_f32_16x16x32_bf16 v[96:99], v[80:83], v[48:51], v[96:99]
    v_mfma_f32_16x16x32_bf16 v[100:103], v[84:87], v[48:51], v[100:103]
    v_mfma_f32_16x16x32_bf16 v[104:107], v[88:91], v[48:51], v[104:107]
    v_mfma_f32_16x16x32_bf16 v[108:111], v[92:95], v[48:51], v[108:111]
    v_mfma_f32_16x16x32_bf16 v[112:115], v[80:83], v[52:55], v[112:115]
    v_mfma_f32_16x16x32_bf16 v[116:119], v[84:87], v[52:55], v[116:119]
    v_mfma_f32_16x16x32_bf16 v[120:123], v[88:91], v[52:55], v[120:123]
    v_mfma_f32_16x16x32_bf16 v[124:127], v[92:95], v[52:55], v[124:127]
    v_mfma_f32_16x16x32_bf16 v[128:131], v[80:83], v[56:59], v[128:131]
    v_mfma_f32_16x16x32_bf16 v[132:135], v[84:87], v[56:59], v[132:135]
    v_mfma_f32_16x16x32_bf16 v[136:139], v[88:91], v[56:59], v[136:139]
    v_mfma_f32_16x16x32_bf16 v[140:143], v[92:95], v[56:59], v[140:143]
    v_mfma_f32_16x16x32_bf16 v[144:147], v[80:83], v[60:63], v[144:147]
    v_mfma_f32_16x16x32_bf16 v[148:151], v[84:87], v[60:63], v[148:151]
    v_mfma_f32_16x16x32_bf16 v[152:155], v[88:91], v[60:63], v[152:155]
    v_mfma_f32_16x16x32_bf16 v[156:159], v[92:95], v[60:63], v[156:159]
    s_barrier
    s_nop 7
    s_nop 7
    v_lshrrev_b32 v3, 1, v2
    v_and_b32 v4, 1, v2
    v_lshrrev_b32 v5, 4, v1
    v_and_b32 v6, 15, v1
    s_mov_b32 s47, 0x3dd2d3e8
    v_mov_b32 v28, 0x40135761
    s_load_dwordx2 s[36:37], s[0:1], 88
    s_waitcnt lgkmcnt(0)
    s_add_u32 s20, s36, 39911424
    s_addc_u32 s21, s37, 0
    s_mov_b32 s22, 6144
    s_mov_b32 s23, 0x00020000
    v_lshlrev_b32 v7, 6, v4
    v_lshl_add_u32 v7, v5, 2, v7
    v_add_u32 v7, s28, v7
    v_lshlrev_b32 v7, 2, v7
    buffer_load_dwordx4 v[64:67], v7, s[20:23], 0 offen offset:0
    buffer_load_dwordx4 v[68:71], v7, s[20:23], 0 offen offset:64
    buffer_load_dwordx4 v[72:75], v7, s[20:23], 0 offen offset:128
    buffer_load_dwordx4 v[76:79], v7, s[20:23], 0 offen offset:192
    s_waitcnt vmcnt(0)
    v_fma_f32 v96, -v8, v64, v96
    v_mul_f32 v96, v96, v12
    v_fma_f32 v97, -v8, v65, v97
    v_mul_f32 v97, v97, v12
    v_fma_f32 v98, -v8, v66, v98
    v_mul_f32 v98, v98, v12
    v_fma_f32 v99, -v8, v67, v99
    v_mul_f32 v99, v99, v12
    v_fma_f32 v100, -v8, v68, v100
    v_mul_f32 v100, v100, v12
    v_fma_f32 v101, -v8, v69, v101
    v_mul_f32 v101, v101, v12
    v_fma_f32 v102, -v8, v70, v102
    v_mul_f32 v102, v102, v12
    v_fma_f32 v103, -v8, v71, v103
    v_mul_f32 v103, v103, v12
    v_fma_f32 v104, -v8, v72, v104
    v_mul_f32 v104, v104, v12
    v_fma_f32 v105, -v8, v73, v105
    v_mul_f32 v105, v105, v12
    v_fma_f32 v106, -v8, v74, v106
    v_mul_f32 v106, v106, v12
    v_fma_f32 v107, -v8, v75, v107
    v_mul_f32 v107, v107, v12
    v_fma_f32 v108, -v8, v76, v108
    v_mul_f32 v108, v108, v12
    v_fma_f32 v109, -v8, v77, v109
    v_mul_f32 v109, v109, v12
    v_fma_f32 v110, -v8, v78, v110
    v_mul_f32 v110, v110, v12
    v_fma_f32 v111, -v8, v79, v111
    v_mul_f32 v111, v111, v12
    v_fma_f32 v112, -v9, v64, v112
    v_mul_f32 v112, v112, v13
    v_fma_f32 v113, -v9, v65, v113
    v_mul_f32 v113, v113, v13
    v_fma_f32 v114, -v9, v66, v114
    v_mul_f32 v114, v114, v13
    v_fma_f32 v115, -v9, v67, v115
    v_mul_f32 v115, v115, v13
    v_fma_f32 v116, -v9, v68, v116
    v_mul_f32 v116, v116, v13
    v_fma_f32 v117, -v9, v69, v117
    v_mul_f32 v117, v117, v13
    v_fma_f32 v118, -v9, v70, v118
    v_mul_f32 v118, v118, v13
    v_fma_f32 v119, -v9, v71, v119
    v_mul_f32 v119, v119, v13
    v_fma_f32 v120, -v9, v72, v120
    v_mul_f32 v120, v120, v13
    v_fma_f32 v121, -v9, v73, v121
    v_mul_f32 v121, v121, v13
    v_fma_f32 v122, -v9, v74, v122
    v_mul_f32 v122, v122, v13
    v_fma_f32 v123, -v9, v75, v123
    v_mul_f32 v123, v123, v13
    v_fma_f32 v124, -v9, v76, v124
    v_mul_f32 v124, v124, v13
    v_fma_f32 v125, -v9, v77, v125
    v_mul_f32 v125, v125, v13
    v_fma_f32 v126, -v9, v78, v126
    v_mul_f32 v126, v126, v13
    v_fma_f32 v127, -v9, v79, v127
    v_mul_f32 v127, v127, v13
    v_fma_f32 v128, -v10, v64, v128
    v_mul_f32 v128, v128, v14
    v_fma_f32 v129, -v10, v65, v129
    v_mul_f32 v129, v129, v14
    v_fma_f32 v130, -v10, v66, v130
    v_mul_f32 v130, v130, v14
    v_fma_f32 v131, -v10, v67, v131
    v_mul_f32 v131, v131, v14
    v_fma_f32 v132, -v10, v68, v132
    v_mul_f32 v132, v132, v14
    v_fma_f32 v133, -v10, v69, v133
    v_mul_f32 v133, v133, v14
    v_fma_f32 v134, -v10, v70, v134
    v_mul_f32 v134, v134, v14
    v_fma_f32 v135, -v10, v71, v135
    v_mul_f32 v135, v135, v14
    v_fma_f32 v136, -v10, v72, v136
    v_mul_f32 v136, v136, v14
    v_fma_f32 v137, -v10, v73, v137
    v_mul_f32 v137, v137, v14
    v_fma_f32 v138, -v10, v74, v138
    v_mul_f32 v138, v138, v14
    v_fma_f32 v139, -v10, v75, v139
    v_mul_f32 v139, v139, v14
    v_fma_f32 v140, -v10, v76, v140
    v_mul_f32 v140, v140, v14
    v_fma_f32 v141, -v10, v77, v141
    v_mul_f32 v141, v141, v14
    v_fma_f32 v142, -v10, v78, v142
    v_mul_f32 v142, v142, v14
    v_fma_f32 v143, -v10, v79, v143
    v_mul_f32 v143, v143, v14
    v_fma_f32 v144, -v11, v64, v144
    v_mul_f32 v144, v144, v15
    v_fma_f32 v145, -v11, v65, v145
    v_mul_f32 v145, v145, v15
    v_fma_f32 v146, -v11, v66, v146
    v_mul_f32 v146, v146, v15
    v_fma_f32 v147, -v11, v67, v147
    v_mul_f32 v147, v147, v15
    v_fma_f32 v148, -v11, v68, v148
    v_mul_f32 v148, v148, v15
    v_fma_f32 v149, -v11, v69, v149
    v_mul_f32 v149, v149, v15
    v_fma_f32 v150, -v11, v70, v150
    v_mul_f32 v150, v150, v15
    v_fma_f32 v151, -v11, v71, v151
    v_mul_f32 v151, v151, v15
    v_fma_f32 v152, -v11, v72, v152
    v_mul_f32 v152, v152, v15
    v_fma_f32 v153, -v11, v73, v153
    v_mul_f32 v153, v153, v15
    v_fma_f32 v154, -v11, v74, v154
    v_mul_f32 v154, v154, v15
    v_fma_f32 v155, -v11, v75, v155
    v_mul_f32 v155, v155, v15
    v_fma_f32 v156, -v11, v76, v156
    v_mul_f32 v156, v156, v15
    v_fma_f32 v157, -v11, v77, v157
    v_mul_f32 v157, v157, v15
    v_fma_f32 v158, -v11, v78, v158
    v_mul_f32 v158, v158, v15
    v_fma_f32 v159, -v11, v79, v159
    v_mul_f32 v159, v159, v15
    v_mul_u32_u24 v7, 9216, v2
    v_mul_u32_u24 v8, 144, v6
    v_add_u32 v7, v7, v8
    v_lshl_add_u32 v7, v5, 3, v7
    v_cvt_pk_bf16_f32 v32, v96, v97
    v_cvt_pk_bf16_f32 v33, v98, v99
    v_lshlrev_b32 v96, 16, v32
    v_and_b32 v97, 0xffff0000, v32
    v_lshlrev_b32 v98, 16, v33
    v_and_b32 v99, 0xffff0000, v33
    v_mul_f32 v34, v96, v96
    v_fma_f32 v34, v34, s47, v28
    v_mul_f32 v34, v34, v96
    v_exp_f32 v34, v34
    v_mul_f32 v35, v97, v97
    v_fma_f32 v35, v35, s47, v28
    v_mul_f32 v35, v35, v97
    v_exp_f32 v35, v35
    v_mul_f32 v36, v98, v98
    v_fma_f32 v36, v36, s47, v28
    v_mul_f32 v36, v36, v98
    v_exp_f32 v36, v36
    v_mul_f32 v37, v99, v99
    v_fma_f32 v37, v37, s47, v28
    v_mul_f32 v37, v37, v99
    v_exp_f32 v37, v37
    v_add_f32 v34, 1.0, v34
    v_rcp_f32 v34, v34
    v_add_f32 v35, 1.0, v35
    v_rcp_f32 v35, v35
    v_add_f32 v36, 1.0, v36
    v_rcp_f32 v36, v36
    v_add_f32 v37, 1.0, v37
    v_rcp_f32 v37, v37
    s_nop 0
    v_fma_f32 v96, -v96, v34, v96
    v_fma_f32 v97, -v97, v35, v97
    v_fma_f32 v98, -v98, v36, v98
    v_fma_f32 v99, -v99, v37, v99
    v_cvt_pk_bf16_f32 v32, v96, v97
    v_cvt_pk_bf16_f32 v33, v98, v99
    ds_write_b64 v7, v[32:33] offset:0
    v_cvt_pk_bf16_f32 v40, v100, v101
    v_cvt_pk_bf16_f32 v41, v102, v103
    v_lshlrev_b32 v100, 16, v40
    v_and_b32 v101, 0xffff0000, v40
    v_lshlrev_b32 v102, 16, v41
    v_and_b32 v103, 0xffff0000, v41
    v_mul_f32 v42, v100, v100
    v_fma_f32 v42, v42, s47, v28
    v_mul_f32 v42, v42, v100
    v_exp_f32 v42, v42
    v_mul_f32 v43, v101, v101
    v_fma_f32 v43, v43, s47, v28
    v_mul_f32 v43, v43, v101
    v_exp_f32 v43, v43
    v_mul_f32 v44, v102, v102
    v_fma_f32 v44, v44, s47, v28
    v_mul_f32 v44, v44, v102
    v_exp_f32 v44, v44
    v_mul_f32 v45, v103, v103
    v_fma_f32 v45, v45, s47, v28
    v_mul_f32 v45, v45, v103
    v_exp_f32 v45, v45
    v_add_f32 v42, 1.0, v42
    v_rcp_f32 v42, v42
    v_add_f32 v43, 1.0, v43
    v_rcp_f32 v43, v43
    v_add_f32 v44, 1.0, v44
    v_rcp_f32 v44, v44
    v_add_f32 v45, 1.0, v45
    v_rcp_f32 v45, v45
    s_nop 0
    v_fma_f32 v100, -v100, v42, v100
    v_fma_f32 v101, -v101, v43, v101
    v_fma_f32 v102, -v102, v44, v102
    v_fma_f32 v103, -v103, v45, v103
    v_cvt_pk_bf16_f32 v40, v100, v101
    v_cvt_pk_bf16_f32 v41, v102, v103
    ds_write_b64 v7, v[40:41] offset:32
    v_cvt_pk_bf16_f32 v48, v104, v105
    v_cvt_pk_bf16_f32 v49, v106, v107
    v_lshlrev_b32 v104, 16, v48
    v_and_b32 v105, 0xffff0000, v48
    v_lshlrev_b32 v106, 16, v49
    v_and_b32 v107, 0xffff0000, v49
    v_mul_f32 v50, v104, v104
    v_fma_f32 v50, v50, s47, v28
    v_mul_f32 v50, v50, v104
    v_exp_f32 v50, v50
    v_mul_f32 v51, v105, v105
    v_fma_f32 v51, v51, s47, v28
    v_mul_f32 v51, v51, v105
    v_exp_f32 v51, v51
    v_mul_f32 v52, v106, v106
    v_fma_f32 v52, v52, s47, v28
    v_mul_f32 v52, v52, v106
    v_exp_f32 v52, v52
    v_mul_f32 v53, v107, v107
    v_fma_f32 v53, v53, s47, v28
    v_mul_f32 v53, v53, v107
    v_exp_f32 v53, v53
    v_add_f32 v50, 1.0, v50
    v_rcp_f32 v50, v50
    v_add_f32 v51, 1.0, v51
    v_rcp_f32 v51, v51
    v_add_f32 v52, 1.0, v52
    v_rcp_f32 v52, v52
    v_add_f32 v53, 1.0, v53
    v_rcp_f32 v53, v53
    s_nop 0
    v_fma_f32 v104, -v104, v50, v104
    v_fma_f32 v105, -v105, v51, v105
    v_fma_f32 v106, -v106, v52, v106
    v_fma_f32 v107, -v107, v53, v107
    v_cvt_pk_bf16_f32 v48, v104, v105
    v_cvt_pk_bf16_f32 v49, v106, v107
    ds_write_b64 v7, v[48:49] offset:64
    v_cvt_pk_bf16_f32 v56, v108, v109
    v_cvt_pk_bf16_f32 v57, v110, v111
    v_lshlrev_b32 v108, 16, v56
    v_and_b32 v109, 0xffff0000, v56
    v_lshlrev_b32 v110, 16, v57
    v_and_b32 v111, 0xffff0000, v57
    v_mul_f32 v58, v108, v108
    v_fma_f32 v58, v58, s47, v28
    v_mul_f32 v58, v58, v108
    v_exp_f32 v58, v58
    v_mul_f32 v59, v109, v109
    v_fma_f32 v59, v59, s47, v28
    v_mul_f32 v59, v59, v109
    v_exp_f32 v59, v59
    v_mul_f32 v60, v110, v110
    v_fma_f32 v60, v60, s47, v28
    v_mul_f32 v60, v60, v110
    v_exp_f32 v60, v60
    v_mul_f32 v61, v111, v111
    v_fma_f32 v61, v61, s47, v28
    v_mul_f32 v61, v61, v111
    v_exp_f32 v61, v61
    v_add_f32 v58, 1.0, v58
    v_rcp_f32 v58, v58
    v_add_f32 v59, 1.0, v59
    v_rcp_f32 v59, v59
    v_add_f32 v60, 1.0, v60
    v_rcp_f32 v60, v60
    v_add_f32 v61, 1.0, v61
    v_rcp_f32 v61, v61
    s_nop 0
    v_fma_f32 v108, -v108, v58, v108
    v_fma_f32 v109, -v109, v59, v109
    v_fma_f32 v110, -v110, v60, v110
    v_fma_f32 v111, -v111, v61, v111
    v_cvt_pk_bf16_f32 v56, v108, v109
    v_cvt_pk_bf16_f32 v57, v110, v111
    ds_write_b64 v7, v[56:57] offset:96
    v_cvt_pk_bf16_f32 v32, v112, v113
    v_cvt_pk_bf16_f32 v33, v114, v115
    v_lshlrev_b32 v112, 16, v32
    v_and_b32 v113, 0xffff0000, v32
    v_lshlrev_b32 v114, 16, v33
    v_and_b32 v115, 0xffff0000, v33
    v_mul_f32 v34, v112, v112
    v_fma_f32 v34, v34, s47, v28
    v_mul_f32 v34, v34, v112
    v_exp_f32 v34, v34
    v_mul_f32 v35, v113, v113
    v_fma_f32 v35, v35, s47, v28
    v_mul_f32 v35, v35, v113
    v_exp_f32 v35, v35
    v_mul_f32 v36, v114, v114
    v_fma_f32 v36, v36, s47, v28
    v_mul_f32 v36, v36, v114
    v_exp_f32 v36, v36
    v_mul_f32 v37, v115, v115
    v_fma_f32 v37, v37, s47, v28
    v_mul_f32 v37, v37, v115
    v_exp_f32 v37, v37
    v_add_f32 v34, 1.0, v34
    v_rcp_f32 v34, v34
    v_add_f32 v35, 1.0, v35
    v_rcp_f32 v35, v35
    v_add_f32 v36, 1.0, v36
    v_rcp_f32 v36, v36
    v_add_f32 v37, 1.0, v37
    v_rcp_f32 v37, v37
    s_nop 0
    v_fma_f32 v112, -v112, v34, v112
    v_fma_f32 v113, -v113, v35, v113
    v_fma_f32 v114, -v114, v36, v114
    v_fma_f32 v115, -v115, v37, v115
    v_cvt_pk_bf16_f32 v32, v112, v113
    v_cvt_pk_bf16_f32 v33, v114, v115
    ds_write_b64 v7, v[32:33] offset:2304
    v_cvt_pk_bf16_f32 v40, v116, v117
    v_cvt_pk_bf16_f32 v41, v118, v119
    v_lshlrev_b32 v116, 16, v40
    v_and_b32 v117, 0xffff0000, v40
    v_lshlrev_b32 v118, 16, v41
    v_and_b32 v119, 0xffff0000, v41
    v_mul_f32 v42, v116, v116
    v_fma_f32 v42, v42, s47, v28
    v_mul_f32 v42, v42, v116
    v_exp_f32 v42, v42
    v_mul_f32 v43, v117, v117
    v_fma_f32 v43, v43, s47, v28
    v_mul_f32 v43, v43, v117
    v_exp_f32 v43, v43
    v_mul_f32 v44, v118, v118
    v_fma_f32 v44, v44, s47, v28
    v_mul_f32 v44, v44, v118
    v_exp_f32 v44, v44
    v_mul_f32 v45, v119, v119
    v_fma_f32 v45, v45, s47, v28
    v_mul_f32 v45, v45, v119
    v_exp_f32 v45, v45
    v_add_f32 v42, 1.0, v42
    v_rcp_f32 v42, v42
    v_add_f32 v43, 1.0, v43
    v_rcp_f32 v43, v43
    v_add_f32 v44, 1.0, v44
    v_rcp_f32 v44, v44
    v_add_f32 v45, 1.0, v45
    v_rcp_f32 v45, v45
    s_nop 0
    v_fma_f32 v116, -v116, v42, v116
    v_fma_f32 v117, -v117, v43, v117
    v_fma_f32 v118, -v118, v44, v118
    v_fma_f32 v119, -v119, v45, v119
    v_cvt_pk_bf16_f32 v40, v116, v117
    v_cvt_pk_bf16_f32 v41, v118, v119
    ds_write_b64 v7, v[40:41] offset:2336
    v_cvt_pk_bf16_f32 v48, v120, v121
    v_cvt_pk_bf16_f32 v49, v122, v123
    v_lshlrev_b32 v120, 16, v48
    v_and_b32 v121, 0xffff0000, v48
    v_lshlrev_b32 v122, 16, v49
    v_and_b32 v123, 0xffff0000, v49
    v_mul_f32 v50, v120, v120
    v_fma_f32 v50, v50, s47, v28
    v_mul_f32 v50, v50, v120
    v_exp_f32 v50, v50
    v_mul_f32 v51, v121, v121
    v_fma_f32 v51, v51, s47, v28
    v_mul_f32 v51, v51, v121
    v_exp_f32 v51, v51
    v_mul_f32 v52, v122, v122
    v_fma_f32 v52, v52, s47, v28
    v_mul_f32 v52, v52, v122
    v_exp_f32 v52, v52
    v_mul_f32 v53, v123, v123
    v_fma_f32 v53, v53, s47, v28
    v_mul_f32 v53, v53, v123
    v_exp_f32 v53, v53
    v_add_f32 v50, 1.0, v50
    v_rcp_f32 v50, v50
    v_add_f32 v51, 1.0, v51
    v_rcp_f32 v51, v51
    v_add_f32 v52, 1.0, v52
    v_rcp_f32 v52, v52
    v_add_f32 v53, 1.0, v53
    v_rcp_f32 v53, v53
    s_nop 0
    v_fma_f32 v120, -v120, v50, v120
    v_fma_f32 v121, -v121, v51, v121
    v_fma_f32 v122, -v122, v52, v122
    v_fma_f32 v123, -v123, v53, v123
    v_cvt_pk_bf16_f32 v48, v120, v121
    v_cvt_pk_bf16_f32 v49, v122, v123
    ds_write_b64 v7, v[48:49] offset:2368
    v_cvt_pk_bf16_f32 v56, v124, v125
    v_cvt_pk_bf16_f32 v57, v126, v127
    v_lshlrev_b32 v124, 16, v56
    v_and_b32 v125, 0xffff0000, v56
    v_lshlrev_b32 v126, 16, v57
    v_and_b32 v127, 0xffff0000, v57
    v_mul_f32 v58, v124, v124
    v_fma_f32 v58, v58, s47, v28
    v_mul_f32 v58, v58, v124
    v_exp_f32 v58, v58
    v_mul_f32 v59, v125, v125
    v_fma_f32 v59, v59, s47, v28
    v_mul_f32 v59, v59, v125
    v_exp_f32 v59, v59
    v_mul_f32 v60, v126, v126
    v_fma_f32 v60, v60, s47, v28
    v_mul_f32 v60, v60, v126
    v_exp_f32 v60, v60
    v_mul_f32 v61, v127, v127
    v_fma_f32 v61, v61, s47, v28
    v_mul_f32 v61, v61, v127
    v_exp_f32 v61, v61
    v_add_f32 v58, 1.0, v58
    v_rcp_f32 v58, v58
    v_add_f32 v59, 1.0, v59
    v_rcp_f32 v59, v59
    v_add_f32 v60, 1.0, v60
    v_rcp_f32 v60, v60
    v_add_f32 v61, 1.0, v61
    v_rcp_f32 v61, v61
    s_nop 0
    v_fma_f32 v124, -v124, v58, v124
    v_fma_f32 v125, -v125, v59, v125
    v_fma_f32 v126, -v126, v60, v126
    v_fma_f32 v127, -v127, v61, v127
    v_cvt_pk_bf16_f32 v56, v124, v125
    v_cvt_pk_bf16_f32 v57, v126, v127
    ds_write_b64 v7, v[56:57] offset:2400
    v_cvt_pk_bf16_f32 v32, v128, v129
    v_cvt_pk_bf16_f32 v33, v130, v131
    v_lshlrev_b32 v128, 16, v32
    v_and_b32 v129, 0xffff0000, v32
    v_lshlrev_b32 v130, 16, v33
    v_and_b32 v131, 0xffff0000, v33
    v_mul_f32 v34, v128, v128
    v_fma_f32 v34, v34, s47, v28
    v_mul_f32 v34, v34, v128
    v_exp_f32 v34, v34
    v_mul_f32 v35, v129, v129
    v_fma_f32 v35, v35, s47, v28
    v_mul_f32 v35, v35, v129
    v_exp_f32 v35, v35
    v_mul_f32 v36, v130, v130
    v_fma_f32 v36, v36, s47, v28
    v_mul_f32 v36, v36, v130
    v_exp_f32 v36, v36
    v_mul_f32 v37, v131, v131
    v_fma_f32 v37, v37, s47, v28
    v_mul_f32 v37, v37, v131
    v_exp_f32 v37, v37
    v_add_f32 v34, 1.0, v34
    v_rcp_f32 v34, v34
    v_add_f32 v35, 1.0, v35
    v_rcp_f32 v35, v35
    v_add_f32 v36, 1.0, v36
    v_rcp_f32 v36, v36
    v_add_f32 v37, 1.0, v37
    v_rcp_f32 v37, v37
    s_nop 0
    v_fma_f32 v128, -v128, v34, v128
    v_fma_f32 v129, -v129, v35, v129
    v_fma_f32 v130, -v130, v36, v130
    v_fma_f32 v131, -v131, v37, v131
    v_cvt_pk_bf16_f32 v32, v128, v129
    v_cvt_pk_bf16_f32 v33, v130, v131
    ds_write_b64 v7, v[32:33] offset:4608
    v_cvt_pk_bf16_f32 v40, v132, v133
    v_cvt_pk_bf16_f32 v41, v134, v135
    v_lshlrev_b32 v132, 16, v40
    v_and_b32 v133, 0xffff0000, v40
    v_lshlrev_b32 v134, 16, v41
    v_and_b32 v135, 0xffff0000, v41
    v_mul_f32 v42, v132, v132
    v_fma_f32 v42, v42, s47, v28
    v_mul_f32 v42, v42, v132
    v_exp_f32 v42, v42
    v_mul_f32 v43, v133, v133
    v_fma_f32 v43, v43, s47, v28
    v_mul_f32 v43, v43, v133
    v_exp_f32 v43, v43
    v_mul_f32 v44, v134, v134
    v_fma_f32 v44, v44, s47, v28
    v_mul_f32 v44, v44, v134
    v_exp_f32 v44, v44
    v_mul_f32 v45, v135, v135
    v_fma_f32 v45, v45, s47, v28
    v_mul_f32 v45, v45, v135
    v_exp_f32 v45, v45
    v_add_f32 v42, 1.0, v42
    v_rcp_f32 v42, v42
    v_add_f32 v43, 1.0, v43
    v_rcp_f32 v43, v43
    v_add_f32 v44, 1.0, v44
    v_rcp_f32 v44, v44
    v_add_f32 v45, 1.0, v45
    v_rcp_f32 v45, v45
    s_nop 0
    v_fma_f32 v132, -v132, v42, v132
    v_fma_f32 v133, -v133, v43, v133
    v_fma_f32 v134, -v134, v44, v134
    v_fma_f32 v135, -v135, v45, v135
    v_cvt_pk_bf16_f32 v40, v132, v133
    v_cvt_pk_bf16_f32 v41, v134, v135
    ds_write_b64 v7, v[40:41] offset:4640
    v_cvt_pk_bf16_f32 v48, v136, v137
    v_cvt_pk_bf16_f32 v49, v138, v139
    v_lshlrev_b32 v136, 16, v48
    v_and_b32 v137, 0xffff0000, v48
    v_lshlrev_b32 v138, 16, v49
    v_and_b32 v139, 0xffff0000, v49
    v_mul_f32 v50, v136, v136
    v_fma_f32 v50, v50, s47, v28
    v_mul_f32 v50, v50, v136
    v_exp_f32 v50, v50
    v_mul_f32 v51, v137, v137
    v_fma_f32 v51, v51, s47, v28
    v_mul_f32 v51, v51, v137
    v_exp_f32 v51, v51
    v_mul_f32 v52, v138, v138
    v_fma_f32 v52, v52, s47, v28
    v_mul_f32 v52, v52, v138
    v_exp_f32 v52, v52
    v_mul_f32 v53, v139, v139
    v_fma_f32 v53, v53, s47, v28
    v_mul_f32 v53, v53, v139
    v_exp_f32 v53, v53
    v_add_f32 v50, 1.0, v50
    v_rcp_f32 v50, v50
    v_add_f32 v51, 1.0, v51
    v_rcp_f32 v51, v51
    v_add_f32 v52, 1.0, v52
    v_rcp_f32 v52, v52
    v_add_f32 v53, 1.0, v53
    v_rcp_f32 v53, v53
    s_nop 0
    v_fma_f32 v136, -v136, v50, v136
    v_fma_f32 v137, -v137, v51, v137
    v_fma_f32 v138, -v138, v52, v138
    v_fma_f32 v139, -v139, v53, v139
    v_cvt_pk_bf16_f32 v48, v136, v137
    v_cvt_pk_bf16_f32 v49, v138, v139
    ds_write_b64 v7, v[48:49] offset:4672
    v_cvt_pk_bf16_f32 v56, v140, v141
    v_cvt_pk_bf16_f32 v57, v142, v143
    v_lshlrev_b32 v140, 16, v56
    v_and_b32 v141, 0xffff0000, v56
    v_lshlrev_b32 v142, 16, v57
    v_and_b32 v143, 0xffff0000, v57
    v_mul_f32 v58, v140, v140
    v_fma_f32 v58, v58, s47, v28
    v_mul_f32 v58, v58, v140
    v_exp_f32 v58, v58
    v_mul_f32 v59, v141, v141
    v_fma_f32 v59, v59, s47, v28
    v_mul_f32 v59, v59, v141
    v_exp_f32 v59, v59
    v_mul_f32 v60, v142, v142
    v_fma_f32 v60, v60, s47, v28
    v_mul_f32 v60, v60, v142
    v_exp_f32 v60, v60
    v_mul_f32 v61, v143, v143
    v_fma_f32 v61, v61, s47, v28
    v_mul_f32 v61, v61, v143
    v_exp_f32 v61, v61
    v_add_f32 v58, 1.0, v58
    v_rcp_f32 v58, v58
    v_add_f32 v59, 1.0, v59
    v_rcp_f32 v59, v59
    v_add_f32 v60, 1.0, v60
    v_rcp_f32 v60, v60
    v_add_f32 v61, 1.0, v61
    v_rcp_f32 v61, v61
    s_nop 0
    v_fma_f32 v140, -v140, v58, v140
    v_fma_f32 v141, -v141, v59, v141
    v_fma_f32 v142, -v142, v60, v142
    v_fma_f32 v143, -v143, v61, v143
    v_cvt_pk_bf16_f32 v56, v140, v141
    v_cvt_pk_bf16_f32 v57, v142, v143
    ds_write_b64 v7, v[56:57] offset:4704
    v_cvt_pk_bf16_f32 v32, v144, v145
    v_cvt_pk_bf16_f32 v33, v146, v147
    v_lshlrev_b32 v144, 16, v32
    v_and_b32 v145, 0xffff0000, v32
    v_lshlrev_b32 v146, 16, v33
    v_and_b32 v147, 0xffff0000, v33
    v_mul_f32 v34, v144, v144
    v_fma_f32 v34, v34, s47, v28
    v_mul_f32 v34, v34, v144
    v_exp_f32 v34, v34
    v_mul_f32 v35, v145, v145
    v_fma_f32 v35, v35, s47, v28
    v_mul_f32 v35, v35, v145
    v_exp_f32 v35, v35
    v_mul_f32 v36, v146, v146
    v_fma_f32 v36, v36, s47, v28
    v_mul_f32 v36, v36, v146
    v_exp_f32 v36, v36
    v_mul_f32 v37, v147, v147
    v_fma_f32 v37, v37, s47, v28
    v_mul_f32 v37, v37, v147
    v_exp_f32 v37, v37
    v_add_f32 v34, 1.0, v34
    v_rcp_f32 v34, v34
    v_add_f32 v35, 1.0, v35
    v_rcp_f32 v35, v35
    v_add_f32 v36, 1.0, v36
    v_rcp_f32 v36, v36
    v_add_f32 v37, 1.0, v37
    v_rcp_f32 v37, v37
    s_nop 0
    v_fma_f32 v144, -v144, v34, v144
    v_fma_f32 v145, -v145, v35, v145
    v_fma_f32 v146, -v146, v36, v146
    v_fma_f32 v147, -v147, v37, v147
    v_cvt_pk_bf16_f32 v32, v144, v145
    v_cvt_pk_bf16_f32 v33, v146, v147
    ds_write_b64 v7, v[32:33] offset:6912
    v_cvt_pk_bf16_f32 v40, v148, v149
    v_cvt_pk_bf16_f32 v41, v150, v151
    v_lshlrev_b32 v148, 16, v40
    v_and_b32 v149, 0xffff0000, v40
    v_lshlrev_b32 v150, 16, v41
    v_and_b32 v151, 0xffff0000, v41
    v_mul_f32 v42, v148, v148
    v_fma_f32 v42, v42, s47, v28
    v_mul_f32 v42, v42, v148
    v_exp_f32 v42, v42
    v_mul_f32 v43, v149, v149
    v_fma_f32 v43, v43, s47, v28
    v_mul_f32 v43, v43, v149
    v_exp_f32 v43, v43
    v_mul_f32 v44, v150, v150
    v_fma_f32 v44, v44, s47, v28
    v_mul_f32 v44, v44, v150
    v_exp_f32 v44, v44
    v_mul_f32 v45, v151, v151
    v_fma_f32 v45, v45, s47, v28
    v_mul_f32 v45, v45, v151
    v_exp_f32 v45, v45
    v_add_f32 v42, 1.0, v42
    v_rcp_f32 v42, v42
    v_add_f32 v43, 1.0, v43
    v_rcp_f32 v43, v43
    v_add_f32 v44, 1.0, v44
    v_rcp_f32 v44, v44
    v_add_f32 v45, 1.0, v45
    v_rcp_f32 v45, v45
    s_nop 0
    v_fma_f32 v148, -v148, v42, v148
    v_fma_f32 v149, -v149, v43, v149
    v_fma_f32 v150, -v150, v44, v150
    v_fma_f32 v151, -v151, v45, v151
    v_cvt_pk_bf16_f32 v40, v148, v149
    v_cvt_pk_bf16_f32 v41, v150, v151
    ds_write_b64 v7, v[40:41] offset:6944
    v_cvt_pk_bf16_f32 v48, v152, v153
    v_cvt_pk_bf16_f32 v49, v154, v155
    v_lshlrev_b32 v152, 16, v48
    v_and_b32 v153, 0xffff0000, v48
    v_lshlrev_b32 v154, 16, v49
    v_and_b32 v155, 0xffff0000, v49
    v_mul_f32 v50, v152, v152
    v_fma_f32 v50, v50, s47, v28
    v_mul_f32 v50, v50, v152
    v_exp_f32 v50, v50
    v_mul_f32 v51, v153, v153
    v_fma_f32 v51, v51, s47, v28
    v_mul_f32 v51, v51, v153
    v_exp_f32 v51, v51
    v_mul_f32 v52, v154, v154
    v_fma_f32 v52, v52, s47, v28
    v_mul_f32 v52, v52, v154
    v_exp_f32 v52, v52
    v_mul_f32 v53, v155, v155
    v_fma_f32 v53, v53, s47, v28
    v_mul_f32 v53, v53, v155
    v_exp_f32 v53, v53
    v_add_f32 v50, 1.0, v50
    v_rcp_f32 v50, v50
    v_add_f32 v51, 1.0, v51
    v_rcp_f32 v51, v51
    v_add_f32 v52, 1.0, v52
    v_rcp_f32 v52, v52
    v_add_f32 v53, 1.0, v53
    v_rcp_f32 v53, v53
    s_nop 0
    v_fma_f32 v152, -v152, v50, v152
    v_fma_f32 v153, -v153, v51, v153
    v_fma_f32 v154, -v154, v52, v154
    v_fma_f32 v155, -v155, v53, v155
    v_cvt_pk_bf16_f32 v48, v152, v153
    v_cvt_pk_bf16_f32 v49, v154, v155
    ds_write_b64 v7, v[48:49] offset:6976
    v_cvt_pk_bf16_f32 v56, v156, v157
    v_cvt_pk_bf16_f32 v57, v158, v159
    v_lshlrev_b32 v156, 16, v56
    v_and_b32 v157, 0xffff0000, v56
    v_lshlrev_b32 v158, 16, v57
    v_and_b32 v159, 0xffff0000, v57
    v_mul_f32 v58, v156, v156
    v_fma_f32 v58, v58, s47, v28
    v_mul_f32 v58, v58, v156
    v_exp_f32 v58, v58
    v_mul_f32 v59, v157, v157
    v_fma_f32 v59, v59, s47, v28
    v_mul_f32 v59, v59, v157
    v_exp_f32 v59, v59
    v_mul_f32 v60, v158, v158
    v_fma_f32 v60, v60, s47, v28
    v_mul_f32 v60, v60, v158
    v_exp_f32 v60, v60
    v_mul_f32 v61, v159, v159
    v_fma_f32 v61, v61, s47, v28
    v_mul_f32 v61, v61, v159
    v_exp_f32 v61, v61
    v_add_f32 v58, 1.0, v58
    v_rcp_f32 v58, v58
    v_add_f32 v59, 1.0, v59
    v_rcp_f32 v59, v59
    v_add_f32 v60, 1.0, v60
    v_rcp_f32 v60, v60
    v_add_f32 v61, 1.0, v61
    v_rcp_f32 v61, v61
    s_nop 0
    v_fma_f32 v156, -v156, v58, v156
    v_fma_f32 v157, -v157, v59, v157
    v_fma_f32 v158, -v158, v60, v158
    v_fma_f32 v159, -v159, v61, v159
    v_cvt_pk_bf16_f32 v56, v156, v157
    v_cvt_pk_bf16_f32 v57, v158, v159
    ds_write_b64 v7, v[56:57] offset:7008
    s_waitcnt lgkmcnt(0)
    v_lshrrev_b32 v8, 3, v1
    v_and_b32 v9, 7, v1
    v_mul_u32_u24 v7, 9216, v2
    v_mul_u32_u24 v10, 144, v8
    v_add_u32 v7, v7, v10
    v_lshl_add_u32 v7, v9, 4, v7
    v_mul_u32_u24 v10, 64, v3
    v_add_u32 v10, v10, v8
    v_add_u32 v10, s27, v10
    v_lshlrev_b32 v11, 6, v4
    v_lshl_add_u32 v11, v9, 3, v11
    v_add_u32 v11, s28, v11
    v_mul_u32_u24 v12, 3072, v10
    v_lshl_add_u32 v12, v11, 1, v12
    ds_read_b128 v[96:99], v7 offset:0
    ds_read_b128 v[100:103], v7 offset:1152
    ds_read_b128 v[104:107], v7 offset:2304
    ds_read_b128 v[108:111], v7 offset:3456
    ds_read_b128 v[112:115], v7 offset:4608
    ds_read_b128 v[116:119], v7 offset:5760
    ds_read_b128 v[120:123], v7 offset:6912
    ds_read_b128 v[124:127], v7 offset:8064
    s_waitcnt lgkmcnt(0)
    buffer_store_dwordx4 v[96:99], v12, s[16:19], 0 offen
    v_add_u32 v12, 24576, v12
    buffer_store_dwordx4 v[100:103], v12, s[16:19], 0 offen
    v_add_u32 v12, 24576, v12
    buffer_store_dwordx4 v[104:107], v12, s[16:19], 0 offen
    v_add_u32 v12, 24576, v12
    buffer_store_dwordx4 v[108:111], v12, s[16:19], 0 offen
    v_add_u32 v12, 24576, v12
    buffer_store_dwordx4 v[112:115], v12, s[16:19], 0 offen
    v_add_u32 v12, 24576, v12
    buffer_store_dwordx4 v[116:119], v12, s[16:19], 0 offen
    v_add_u32 v12, 24576, v12
    buffer_store_dwordx4 v[120:123], v12, s[16:19], 0 offen
    v_add_u32 v12, 24576, v12
    buffer_store_dwordx4 v[124:127], v12, s[16:19], 0 offen
Lend_win1_kernel_1:
    s_endpgm
Lloader_win1_kernel_2:
    v_subrev_u32 v0, 256, v0
    v_and_b32 v1, 63, v0
    s_sub_u32 s42, s41, 4
    v_lshrrev_b32 v3, 3, v1
    v_and_b32 v4, 7, v1
    v_xor_b32 v4, v4, v3
    s_mul_i32 s43, s42, 32
    s_add_u32 s43, s43, s27
    v_add_u32 v5, s43, v3
    v_mul_u32_u24 v5, 1280, v5
    v_lshl_add_u32 v8, v4, 4, v5
    v_add_u32 v9, 10240, v8
    v_add_u32 v10, 20480, v8
    v_add_u32 v11, 30720, v8
    v_lshrrev_b32 v3, 4, v1
    v_and_b32 v4, 15, v1
    v_lshrrev_b32 v5, 1, v4
    v_and_b32 v6, 1, v4
    s_mul_i32 s43, s42, 4
    s_add_u32 s44, s43, 0
    s_lshr_b32 s44, s44, 1
    s_and_b32 s44, s44, 1
    s_lshl_b32 s44, s44, 2
    v_add_u32 v7, s44, v3
    v_xor_b32 v7, v5, v7
    v_lshl_add_u32 v7, v7, 1, v6
    v_lshlrev_b32 v7, 4, v7
    s_add_u32 s44, s43, 0
    s_lshl_b32 s44, s44, 2
    v_add_u32 v12, s44, v3
    v_mul_u32_u24 v12, 3072, v12
    v_add_u32 v12, v12, v7
    v_lshl_add_u32 v12, s28, 1, v12
    s_add_u32 s44, s43, 1
    s_lshr_b32 s44, s44, 1
    s_and_b32 s44, s44, 1
    s_lshl_b32 s44, s44, 2
    v_add_u32 v7, s44, v3
    v_xor_b32 v7, v5, v7
    v_lshl_add_u32 v7, v7, 1, v6
    v_lshlrev_b32 v7, 4, v7
    s_add_u32 s44, s43, 1
    s_lshl_b32 s44, s44, 2
    v_add_u32 v13, s44, v3
    v_mul_u32_u24 v13, 3072, v13
    v_add_u32 v13, v13, v7
    v_lshl_add_u32 v13, s28, 1, v13
    s_add_u32 s44, s43, 2
    s_lshr_b32 s44, s44, 1
    s_and_b32 s44, s44, 1
    s_lshl_b32 s44, s44, 2
    v_add_u32 v7, s44, v3
    v_xor_b32 v7, v5, v7
    v_lshl_add_u32 v7, v7, 1, v6
    v_lshlrev_b32 v7, 4, v7
    s_add_u32 s44, s43, 2
    s_lshl_b32 s44, s44, 2
    v_add_u32 v14, s44, v3
    v_mul_u32_u24 v14, 3072, v14
    v_add_u32 v14, v14, v7
    v_lshl_add_u32 v14, s28, 1, v14
    s_add_u32 s44, s43, 3
    s_lshr_b32 s44, s44, 1
    s_and_b32 s44, s44, 1
    s_lshl_b32 s44, s44, 2
    v_add_u32 v7, s44, v3
    v_xor_b32 v7, v5, v7
    v_lshl_add_u32 v7, v7, 1, v6
    v_lshlrev_b32 v7, 4, v7
    s_add_u32 s44, s43, 3
    s_lshl_b32 s44, s44, 2
    v_add_u32 v15, s44, v3
    v_mul_u32_u24 v15, 3072, v15
    v_add_u32 v15, v15, v7
    v_lshl_add_u32 v15, s28, 1, v15
    s_mul_i32 s45, s42, 4096
    s_mul_i32 s46, s42, 4096
    s_add_u32 s46, s46, 16384
    s_mov_b32 s29, 0
    s_mov_b32 s30, 0
    s_add_u32 m0, s45, 0
    s_nop 0
    buffer_load_dwordx4 v8, s[8:11], s29 offen lds
    s_add_u32 m0, s45, 1024
    s_nop 0
    buffer_load_dwordx4 v9, s[8:11], s29 offen lds
    s_add_u32 m0, s45, 2048
    s_nop 0
    buffer_load_dwordx4 v10, s[8:11], s29 offen lds
    s_add_u32 m0, s45, 3072
    s_nop 0
    buffer_load_dwordx4 v11, s[8:11], s29 offen lds
    s_add_u32 m0, s46, 0
    s_nop 0
    buffer_load_dwordx4 v12, s[12:15], s30 offen lds
    s_add_u32 m0, s46, 1024
    s_nop 0
    buffer_load_dwordx4 v13, s[12:15], s30 offen lds
    s_add_u32 m0, s46, 2048
    s_nop 0
    buffer_load_dwordx4 v14, s[12:15], s30 offen lds
    s_add_u32 m0, s46, 3072
    s_nop 0
    buffer_load_dwordx4 v15, s[12:15], s30 offen lds
    s_add_u32 s29, s29, 128
    s_add_u32 s30, s30, 196608
    s_add_u32 m0, s45, 32768
    s_nop 0
    buffer_load_dwordx4 v8, s[8:11], s29 offen lds
    s_add_u32 m0, s45, 33792
    s_nop 0
    buffer_load_dwordx4 v9, s[8:11], s29 offen lds
    s_add_u32 m0, s45, 34816
    s_nop 0
    buffer_load_dwordx4 v10, s[8:11], s29 offen lds
    s_add_u32 m0, s45, 35840
    s_nop 0
    buffer_load_dwordx4 v11, s[8:11], s29 offen lds
    s_add_u32 m0, s46, 32768
    s_nop 0
    buffer_load_dwordx4 v12, s[12:15], s30 offen lds
    s_add_u32 m0, s46, 33792
    s_nop 0
    buffer_load_dwordx4 v13, s[12:15], s30 offen lds
    s_add_u32 m0, s46, 34816
    s_nop 0
    buffer_load_dwordx4 v14, s[12:15], s30 offen lds
    s_add_u32 m0, s46, 35840
    s_nop 0
    buffer_load_dwordx4 v15, s[12:15], s30 offen lds
    s_add_u32 s29, s29, 128
    s_add_u32 s30, s30, 196608
    s_add_u32 m0, s45, 65536
    s_nop 0
    buffer_load_dwordx4 v8, s[8:11], s29 offen lds
    s_add_u32 m0, s45, 66560
    s_nop 0
    buffer_load_dwordx4 v9, s[8:11], s29 offen lds
    s_add_u32 m0, s45, 67584
    s_nop 0
    buffer_load_dwordx4 v10, s[8:11], s29 offen lds
    s_add_u32 m0, s45, 68608
    s_nop 0
    buffer_load_dwordx4 v11, s[8:11], s29 offen lds
    s_add_u32 m0, s46, 65536
    s_nop 0
    buffer_load_dwordx4 v12, s[12:15], s30 offen lds
    s_add_u32 m0, s46, 66560
    s_nop 0
    buffer_load_dwordx4 v13, s[12:15], s30 offen lds
    s_add_u32 m0, s46, 67584
    s_nop 0
    buffer_load_dwordx4 v14, s[12:15], s30 offen lds
    s_add_u32 m0, s46, 68608
    s_nop 0
    buffer_load_dwordx4 v15, s[12:15], s30 offen lds
    s_add_u32 s29, s29, 128
    s_add_u32 s30, s30, 196608
    s_waitcnt vmcnt(8)
    s_barrier
    s_mov_b32 s31, 0
Llloop_win1_kernel_4:
    s_add_u32 m0, s45, 98304
    s_nop 0
    buffer_load_dwordx4 v8, s[8:11], s29 offen lds
    s_add_u32 m0, s45, 99328
    s_nop 0
    buffer_load_dwordx4 v9, s[8:11], s29 offen lds
    s_add_u32 m0, s45, 100352
    s_nop 0
    buffer_load_dwordx4 v10, s[8:11], s29 offen lds
    s_add_u32 m0, s45, 101376
    s_nop 0
    buffer_load_dwordx4 v11, s[8:11], s29 offen lds
    s_add_u32 m0, s46, 98304
    s_nop 0
    buffer_load_dwordx4 v12, s[12:15], s30 offen lds
    s_add_u32 m0, s46, 99328
    s_nop 0
    buffer_load_dwordx4 v13, s[12:15], s30 offen lds
    s_add_u32 m0, s46, 100352
    s_nop 0
    buffer_load_dwordx4 v14, s[12:15], s30 offen lds
    s_add_u32 m0, s46, 101376
    s_nop 0
    buffer_load_dwordx4 v15, s[12:15], s30 offen lds
    s_add_u32 s29, s29, 128
    s_add_u32 s30, s30, 196608
    s_waitcnt vmcnt(8)
    s_barrier
    s_add_u32 m0, s45, 0
    s_nop 0
    buffer_load_dwordx4 v8, s[8:11], s29 offen lds
    s_add_u32 m0, s45, 1024
    s_nop 0
    buffer_load_dwordx4 v9, s[8:11], s29 offen lds
    s_add_u32 m0, s45, 2048
    s_nop 0
    buffer_load_dwordx4 v10, s[8:11], s29 offen lds
    s_add_u32 m0, s45, 3072
    s_nop 0
    buffer_load_dwordx4 v11, s[8:11], s29 offen lds
    s_add_u32 m0, s46, 0
    s_nop 0
    buffer_load_dwordx4 v12, s[12:15], s30 offen lds
    s_add_u32 m0, s46, 1024
    s_nop 0
    buffer_load_dwordx4 v13, s[12:15], s30 offen lds
    s_add_u32 m0, s46, 2048
    s_nop 0
    buffer_load_dwordx4 v14, s[12:15], s30 offen lds
    s_add_u32 m0, s46, 3072
    s_nop 0
    buffer_load_dwordx4 v15, s[12:15], s30 offen lds
    s_add_u32 s29, s29, 128
    s_add_u32 s30, s30, 196608
    s_waitcnt vmcnt(8)
    s_barrier
    s_add_u32 m0, s45, 32768
    s_nop 0
    buffer_load_dwordx4 v8, s[8:11], s29 offen lds
    s_add_u32 m0, s45, 33792
    s_nop 0
    buffer_load_dwordx4 v9, s[8:11], s29 offen lds
    s_add_u32 m0, s45, 34816
    s_nop 0
    buffer_load_dwordx4 v10, s[8:11], s29 offen lds
    s_add_u32 m0, s45, 35840
    s_nop 0
    buffer_load_dwordx4 v11, s[8:11], s29 offen lds
    s_add_u32 m0, s46, 32768
    s_nop 0
    buffer_load_dwordx4 v12, s[12:15], s30 offen lds
    s_add_u32 m0, s46, 33792
    s_nop 0
    buffer_load_dwordx4 v13, s[12:15], s30 offen lds
    s_add_u32 m0, s46, 34816
    s_nop 0
    buffer_load_dwordx4 v14, s[12:15], s30 offen lds
    s_add_u32 m0, s46, 35840
    s_nop 0
    buffer_load_dwordx4 v15, s[12:15], s30 offen lds
    s_add_u32 s29, s29, 128
    s_add_u32 s30, s30, 196608
    s_waitcnt vmcnt(8)
    s_barrier
    s_add_u32 m0, s45, 65536
    s_nop 0
    buffer_load_dwordx4 v8, s[8:11], s29 offen lds
    s_add_u32 m0, s45, 66560
    s_nop 0
    buffer_load_dwordx4 v9, s[8:11], s29 offen lds
    s_add_u32 m0, s45, 67584
    s_nop 0
    buffer_load_dwordx4 v10, s[8:11], s29 offen lds
    s_add_u32 m0, s45, 68608
    s_nop 0
    buffer_load_dwordx4 v11, s[8:11], s29 offen lds
    s_add_u32 m0, s46, 65536
    s_nop 0
    buffer_load_dwordx4 v12, s[12:15], s30 offen lds
    s_add_u32 m0, s46, 66560
    s_nop 0
    buffer_load_dwordx4 v13, s[12:15], s30 offen lds
    s_add_u32 m0, s46, 67584
    s_nop 0
    buffer_load_dwordx4 v14, s[12:15], s30 offen lds
    s_add_u32 m0, s46, 68608
    s_nop 0
    buffer_load_dwordx4 v15, s[12:15], s30 offen lds
    s_add_u32 s29, s29, 128
    s_add_u32 s30, s30, 196608
    s_waitcnt vmcnt(8)
    s_barrier
    s_add_u32 s31, s31, 1
    s_cmp_lt_u32 s31, 1
    s_cbranch_scc1 Llloop_win1_kernel_4
    s_add_u32 m0, s45, 98304
    s_nop 0
    buffer_load_dwordx4 v8, s[8:11], s29 offen lds
    s_add_u32 m0, s45, 99328
    s_nop 0
    buffer_load_dwordx4 v9, s[8:11], s29 offen lds
    s_add_u32 m0, s45, 100352
    s_nop 0
    buffer_load_dwordx4 v10, s[8:11], s29 offen lds
    s_add_u32 m0, s45, 101376
    s_nop 0
    buffer_load_dwordx4 v11, s[8:11], s29 offen lds
    s_add_u32 m0, s46, 98304
    s_nop 0
    buffer_load_dwordx4 v12, s[12:15], s30 offen lds
    s_add_u32 m0, s46, 99328
    s_nop 0
    buffer_load_dwordx4 v13, s[12:15], s30 offen lds
    s_add_u32 m0, s46, 100352
    s_nop 0
    buffer_load_dwordx4 v14, s[12:15], s30 offen lds
    s_add_u32 m0, s46, 101376
    s_nop 0
    buffer_load_dwordx4 v15, s[12:15], s30 offen lds
    s_add_u32 s29, s29, 128
    s_add_u32 s30, s30, 196608
    s_waitcnt vmcnt(8)
    s_barrier
    s_add_u32 m0, s45, 0
    s_nop 0
    buffer_load_dwordx4 v8, s[8:11], s29 offen lds
    s_add_u32 m0, s45, 1024
    s_nop 0
    buffer_load_dwordx4 v9, s[8:11], s29 offen lds
    s_add_u32 m0, s45, 2048
    s_nop 0
    buffer_load_dwordx4 v10, s[8:11], s29 offen lds
    s_add_u32 m0, s45, 3072
    s_nop 0
    buffer_load_dwordx4 v11, s[8:11], s29 offen lds
    s_add_u32 m0, s46, 0
    s_nop 0
    buffer_load_dwordx4 v12, s[12:15], s30 offen lds
    s_add_u32 m0, s46, 1024
    s_nop 0
    buffer_load_dwordx4 v13, s[12:15], s30 offen lds
    s_add_u32 m0, s46, 2048
    s_nop 0
    buffer_load_dwordx4 v14, s[12:15], s30 offen lds
    s_add_u32 m0, s46, 3072
    s_nop 0
    buffer_load_dwordx4 v15, s[12:15], s30 offen lds
    s_add_u32 s29, s29, 128
    s_add_u32 s30, s30, 196608
    s_waitcnt vmcnt(8)
    s_barrier
    s_add_u32 m0, s45, 32768
    s_nop 0
    buffer_load_dwordx4 v8, s[8:11], s29 offen lds
    s_add_u32 m0, s45, 33792
    s_nop 0
    buffer_load_dwordx4 v9, s[8:11], s29 offen lds
    s_add_u32 m0, s45, 34816
    s_nop 0
    buffer_load_dwordx4 v10, s[8:11], s29 offen lds
    s_add_u32 m0, s45, 35840
    s_nop 0
    buffer_load_dwordx4 v11, s[8:11], s29 offen lds
    s_add_u32 m0, s46, 32768
    s_nop 0
    buffer_load_dwordx4 v12, s[12:15], s30 offen lds
    s_add_u32 m0, s46, 33792
    s_nop 0
    buffer_load_dwordx4 v13, s[12:15], s30 offen lds
    s_add_u32 m0, s46, 34816
    s_nop 0
    buffer_load_dwordx4 v14, s[12:15], s30 offen lds
    s_add_u32 m0, s46, 35840
    s_nop 0
    buffer_load_dwordx4 v15, s[12:15], s30 offen lds
    s_add_u32 s29, s29, 128
    s_add_u32 s30, s30, 196608
    s_waitcnt vmcnt(8)
    s_barrier
    s_waitcnt vmcnt(0)
    s_barrier
    s_waitcnt vmcnt(0)
    s_barrier
    s_waitcnt vmcnt(0)
    s_barrier
    s_endpgm
.section .rodata,"a"
.p2align 6
.amdhsa_kernel win1_kernel
  .amdhsa_next_free_vgpr 160
  .amdhsa_next_free_sgpr 56
  .amdhsa_accum_offset 160
  .amdhsa_group_segment_fixed_size 0
  .amdhsa_kernarg_size 96
  .amdhsa_user_sgpr_count 2
  .amdhsa_user_sgpr_kernarg_segment_ptr 1
  .amdhsa_system_sgpr_workgroup_id_x 1
.end_amdhsa_kernel
.text

.globl wout1_kernel
.p2align 8
.type wout1_kernel,@function
wout1_kernel:
    s_cmp_ge_u32 s2, 160
    s_cbranch_scc1 Lend_wout1_kernel_1
    s_load_dwordx2 s[4:5], s[0:1], 88
    s_load_dwordx2 s[6:7], s[0:1], 64
    s_load_dwordx2 s[24:25], s[0:1], 72
    s_and_b32 s26, s2, 7
    s_lshr_b32 s27, s2, 3
    s_mul_i32 s26, s26, 20
    s_add_u32 s26, s26, s27
    s_mul_hi_u32 s27, s26, 858993460
    s_mul_i32 s28, s27, 5
    s_sub_u32 s28, s26, s28
    s_mul_i32 s27, s27, 64
    s_mul_i32 s28, s28, 128
    s_waitcnt lgkmcnt(0)
    s_add_u32 s8, s4, 25165824
    s_addc_u32 s9, s5, 0
    s_mov_b32 s10, 3145728
    s_mov_b32 s11, 0x00020000
    s_mov_b32 s12, s6
    s_mov_b32 s13, s7
    s_mov_b32 s14, 983040
    s_mov_b32 s15, 0x00020000
    s_mov_b32 s16, s24
    s_mov_b32 s17, s25
    s_mov_b32 s18, 2621440
    s_mov_b32 s19, 0x00020000
    v_and_b32 v1, 63, v0
    v_lshrrev_b32 v2, 6, v0
    s_nop 0
    v_readfirstlane_b32 s41, v2
    s_nop 3
    s_cmp_ge_u32 s41, 4
    s_cbranch_scc1 Lloader_wout1_kernel_2
    v_lshrrev_b32 v3, 1, v2
    v_and_b32 v4, 1, v2
    v_lshrrev_b32 v5, 4, v1
    v_and_b32 v6, 15, v1
    v_mul_u32_u24 v7, 32, v3
    v_add_u32 v7, v7, v6
    v_lshlrev_b32 v7, 7, v7
    v_add_u32 v18, 0, v5
    v_and_b32 v3, 7, v6
    v_xor_b32 v18, v18, v3
    v_lshl_add_u32 v18, v18, 4, v7
    v_add_u32 v26, 49152, v18
    v_add_u32 v19, 4, v5
    v_and_b32 v3, 7, v6
    v_xor_b32 v19, v19, v3
    v_lshl_add_u32 v19, v19, 4, v7
    v_add_u32 v27, 49152, v19
    v_lshrrev_b32 v3, 2, v6
    v_and_b32 v7, 1, v5
    v_lshl_add_u32 v7, v7, 2, v3
    v_lshl_add_u32 v32, v5, 3, v3
    v_lshlrev_b32 v32, 8, v32
    v_and_b32 v33, 3, v6
    v_lshl_add_u32 v32, v33, 3, v32
    v_lshlrev_b32 v33, 2, v4
    v_add_u32 v34, 0, v33
    v_xor_b32 v34, v34, v7
    v_lshl_add_u32 v20, v34, 5, v32
    v_add_u32 v28, 49152, v20
    v_add_u32 v34, 1, v33
    v_xor_b32 v34, v34, v7
    v_lshl_add_u32 v21, v34, 5, v32
    v_add_u32 v29, 49152, v21
    v_add_u32 v34, 2, v33
    v_xor_b32 v34, v34, v7
    v_lshl_add_u32 v22, v34, 5, v32
    v_add_u32 v30, 49152, v22
    v_add_u32 v34, 3, v33
    v_xor_b32 v34, v34, v7
    v_lshl_add_u32 v23, v34, 5, v32
    v_add_u32 v31, 49152, v23
    v_mov_b32 v80, 0
    v_mov_b32 v81, 0
    v_mov_b32 v82, 0
    v_mov_b32 v83, 0
    v_mov_b32 v84, 0
    v_mov_b32 v85, 0
    v_mov_b32 v86, 0
    v_mov_b32 v87, 0
    v_mov_b32 v88, 0
    v_mov_b32 v89, 0
    v_mov_b32 v90, 0
    v_mov_b32 v91, 0
    v_mov_b32 v92, 0
    v_mov_b32 v93, 0
    v_mov_b32 v94, 0
    v_mov_b32 v95, 0
    v_mov_b32 v96, 0
    v_mov_b32 v97, 0
    v_mov_b32 v98, 0
    v_mov_b32 v99, 0
    v_mov_b32 v100, 0
    v_mov_b32 v101, 0
    v_mov_b32 v102, 0
    v_mov_b32 v103, 0
    v_mov_b32 v104, 0
    v_mov_b32 v105, 0
    v_mov_b32 v106, 0
    v_mov_b32 v107, 0
    v_mov_b32 v108, 0
    v_mov_b32 v109, 0
    v_mov_b32 v110, 0
    v_mov_b32 v111, 0
    s_barrier
    ds_read_b128 v[32:35], v18 offset:0
    ds_read_b128 v[36:39], v18 offset:2048
    ds_read_b64_tr_b16 v[48:49], v20 offset:8192
    ds_read_b64_tr_b16 v[50:51], v20 offset:9216
    ds_read_b64_tr_b16 v[52:53], v21 offset:8192
    ds_read_b64_tr_b16 v[54:55], v21 offset:9216
    ds_read_b64_tr_b16 v[56:57], v22 offset:8192
    ds_read_b64_tr_b16 v[58:59], v22 offset:9216
    ds_read_b64_tr_b16 v[60:61], v23 offset:8192
    ds_read_b64_tr_b16 v[62:63], v23 offset:9216
    s_mov_b32 s31, 0
Lcloop_wout1_kernel_3:
    s_waitcnt lgkmcnt(0)
    v_mfma_f32_16x16x32_bf16 v[80:83], v[48:51], v[32:35], v[80:83]
    ds_read_b128 v[40:43], v19 offset:0
    v_mfma_f32_16x16x32_bf16 v[84:87], v[52:55], v[32:35], v[84:87]
    ds_read_b128 v[44:47], v19 offset:2048
    v_mfma_f32_16x16x32_bf16 v[88:91], v[56:59], v[32:35], v[88:91]
    ds_read_b64_tr_b16 v[64:65], v20 offset:16384
    v_mfma_f32_16x16x32_bf16 v[92:95], v[60:63], v[32:35], v[92:95]
    ds_read_b64_tr_b16 v[66:67], v20 offset:17408
    ds_read_b64_tr_b16 v[68:69], v21 offset:16384
    v_mfma_f32_16x16x32_bf16 v[96:99], v[48:51], v[36:39], v[96:99]
    ds_read_b64_tr_b16 v[70:71], v21 offset:17408
    v_mfma_f32_16x16x32_bf16 v[100:103], v[52:55], v[36:39], v[100:103]
    ds_read_b64_tr_b16 v[72:73], v22 offset:16384
    v_mfma_f32_16x16x32_bf16 v[104:107], v[56:59], v[36:39], v[104:107]
    ds_read_b64_tr_b16 v[74:75], v22 offset:17408
    v_mfma_f32_16x16x32_bf16 v[108:111], v[60:63], v[36:39], v[108:111]
    ds_read_b64_tr_b16 v[76:77], v23 offset:16384
    ds_read_b64_tr_b16 v[78:79], v23 offset:17408
    s_waitcnt lgkmcnt(0)
    v_mfma_f32_16x16x32_bf16 v[80:83], v[64:67], v[40:43], v[80:83]
    ds_read_b128 v[32:35], v18 offset:24576
    v_mfma_f32_16x16x32_bf16 v[84:87], v[68:71], v[40:43], v[84:87]
    ds_read_b128 v[36:39], v18 offset:26624
    v_mfma_f32_16x16x32_bf16 v[88:91], v[72:75], v[40:43], v[88:91]
    ds_read_b64_tr_b16 v[48:49], v20 offset:32768
    v_mfma_f32_16x16x32_bf16 v[92:95], v[76:79], v[40:43], v[92:95]
    ds_read_b64_tr_b16 v[50:51], v20 offset:33792
    ds_read_b64_tr_b16 v[52:53], v21 offset:32768
    v_mfma_f32_16x16x32_bf16 v[96:99], v[64:67], v[44:47], v[96:99]
    ds_read_b64_tr_b16 v[54:55], v21 offset:33792
    v_mfma_f32_16x16x32_bf16 v[100:103], v[68:71], v[44:47], v[100:103]
    ds_read_b64_tr_b16 v[56:57], v22 offset:32768
    v_mfma_f32_16x16x32_bf16 v[104:107], v[72:75], v[44:47], v[104:107]
    ds_read_b64_tr_b16 v[58:59], v22 offset:33792
    v_mfma_f32_16x16x32_bf16 v[108:111], v[76:79], v[44:47], v[108:111]
    ds_read_b64_tr_b16 v[60:61], v23 offset:32768
    ds_read_b64_tr_b16 v[62:63], v23 offset:33792
    s_barrier
    s_waitcnt lgkmcnt(0)
    v_mfma_f32_16x16x32_bf16 v[80:83], v[48:51], v[32:35], v[80:83]
    ds_read_b128 v[40:43], v19 offset:24576
    v_mfma_f32_16x16x32_bf16 v[84:87], v[52:55], v[32:35], v[84:87]
    ds_read_b128 v[44:47], v19 offset:26624
    v_mfma_f32_16x16x32_bf16 v[88:91], v[56:59], v[32:35], v[88:91]
    ds_read_b64_tr_b16 v[64:65], v20 offset:40960
    v_mfma_f32_16x16x32_bf16 v[92:95], v[60:63], v[32:35], v[92:95]
    ds_read_b64_tr_b16 v[66:67], v20 offset:41984
    ds_read_b64_tr_b16 v[68:69], v21 offset:40960
    v_mfma_f32_16x16x32_bf16 v[96:99], v[48:51], v[36:39], v[96:99]
    ds_read_b64_tr_b16 v[70:71], v21 offset:41984
    v_mfma_f32_16x16x32_bf16 v[100:103], v[52:55], v[36:39], v[100:103]
    ds_read_b64_tr_b16 v[72:73], v22 offset:40960
    v_mfma_f32_16x16x32_bf16 v[104:107], v[56:59], v[36:39], v[104:107]
    ds_read_b64_tr_b16 v[74:75], v22 offset:41984
    v_mfma_f32_16x16x32_bf16 v[108:111], v[60:63], v[36:39], v[108:111]
    ds_read_b64_tr_b16 v[76:77], v23 offset:40960
    ds_read_b64_tr_b16 v[78:79], v23 offset:41984
    s_waitcnt lgkmcnt(0)
    v_mfma_f32_16x16x32_bf16 v[80:83], v[64:67], v[40:43], v[80:83]
    ds_read_b128 v[32:35], v26 offset:0
    v_mfma_f32_16x16x32_bf16 v[84:87], v[68:71], v[40:43], v[84:87]
    ds_read_b128 v[36:39], v26 offset:2048
    v_mfma_f32_16x16x32_bf16 v[88:91], v[72:75], v[40:43], v[88:91]
    ds_read_b64_tr_b16 v[48:49], v28 offset:8192
    v_mfma_f32_16x16x32_bf16 v[92:95], v[76:79], v[40:43], v[92:95]
    ds_read_b64_tr_b16 v[50:51], v28 offset:9216
    ds_read_b64_tr_b16 v[52:53], v29 offset:8192
    v_mfma_f32_16x16x32_bf16 v[96:99], v[64:67], v[44:47], v[96:99]
    ds_read_b64_tr_b16 v[54:55], v29 offset:9216
    v_mfma_f32_16x16x32_bf16 v[100:103], v[68:71], v[44:47], v[100:103]
    ds_read_b64_tr_b16 v[56:57], v30 offset:8192
    v_mfma_f32_16x16x32_bf16 v[104:107], v[72:75], v[44:47], v[104:107]
    ds_read_b64_tr_b16 v[58:59], v30 offset:9216
    v_mfma_f32_16x16x32_bf16 v[108:111], v[76:79], v[44:47], v[108:111]
    ds_read_b64_tr_b16 v[60:61], v31 offset:8192
    ds_read_b64_tr_b16 v[62:63], v31 offset:9216
    s_barrier
    s_waitcnt lgkmcnt(0)
    v_mfma_f32_16x16x32_bf16 v[80:83], v[48:51], v[32:35], v[80:83]
    ds_read_b128 v[40:43], v27 offset:0
    v_mfma_f32_16x16x32_bf16 v[84:87], v[52:55], v[32:35], v[84:87]
    ds_read_b128 v[44:47], v27 offset:2048
    v_mfma_f32_16x16x32_bf16 v[88:91], v[56:59], v[32:35], v[88:91]
    ds_read_b64_tr_b16 v[64:65], v28 offset:16384
    v_mfma_f32_16x16x32_bf16 v[92:95], v[60:63], v[32:35], v[92:95]
    ds_read_b64_tr_b16 v[66:67], v28 offset:17408
    ds_read_b64_tr_b16 v[68:69], v29 offset:16384
    v_mfma_f32_16x16x32_bf16 v[96:99], v[48:51], v[36:39], v[96:99]
    ds_read_b64_tr_b16 v[70:71], v29 offset:17408
    v_mfma_f32_16x16x32_bf16 v[100:103], v[52:55], v[36:39], v[100:103]
    ds_read_b64_tr_b16 v[72:73], v30 offset:16384
    v_mfma_f32_16x16x32_bf16 v[104:107], v[56:59], v[36:39], v[104:107]
    ds_read_b64_tr_b16 v[74:75], v30 offset:17408
    v_mfma_f32_16x16x32_bf16 v[108:111], v[60:63], v[36:39], v[108:111]
    ds_read_b64_tr_b16 v[76:77], v31 offset:16384
    ds_read_b64_tr_b16 v[78:79], v31 offset:17408
    s_waitcnt lgkmcnt(0)
    v_mfma_f32_16x16x32_bf16 v[80:83], v[64:67], v[40:43], v[80:83]
    ds_read_b128 v[32:35], v26 offset:24576
    v_mfma_f32_16x16x32_bf16 v[84:87], v[68:71], v[40:43], v[84:87]
    ds_read_b128 v[36:39], v26 offset:26624
    v_mfma_f32_16x16x32_bf16 v[88:91], v[72:75], v[40:43], v[88:91]
    ds_read_b64_tr_b16 v[48:49], v28 offset:32768
    v_mfma_f32_16x16x32_bf16 v[92:95], v[76:79], v[40:43], v[92:95]
    ds_read_b64_tr_b16 v[50:51], v28 offset:33792
    ds_read_b64_tr_b16 v[52:53], v29 offset:32768
    v_mfma_f32_16x16x32_bf16 v[96:99], v[64:67], v[44:47], v[96:99]
    ds_read_b64_tr_b16 v[54:55], v29 offset:33792
    v_mfma_f32_16x16x32_bf16 v[100:103], v[68:71], v[44:47], v[100:103]
    ds_read_b64_tr_b16 v[56:57], v30 offset:32768
    v_mfma_f32_16x16x32_bf16 v[104:107], v[72:75], v[44:47], v[104:107]
    ds_read_b64_tr_b16 v[58:59], v30 offset:33792
    v_mfma_f32_16x16x32_bf16 v[108:111], v[76:79], v[44:47], v[108:111]
    ds_read_b64_tr_b16 v[60:61], v31 offset:32768
    ds_read_b64_tr_b16 v[62:63], v31 offset:33792
    s_barrier
    s_waitcnt lgkmcnt(0)
    v_mfma_f32_16x16x32_bf16 v[80:83], v[48:51], v[32:35], v[80:83]
    ds_read_b128 v[40:43], v27 offset:24576
    v_mfma_f32_16x16x32_bf16 v[84:87], v[52:55], v[32:35], v[84:87]
    ds_read_b128 v[44:47], v27 offset:26624
    v_mfma_f32_16x16x32_bf16 v[88:91], v[56:59], v[32:35], v[88:91]
    ds_read_b64_tr_b16 v[64:65], v28 offset:40960
    v_mfma_f32_16x16x32_bf16 v[92:95], v[60:63], v[32:35], v[92:95]
    ds_read_b64_tr_b16 v[66:67], v28 offset:41984
    ds_read_b64_tr_b16 v[68:69], v29 offset:40960
    v_mfma_f32_16x16x32_bf16 v[96:99], v[48:51], v[36:39], v[96:99]
    ds_read_b64_tr_b16 v[70:71], v29 offset:41984
    v_mfma_f32_16x16x32_bf16 v[100:103], v[52:55], v[36:39], v[100:103]
    ds_read_b64_tr_b16 v[72:73], v30 offset:40960
    v_mfma_f32_16x16x32_bf16 v[104:107], v[56:59], v[36:39], v[104:107]
    ds_read_b64_tr_b16 v[74:75], v30 offset:41984
    v_mfma_f32_16x16x32_bf16 v[108:111], v[60:63], v[36:39], v[108:111]
    ds_read_b64_tr_b16 v[76:77], v31 offset:40960
    ds_read_b64_tr_b16 v[78:79], v31 offset:41984
    s_waitcnt lgkmcnt(0)
    v_mfma_f32_16x16x32_bf16 v[80:83], v[64:67], v[40:43], v[80:83]
    ds_read_b128 v[32:35], v18 offset:0
    v_mfma_f32_16x16x32_bf16 v[84:87], v[68:71], v[40:43], v[84:87]
    ds_read_b128 v[36:39], v18 offset:2048
    v_mfma_f32_16x16x32_bf16 v[88:91], v[72:75], v[40:43], v[88:91]
    ds_read_b64_tr_b16 v[48:49], v20 offset:8192
    v_mfma_f32_16x16x32_bf16 v[92:95], v[76:79], v[40:43], v[92:95]
    ds_read_b64_tr_b16 v[50:51], v20 offset:9216
    ds_read_b64_tr_b16 v[52:53], v21 offset:8192
    v_mfma_f32_16x16x32_bf16 v[96:99], v[64:67], v[44:47], v[96:99]
    ds_read_b64_tr_b16 v[54:55], v21 offset:9216
    v_mfma_f32_16x16x32_bf16 v[100:103], v[68:71], v[44:47], v[100:103]
    ds_read_b64_tr_b16 v[56:57], v22 offset:8192
    v_mfma_f32_16x16x32_bf16 v[104:107], v[72:75], v[44:47], v[104:107]
    ds_read_b64_tr_b16 v[58:59], v22 offset:9216
    v_mfma_f32_16x16x32_bf16 v[108:111], v[76:79], v[44:47], v[108:111]
    ds_read_b64_tr_b16 v[60:61], v23 offset:8192
    ds_read_b64_tr_b16 v[62:63], v23 offset:9216
    s_barrier
    s_add_u32 s31, s31, 1
    s_cmp_lt_u32 s31, 2
    s_cbranch_scc1 Lcloop_wout1_kernel_3
    s_waitcnt lgkmcnt(0)
    v_mfma_f32_16x16x32_bf16 v[80:83], v[48:51], v[32:35], v[80:83]
    ds_read_b128 v[40:43], v19 offset:0
    v_mfma_f32_16x16x32_bf16 v[84:87], v[52:55], v[32:35], v[84:87]
    ds_read_b128 v[44:47], v19 offset:2048
    v_mfma_f32_16x16x32_bf16 v[88:91], v[56:59], v[32:35], v[88:91]
    ds_read_b64_tr_b16 v[64:65], v20 offset:16384
    v_mfma_f32_16x16x32_bf16 v[92:95], v[60:63], v[32:35], v[92:95]
    ds_read_b64_tr_b16 v[66:67], v20 offset:17408
    ds_read_b64_tr_b16 v[68:69], v21 offset:16384
    v_mfma_f32_16x16x32_bf16 v[96:99], v[48:51], v[36:39], v[96:99]
    ds_read_b64_tr_b16 v[70:71], v21 offset:17408
    v_mfma_f32_16x16x32_bf16 v[100:103], v[52:55], v[36:39], v[100:103]
    ds_read_b64_tr_b16 v[72:73], v22 offset:16384
    v_mfma_f32_16x16x32_bf16 v[104:107], v[56:59], v[36:39], v[104:107]
    ds_read_b64_tr_b16 v[74:75], v22 offset:17408
    v_mfma_f32_16x16x32_bf16 v[108:111], v[60:63], v[36:39], v[108:111]
    ds_read_b64_tr_b16 v[76:77], v23 offset:16384
    ds_read_b64_tr_b16 v[78:79], v23 offset:17408
    s_waitcnt lgkmcnt(0)
    v_mfma_f32_16x16x32_bf16 v[80:83], v[64:67], v[40:43], v[80:83]
    ds_read_b128 v[32:35], v18 offset:24576
    v_mfma_f32_16x16x32_bf16 v[84:87], v[68:71], v[40:43], v[84:87]
    ds_read_b128 v[36:39], v18 offset:26624
    v_mfma_f32_16x16x32_bf16 v[88:91], v[72:75], v[40:43], v[88:91]
    ds_read_b64_tr_b16 v[48:49], v20 offset:32768
    v_mfma_f32_16x16x32_bf16 v[92:95], v[76:79], v[40:43], v[92:95]
    ds_read_b64_tr_b16 v[50:51], v20 offset:33792
    ds_read_b64_tr_b16 v[52:53], v21 offset:32768
    v_mfma_f32_16x16x32_bf16 v[96:99], v[64:67], v[44:47], v[96:99]
    ds_read_b64_tr_b16 v[54:55], v21 offset:33792
    v_mfma_f32_16x16x32_bf16 v[100:103], v[68:71], v[44:47], v[100:103]
    ds_read_b64_tr_b16 v[56:57], v22 offset:32768
    v_mfma_f32_16x16x32_bf16 v[104:107], v[72:75], v[44:47], v[104:107]
    ds_read_b64_tr_b16 v[58:59], v22 offset:33792
    v_mfma_f32_16x16x32_bf16 v[108:111], v[76:79], v[44:47], v[108:111]
    ds_read_b64_tr_b16 v[60:61], v23 offset:32768
    ds_read_b64_tr_b16 v[62:63], v23 offset:33792
    s_barrier
    s_waitcnt lgkmcnt(0)
    v_mfma_f32_16x16x32_bf16 v[80:83], v[48:51], v[32:35], v[80:83]
    ds_read_b128 v[40:43], v19 offset:24576
    v_mfma_f32_16x16x32_bf16 v[84:87], v[52:55], v[32:35], v[84:87]
    ds_read_b128 v[44:47], v19 offset:26624
    v_mfma_f32_16x16x32_bf16 v[88:91], v[56:59], v[32:35], v[88:91]
    ds_read_b64_tr_b16 v[64:65], v20 offset:40960
    v_mfma_f32_16x16x32_bf16 v[92:95], v[60:63], v[32:35], v[92:95]
    ds_read_b64_tr_b16 v[66:67], v20 offset:41984
    ds_read_b64_tr_b16 v[68:69], v21 offset:40960
    v_mfma_f32_16x16x32_bf16 v[96:99], v[48:51], v[36:39], v[96:99]
    ds_read_b64_tr_b16 v[70:71], v21 offset:41984
    v_mfma_f32_16x16x32_bf16 v[100:103], v[52:55], v[36:39], v[100:103]
    ds_read_b64_tr_b16 v[72:73], v22 offset:40960
    v_mfma_f32_16x16x32_bf16 v[104:107], v[56:59], v[36:39], v[104:107]
    ds_read_b64_tr_b16 v[74:75], v22 offset:41984
    v_mfma_f32_16x16x32_bf16 v[108:111], v[60:63], v[36:39], v[108:111]
    ds_read_b64_tr_b16 v[76:77], v23 offset:40960
    ds_read_b64_tr_b16 v[78:79], v23 offset:41984
    s_waitcnt lgkmcnt(0)
    v_mfma_f32_16x16x32_bf16 v[80:83], v[64:67], v[40:43], v[80:83]
    ds_read_b128 v[32:35], v26 offset:0
    v_mfma_f32_16x16x32_bf16 v[84:87], v[68:71], v[40:43], v[84:87]
    ds_read_b128 v[36:39], v26 offset:2048
    v_mfma_f32_16x16x32_bf16 v[88:91], v[72:75], v[40:43], v[88:91]
    ds_read_b64_tr_b16 v[48:49], v28 offset:8192
    v_mfma_f32_16x16x32_bf16 v[92:95], v[76:79], v[40:43], v[92:95]
    ds_read_b64_tr_b16 v[50:51], v28 offset:9216
    ds_read_b64_tr_b16 v[52:53], v29 offset:8192
    v_mfma_f32_16x16x32_bf16 v[96:99], v[64:67], v[44:47], v[96:99]
    ds_read_b64_tr_b16 v[54:55], v29 offset:9216
    v_mfma_f32_16x16x32_bf16 v[100:103], v[68:71], v[44:47], v[100:103]
    ds_read_b64_tr_b16 v[56:57], v30 offset:8192
    v_mfma_f32_16x16x32_bf16 v[104:107], v[72:75], v[44:47], v[104:107]
    ds_read_b64_tr_b16 v[58:59], v30 offset:9216
    v_mfma_f32_16x16x32_bf16 v[108:111], v[76:79], v[44:47], v[108:111]
    ds_read_b64_tr_b16 v[60:61], v31 offset:8192
    ds_read_b64_tr_b16 v[62:63], v31 offset:9216
    s_barrier
    s_waitcnt lgkmcnt(0)
    v_mfma_f32_16x16x32_bf16 v[80:83], v[48:51], v[32:35], v[80:83]
    ds_read_b128 v[40:43], v27 offset:0
    v_mfma_f32_16x16x32_bf16 v[84:87], v[52:55], v[32:35], v[84:87]
    ds_read_b128 v[44:47], v27 offset:2048
    v_mfma_f32_16x16x32_bf16 v[88:91], v[56:59], v[32:35], v[88:91]
    ds_read_b64_tr_b16 v[64:65], v28 offset:16384
    v_mfma_f32_16x16x32_bf16 v[92:95], v[60:63], v[32:35], v[92:95]
    ds_read_b64_tr_b16 v[66:67], v28 offset:17408
    ds_read_b64_tr_b16 v[68:69], v29 offset:16384
    v_mfma_f32_16x16x32_bf16 v[96:99], v[48:51], v[36:39], v[96:99]
    ds_read_b64_tr_b16 v[70:71], v29 offset:17408
    v_mfma_f32_16x16x32_bf16 v[100:103], v[52:55], v[36:39], v[100:103]
    ds_read_b64_tr_b16 v[72:73], v30 offset:16384
    v_mfma_f32_16x16x32_bf16 v[104:107], v[56:59], v[36:39], v[104:107]
    ds_read_b64_tr_b16 v[74:75], v30 offset:17408
    v_mfma_f32_16x16x32_bf16 v[108:111], v[60:63], v[36:39], v[108:111]
    ds_read_b64_tr_b16 v[76:77], v31 offset:16384
    ds_read_b64_tr_b16 v[78:79], v31 offset:17408
    s_waitcnt lgkmcnt(0)
    v_mfma_f32_16x16x32_bf16 v[80:83], v[64:67], v[40:43], v[80:83]
    ds_read_b128 v[32:35], v26 offset:24576
    v_mfma_f32_16x16x32_bf16 v[84:87], v[68:71], v[40:43], v[84:87]
    ds_read_b128 v[36:39], v26 offset:26624
    v_mfma_f32_16x16x32_bf16 v[88:91], v[72:75], v[40:43], v[88:91]
    ds_read_b64_tr_b16 v[48:49], v28 offset:32768
    v_mfma_f32_16x16x32_bf16 v[92:95], v[76:79], v[40:43], v[92:95]
    ds_read_b64_tr_b16 v[50:51], v28 offset:33792
    ds_read_b64_tr_b16 v[52:53], v29 offset:32768
    v_mfma_f32_16x16x32_bf16 v[96:99], v[64:67], v[44:47], v[96:99]
    ds_read_b64_tr_b16 v[54:55], v29 offset:33792
    v_mfma_f32_16x16x32_bf16 v[100:103], v[68:71], v[44:47], v[100:103]
    ds_read_b64_tr_b16 v[56:57], v30 offset:32768
    v_mfma_f32_16x16x32_bf16 v[104:107], v[72:75], v[44:47], v[104:107]
    ds_read_b64_tr_b16 v[58:59], v30 offset:33792
    v_mfma_f32_16x16x32_bf16 v[108:111], v[76:79], v[44:47], v[108:111]
    ds_read_b64_tr_b16 v[60:61], v31 offset:32768
    ds_read_b64_tr_b16 v[62:63], v31 offset:33792
    s_barrier
    s_waitcnt lgkmcnt(0)
    v_mfma_f32_16x16x32_bf16 v[80:83], v[48:51], v[32:35], v[80:83]
    ds_read_b128 v[40:43], v27 offset:24576
    v_mfma_f32_16x16x32_bf16 v[84:87], v[52:55], v[32:35], v[84:87]
    ds_read_b128 v[44:47], v27 offset:26624
    v_mfma_f32_16x16x32_bf16 v[88:91], v[56:59], v[32:35], v[88:91]
    ds_read_b64_tr_b16 v[64:65], v28 offset:40960
    v_mfma_f32_16x16x32_bf16 v[92:95], v[60:63], v[32:35], v[92:95]
    ds_read_b64_tr_b16 v[66:67], v28 offset:41984
    ds_read_b64_tr_b16 v[68:69], v29 offset:40960
    v_mfma_f32_16x16x32_bf16 v[96:99], v[48:51], v[36:39], v[96:99]
    ds_read_b64_tr_b16 v[70:71], v29 offset:41984
    v_mfma_f32_16x16x32_bf16 v[100:103], v[52:55], v[36:39], v[100:103]
    ds_read_b64_tr_b16 v[72:73], v30 offset:40960
    v_mfma_f32_16x16x32_bf16 v[104:107], v[56:59], v[36:39], v[104:107]
    ds_read_b64_tr_b16 v[74:75], v30 offset:41984
    v_mfma_f32_16x16x32_bf16 v[108:111], v[60:63], v[36:39], v[108:111]
    ds_read_b64_tr_b16 v[76:77], v31 offset:40960
    ds_read_b64_tr_b16 v[78:79], v31 offset:41984
    s_waitcnt lgkmcnt(0)
    v_mfma_f32_16x16x32_bf16 v[80:83], v[64:67], v[40:43], v[80:83]
    v_mfma_f32_16x16x32_bf16 v[84:87], v[68:71], v[40:43], v[84:87]
    v_mfma_f32_16x16x32_bf16 v[88:91], v[72:75], v[40:43], v[88:91]
    v_mfma_f32_16x16x32_bf16 v[92:95], v[76:79], v[40:43], v[92:95]
    v_mfma_f32_16x16x32_bf16 v[96:99], v[64:67], v[44:47], v[96:99]
    v_mfma_f32_16x16x32_bf16 v[100:103], v[68:71], v[44:47], v[100:103]
    v_mfma_f32_16x16x32_bf16 v[104:107], v[72:75], v[44:47], v[104:107]
    v_mfma_f32_16x16x32_bf16 v[108:111], v[76:79], v[44:47], v[108:111]
    s_barrier
    s_nop 7
    s_nop 7
    v_lshrrev_b32 v3, 1, v2
    v_and_b32 v4, 1, v2
    v_lshrrev_b32 v5, 4, v1
    v_and_b32 v6, 15, v1
    v_mul_u32_u24 v7, 4608, v2
    v_mul_u32_u24 v8, 144, v6
    v_add_u32 v7, v7, v8
    v_lshl_add_u32 v7, v5, 3, v7
    v_cvt_pk_bf16_f32 v32, v80, v81
    v_cvt_pk_bf16_f32 v33, v82, v83
    ds_write_b64 v7, v[32:33] offset:0
    v_cvt_pk_bf16_f32 v40, v84, v85
    v_cvt_pk_bf16_f32 v41, v86, v87
    ds_write_b64 v7, v[40:41] offset:32
    v_cvt_pk_bf16_f32 v48, v88, v89
    v_cvt_pk_bf16_f32 v49, v90, v91
    ds_write_b64 v7, v[48:49] offset:64
    v_cvt_pk_bf16_f32 v56, v92, v93
    v_cvt_pk_bf16_f32 v57, v94, v95
    ds_write_b64 v7, v[56:57] offset:96
    v_cvt_pk_bf16_f32 v32, v96, v97
    v_cvt_pk_bf16_f32 v33, v98, v99
    ds_write_b64 v7, v[32:33] offset:2304
    v_cvt_pk_bf16_f32 v40, v100, v101
    v_cvt_pk_bf16_f32 v41, v102, v103
    ds_write_b64 v7, v[40:41] offset:2336
    v_cvt_pk_bf16_f32 v48, v104, v105
    v_cvt_pk_bf16_f32 v49, v106, v107
    ds_write_b64 v7, v[48:49] offset:2368
    v_cvt_pk_bf16_f32 v56, v108, v109
    v_cvt_pk_bf16_f32 v57, v110, v111
    ds_write_b64 v7, v[56:57] offset:2400
    s_waitcnt lgkmcnt(0)
    v_lshrrev_b32 v8, 3, v1
    v_and_b32 v9, 7, v1
    v_mul_u32_u24 v7, 4608, v2
    v_mul_u32_u24 v10, 144, v8
    v_add_u32 v7, v7, v10
    v_lshl_add_u32 v7, v9, 4, v7
    v_mul_u32_u24 v10, 32, v3
    v_add_u32 v10, v10, v8
    v_add_u32 v10, s27, v10
    v_lshlrev_b32 v11, 6, v4
    v_lshl_add_u32 v11, v9, 3, v11
    v_add_u32 v11, s28, v11
    v_mul_u32_u24 v12, 1280, v10
    v_lshl_add_u32 v12, v11, 1, v12
    ds_read_b128 v[80:83], v7 offset:0
    ds_read_b128 v[84:87], v7 offset:1152
    ds_read_b128 v[88:91], v7 offset:2304
    ds_read_b128 v[92:95], v7 offset:3456
    s_load_dwordx2 s[36:37], s[0:1], 88
    s_waitcnt lgkmcnt(0)
    s_mov_b32 s20, s36
    s_mov_b32 s21, s37
    s_mov_b32 s22, 2621440
    s_mov_b32 s23, 0x00020000
    v_mul_u32_u24 v13, 1280, v10
    v_lshl_add_u32 v13, v11, 1, v13
    v_add_u32 v14, 0, v13
    buffer_load_dwordx4 v[32:35], v14, s[20:23], 0 offen
    v_add_u32 v14, 10240, v13
    buffer_load_dwordx4 v[36:39], v14, s[20:23], 0 offen
    v_add_u32 v14, 20480, v13
    buffer_load_dwordx4 v[40:43], v14, s[20:23], 0 offen
    v_add_u32 v14, 30720, v13
    buffer_load_dwordx4 v[44:47], v14, s[20:23], 0 offen
    s_waitcnt vmcnt(0) lgkmcnt(0)
    v_lshlrev_b32 v48, 16, v80
    v_and_b32 v49, 0xffff0000, v80
    v_lshlrev_b32 v50, 16, v32
    v_and_b32 v51, 0xffff0000, v32
    v_add_f32 v48, v48, v50
    v_add_f32 v49, v49, v51
    v_cvt_pk_bf16_f32 v80, v48, v49
    v_lshlrev_b32 v48, 16, v81
    v_and_b32 v49, 0xffff0000, v81
    v_lshlrev_b32 v50, 16, v33
    v_and_b32 v51, 0xffff0000, v33
    v_add_f32 v48, v48, v50
    v_add_f32 v49, v49, v51
    v_cvt_pk_bf16_f32 v81, v48, v49
    v_lshlrev_b32 v48, 16, v82
    v_and_b32 v49, 0xffff0000, v82
    v_lshlrev_b32 v50, 16, v34
    v_and_b32 v51, 0xffff0000, v34
    v_add_f32 v48, v48, v50
    v_add_f32 v49, v49, v51
    v_cvt_pk_bf16_f32 v82, v48, v49
    v_lshlrev_b32 v48, 16, v83
    v_and_b32 v49, 0xffff0000, v83
    v_lshlrev_b32 v50, 16, v35
    v_and_b32 v51, 0xffff0000, v35
    v_add_f32 v48, v48, v50
    v_add_f32 v49, v49, v51
    v_cvt_pk_bf16_f32 v83, v48, v49
    v_lshlrev_b32 v48, 16, v84
    v_and_b32 v49, 0xffff0000, v84
    v_lshlrev_b32 v50, 16, v36
    v_and_b32 v51, 0xffff0000, v36
    v_add_f32 v48, v48, v50
    v_add_f32 v49, v49, v51
    v_cvt_pk_bf16_f32 v84, v48, v49
    v_lshlrev_b32 v48, 16, v85
    v_and_b32 v49, 0xffff0000, v85
    v_lshlrev_b32 v50, 16, v37
    v_and_b32 v51, 0xffff0000, v37
    v_add_f32 v48, v48, v50
    v_add_f32 v49, v49, v51
    v_cvt_pk_bf16_f32 v85, v48, v49
    v_lshlrev_b32 v48, 16, v86
    v_and_b32 v49, 0xffff0000, v86
    v_lshlrev_b32 v50, 16, v38
    v_and_b32 v51, 0xffff0000, v38
    v_add_f32 v48, v48, v50
    v_add_f32 v49, v49, v51
    v_cvt_pk_bf16_f32 v86, v48, v49
    v_lshlrev_b32 v48, 16, v87
    v_and_b32 v49, 0xffff0000, v87
    v_lshlrev_b32 v50, 16, v39
    v_and_b32 v51, 0xffff0000, v39
    v_add_f32 v48, v48, v50
    v_add_f32 v49, v49, v51
    v_cvt_pk_bf16_f32 v87, v48, v49
    v_lshlrev_b32 v48, 16, v88
    v_and_b32 v49, 0xffff0000, v88
    v_lshlrev_b32 v50, 16, v40
    v_and_b32 v51, 0xffff0000, v40
    v_add_f32 v48, v48, v50
    v_add_f32 v49, v49, v51
    v_cvt_pk_bf16_f32 v88, v48, v49
    v_lshlrev_b32 v48, 16, v89
    v_and_b32 v49, 0xffff0000, v89
    v_lshlrev_b32 v50, 16, v41
    v_and_b32 v51, 0xffff0000, v41
    v_add_f32 v48, v48, v50
    v_add_f32 v49, v49, v51
    v_cvt_pk_bf16_f32 v89, v48, v49
    v_lshlrev_b32 v48, 16, v90
    v_and_b32 v49, 0xffff0000, v90
    v_lshlrev_b32 v50, 16, v42
    v_and_b32 v51, 0xffff0000, v42
    v_add_f32 v48, v48, v50
    v_add_f32 v49, v49, v51
    v_cvt_pk_bf16_f32 v90, v48, v49
    v_lshlrev_b32 v48, 16, v91
    v_and_b32 v49, 0xffff0000, v91
    v_lshlrev_b32 v50, 16, v43
    v_and_b32 v51, 0xffff0000, v43
    v_add_f32 v48, v48, v50
    v_add_f32 v49, v49, v51
    v_cvt_pk_bf16_f32 v91, v48, v49
    v_lshlrev_b32 v48, 16, v92
    v_and_b32 v49, 0xffff0000, v92
    v_lshlrev_b32 v50, 16, v44
    v_and_b32 v51, 0xffff0000, v44
    v_add_f32 v48, v48, v50
    v_add_f32 v49, v49, v51
    v_cvt_pk_bf16_f32 v92, v48, v49
    v_lshlrev_b32 v48, 16, v93
    v_and_b32 v49, 0xffff0000, v93
    v_lshlrev_b32 v50, 16, v45
    v_and_b32 v51, 0xffff0000, v45
    v_add_f32 v48, v48, v50
    v_add_f32 v49, v49, v51
    v_cvt_pk_bf16_f32 v93, v48, v49
    v_lshlrev_b32 v48, 16, v94
    v_and_b32 v49, 0xffff0000, v94
    v_lshlrev_b32 v50, 16, v46
    v_and_b32 v51, 0xffff0000, v46
    v_add_f32 v48, v48, v50
    v_add_f32 v49, v49, v51
    v_cvt_pk_bf16_f32 v94, v48, v49
    v_lshlrev_b32 v48, 16, v95
    v_and_b32 v49, 0xffff0000, v95
    v_lshlrev_b32 v50, 16, v47
    v_and_b32 v51, 0xffff0000, v47
    v_add_f32 v48, v48, v50
    v_add_f32 v49, v49, v51
    v_cvt_pk_bf16_f32 v95, v48, v49
    buffer_store_dwordx4 v[80:83], v12, s[16:19], 0 offen
    v_add_u32 v12, 10240, v12
    buffer_store_dwordx4 v[84:87], v12, s[16:19], 0 offen
    v_add_u32 v12, 10240, v12
    buffer_store_dwordx4 v[88:91], v12, s[16:19], 0 offen
    v_add_u32 v12, 10240, v12
    buffer_store_dwordx4 v[92:95], v12, s[16:19], 0 offen
Lend_wout1_kernel_1:
    s_endpgm
Lloader_wout1_kernel_2:
    v_subrev_u32 v0, 256, v0
    v_and_b32 v1, 63, v0
    s_sub_u32 s42, s41, 4
    v_lshrrev_b32 v3, 3, v1
    v_and_b32 v4, 7, v1
    v_xor_b32 v4, v4, v3
    s_mul_i32 s43, s42, 16
    s_add_u32 s43, s43, s27
    v_add_u32 v5, s43, v3
    v_mul_u32_u24 v5, 1536, v5
    v_lshl_add_u32 v8, v4, 4, v5
    v_add_u32 v9, 12288, v8
    v_lshrrev_b32 v3, 4, v1
    v_and_b32 v4, 15, v1
    v_lshrrev_b32 v5, 1, v4
    v_and_b32 v6, 1, v4
    s_mul_i32 s43, s42, 4
    s_add_u32 s44, s43, 0
    s_lshr_b32 s44, s44, 1
    s_and_b32 s44, s44, 1
    s_lshl_b32 s44, s44, 2
    v_add_u32 v7, s44, v3
    v_xor_b32 v7, v5, v7
    v_lshl_add_u32 v7, v7, 1, v6
    v_lshlrev_b32 v7, 4, v7
    s_add_u32 s44, s43, 0
    s_lshl_b32 s44, s44, 2
    v_add_u32 v12, s44, v3
    v_mul_u32_u24 v12, 1280, v12
    v_add_u32 v12, v12, v7
    v_lshl_add_u32 v12, s28, 1, v12
    s_add_u32 s44, s43, 1
    s_lshr_b32 s44, s44, 1
    s_and_b32 s44, s44, 1
    s_lshl_b32 s44, s44, 2
    v_add_u32 v7, s44, v3
    v_xor_b32 v7, v5, v7
    v_lshl_add_u32 v7, v7, 1, v6
    v_lshlrev_b32 v7, 4, v7
    s_add_u32 s44, s43, 1
    s_lshl_b32 s44, s44, 2
    v_add_u32 v13, s44, v3
    v_mul_u32_u24 v13, 1280, v13
    v_add_u32 v13, v13, v7
    v_lshl_add_u32 v13, s28, 1, v13
    s_add_u32 s44, s43, 2
    s_lshr_b32 s44, s44, 1
    s_and_b32 s44, s44, 1
    s_lshl_b32 s44, s44, 2
    v_add_u32 v7, s44, v3
    v_xor_b32 v7, v5, v7
    v_lshl_add_u32 v7, v7, 1, v6
    v_lshlrev_b32 v7, 4, v7
    s_add_u32 s44, s43, 2
    s_lshl_b32 s44, s44, 2
    v_add_u32 v14, s44, v3
    v_mul_u32_u24 v14, 1280, v14
    v_add_u32 v14, v14, v7
    v_lshl_add_u32 v14, s28, 1, v14
    s_add_u32 s44, s43, 3
    s_lshr_b32 s44, s44, 1
    s_and_b32 s44, s44, 1
    s_lshl_b32 s44, s44, 2
    v_add_u32 v7, s44, v3
    v_xor_b32 v7, v5, v7
    v_lshl_add_u32 v7, v7, 1, v6
    v_lshlrev_b32 v7, 4, v7
    s_add_u32 s44, s43, 3
    s_lshl_b32 s44, s44, 2
    v_add_u32 v15, s44, v3
    v_mul_u32_u24 v15, 1280, v15
    v_add_u32 v15, v15, v7
    v_lshl_add_u32 v15, s28, 1, v15
    s_mul_i32 s45, s42, 2048
    s_mul_i32 s46, s42, 4096
    s_add_u32 s46, s46, 8192
    s_mov_b32 s29, 0
    s_mov_b32 s30, 0
    s_add_u32 m0, s45, 0
    s_nop 0
    buffer_load_dwordx4 v8, s[8:11], s29 offen lds
    s_add_u32 m0, s45, 1024
    s_nop 0
    buffer_load_dwordx4 v9, s[8:11], s29 offen lds
    s_add_u32 m0, s46, 0
    s_nop 0
    buffer_load_dwordx4 v12, s[12:15], s30 offen lds
    s_add_u32 m0, s46, 1024
    s_nop 0
    buffer_load_dwordx4 v13, s[12:15], s30 offen lds
    s_add_u32 m0, s46, 2048
    s_nop 0
    buffer_load_dwordx4 v14, s[12:15], s30 offen lds
    s_add_u32 m0, s46, 3072
    s_nop 0
    buffer_load_dwordx4 v15, s[12:15], s30 offen lds
    s_add_u32 s29, s29, 128
    s_add_u32 s30, s30, 81920
    s_add_u32 m0, s45, 24576
    s_nop 0
    buffer_load_dwordx4 v8, s[8:11], s29 offen lds
    s_add_u32 m0, s45, 25600
    s_nop 0
    buffer_load_dwordx4 v9, s[8:11], s29 offen lds
    s_add_u32 m0, s46, 24576
    s_nop 0
    buffer_load_dwordx4 v12, s[12:15], s30 offen lds
    s_add_u32 m0, s46, 25600
    s_nop 0
    buffer_load_dwordx4 v13, s[12:15], s30 offen lds
    s_add_u32 m0, s46, 26624
    s_nop 0
    buffer_load_dwordx4 v14, s[12:15], s30 offen lds
    s_add_u32 m0, s46, 27648
    s_nop 0
    buffer_load_dwordx4 v15, s[12:15], s30 offen lds
    s_add_u32 s29, s29, 128
    s_add_u32 s30, s30, 81920
    s_add_u32 m0, s45, 49152
    s_nop 0
    buffer_load_dwordx4 v8, s[8:11], s29 offen lds
    s_add_u32 m0, s45, 50176
    s_nop 0
    buffer_load_dwordx4 v9, s[8:11], s29 offen lds
    s_add_u32 m0, s46, 49152
    s_nop 0
    buffer_load_dwordx4 v12, s[12:15], s30 offen lds
    s_add_u32 m0, s46, 50176
    s_nop 0
    buffer_load_dwordx4 v13, s[12:15], s30 offen lds
    s_add_u32 m0, s46, 51200
    s_nop 0
    buffer_load_dwordx4 v14, s[12:15], s30 offen lds
    s_add_u32 m0, s46, 52224
    s_nop 0
    buffer_load_dwordx4 v15, s[12:15], s30 offen lds
    s_add_u32 s29, s29, 128
    s_add_u32 s30, s30, 81920
    s_waitcnt vmcnt(6)
    s_barrier
    s_mov_b32 s31, 0
Llloop_wout1_kernel_4:
    s_add_u32 m0, s45, 73728
    s_nop 0
    buffer_load_dwordx4 v8, s[8:11], s29 offen lds
    s_add_u32 m0, s45, 74752
    s_nop 0
    buffer_load_dwordx4 v9, s[8:11], s29 offen lds
    s_add_u32 m0, s46, 73728
    s_nop 0
    buffer_load_dwordx4 v12, s[12:15], s30 offen lds
    s_add_u32 m0, s46, 74752
    s_nop 0
    buffer_load_dwordx4 v13, s[12:15], s30 offen lds
    s_add_u32 m0, s46, 75776
    s_nop 0
    buffer_load_dwordx4 v14, s[12:15], s30 offen lds
    s_add_u32 m0, s46, 76800
    s_nop 0
    buffer_load_dwordx4 v15, s[12:15], s30 offen lds
    s_add_u32 s29, s29, 128
    s_add_u32 s30, s30, 81920
    s_waitcnt vmcnt(6)
    s_barrier
    s_add_u32 m0, s45, 0
    s_nop 0
    buffer_load_dwordx4 v8, s[8:11], s29 offen lds
    s_add_u32 m0, s45, 1024
    s_nop 0
    buffer_load_dwordx4 v9, s[8:11], s29 offen lds
    s_add_u32 m0, s46, 0
    s_nop 0
    buffer_load_dwordx4 v12, s[12:15], s30 offen lds
    s_add_u32 m0, s46, 1024
    s_nop 0
    buffer_load_dwordx4 v13, s[12:15], s30 offen lds
    s_add_u32 m0, s46, 2048
    s_nop 0
    buffer_load_dwordx4 v14, s[12:15], s30 offen lds
    s_add_u32 m0, s46, 3072
    s_nop 0
    buffer_load_dwordx4 v15, s[12:15], s30 offen lds
    s_add_u32 s29, s29, 128
    s_add_u32 s30, s30, 81920
    s_waitcnt vmcnt(6)
    s_barrier
    s_add_u32 m0, s45, 24576
    s_nop 0
    buffer_load_dwordx4 v8, s[8:11], s29 offen lds
    s_add_u32 m0, s45, 25600
    s_nop 0
    buffer_load_dwordx4 v9, s[8:11], s29 offen lds
    s_add_u32 m0, s46, 24576
    s_nop 0
    buffer_load_dwordx4 v12, s[12:15], s30 offen lds
    s_add_u32 m0, s46, 25600
    s_nop 0
    buffer_load_dwordx4 v13, s[12:15], s30 offen lds
    s_add_u32 m0, s46, 26624
    s_nop 0
    buffer_load_dwordx4 v14, s[12:15], s30 offen lds
    s_add_u32 m0, s46, 27648
    s_nop 0
    buffer_load_dwordx4 v15, s[12:15], s30 offen lds
    s_add_u32 s29, s29, 128
    s_add_u32 s30, s30, 81920
    s_waitcnt vmcnt(6)
    s_barrier
    s_add_u32 m0, s45, 49152
    s_nop 0
    buffer_load_dwordx4 v8, s[8:11], s29 offen lds
    s_add_u32 m0, s45, 50176
    s_nop 0
    buffer_load_dwordx4 v9, s[8:11], s29 offen lds
    s_add_u32 m0, s46, 49152
    s_nop 0
    buffer_load_dwordx4 v12, s[12:15], s30 offen lds
    s_add_u32 m0, s46, 50176
    s_nop 0
    buffer_load_dwordx4 v13, s[12:15], s30 offen lds
    s_add_u32 m0, s46, 51200
    s_nop 0
    buffer_load_dwordx4 v14, s[12:15], s30 offen lds
    s_add_u32 m0, s46, 52224
    s_nop 0
    buffer_load_dwordx4 v15, s[12:15], s30 offen lds
    s_add_u32 s29, s29, 128
    s_add_u32 s30, s30, 81920
    s_waitcnt vmcnt(6)
    s_barrier
    s_add_u32 s31, s31, 1
    s_cmp_lt_u32 s31, 2
    s_cbranch_scc1 Llloop_wout1_kernel_4
    s_add_u32 m0, s45, 73728
    s_nop 0
    buffer_load_dwordx4 v8, s[8:11], s29 offen lds
    s_add_u32 m0, s45, 74752
    s_nop 0
    buffer_load_dwordx4 v9, s[8:11], s29 offen lds
    s_add_u32 m0, s46, 73728
    s_nop 0
    buffer_load_dwordx4 v12, s[12:15], s30 offen lds
    s_add_u32 m0, s46, 74752
    s_nop 0
    buffer_load_dwordx4 v13, s[12:15], s30 offen lds
    s_add_u32 m0, s46, 75776
    s_nop 0
    buffer_load_dwordx4 v14, s[12:15], s30 offen lds
    s_add_u32 m0, s46, 76800
    s_nop 0
    buffer_load_dwordx4 v15, s[12:15], s30 offen lds
    s_add_u32 s29, s29, 128
    s_add_u32 s30, s30, 81920
    s_waitcnt vmcnt(6)
    s_barrier
    s_waitcnt vmcnt(0)
    s_barrier
    s_waitcnt vmcnt(0)
    s_barrier
    s_waitcnt vmcnt(0)
    s_barrier
    s_endpgm
.section .rodata,"a"
.p2align 6
.amdhsa_kernel wout1_kernel
  .amdhsa_next_free_vgpr 112
  .amdhsa_next_free_sgpr 56
  .amdhsa_accum_offset 112
  .amdhsa_group_segment_fixed_size 0
  .amdhsa_kernarg_size 96
  .amdhsa_user_sgpr_count 2
  .amdhsa_user_sgpr_kernarg_segment_ptr 1
  .amdhsa_system_sgpr_workgroup_id_x 1
.end_amdhsa_kernel
.text
```
